```python
import torch

def _softmax(x, axis=-1):
    return torch.softmax(x, dim=axis)

def _gelu(x):
    return torch.nn.functional.gelu(x, approximate='tanh')

def _silu(x):
    return torch.nn.functional.silu(x)

def _sigmoid(x):
    return torch.sigmoid(x)

def _layernorm(x, axis=-1, eps=1e-05):
    m = x.mean(dim=axis, keepdim=True)
    v = x.var(dim=axis, keepdim=True, unbiased=False)
    return (x - m) / torch.sqrt(v + eps)

def _scatter_add(tgt, idx, src, axis=0):
    return tgt.clone().index_add_(axis, idx, src)

def _segment_sum(src, seg, n):
    out = torch.zeros((n,) + src.shape[1:], dtype=src.dtype)
    return out.index_add_(0, seg, src)

def _pad(x, pw):
    flat = tuple((v for pair in reversed(pw) for v in pair))
    return torch.nn.functional.pad(x, flat)
kernel_name = 'concat_heads__memory_aug_recurrent_mem_tr__compressed_kv_cla__prompt'

def setup_inputs():

    _w = lambda a: (lambda t: t.to(torch.bfloat16) if t.is_floating_point() else t)(torch.as_tensor(a))

    def _A_setup():
        B, S, Dm = (1, 2048, 512)
        H, Dh = (32, 128)
        M, seg = (8, 32)
        seg = min(seg, S)
        S = S // seg * seg
        return {'x': _w((lambda *s: torch.randn(*s, dtype=torch.bfloat16) * 0.05)(B, S, Dm)), 'mem0': _w((lambda *s: torch.randn(*s, dtype=torch.bfloat16) * 0.4)(B, M, Dm)), 'Wq': _w((lambda *s: torch.randn(*s, dtype=torch.bfloat16) * 6.4)(Dm, H, Dh) * Dm ** (-0.5)), 'Wk': _w((lambda *s: torch.randn(*s, dtype=torch.bfloat16) * 6.4)(Dm, H, Dh) * Dm ** (-0.5)), 'Wv': _w((lambda *s: torch.randn(*s, dtype=torch.bfloat16) * 0.4)(Dm, H, Dh) * Dm ** (-0.5)), 'Wo': _w((lambda *s: torch.randn(*s, dtype=torch.bfloat16) * 0.4)(H, Dh, Dm) * (H * Dh) ** (-0.5)), 'seg_len': seg}
    _A_in = _A_setup()

    def _B_setup():
        B, H, Sq, Sk, D, M = (1, 32, 2048, 2048, 128, 512)
        Dc = 4 * D
        return {'x': _w((lambda *s: torch.randn(*s, dtype=torch.bfloat16) * 1.6)(B, Sq, M)), 'c_kv': _w((lambda *s: torch.randn(*s, dtype=torch.bfloat16) * 0.2)(B, Sk, Dc)), 'w_q': _w((lambda *s: torch.randn(*s, dtype=torch.bfloat16) * 3.2)(M, H, D) * M ** (-0.5)), 'w_uk': _w((lambda *s: torch.randn(*s, dtype=torch.bfloat16) * 3.2)(Dc, H, D) * Dc ** (-0.5)), 'w_uv': _w((lambda *s: torch.randn(*s, dtype=torch.bfloat16) * 0.2)(Dc, H, D) * Dc ** (-0.5)), 'w_o': _w((lambda *s: torch.randn(*s, dtype=torch.bfloat16) * 0.2)(H, D, M) * (H * D) ** (-0.5))}
    _B_in = _B_setup()
    return {'A_x': _A_in['x'], 'A_mem0': _A_in['mem0'], 'A_Wq': _A_in['Wq'], 'A_Wk': _A_in['Wk'], 'A_Wv': _A_in['Wv'], 'A_Wo': _A_in['Wo'], 'A_seg_len': _A_in['seg_len'], 'B_x': _B_in['x'], 'B_c_kv': _B_in['c_kv'], 'B_w_q': _B_in['w_q'], 'B_w_uk': _B_in['w_uk'], 'B_w_uv': _B_in['w_uv'], 'B_w_o': _B_in['w_o']}

def reference(A_x, A_mem0, A_Wq, A_Wk, A_Wv, A_Wo, A_seg_len, B_x, B_c_kv, B_w_q, B_w_uk, B_w_uv, B_w_o):

    def _A_ref(x, mem0, Wq, Wk, Wv, Wo, seg_len):
        B, S, Dm = x.shape
        H, Dh = (Wq.shape[1], Wq.shape[2])
        M = mem0.shape[1]
        scale = Dh ** (-0.5)
        n_seg = S // seg_len
        L = M + seg_len
        idx = torch.arange(L)
        mask = (idx[:, None] < M) | (idx[:, None] >= idx[None, :])
        mem = mem0
        outs = []
        for s in range(n_seg):
            xs = x[:, s * seg_len:(s + 1) * seg_len, :].clone()
            h = torch.concatenate([mem, xs], axis=1)
            q = torch.einsum('btd,dhe->bhte', h, Wq)
            k = torch.einsum('btd,dhe->bhte', h, Wk)
            v = torch.einsum('btd,dhe->bhte', h, Wv)
            scores = torch.einsum('bhqe,bhke->bhqk', q, k) * scale
            scores = torch.where(mask[None, None], scores, -1000000000.0)
            p = _softmax(scores, axis=-1)
            o = torch.einsum('bhqk,bhke->bhqe', p, v)
            o = torch.einsum('bhte,hed->btd', o, Wo)
            mem = o[:, :M, :].clone()
            outs.append(o[:, M:, :])
        return torch.concatenate(outs, axis=1)

    def _B_ref(x, c_kv, w_q, w_uk, w_uv, w_o):
        B, Sq, M = (x.shape[0], x.shape[1], x.shape[2])
        Sk = c_kv.shape[1]
        H, D = (w_q.shape[1], w_q.shape[2])
        q = torch.einsum('bqm,mhd->bhqd', x, w_q)
        k = torch.einsum('bkc,chd->bhkd', c_kv, w_uk)
        v = torch.einsum('bkc,chd->bhkd', c_kv, w_uv)
        scores = torch.einsum('bhqd,bhkd->bhqk', q, k) * D ** (-0.5)
        off = Sk - Sq
        qi = torch.arange(Sq)[:, None]
        kj = torch.arange(Sk)[None, :]
        cmask = kj <= qi + off
        scores = torch.where(cmask[None, None], scores, -1000000000.0)
        p = _softmax(scores, axis=-1)
        ctx = torch.einsum('bhqk,bhkd->bhqd', p, v)
        return torch.einsum('bhqd,hdm->bqm', ctx, w_o)
    a = _A_ref(A_x, A_mem0, A_Wq, A_Wk, A_Wv, A_Wo, A_seg_len)
    b = _B_ref(B_x, B_c_kv, B_w_q, B_w_uk, B_w_uv, B_w_o)
    return torch.concatenate([a, b], axis=-1)
```

```asm
; @launch grid=(256,1,1) block=(256,1,1) lds=163840
.amdgcn_target "amdgcn-amd-amdhsa--gfx950"
.text
.globl concat_heads__memory_aug_recurrent_mem_tr__compressed_kv_cla__prompt_kernel
.p2align 8
.type concat_heads__memory_aug_recurrent_mem_tr__compressed_kv_cla__prompt_kernel,@function
concat_heads__memory_aug_recurrent_mem_tr__compressed_kv_cla__prompt_kernel:
    s_cmp_ge_u32 s2, 256
    s_cbranch_scc1 mn_exit
    s_cmp_eq_u32 s2, 1
    s_cbranch_scc1 mn_zero
mn_noz:
    s_load_dwordx2 s[40:41], s[0:1], 112
    s_load_dwordx2 s[50:51], s[0:1], 16
    s_getreg_b32 s42, hwreg(HW_REG_XCC_ID, 0, 4)
    v_lshrrev_b32 v1, 6, v0
    v_and_b32 v0, 63, v0
    v_readfirstlane_b32 s4, v1
    v_mov_b32 v2, 0
    s_lshl_b32 s43, s42, 5
    s_cmp_ge_u32 s42, 8
    s_cselect_b32 s46, 132, s43
    s_cselect_b32 s47, 32, 0
    s_waitcnt lgkmcnt(0)
    s_mov_b32 s16, s40
    s_mov_b32 s17, s41
    s_mov_b32 s18, 0x100
    s_mov_b32 s19, 0x00020000
    s_mov_b32 s8, s50
    s_mov_b32 s9, s51
    s_mov_b32 s10, 0x400000
    s_mov_b32 s11, 0x00020000
    s_cmp_lg_u32 s4, 0
    s_cbranch_scc1 rl_oth_3
    s_mov_b64 exec, 1
    v_mov_b32 v3, 1
    buffer_atomic_add v3, off, s[16:19], s46 sc0
    s_waitcnt vmcnt(0)
    v_readfirstlane_b32 s44, v3
    s_nop 0
    s_add_u32 s45, s43, s44
    s_max_u32 s44, s44, s47
    s_cmp_lt_u32 s44, 32
    s_cbranch_scc0 rl_ovf_1
rl_got_2:
    v_mov_b32 v3, s45
    ds_write_b32 v2, v3
    s_mov_b64 exec, -1
    s_waitcnt lgkmcnt(0)
    s_branch rl_jn_4
rl_oth_3:
    s_cmp_lg_u32 s42, 0
    s_cbranch_scc1 rl_jn_4
    s_lshr_b32 s43, s2, 3
    s_and_b32 s43, s43, 31
    s_mul_i32 s44, s4, 32
    s_add_u32 s43, s43, s44
    s_lshl_b32 s43, s43, 13
    s_sub_u32 s43, s43, 262144
    v_lshlrev_b32 v4, 7, v0
    buffer_load_dword v127, v4, s[8:11], s43 offen
    s_add_u32 s43, s43, 786432
    buffer_load_dword v127, v4, s[8:11], s43 offen
    s_add_u32 s43, s43, 786432
rl_jn_4:
    s_barrier
    ds_read_b32 v3, v2
    s_waitcnt lgkmcnt(0)
    v_readfirstlane_b32 s5, v3
    s_barrier
    s_cmp_ge_u32 s5, 256
    s_cbranch_scc1 mn_exit
    s_cmp_ge_u32 s5, 32
    s_cbranch_scc1 mn_bulk
    s_mov_b32 s3, s5
    s_load_dwordx2 s[48:49], s[0:1], 120
    s_load_dwordx2 s[50:51], s[0:1], 112
    s_load_dwordx8 s[24:31], s[0:1], 16
    s_load_dwordx2 s[32:33], s[0:1], 8
    v_mov_b32 v17, v0
    v_bfe_u32 v18, v17, 2, 2
    v_lshlrev_b32 v28, 13, v18
    v_bfe_u32 v18, v17, 4, 2
    v_lshl_add_u32 v28, v18, 6, v28
    v_bfe_u32 v18, v17, 0, 2
    v_lshl_add_u32 v28, v18, 4, v28
    s_lshl_b32 s56, s4, 18
    v_add_u32 v28, s56, v28
    v_bfe_u32 v18, v17, 3, 3
    v_lshlrev_b32 v30, 10, v18
    v_bfe_u32 v18, v17, 0, 3
    v_lshl_add_u32 v30, v18, 4, v30
    s_and_b32 s56, s4, 1
    s_lshl_b32 s56, s56, 16
    s_lshr_b32 s57, s4, 1
    s_lshl_b32 s57, s57, 7
    s_add_u32 s56, s56, s57
    v_add_u32 v30, s56, v30
    s_lshl_b32 s52, s4, 15
    s_lshl_b32 s53, s3, 8
    s_lshl_b32 s54, s3, 17
    s_lshl_b32 s59, s4, 13
    s_waitcnt lgkmcnt(0)
    s_mov_b32 s12, s48
    s_mov_b32 s13, s49
    s_mov_b32 s14, 0x10000000
    s_mov_b32 s15, 0x00020000
    s_mov_b32 s16, s50
    s_mov_b32 s17, s51
    s_mov_b32 s18, 0x100
    s_mov_b32 s19, 0x00020000
    s_mov_b32 s8, s24
    s_mov_b32 s9, s25
    s_mov_b32 s10, 0x400000
    s_mov_b32 s11, 0x00020000
    s_add_u32 m0, s59, 0
    s_add_u32 s55, s53, 0
    buffer_load_dwordx4 v28, s[8:11], s55 offen  lds
    s_add_u32 m0, s59, 1024
    s_add_u32 s55, s53, 32768
    buffer_load_dwordx4 v28, s[8:11], s55 offen  lds
    s_add_u32 m0, s59, 2048
    s_add_u32 s55, s53, 65536
    buffer_load_dwordx4 v28, s[8:11], s55 offen  lds
    s_add_u32 m0, s59, 3072
    s_add_u32 s55, s53, 98304
    buffer_load_dwordx4 v28, s[8:11], s55 offen  lds
    s_add_u32 m0, s59, 4096
    s_add_u32 s55, s53, 131072
    buffer_load_dwordx4 v28, s[8:11], s55 offen  lds
    s_add_u32 m0, s59, 5120
    s_add_u32 s55, s53, 163840
    buffer_load_dwordx4 v28, s[8:11], s55 offen  lds
    s_add_u32 m0, s59, 6144
    s_add_u32 s55, s53, 196608
    buffer_load_dwordx4 v28, s[8:11], s55 offen  lds
    s_add_u32 m0, s59, 7168
    s_add_u32 s55, s53, 229376
    buffer_load_dwordx4 v28, s[8:11], s55 offen  lds
    s_add_u32 m0, s59, 32768
    s_add_u32 s55, s53, 1048576
    buffer_load_dwordx4 v28, s[8:11], s55 offen  lds
    s_add_u32 m0, s59, 33792
    s_add_u32 s55, s53, 1081344
    buffer_load_dwordx4 v28, s[8:11], s55 offen  lds
    s_add_u32 m0, s59, 34816
    s_add_u32 s55, s53, 1114112
    buffer_load_dwordx4 v28, s[8:11], s55 offen  lds
    s_add_u32 m0, s59, 35840
    s_add_u32 s55, s53, 1146880
    buffer_load_dwordx4 v28, s[8:11], s55 offen  lds
    s_add_u32 m0, s59, 36864
    s_add_u32 s55, s53, 1179648
    buffer_load_dwordx4 v28, s[8:11], s55 offen  lds
    s_add_u32 m0, s59, 37888
    s_add_u32 s55, s53, 1212416
    buffer_load_dwordx4 v28, s[8:11], s55 offen  lds
    s_add_u32 m0, s59, 38912
    s_add_u32 s55, s53, 1245184
    buffer_load_dwordx4 v28, s[8:11], s55 offen  lds
    s_add_u32 m0, s59, 39936
    s_add_u32 s55, s53, 1277952
    buffer_load_dwordx4 v28, s[8:11], s55 offen  lds
    s_add_u32 m0, s59, 65536
    s_add_u32 s55, s53, 2097152
    buffer_load_dwordx4 v28, s[8:11], s55 offen  lds
    s_add_u32 m0, s59, 66560
    s_add_u32 s55, s53, 2129920
    buffer_load_dwordx4 v28, s[8:11], s55 offen  lds
    s_add_u32 m0, s59, 67584
    s_add_u32 s55, s53, 2162688
    buffer_load_dwordx4 v28, s[8:11], s55 offen  lds
    s_add_u32 m0, s59, 68608
    s_add_u32 s55, s53, 2195456
    buffer_load_dwordx4 v28, s[8:11], s55 offen  lds
    s_add_u32 m0, s59, 69632
    s_add_u32 s55, s53, 2228224
    buffer_load_dwordx4 v28, s[8:11], s55 offen  lds
    s_add_u32 m0, s59, 70656
    s_add_u32 s55, s53, 2260992
    buffer_load_dwordx4 v28, s[8:11], s55 offen  lds
    s_add_u32 m0, s59, 71680
    s_add_u32 s55, s53, 2293760
    buffer_load_dwordx4 v28, s[8:11], s55 offen  lds
    s_add_u32 m0, s59, 72704
    s_add_u32 s55, s53, 2326528
    buffer_load_dwordx4 v28, s[8:11], s55 offen  lds
    s_add_u32 m0, s59, 98304
    s_add_u32 s55, s53, 3145728
    buffer_load_dwordx4 v28, s[8:11], s55 offen  lds
    s_add_u32 m0, s59, 99328
    s_add_u32 s55, s53, 3178496
    buffer_load_dwordx4 v28, s[8:11], s55 offen  lds
    s_add_u32 m0, s59, 100352
    s_add_u32 s55, s53, 3211264
    buffer_load_dwordx4 v28, s[8:11], s55 offen  lds
    s_add_u32 m0, s59, 101376
    s_add_u32 s55, s53, 3244032
    buffer_load_dwordx4 v28, s[8:11], s55 offen  lds
    s_add_u32 m0, s59, 102400
    s_add_u32 s55, s53, 3276800
    buffer_load_dwordx4 v28, s[8:11], s55 offen  lds
    s_add_u32 m0, s59, 103424
    s_add_u32 s55, s53, 3309568
    buffer_load_dwordx4 v28, s[8:11], s55 offen  lds
    s_add_u32 m0, s59, 104448
    s_add_u32 s55, s53, 3342336
    buffer_load_dwordx4 v28, s[8:11], s55 offen  lds
    s_add_u32 m0, s59, 105472
    s_add_u32 s55, s53, 3375104
    buffer_load_dwordx4 v28, s[8:11], s55 offen  lds
    v_bfe_u32 v18, v17, 0, 6
    v_lshlrev_b32 v3, 4, v18
    v_mov_b32 v19, v3
    v_add_u32 v3, 131072, v3
    s_lshl_b32 s48, s4, 11
    v_add_u32 v0, s48, v3
    v_and_b32 v20, 2, v17
    v_cmp_eq_u32 s[40:41], 0, v20
    v_cmp_ne_u32 s[42:43], 0, v20
    v_mov_b32 v21, 0xeeee
    v_mov_b32 v22, 0x4444
    v_cndmask_b32 v1, v21, v22, s[40:41]
    v_bfe_u32 v18, v17, 5, 1
    v_lshlrev_b32 v2, 8, v18
    v_bfe_u32 v18, v17, 0, 2
    v_lshl_add_u32 v2, v18, 6, v2
    v_bfe_u32 v18, v17, 2, 2
    v_lshl_add_u32 v2, v18, 4, v2
    v_bfe_u32 v18, v17, 4, 1
    v_lshl_add_u32 v2, v18, 3, v2
    v_add_u32 v2, 131072, v2
    v_bfe_u32 v18, v17, 5, 1
    v_lshlrev_b32 v5, 9, v18
    v_bfe_u32 v18, v17, 4, 1
    v_lshl_add_u32 v5, v18, 7, v5
    v_bfe_u32 v18, v17, 2, 2
    v_lshl_add_u32 v5, v18, 5, v5
    v_lshrrev_b32 v20, 4, v17
    v_and_b32 v21, 3, v17
    v_xor_b32 v20, v20, v21
    v_lshl_add_u32 v5, v20, 3, v5
    v_add_u32 v5, 131072, v5
    v_bfe_u32 v18, v17, 3, 1
    v_lshlrev_b32 v4, 9, v18
    v_bfe_u32 v18, v17, 0, 3
    v_lshl_add_u32 v4, v18, 5, v4
    v_lshrrev_b32 v20, 4, v17
    v_bfe_u32 v21, v17, 2, 2
    v_xor_b32 v20, v20, v21
    v_lshl_add_u32 v4, v20, 3, v4
    s_lshl_b32 s35, s4, 10
    s_add_u32 s56, s35, 139264
    v_add_u32 v4, s56, v4
    v_bfe_u32 v18, v17, 2, 4
    v_lshlrev_b32 v11, 5, v18
    v_bfe_u32 v18, v17, 0, 1
    v_lshl_add_u32 v11, v18, 4, v11
    v_add_u32 v11, 139264, v11
    v_bfe_u32 v20, v17, 1, 1
    v_lshl_add_u32 v6, v20, 3, v11
    s_lshl_b32 s56, s4, 9
    v_add_u32 v6, s56, v6
    s_lshl_b32 s56, s4, 11
    v_add_u32 v2, s56, v2
    v_add_u32 v7, s52, v19
    v_bfe_u32 v18, v17, 4, 2
    v_lshlrev_b32 v8, 9, v18
    v_bfe_u32 v18, v17, 3, 1
    v_lshl_add_u32 v8, v18, 8, v8
    v_bfe_u32 v18, v17, 0, 3
    v_lshl_add_u32 v8, v18, 4, v8
    v_bfe_u32 v18, v17, 4, 2
    v_lshlrev_b32 v9, 9, v18
    v_bfe_u32 v18, v17, 0, 4
    v_lshl_add_u32 v9, v18, 4, v9
    v_bfe_u32 v18, v17, 2, 2
    v_lshlrev_b32 v10, 13, v18
    v_bfe_u32 v18, v17, 4, 2
    v_lshl_add_u32 v10, v18, 11, v10
    v_bfe_u32 v18, v17, 0, 2
    v_lshl_add_u32 v10, v18, 4, v10
    s_lshl_b32 s56, s4, 16
    s_lshl_b32 s57, s3, 6
    s_add_u32 s56, s56, s57
    v_add_u32 v10, s56, v10
    v_and_b32 v20, 1, v17
    v_lshlrev_b32 v21, 4, v20
    v_mov_b32 v22, 0x3f80
    v_lshlrev_b32 v22, v21, v22
    v_bfe_u32 v20, v17, 1, 3
    v_cmp_eq_u32 vcc, 0, v20
    s_nop 1
    v_cndmask_b32 v12, 0, v22, vcc
    v_cmp_eq_u32 vcc, 1, v20
    s_nop 1
    v_cndmask_b32 v13, 0, v22, vcc
    v_cmp_eq_u32 vcc, 2, v20
    s_nop 1
    v_cndmask_b32 v14, 0, v22, vcc
    v_cmp_eq_u32 vcc, 3, v20
    s_nop 1
    v_cndmask_b32 v15, 0, v22, vcc
    v_bfe_u32 v18, v17, 0, 2
    v_lshlrev_b32 v126, 4, v18
    v_bfe_u32 v18, v17, 4, 1
    v_lshl_add_u32 v126, v18, 3, v126
    v_and_b32 v20, 0, v17
    v_cmp_eq_u32 s[38:39], 0, v20
    s_mov_b32 s46, 0x3e0293ee
    s_mov_b32 s44, 0x3f803f80
    s_mov_b32 s45, 0x3f803f80
    s_mov_b32 s47, 0x42700000
    v_bfe_u32 v18, v17, 5, 1
    v_lshlrev_b32 v29, 13, v18
    v_bfe_u32 v18, v17, 3, 1
    v_lshl_add_u32 v29, v18, 12, v29
    v_bfe_u32 v18, v17, 4, 1
    v_lshl_add_u32 v29, v18, 11, v29
    v_bfe_u32 v18, v17, 2, 1
    v_lshl_add_u32 v29, v18, 6, v29
    v_bfe_u32 v18, v17, 1, 1
    v_lshl_add_u32 v29, v18, 5, v29
    v_bfe_u32 v18, v17, 0, 1
    v_lshl_add_u32 v29, v18, 3, v29
    s_lshl_b32 s56, s4, 8
    v_add_u32 v29, s56, v29
    v_bfe_u32 v18, v17, 5, 1
    v_lshlrev_b32 v27, 13, v18
    v_bfe_u32 v18, v17, 3, 1
    v_lshl_add_u32 v27, v18, 12, v27
    v_bfe_u32 v18, v17, 4, 1
    v_lshl_add_u32 v27, v18, 11, v27
    v_bfe_u32 v18, v17, 2, 1
    v_lshl_add_u32 v27, v18, 6, v27
    v_bfe_u32 v18, v17, 0, 2
    v_lshl_add_u32 v27, v18, 3, v27
    s_lshl_b32 s56, s4, 8
    v_add_u32 v27, s56, v27
    v_add_u32 v25, 0x10000, v29
    v_add_u32 v26, 0x10000, v27
    v_bfe_u32 v18, v17, 4, 1
    v_lshlrev_b32 v31, 11, v18
    v_bfe_u32 v18, v17, 5, 1
    v_lshl_add_u32 v31, v18, 9, v31
    v_bfe_u32 v18, v17, 2, 1
    v_lshl_add_u32 v31, v18, 7, v31
    v_bfe_u32 v18, v17, 3, 1
    v_lshl_add_u32 v31, v18, 5, v31
    v_bfe_u32 v18, v17, 0, 2
    v_lshl_add_u32 v31, v18, 3, v31
    v_add_u32 v31, s52, v31
    v_mov_b64 v[20:21], -1
    v_mov_b64 v[22:23], -1
    s_lshl_b32 s48, s3, 13
    s_add_u32 s48, s48, 144572416
    buffer_store_dwordx4 v[20:23], v0, s[12:15], s48 offen sc1
    buffer_store_dwordx4 v[20:23], v0, s[12:15], s48 offen offset:1024 sc1
    s_lshl_b32 s49, s4, 13
    s_add_u32 s48, s53, s49
    s_add_u32 s48, s48, 145752064
    v_lshlrev_b32 v24, 2, v17
    buffer_store_dword v20, v24, s[12:15], s48 offen sc1
    s_waitcnt vmcnt(27)
    s_barrier
    s_cmp_lg_u32 s4, 0
    s_cbranch_scc1 ch_rn_6
    ds_read_b64_tr_b16 v[88:89], v29 offset:0
    ds_read_b64_tr_b16 v[90:91], v29 offset:128
    ds_read_b64_tr_b16 v[92:93], v29 offset:1024
    ds_read_b64_tr_b16 v[94:95], v29 offset:1152
    ds_read_b64_tr_b16 v[96:97], v29 offset:16
    ds_read_b64_tr_b16 v[98:99], v29 offset:144
    ds_read_b64_tr_b16 v[100:101], v29 offset:1040
    ds_read_b64_tr_b16 v[102:103], v29 offset:1168
    ds_read_b64_tr_b16 v[104:105], v29 offset:16384
    ds_read_b64_tr_b16 v[106:107], v29 offset:16512
    ds_read_b64_tr_b16 v[108:109], v29 offset:17408
    ds_read_b64_tr_b16 v[110:111], v29 offset:17536
    ds_read_b64_tr_b16 v[112:113], v29 offset:16400
    ds_read_b64_tr_b16 v[114:115], v29 offset:16528
    ds_read_b64_tr_b16 v[116:117], v29 offset:17424
    ds_read_b64_tr_b16 v[118:119], v29 offset:17552
    s_branch ch_rj_5
ch_rn_6:
    s_cmp_lg_u32 s4, 1
    s_cbranch_scc1 ch_rn_7
    ds_read_b64_tr_b16 v[72:73], v29 offset:0
    ds_read_b64_tr_b16 v[74:75], v29 offset:128
    ds_read_b64_tr_b16 v[76:77], v29 offset:1024
    ds_read_b64_tr_b16 v[78:79], v29 offset:1152
    ds_read_b64_tr_b16 v[80:81], v29 offset:16
    ds_read_b64_tr_b16 v[82:83], v29 offset:144
    ds_read_b64_tr_b16 v[84:85], v29 offset:1040
    ds_read_b64_tr_b16 v[86:87], v29 offset:1168
    ds_read_b64_tr_b16 a[24:25], v29 offset:16384
    ds_read_b64_tr_b16 a[26:27], v29 offset:16512
    ds_read_b64_tr_b16 a[28:29], v29 offset:17408
    ds_read_b64_tr_b16 a[30:31], v29 offset:17536
    ds_read_b64_tr_b16 a[88:89], v29 offset:16400
    ds_read_b64_tr_b16 a[90:91], v29 offset:16528
    ds_read_b64_tr_b16 a[92:93], v29 offset:17424
    ds_read_b64_tr_b16 a[94:95], v29 offset:17552
    s_branch ch_rj_5
ch_rn_7:
    s_cmp_lg_u32 s4, 2
    s_cbranch_scc1 ch_rn_8
    ds_read_b64_tr_b16 a[32:33], v29 offset:0
    ds_read_b64_tr_b16 a[34:35], v29 offset:128
    ds_read_b64_tr_b16 a[36:37], v29 offset:1024
    ds_read_b64_tr_b16 a[38:39], v29 offset:1152
    ds_read_b64_tr_b16 a[96:97], v29 offset:16
    ds_read_b64_tr_b16 a[98:99], v29 offset:144
    ds_read_b64_tr_b16 a[100:101], v29 offset:1040
    ds_read_b64_tr_b16 a[102:103], v29 offset:1168
    ds_read_b64_tr_b16 a[40:41], v29 offset:16384
    ds_read_b64_tr_b16 a[42:43], v29 offset:16512
    ds_read_b64_tr_b16 a[44:45], v29 offset:17408
    ds_read_b64_tr_b16 a[46:47], v29 offset:17536
    ds_read_b64_tr_b16 a[104:105], v29 offset:16400
    ds_read_b64_tr_b16 a[106:107], v29 offset:16528
    ds_read_b64_tr_b16 a[108:109], v29 offset:17424
    ds_read_b64_tr_b16 a[110:111], v29 offset:17552
    s_branch ch_rj_5
ch_rn_8:
    ds_read_b64_tr_b16 a[48:49], v29 offset:0
    ds_read_b64_tr_b16 a[50:51], v29 offset:128
    ds_read_b64_tr_b16 a[52:53], v29 offset:1024
    ds_read_b64_tr_b16 a[54:55], v29 offset:1152
    ds_read_b64_tr_b16 a[112:113], v29 offset:16
    ds_read_b64_tr_b16 a[114:115], v29 offset:144
    ds_read_b64_tr_b16 a[116:117], v29 offset:1040
    ds_read_b64_tr_b16 a[118:119], v29 offset:1168
    ds_read_b64_tr_b16 a[56:57], v29 offset:16384
    ds_read_b64_tr_b16 a[58:59], v29 offset:16512
    ds_read_b64_tr_b16 a[60:61], v29 offset:17408
    ds_read_b64_tr_b16 a[62:63], v29 offset:17536
    ds_read_b64_tr_b16 a[120:121], v29 offset:16400
    ds_read_b64_tr_b16 a[122:123], v29 offset:16528
    ds_read_b64_tr_b16 a[124:125], v29 offset:17424
    ds_read_b64_tr_b16 a[126:127], v29 offset:17552
ch_rj_5:
    s_waitcnt lgkmcnt(0)
    s_waitcnt vmcnt(19)
    s_barrier
    s_mov_b32 s8, s26
    s_mov_b32 s9, s27
    s_mov_b32 s10, 0x400000
    s_mov_b32 s11, 0x00020000
    s_add_u32 m0, s59, 0
    s_add_u32 s55, s53, 0
    buffer_load_dwordx4 v28, s[8:11], s55 offen  lds
    s_add_u32 m0, s59, 1024
    s_add_u32 s55, s53, 32768
    buffer_load_dwordx4 v28, s[8:11], s55 offen  lds
    s_add_u32 m0, s59, 2048
    s_add_u32 s55, s53, 65536
    buffer_load_dwordx4 v28, s[8:11], s55 offen  lds
    s_add_u32 m0, s59, 3072
    s_add_u32 s55, s53, 98304
    buffer_load_dwordx4 v28, s[8:11], s55 offen  lds
    s_add_u32 m0, s59, 4096
    s_add_u32 s55, s53, 131072
    buffer_load_dwordx4 v28, s[8:11], s55 offen  lds
    s_add_u32 m0, s59, 5120
    s_add_u32 s55, s53, 163840
    buffer_load_dwordx4 v28, s[8:11], s55 offen  lds
    s_add_u32 m0, s59, 6144
    s_add_u32 s55, s53, 196608
    buffer_load_dwordx4 v28, s[8:11], s55 offen  lds
    s_add_u32 m0, s59, 7168
    s_add_u32 s55, s53, 229376
    buffer_load_dwordx4 v28, s[8:11], s55 offen  lds
    s_cmp_lg_u32 s4, 0
    s_cbranch_scc1 ch_rn_11
    ds_read_b64_tr_b16 v[72:73], v29 offset:32768
    ds_read_b64_tr_b16 v[74:75], v29 offset:32896
    ds_read_b64_tr_b16 v[76:77], v29 offset:33792
    ds_read_b64_tr_b16 v[78:79], v29 offset:33920
    ds_read_b64_tr_b16 v[80:81], v29 offset:32784
    ds_read_b64_tr_b16 v[82:83], v29 offset:32912
    ds_read_b64_tr_b16 v[84:85], v29 offset:33808
    ds_read_b64_tr_b16 v[86:87], v29 offset:33936
    ds_read_b64_tr_b16 a[24:25], v29 offset:49152
    ds_read_b64_tr_b16 a[26:27], v29 offset:49280
    ds_read_b64_tr_b16 a[28:29], v29 offset:50176
    ds_read_b64_tr_b16 a[30:31], v29 offset:50304
    ds_read_b64_tr_b16 a[88:89], v29 offset:49168
    ds_read_b64_tr_b16 a[90:91], v29 offset:49296
    ds_read_b64_tr_b16 a[92:93], v29 offset:50192
    ds_read_b64_tr_b16 a[94:95], v29 offset:50320
    s_branch ch_rj_10
ch_rn_11:
    s_cmp_lg_u32 s4, 1
    s_cbranch_scc1 ch_rn_12
    ds_read_b64_tr_b16 v[88:89], v29 offset:32768
    ds_read_b64_tr_b16 v[90:91], v29 offset:32896
    ds_read_b64_tr_b16 v[92:93], v29 offset:33792
    ds_read_b64_tr_b16 v[94:95], v29 offset:33920
    ds_read_b64_tr_b16 v[96:97], v29 offset:32784
    ds_read_b64_tr_b16 v[98:99], v29 offset:32912
    ds_read_b64_tr_b16 v[100:101], v29 offset:33808
    ds_read_b64_tr_b16 v[102:103], v29 offset:33936
    ds_read_b64_tr_b16 v[104:105], v29 offset:49152
    ds_read_b64_tr_b16 v[106:107], v29 offset:49280
    ds_read_b64_tr_b16 v[108:109], v29 offset:50176
    ds_read_b64_tr_b16 v[110:111], v29 offset:50304
    ds_read_b64_tr_b16 v[112:113], v29 offset:49168
    ds_read_b64_tr_b16 v[114:115], v29 offset:49296
    ds_read_b64_tr_b16 v[116:117], v29 offset:50192
    ds_read_b64_tr_b16 v[118:119], v29 offset:50320
    s_branch ch_rj_10
ch_rn_12:
    s_cmp_lg_u32 s4, 2
    s_cbranch_scc1 ch_rn_13
    ds_read_b64_tr_b16 a[48:49], v29 offset:32768
    ds_read_b64_tr_b16 a[50:51], v29 offset:32896
    ds_read_b64_tr_b16 a[52:53], v29 offset:33792
    ds_read_b64_tr_b16 a[54:55], v29 offset:33920
    ds_read_b64_tr_b16 a[112:113], v29 offset:32784
    ds_read_b64_tr_b16 a[114:115], v29 offset:32912
    ds_read_b64_tr_b16 a[116:117], v29 offset:33808
    ds_read_b64_tr_b16 a[118:119], v29 offset:33936
    ds_read_b64_tr_b16 a[56:57], v29 offset:49152
    ds_read_b64_tr_b16 a[58:59], v29 offset:49280
    ds_read_b64_tr_b16 a[60:61], v29 offset:50176
    ds_read_b64_tr_b16 a[62:63], v29 offset:50304
    ds_read_b64_tr_b16 a[120:121], v29 offset:49168
    ds_read_b64_tr_b16 a[122:123], v29 offset:49296
    ds_read_b64_tr_b16 a[124:125], v29 offset:50192
    ds_read_b64_tr_b16 a[126:127], v29 offset:50320
    s_branch ch_rj_10
ch_rn_13:
    ds_read_b64_tr_b16 a[32:33], v29 offset:32768
    ds_read_b64_tr_b16 a[34:35], v29 offset:32896
    ds_read_b64_tr_b16 a[36:37], v29 offset:33792
    ds_read_b64_tr_b16 a[38:39], v29 offset:33920
    ds_read_b64_tr_b16 a[96:97], v29 offset:32784
    ds_read_b64_tr_b16 a[98:99], v29 offset:32912
    ds_read_b64_tr_b16 a[100:101], v29 offset:33808
    ds_read_b64_tr_b16 a[102:103], v29 offset:33936
    ds_read_b64_tr_b16 a[40:41], v29 offset:49152
    ds_read_b64_tr_b16 a[42:43], v29 offset:49280
    ds_read_b64_tr_b16 a[44:45], v29 offset:50176
    ds_read_b64_tr_b16 a[46:47], v29 offset:50304
    ds_read_b64_tr_b16 a[104:105], v29 offset:49168
    ds_read_b64_tr_b16 a[106:107], v29 offset:49296
    ds_read_b64_tr_b16 a[108:109], v29 offset:50192
    ds_read_b64_tr_b16 a[110:111], v29 offset:50320
ch_rj_10:
    s_waitcnt lgkmcnt(0)
    s_waitcnt vmcnt(19)
    s_barrier
    s_add_u32 m0, s59, 32768
    s_add_u32 s55, s53, 1048576
    buffer_load_dwordx4 v28, s[8:11], s55 offen  lds
    s_add_u32 m0, s59, 33792
    s_add_u32 s55, s53, 1081344
    buffer_load_dwordx4 v28, s[8:11], s55 offen  lds
    s_add_u32 m0, s59, 34816
    s_add_u32 s55, s53, 1114112
    buffer_load_dwordx4 v28, s[8:11], s55 offen  lds
    s_add_u32 m0, s59, 35840
    s_add_u32 s55, s53, 1146880
    buffer_load_dwordx4 v28, s[8:11], s55 offen  lds
    s_add_u32 m0, s59, 36864
    s_add_u32 s55, s53, 1179648
    buffer_load_dwordx4 v28, s[8:11], s55 offen  lds
    s_add_u32 m0, s59, 37888
    s_add_u32 s55, s53, 1212416
    buffer_load_dwordx4 v28, s[8:11], s55 offen  lds
    s_add_u32 m0, s59, 38912
    s_add_u32 s55, s53, 1245184
    buffer_load_dwordx4 v28, s[8:11], s55 offen  lds
    s_add_u32 m0, s59, 39936
    s_add_u32 s55, s53, 1277952
    buffer_load_dwordx4 v28, s[8:11], s55 offen  lds
    s_cmp_lg_u32 s4, 0
    s_cbranch_scc1 ch_rn_16
    ds_read_b64_tr_b16 a[32:33], v25 offset:0
    ds_read_b64_tr_b16 a[34:35], v25 offset:128
    ds_read_b64_tr_b16 a[36:37], v25 offset:1024
    ds_read_b64_tr_b16 a[38:39], v25 offset:1152
    ds_read_b64_tr_b16 a[96:97], v25 offset:16
    ds_read_b64_tr_b16 a[98:99], v25 offset:144
    ds_read_b64_tr_b16 a[100:101], v25 offset:1040
    ds_read_b64_tr_b16 a[102:103], v25 offset:1168
    ds_read_b64_tr_b16 a[40:41], v25 offset:16384
    ds_read_b64_tr_b16 a[42:43], v25 offset:16512
    ds_read_b64_tr_b16 a[44:45], v25 offset:17408
    ds_read_b64_tr_b16 a[46:47], v25 offset:17536
    ds_read_b64_tr_b16 a[104:105], v25 offset:16400
    ds_read_b64_tr_b16 a[106:107], v25 offset:16528
    ds_read_b64_tr_b16 a[108:109], v25 offset:17424
    ds_read_b64_tr_b16 a[110:111], v25 offset:17552
    s_branch ch_rj_15
ch_rn_16:
    s_cmp_lg_u32 s4, 1
    s_cbranch_scc1 ch_rn_17
    ds_read_b64_tr_b16 a[48:49], v25 offset:0
    ds_read_b64_tr_b16 a[50:51], v25 offset:128
    ds_read_b64_tr_b16 a[52:53], v25 offset:1024
    ds_read_b64_tr_b16 a[54:55], v25 offset:1152
    ds_read_b64_tr_b16 a[112:113], v25 offset:16
    ds_read_b64_tr_b16 a[114:115], v25 offset:144
    ds_read_b64_tr_b16 a[116:117], v25 offset:1040
    ds_read_b64_tr_b16 a[118:119], v25 offset:1168
    ds_read_b64_tr_b16 a[56:57], v25 offset:16384
    ds_read_b64_tr_b16 a[58:59], v25 offset:16512
    ds_read_b64_tr_b16 a[60:61], v25 offset:17408
    ds_read_b64_tr_b16 a[62:63], v25 offset:17536
    ds_read_b64_tr_b16 a[120:121], v25 offset:16400
    ds_read_b64_tr_b16 a[122:123], v25 offset:16528
    ds_read_b64_tr_b16 a[124:125], v25 offset:17424
    ds_read_b64_tr_b16 a[126:127], v25 offset:17552
    s_branch ch_rj_15
ch_rn_17:
    s_cmp_lg_u32 s4, 2
    s_cbranch_scc1 ch_rn_18
    ds_read_b64_tr_b16 v[88:89], v25 offset:0
    ds_read_b64_tr_b16 v[90:91], v25 offset:128
    ds_read_b64_tr_b16 v[92:93], v25 offset:1024
    ds_read_b64_tr_b16 v[94:95], v25 offset:1152
    ds_read_b64_tr_b16 v[96:97], v25 offset:16
    ds_read_b64_tr_b16 v[98:99], v25 offset:144
    ds_read_b64_tr_b16 v[100:101], v25 offset:1040
    ds_read_b64_tr_b16 v[102:103], v25 offset:1168
    ds_read_b64_tr_b16 v[104:105], v25 offset:16384
    ds_read_b64_tr_b16 v[106:107], v25 offset:16512
    ds_read_b64_tr_b16 v[108:109], v25 offset:17408
    ds_read_b64_tr_b16 v[110:111], v25 offset:17536
    ds_read_b64_tr_b16 v[112:113], v25 offset:16400
    ds_read_b64_tr_b16 v[114:115], v25 offset:16528
    ds_read_b64_tr_b16 v[116:117], v25 offset:17424
    ds_read_b64_tr_b16 v[118:119], v25 offset:17552
    s_branch ch_rj_15
ch_rn_18:
    ds_read_b64_tr_b16 v[72:73], v25 offset:0
    ds_read_b64_tr_b16 v[74:75], v25 offset:128
    ds_read_b64_tr_b16 v[76:77], v25 offset:1024
    ds_read_b64_tr_b16 v[78:79], v25 offset:1152
    ds_read_b64_tr_b16 v[80:81], v25 offset:16
    ds_read_b64_tr_b16 v[82:83], v25 offset:144
    ds_read_b64_tr_b16 v[84:85], v25 offset:1040
    ds_read_b64_tr_b16 v[86:87], v25 offset:1168
    ds_read_b64_tr_b16 a[24:25], v25 offset:16384
    ds_read_b64_tr_b16 a[26:27], v25 offset:16512
    ds_read_b64_tr_b16 a[28:29], v25 offset:17408
    ds_read_b64_tr_b16 a[30:31], v25 offset:17536
    ds_read_b64_tr_b16 a[88:89], v25 offset:16400
    ds_read_b64_tr_b16 a[90:91], v25 offset:16528
    ds_read_b64_tr_b16 a[92:93], v25 offset:17424
    ds_read_b64_tr_b16 a[94:95], v25 offset:17552
ch_rj_15:
    s_waitcnt lgkmcnt(0)
    s_waitcnt vmcnt(19)
    s_barrier
    s_add_u32 m0, s59, 65536
    s_add_u32 s55, s53, 2097152
    buffer_load_dwordx4 v28, s[8:11], s55 offen  lds
    s_add_u32 m0, s59, 66560
    s_add_u32 s55, s53, 2129920
    buffer_load_dwordx4 v28, s[8:11], s55 offen  lds
    s_add_u32 m0, s59, 67584
    s_add_u32 s55, s53, 2162688
    buffer_load_dwordx4 v28, s[8:11], s55 offen  lds
    s_add_u32 m0, s59, 68608
    s_add_u32 s55, s53, 2195456
    buffer_load_dwordx4 v28, s[8:11], s55 offen  lds
    s_add_u32 m0, s59, 69632
    s_add_u32 s55, s53, 2228224
    buffer_load_dwordx4 v28, s[8:11], s55 offen  lds
    s_add_u32 m0, s59, 70656
    s_add_u32 s55, s53, 2260992
    buffer_load_dwordx4 v28, s[8:11], s55 offen  lds
    s_add_u32 m0, s59, 71680
    s_add_u32 s55, s53, 2293760
    buffer_load_dwordx4 v28, s[8:11], s55 offen  lds
    s_add_u32 m0, s59, 72704
    s_add_u32 s55, s53, 2326528
    buffer_load_dwordx4 v28, s[8:11], s55 offen  lds
    s_cmp_lg_u32 s4, 0
    s_cbranch_scc1 ch_rn_21
    ds_read_b64_tr_b16 a[48:49], v25 offset:32768
    ds_read_b64_tr_b16 a[50:51], v25 offset:32896
    ds_read_b64_tr_b16 a[52:53], v25 offset:33792
    ds_read_b64_tr_b16 a[54:55], v25 offset:33920
    ds_read_b64_tr_b16 a[112:113], v25 offset:32784
    ds_read_b64_tr_b16 a[114:115], v25 offset:32912
    ds_read_b64_tr_b16 a[116:117], v25 offset:33808
    ds_read_b64_tr_b16 a[118:119], v25 offset:33936
    ds_read_b64_tr_b16 a[56:57], v25 offset:49152
    ds_read_b64_tr_b16 a[58:59], v25 offset:49280
    ds_read_b64_tr_b16 a[60:61], v25 offset:50176
    ds_read_b64_tr_b16 a[62:63], v25 offset:50304
    ds_read_b64_tr_b16 a[120:121], v25 offset:49168
    ds_read_b64_tr_b16 a[122:123], v25 offset:49296
    ds_read_b64_tr_b16 a[124:125], v25 offset:50192
    ds_read_b64_tr_b16 a[126:127], v25 offset:50320
    s_branch ch_rj_20
ch_rn_21:
    s_cmp_lg_u32 s4, 1
    s_cbranch_scc1 ch_rn_22
    ds_read_b64_tr_b16 a[32:33], v25 offset:32768
    ds_read_b64_tr_b16 a[34:35], v25 offset:32896
    ds_read_b64_tr_b16 a[36:37], v25 offset:33792
    ds_read_b64_tr_b16 a[38:39], v25 offset:33920
    ds_read_b64_tr_b16 a[96:97], v25 offset:32784
    ds_read_b64_tr_b16 a[98:99], v25 offset:32912
    ds_read_b64_tr_b16 a[100:101], v25 offset:33808
    ds_read_b64_tr_b16 a[102:103], v25 offset:33936
    ds_read_b64_tr_b16 a[40:41], v25 offset:49152
    ds_read_b64_tr_b16 a[42:43], v25 offset:49280
    ds_read_b64_tr_b16 a[44:45], v25 offset:50176
    ds_read_b64_tr_b16 a[46:47], v25 offset:50304
    ds_read_b64_tr_b16 a[104:105], v25 offset:49168
    ds_read_b64_tr_b16 a[106:107], v25 offset:49296
    ds_read_b64_tr_b16 a[108:109], v25 offset:50192
    ds_read_b64_tr_b16 a[110:111], v25 offset:50320
    s_branch ch_rj_20
ch_rn_22:
    s_cmp_lg_u32 s4, 2
    s_cbranch_scc1 ch_rn_23
    ds_read_b64_tr_b16 v[72:73], v25 offset:32768
    ds_read_b64_tr_b16 v[74:75], v25 offset:32896
    ds_read_b64_tr_b16 v[76:77], v25 offset:33792
    ds_read_b64_tr_b16 v[78:79], v25 offset:33920
    ds_read_b64_tr_b16 v[80:81], v25 offset:32784
    ds_read_b64_tr_b16 v[82:83], v25 offset:32912
    ds_read_b64_tr_b16 v[84:85], v25 offset:33808
    ds_read_b64_tr_b16 v[86:87], v25 offset:33936
    ds_read_b64_tr_b16 a[24:25], v25 offset:49152
    ds_read_b64_tr_b16 a[26:27], v25 offset:49280
    ds_read_b64_tr_b16 a[28:29], v25 offset:50176
    ds_read_b64_tr_b16 a[30:31], v25 offset:50304
    ds_read_b64_tr_b16 a[88:89], v25 offset:49168
    ds_read_b64_tr_b16 a[90:91], v25 offset:49296
    ds_read_b64_tr_b16 a[92:93], v25 offset:50192
    ds_read_b64_tr_b16 a[94:95], v25 offset:50320
    s_branch ch_rj_20
ch_rn_23:
    ds_read_b64_tr_b16 v[88:89], v25 offset:32768
    ds_read_b64_tr_b16 v[90:91], v25 offset:32896
    ds_read_b64_tr_b16 v[92:93], v25 offset:33792
    ds_read_b64_tr_b16 v[94:95], v25 offset:33920
    ds_read_b64_tr_b16 v[96:97], v25 offset:32784
    ds_read_b64_tr_b16 v[98:99], v25 offset:32912
    ds_read_b64_tr_b16 v[100:101], v25 offset:33808
    ds_read_b64_tr_b16 v[102:103], v25 offset:33936
    ds_read_b64_tr_b16 v[104:105], v25 offset:49152
    ds_read_b64_tr_b16 v[106:107], v25 offset:49280
    ds_read_b64_tr_b16 v[108:109], v25 offset:50176
    ds_read_b64_tr_b16 v[110:111], v25 offset:50304
    ds_read_b64_tr_b16 v[112:113], v25 offset:49168
    ds_read_b64_tr_b16 v[114:115], v25 offset:49296
    ds_read_b64_tr_b16 v[116:117], v25 offset:50192
    ds_read_b64_tr_b16 v[118:119], v25 offset:50320
ch_rj_20:
    s_waitcnt lgkmcnt(0)
    s_waitcnt vmcnt(16)
    s_barrier
    s_add_u32 m0, s59, 98304
    s_add_u32 s55, s53, 3145728
    buffer_load_dwordx4 v28, s[8:11], s55 offen  lds
    s_add_u32 m0, s59, 99328
    s_add_u32 s55, s53, 3178496
    buffer_load_dwordx4 v28, s[8:11], s55 offen  lds
    s_add_u32 m0, s59, 100352
    s_add_u32 s55, s53, 3211264
    buffer_load_dwordx4 v28, s[8:11], s55 offen  lds
    s_add_u32 m0, s59, 101376
    s_add_u32 s55, s53, 3244032
    buffer_load_dwordx4 v28, s[8:11], s55 offen  lds
    s_add_u32 m0, s59, 102400
    s_add_u32 s55, s53, 3276800
    buffer_load_dwordx4 v28, s[8:11], s55 offen  lds
    s_add_u32 m0, s59, 103424
    s_add_u32 s55, s53, 3309568
    buffer_load_dwordx4 v28, s[8:11], s55 offen  lds
    s_add_u32 m0, s59, 104448
    s_add_u32 s55, s53, 3342336
    buffer_load_dwordx4 v28, s[8:11], s55 offen  lds
    s_add_u32 m0, s59, 105472
    s_add_u32 s55, s53, 3375104
    buffer_load_dwordx4 v28, s[8:11], s55 offen  lds
    v_mov_b32 v22, 1
    s_mov_b64 exec, 1
    buffer_atomic_add v22, off, s[16:19], 0 offset:4
    s_mov_b64 exec, -1
    s_mov_b32 s8, s32
    s_mov_b32 s9, s33
    s_mov_b32 s10, 0x2000
    s_mov_b32 s11, 0x00020000
    v_lshlrev_b32 v20, 1, v17
    s_lshl_b32 s48, s4, 8
    v_add_u32 v20, s48, v20
    s_mov_b32 s49, 0
    buffer_load_ushort v48, v20, s[8:11], s49 offen offset:0
    s_mov_b32 s49, 1024
    buffer_load_ushort v49, v20, s[8:11], s49 offen offset:0
    s_mov_b32 s49, 2048
    buffer_load_ushort v50, v20, s[8:11], s49 offen offset:0
    s_mov_b32 s49, 3072
    buffer_load_ushort v51, v20, s[8:11], s49 offen offset:0
    s_mov_b32 s49, 4096
    buffer_load_ushort v52, v20, s[8:11], s49 offen offset:0
    s_mov_b32 s49, 5120
    buffer_load_ushort v53, v20, s[8:11], s49 offen offset:0
    s_mov_b32 s49, 6144
    buffer_load_ushort v54, v20, s[8:11], s49 offen offset:0
    s_mov_b32 s49, 7168
    buffer_load_ushort v55, v20, s[8:11], s49 offen offset:0
    s_mov_b32 s49, 0
    buffer_load_ushort v56, v20, s[8:11], s49 offen offset:128
    s_mov_b32 s49, 1024
    buffer_load_ushort v57, v20, s[8:11], s49 offen offset:128
    s_mov_b32 s49, 2048
    buffer_load_ushort v58, v20, s[8:11], s49 offen offset:128
    s_mov_b32 s49, 3072
    buffer_load_ushort v59, v20, s[8:11], s49 offen offset:128
    s_mov_b32 s49, 4096
    buffer_load_ushort v60, v20, s[8:11], s49 offen offset:128
    s_mov_b32 s49, 5120
    buffer_load_ushort v61, v20, s[8:11], s49 offen offset:128
    s_mov_b32 s49, 6144
    buffer_load_ushort v62, v20, s[8:11], s49 offen offset:128
    s_mov_b32 s49, 7168
    buffer_load_ushort v63, v20, s[8:11], s49 offen offset:128
    s_cmp_lg_u32 s4, 0
    s_cbranch_scc1 ch_rn_26
    ds_read_b64_tr_b16 a[128:129], v29 offset:0
    ds_read_b64_tr_b16 a[130:131], v29 offset:128
    ds_read_b64_tr_b16 a[132:133], v29 offset:1024
    ds_read_b64_tr_b16 a[134:135], v29 offset:1152
    ds_read_b64_tr_b16 a[192:193], v29 offset:16
    ds_read_b64_tr_b16 a[194:195], v29 offset:144
    ds_read_b64_tr_b16 a[196:197], v29 offset:1040
    ds_read_b64_tr_b16 a[198:199], v29 offset:1168
    ds_read_b64_tr_b16 a[136:137], v29 offset:16384
    ds_read_b64_tr_b16 a[138:139], v29 offset:16512
    ds_read_b64_tr_b16 a[140:141], v29 offset:17408
    ds_read_b64_tr_b16 a[142:143], v29 offset:17536
    ds_read_b64_tr_b16 a[200:201], v29 offset:16400
    ds_read_b64_tr_b16 a[202:203], v29 offset:16528
    ds_read_b64_tr_b16 a[204:205], v29 offset:17424
    ds_read_b64_tr_b16 a[206:207], v29 offset:17552
    s_branch ch_rj_25
ch_rn_26:
    s_cmp_lg_u32 s4, 1
    s_cbranch_scc1 ch_rn_27
    ds_read_b64_tr_b16 a[144:145], v29 offset:0
    ds_read_b64_tr_b16 a[146:147], v29 offset:128
    ds_read_b64_tr_b16 a[148:149], v29 offset:1024
    ds_read_b64_tr_b16 a[150:151], v29 offset:1152
    ds_read_b64_tr_b16 a[208:209], v29 offset:16
    ds_read_b64_tr_b16 a[210:211], v29 offset:144
    ds_read_b64_tr_b16 a[212:213], v29 offset:1040
    ds_read_b64_tr_b16 a[214:215], v29 offset:1168
    ds_read_b64_tr_b16 a[152:153], v29 offset:16384
    ds_read_b64_tr_b16 a[154:155], v29 offset:16512
    ds_read_b64_tr_b16 a[156:157], v29 offset:17408
    ds_read_b64_tr_b16 a[158:159], v29 offset:17536
    ds_read_b64_tr_b16 a[216:217], v29 offset:16400
    ds_read_b64_tr_b16 a[218:219], v29 offset:16528
    ds_read_b64_tr_b16 a[220:221], v29 offset:17424
    ds_read_b64_tr_b16 a[222:223], v29 offset:17552
    s_branch ch_rj_25
ch_rn_27:
    s_cmp_lg_u32 s4, 2
    s_cbranch_scc1 ch_rn_28
    ds_read_b64_tr_b16 a[160:161], v29 offset:0
    ds_read_b64_tr_b16 a[162:163], v29 offset:128
    ds_read_b64_tr_b16 a[164:165], v29 offset:1024
    ds_read_b64_tr_b16 a[166:167], v29 offset:1152
    ds_read_b64_tr_b16 a[224:225], v29 offset:16
    ds_read_b64_tr_b16 a[226:227], v29 offset:144
    ds_read_b64_tr_b16 a[228:229], v29 offset:1040
    ds_read_b64_tr_b16 a[230:231], v29 offset:1168
    ds_read_b64_tr_b16 a[168:169], v29 offset:16384
    ds_read_b64_tr_b16 a[170:171], v29 offset:16512
    ds_read_b64_tr_b16 a[172:173], v29 offset:17408
    ds_read_b64_tr_b16 a[174:175], v29 offset:17536
    ds_read_b64_tr_b16 a[232:233], v29 offset:16400
    ds_read_b64_tr_b16 a[234:235], v29 offset:16528
    ds_read_b64_tr_b16 a[236:237], v29 offset:17424
    ds_read_b64_tr_b16 a[238:239], v29 offset:17552
    s_branch ch_rj_25
ch_rn_28:
    ds_read_b64_tr_b16 a[176:177], v29 offset:0
    ds_read_b64_tr_b16 a[178:179], v29 offset:128
    ds_read_b64_tr_b16 a[180:181], v29 offset:1024
    ds_read_b64_tr_b16 a[182:183], v29 offset:1152
    ds_read_b64_tr_b16 a[240:241], v29 offset:16
    ds_read_b64_tr_b16 a[242:243], v29 offset:144
    ds_read_b64_tr_b16 a[244:245], v29 offset:1040
    ds_read_b64_tr_b16 a[246:247], v29 offset:1168
    ds_read_b64_tr_b16 a[184:185], v29 offset:16384
    ds_read_b64_tr_b16 a[186:187], v29 offset:16512
    ds_read_b64_tr_b16 a[188:189], v29 offset:17408
    ds_read_b64_tr_b16 a[190:191], v29 offset:17536
    ds_read_b64_tr_b16 a[248:249], v29 offset:16400
    ds_read_b64_tr_b16 a[250:251], v29 offset:16528
    ds_read_b64_tr_b16 a[252:253], v29 offset:17424
    ds_read_b64_tr_b16 a[254:255], v29 offset:17552
ch_rj_25:
    s_waitcnt lgkmcnt(0)
    s_waitcnt vmcnt(33)
    s_barrier
    s_mov_b32 s8, s28
    s_mov_b32 s9, s29
    s_mov_b32 s10, 0x400000
    s_mov_b32 s11, 0x00020000
    s_add_u32 m0, s59, 0
    s_add_u32 s55, s53, 0
    buffer_load_dwordx4 v28, s[8:11], s55 offen  lds
    s_add_u32 m0, s59, 1024
    s_add_u32 s55, s53, 32768
    buffer_load_dwordx4 v28, s[8:11], s55 offen  lds
    s_add_u32 m0, s59, 2048
    s_add_u32 s55, s53, 65536
    buffer_load_dwordx4 v28, s[8:11], s55 offen  lds
    s_add_u32 m0, s59, 3072
    s_add_u32 s55, s53, 98304
    buffer_load_dwordx4 v28, s[8:11], s55 offen  lds
    s_add_u32 m0, s59, 4096
    s_add_u32 s55, s53, 131072
    buffer_load_dwordx4 v28, s[8:11], s55 offen  lds
    s_add_u32 m0, s59, 5120
    s_add_u32 s55, s53, 163840
    buffer_load_dwordx4 v28, s[8:11], s55 offen  lds
    s_add_u32 m0, s59, 6144
    s_add_u32 s55, s53, 196608
    buffer_load_dwordx4 v28, s[8:11], s55 offen  lds
    s_add_u32 m0, s59, 7168
    s_add_u32 s55, s53, 229376
    buffer_load_dwordx4 v28, s[8:11], s55 offen  lds
    buffer_load_dword v23, off, s[16:19], 0 offset:196 sc1
    s_cmp_lg_u32 s4, 0
    s_cbranch_scc1 ch_rn_31
    ds_read_b64_tr_b16 a[144:145], v29 offset:32768
    ds_read_b64_tr_b16 a[146:147], v29 offset:32896
    ds_read_b64_tr_b16 a[148:149], v29 offset:33792
    ds_read_b64_tr_b16 a[150:151], v29 offset:33920
    ds_read_b64_tr_b16 a[208:209], v29 offset:32784
    ds_read_b64_tr_b16 a[210:211], v29 offset:32912
    ds_read_b64_tr_b16 a[212:213], v29 offset:33808
    ds_read_b64_tr_b16 a[214:215], v29 offset:33936
    ds_read_b64_tr_b16 a[152:153], v29 offset:49152
    ds_read_b64_tr_b16 a[154:155], v29 offset:49280
    ds_read_b64_tr_b16 a[156:157], v29 offset:50176
    ds_read_b64_tr_b16 a[158:159], v29 offset:50304
    ds_read_b64_tr_b16 a[216:217], v29 offset:49168
    ds_read_b64_tr_b16 a[218:219], v29 offset:49296
    ds_read_b64_tr_b16 a[220:221], v29 offset:50192
    ds_read_b64_tr_b16 a[222:223], v29 offset:50320
    s_branch ch_rj_30
ch_rn_31:
    s_cmp_lg_u32 s4, 1
    s_cbranch_scc1 ch_rn_32
    ds_read_b64_tr_b16 a[128:129], v29 offset:32768
    ds_read_b64_tr_b16 a[130:131], v29 offset:32896
    ds_read_b64_tr_b16 a[132:133], v29 offset:33792
    ds_read_b64_tr_b16 a[134:135], v29 offset:33920
    ds_read_b64_tr_b16 a[192:193], v29 offset:32784
    ds_read_b64_tr_b16 a[194:195], v29 offset:32912
    ds_read_b64_tr_b16 a[196:197], v29 offset:33808
    ds_read_b64_tr_b16 a[198:199], v29 offset:33936
    ds_read_b64_tr_b16 a[136:137], v29 offset:49152
    ds_read_b64_tr_b16 a[138:139], v29 offset:49280
    ds_read_b64_tr_b16 a[140:141], v29 offset:50176
    ds_read_b64_tr_b16 a[142:143], v29 offset:50304
    ds_read_b64_tr_b16 a[200:201], v29 offset:49168
    ds_read_b64_tr_b16 a[202:203], v29 offset:49296
    ds_read_b64_tr_b16 a[204:205], v29 offset:50192
    ds_read_b64_tr_b16 a[206:207], v29 offset:50320
    s_branch ch_rj_30
ch_rn_32:
    s_cmp_lg_u32 s4, 2
    s_cbranch_scc1 ch_rn_33
    ds_read_b64_tr_b16 a[176:177], v29 offset:32768
    ds_read_b64_tr_b16 a[178:179], v29 offset:32896
    ds_read_b64_tr_b16 a[180:181], v29 offset:33792
    ds_read_b64_tr_b16 a[182:183], v29 offset:33920
    ds_read_b64_tr_b16 a[240:241], v29 offset:32784
    ds_read_b64_tr_b16 a[242:243], v29 offset:32912
    ds_read_b64_tr_b16 a[244:245], v29 offset:33808
    ds_read_b64_tr_b16 a[246:247], v29 offset:33936
    ds_read_b64_tr_b16 a[184:185], v29 offset:49152
    ds_read_b64_tr_b16 a[186:187], v29 offset:49280
    ds_read_b64_tr_b16 a[188:189], v29 offset:50176
    ds_read_b64_tr_b16 a[190:191], v29 offset:50304
    ds_read_b64_tr_b16 a[248:249], v29 offset:49168
    ds_read_b64_tr_b16 a[250:251], v29 offset:49296
    ds_read_b64_tr_b16 a[252:253], v29 offset:50192
    ds_read_b64_tr_b16 a[254:255], v29 offset:50320
    s_branch ch_rj_30
ch_rn_33:
    ds_read_b64_tr_b16 a[160:161], v29 offset:32768
    ds_read_b64_tr_b16 a[162:163], v29 offset:32896
    ds_read_b64_tr_b16 a[164:165], v29 offset:33792
    ds_read_b64_tr_b16 a[166:167], v29 offset:33920
    ds_read_b64_tr_b16 a[224:225], v29 offset:32784
    ds_read_b64_tr_b16 a[226:227], v29 offset:32912
    ds_read_b64_tr_b16 a[228:229], v29 offset:33808
    ds_read_b64_tr_b16 a[230:231], v29 offset:33936
    ds_read_b64_tr_b16 a[168:169], v29 offset:49152
    ds_read_b64_tr_b16 a[170:171], v29 offset:49280
    ds_read_b64_tr_b16 a[172:173], v29 offset:50176
    ds_read_b64_tr_b16 a[174:175], v29 offset:50304
    ds_read_b64_tr_b16 a[232:233], v29 offset:49168
    ds_read_b64_tr_b16 a[234:235], v29 offset:49296
    ds_read_b64_tr_b16 a[236:237], v29 offset:50192
    ds_read_b64_tr_b16 a[238:239], v29 offset:50320
ch_rj_30:
    s_waitcnt lgkmcnt(0)
    s_waitcnt vmcnt(34)
    s_barrier
    s_add_u32 m0, s59, 32768
    s_add_u32 s55, s53, 1048576
    buffer_load_dwordx4 v28, s[8:11], s55 offen  lds
    s_add_u32 m0, s59, 33792
    s_add_u32 s55, s53, 1081344
    buffer_load_dwordx4 v28, s[8:11], s55 offen  lds
    s_add_u32 m0, s59, 34816
    s_add_u32 s55, s53, 1114112
    buffer_load_dwordx4 v28, s[8:11], s55 offen  lds
    s_add_u32 m0, s59, 35840
    s_add_u32 s55, s53, 1146880
    buffer_load_dwordx4 v28, s[8:11], s55 offen  lds
    s_add_u32 m0, s59, 36864
    s_add_u32 s55, s53, 1179648
    buffer_load_dwordx4 v28, s[8:11], s55 offen  lds
    s_add_u32 m0, s59, 37888
    s_add_u32 s55, s53, 1212416
    buffer_load_dwordx4 v28, s[8:11], s55 offen  lds
    s_add_u32 m0, s59, 38912
    s_add_u32 s55, s53, 1245184
    buffer_load_dwordx4 v28, s[8:11], s55 offen  lds
    s_add_u32 m0, s59, 39936
    s_add_u32 s55, s53, 1277952
    buffer_load_dwordx4 v28, s[8:11], s55 offen  lds
    s_cmp_lg_u32 s4, 0
    s_cbranch_scc1 ch_rn_36
    ds_read_b64_tr_b16 a[160:161], v25 offset:0
    ds_read_b64_tr_b16 a[162:163], v25 offset:128
    ds_read_b64_tr_b16 a[164:165], v25 offset:1024
    ds_read_b64_tr_b16 a[166:167], v25 offset:1152
    ds_read_b64_tr_b16 a[224:225], v25 offset:16
    ds_read_b64_tr_b16 a[226:227], v25 offset:144
    ds_read_b64_tr_b16 a[228:229], v25 offset:1040
    ds_read_b64_tr_b16 a[230:231], v25 offset:1168
    ds_read_b64_tr_b16 a[168:169], v25 offset:16384
    ds_read_b64_tr_b16 a[170:171], v25 offset:16512
    ds_read_b64_tr_b16 a[172:173], v25 offset:17408
    ds_read_b64_tr_b16 a[174:175], v25 offset:17536
    ds_read_b64_tr_b16 a[232:233], v25 offset:16400
    ds_read_b64_tr_b16 a[234:235], v25 offset:16528
    ds_read_b64_tr_b16 a[236:237], v25 offset:17424
    ds_read_b64_tr_b16 a[238:239], v25 offset:17552
    s_branch ch_rj_35
ch_rn_36:
    s_cmp_lg_u32 s4, 1
    s_cbranch_scc1 ch_rn_37
    ds_read_b64_tr_b16 a[176:177], v25 offset:0
    ds_read_b64_tr_b16 a[178:179], v25 offset:128
    ds_read_b64_tr_b16 a[180:181], v25 offset:1024
    ds_read_b64_tr_b16 a[182:183], v25 offset:1152
    ds_read_b64_tr_b16 a[240:241], v25 offset:16
    ds_read_b64_tr_b16 a[242:243], v25 offset:144
    ds_read_b64_tr_b16 a[244:245], v25 offset:1040
    ds_read_b64_tr_b16 a[246:247], v25 offset:1168
    ds_read_b64_tr_b16 a[184:185], v25 offset:16384
    ds_read_b64_tr_b16 a[186:187], v25 offset:16512
    ds_read_b64_tr_b16 a[188:189], v25 offset:17408
    ds_read_b64_tr_b16 a[190:191], v25 offset:17536
    ds_read_b64_tr_b16 a[248:249], v25 offset:16400
    ds_read_b64_tr_b16 a[250:251], v25 offset:16528
    ds_read_b64_tr_b16 a[252:253], v25 offset:17424
    ds_read_b64_tr_b16 a[254:255], v25 offset:17552
    s_branch ch_rj_35
ch_rn_37:
    s_cmp_lg_u32 s4, 2
    s_cbranch_scc1 ch_rn_38
    ds_read_b64_tr_b16 a[128:129], v25 offset:0
    ds_read_b64_tr_b16 a[130:131], v25 offset:128
    ds_read_b64_tr_b16 a[132:133], v25 offset:1024
    ds_read_b64_tr_b16 a[134:135], v25 offset:1152
    ds_read_b64_tr_b16 a[192:193], v25 offset:16
    ds_read_b64_tr_b16 a[194:195], v25 offset:144
    ds_read_b64_tr_b16 a[196:197], v25 offset:1040
    ds_read_b64_tr_b16 a[198:199], v25 offset:1168
    ds_read_b64_tr_b16 a[136:137], v25 offset:16384
    ds_read_b64_tr_b16 a[138:139], v25 offset:16512
    ds_read_b64_tr_b16 a[140:141], v25 offset:17408
    ds_read_b64_tr_b16 a[142:143], v25 offset:17536
    ds_read_b64_tr_b16 a[200:201], v25 offset:16400
    ds_read_b64_tr_b16 a[202:203], v25 offset:16528
    ds_read_b64_tr_b16 a[204:205], v25 offset:17424
    ds_read_b64_tr_b16 a[206:207], v25 offset:17552
    s_branch ch_rj_35
ch_rn_38:
    ds_read_b64_tr_b16 a[144:145], v25 offset:0
    ds_read_b64_tr_b16 a[146:147], v25 offset:128
    ds_read_b64_tr_b16 a[148:149], v25 offset:1024
    ds_read_b64_tr_b16 a[150:151], v25 offset:1152
    ds_read_b64_tr_b16 a[208:209], v25 offset:16
    ds_read_b64_tr_b16 a[210:211], v25 offset:144
    ds_read_b64_tr_b16 a[212:213], v25 offset:1040
    ds_read_b64_tr_b16 a[214:215], v25 offset:1168
    ds_read_b64_tr_b16 a[152:153], v25 offset:16384
    ds_read_b64_tr_b16 a[154:155], v25 offset:16512
    ds_read_b64_tr_b16 a[156:157], v25 offset:17408
    ds_read_b64_tr_b16 a[158:159], v25 offset:17536
    ds_read_b64_tr_b16 a[216:217], v25 offset:16400
    ds_read_b64_tr_b16 a[218:219], v25 offset:16528
    ds_read_b64_tr_b16 a[220:221], v25 offset:17424
    ds_read_b64_tr_b16 a[222:223], v25 offset:17552
ch_rj_35:
    s_waitcnt lgkmcnt(0)
    s_waitcnt vmcnt(34)
    s_barrier
    s_add_u32 m0, s59, 65536
    s_add_u32 s55, s53, 2097152
    buffer_load_dwordx4 v28, s[8:11], s55 offen  lds
    s_add_u32 m0, s59, 66560
    s_add_u32 s55, s53, 2129920
    buffer_load_dwordx4 v28, s[8:11], s55 offen  lds
    s_add_u32 m0, s59, 67584
    s_add_u32 s55, s53, 2162688
    buffer_load_dwordx4 v28, s[8:11], s55 offen  lds
    s_add_u32 m0, s59, 68608
    s_add_u32 s55, s53, 2195456
    buffer_load_dwordx4 v28, s[8:11], s55 offen  lds
    s_add_u32 m0, s59, 69632
    s_add_u32 s55, s53, 2228224
    buffer_load_dwordx4 v28, s[8:11], s55 offen  lds
    s_add_u32 m0, s59, 70656
    s_add_u32 s55, s53, 2260992
    buffer_load_dwordx4 v28, s[8:11], s55 offen  lds
    s_add_u32 m0, s59, 71680
    s_add_u32 s55, s53, 2293760
    buffer_load_dwordx4 v28, s[8:11], s55 offen  lds
    s_add_u32 m0, s59, 72704
    s_add_u32 s55, s53, 2326528
    buffer_load_dwordx4 v28, s[8:11], s55 offen  lds
    s_cmp_lg_u32 s4, 0
    s_cbranch_scc1 ch_rn_41
    ds_read_b64_tr_b16 a[176:177], v25 offset:32768
    ds_read_b64_tr_b16 a[178:179], v25 offset:32896
    ds_read_b64_tr_b16 a[180:181], v25 offset:33792
    ds_read_b64_tr_b16 a[182:183], v25 offset:33920
    ds_read_b64_tr_b16 a[240:241], v25 offset:32784
    ds_read_b64_tr_b16 a[242:243], v25 offset:32912
    ds_read_b64_tr_b16 a[244:245], v25 offset:33808
    ds_read_b64_tr_b16 a[246:247], v25 offset:33936
    ds_read_b64_tr_b16 a[184:185], v25 offset:49152
    ds_read_b64_tr_b16 a[186:187], v25 offset:49280
    ds_read_b64_tr_b16 a[188:189], v25 offset:50176
    ds_read_b64_tr_b16 a[190:191], v25 offset:50304
    ds_read_b64_tr_b16 a[248:249], v25 offset:49168
    ds_read_b64_tr_b16 a[250:251], v25 offset:49296
    ds_read_b64_tr_b16 a[252:253], v25 offset:50192
    ds_read_b64_tr_b16 a[254:255], v25 offset:50320
    s_branch ch_rj_40
ch_rn_41:
    s_cmp_lg_u32 s4, 1
    s_cbranch_scc1 ch_rn_42
    ds_read_b64_tr_b16 a[160:161], v25 offset:32768
    ds_read_b64_tr_b16 a[162:163], v25 offset:32896
    ds_read_b64_tr_b16 a[164:165], v25 offset:33792
    ds_read_b64_tr_b16 a[166:167], v25 offset:33920
    ds_read_b64_tr_b16 a[224:225], v25 offset:32784
    ds_read_b64_tr_b16 a[226:227], v25 offset:32912
    ds_read_b64_tr_b16 a[228:229], v25 offset:33808
    ds_read_b64_tr_b16 a[230:231], v25 offset:33936
    ds_read_b64_tr_b16 a[168:169], v25 offset:49152
    ds_read_b64_tr_b16 a[170:171], v25 offset:49280
    ds_read_b64_tr_b16 a[172:173], v25 offset:50176
    ds_read_b64_tr_b16 a[174:175], v25 offset:50304
    ds_read_b64_tr_b16 a[232:233], v25 offset:49168
    ds_read_b64_tr_b16 a[234:235], v25 offset:49296
    ds_read_b64_tr_b16 a[236:237], v25 offset:50192
    ds_read_b64_tr_b16 a[238:239], v25 offset:50320
    s_branch ch_rj_40
ch_rn_42:
    s_cmp_lg_u32 s4, 2
    s_cbranch_scc1 ch_rn_43
    ds_read_b64_tr_b16 a[144:145], v25 offset:32768
    ds_read_b64_tr_b16 a[146:147], v25 offset:32896
    ds_read_b64_tr_b16 a[148:149], v25 offset:33792
    ds_read_b64_tr_b16 a[150:151], v25 offset:33920
    ds_read_b64_tr_b16 a[208:209], v25 offset:32784
    ds_read_b64_tr_b16 a[210:211], v25 offset:32912
    ds_read_b64_tr_b16 a[212:213], v25 offset:33808
    ds_read_b64_tr_b16 a[214:215], v25 offset:33936
    ds_read_b64_tr_b16 a[152:153], v25 offset:49152
    ds_read_b64_tr_b16 a[154:155], v25 offset:49280
    ds_read_b64_tr_b16 a[156:157], v25 offset:50176
    ds_read_b64_tr_b16 a[158:159], v25 offset:50304
    ds_read_b64_tr_b16 a[216:217], v25 offset:49168
    ds_read_b64_tr_b16 a[218:219], v25 offset:49296
    ds_read_b64_tr_b16 a[220:221], v25 offset:50192
    ds_read_b64_tr_b16 a[222:223], v25 offset:50320
    s_branch ch_rj_40
ch_rn_43:
    ds_read_b64_tr_b16 a[128:129], v25 offset:32768
    ds_read_b64_tr_b16 a[130:131], v25 offset:32896
    ds_read_b64_tr_b16 a[132:133], v25 offset:33792
    ds_read_b64_tr_b16 a[134:135], v25 offset:33920
    ds_read_b64_tr_b16 a[192:193], v25 offset:32784
    ds_read_b64_tr_b16 a[194:195], v25 offset:32912
    ds_read_b64_tr_b16 a[196:197], v25 offset:33808
    ds_read_b64_tr_b16 a[198:199], v25 offset:33936
    ds_read_b64_tr_b16 a[136:137], v25 offset:49152
    ds_read_b64_tr_b16 a[138:139], v25 offset:49280
    ds_read_b64_tr_b16 a[140:141], v25 offset:50176
    ds_read_b64_tr_b16 a[142:143], v25 offset:50304
    ds_read_b64_tr_b16 a[200:201], v25 offset:49168
    ds_read_b64_tr_b16 a[202:203], v25 offset:49296
    ds_read_b64_tr_b16 a[204:205], v25 offset:50192
    ds_read_b64_tr_b16 a[206:207], v25 offset:50320
ch_rj_40:
    s_waitcnt lgkmcnt(0)
    s_waitcnt vmcnt(17)
    s_barrier
    s_add_u32 m0, s59, 98304
    s_add_u32 s55, s53, 3145728
    buffer_load_dwordx4 v28, s[8:11], s55 offen  lds
    s_add_u32 m0, s59, 99328
    s_add_u32 s55, s53, 3178496
    buffer_load_dwordx4 v28, s[8:11], s55 offen  lds
    s_add_u32 m0, s59, 100352
    s_add_u32 s55, s53, 3211264
    buffer_load_dwordx4 v28, s[8:11], s55 offen  lds
    s_add_u32 m0, s59, 101376
    s_add_u32 s55, s53, 3244032
    buffer_load_dwordx4 v28, s[8:11], s55 offen  lds
    s_add_u32 m0, s59, 102400
    s_add_u32 s55, s53, 3276800
    buffer_load_dwordx4 v28, s[8:11], s55 offen  lds
    s_add_u32 m0, s59, 103424
    s_add_u32 s55, s53, 3309568
    buffer_load_dwordx4 v28, s[8:11], s55 offen  lds
    s_add_u32 m0, s59, 104448
    s_add_u32 s55, s53, 3342336
    buffer_load_dwordx4 v28, s[8:11], s55 offen  lds
    s_add_u32 m0, s59, 105472
    s_add_u32 s55, s53, 3375104
    buffer_load_dwordx4 v28, s[8:11], s55 offen  lds
    s_cmp_lg_u32 s4, 0
    s_cbranch_scc1 ch_rn_46
    ds_read_b64_tr_b16 v[128:129], v27 offset:0
    ds_read_b64_tr_b16 v[130:131], v27 offset:128
    ds_read_b64_tr_b16 v[132:133], v27 offset:1024
    ds_read_b64_tr_b16 v[134:135], v27 offset:1152
    ds_read_b64_tr_b16 v[192:193], v27 offset:32
    ds_read_b64_tr_b16 v[194:195], v27 offset:160
    ds_read_b64_tr_b16 v[196:197], v27 offset:1056
    ds_read_b64_tr_b16 v[198:199], v27 offset:1184
    ds_read_b64_tr_b16 v[136:137], v27 offset:16384
    ds_read_b64_tr_b16 v[138:139], v27 offset:16512
    ds_read_b64_tr_b16 v[140:141], v27 offset:17408
    ds_read_b64_tr_b16 v[142:143], v27 offset:17536
    ds_read_b64_tr_b16 v[200:201], v27 offset:16416
    ds_read_b64_tr_b16 v[202:203], v27 offset:16544
    ds_read_b64_tr_b16 v[204:205], v27 offset:17440
    ds_read_b64_tr_b16 v[206:207], v27 offset:17568
    s_branch ch_rj_45
ch_rn_46:
    s_cmp_lg_u32 s4, 1
    s_cbranch_scc1 ch_rn_47
    ds_read_b64_tr_b16 v[144:145], v27 offset:0
    ds_read_b64_tr_b16 v[146:147], v27 offset:128
    ds_read_b64_tr_b16 v[148:149], v27 offset:1024
    ds_read_b64_tr_b16 v[150:151], v27 offset:1152
    ds_read_b64_tr_b16 v[208:209], v27 offset:32
    ds_read_b64_tr_b16 v[210:211], v27 offset:160
    ds_read_b64_tr_b16 v[212:213], v27 offset:1056
    ds_read_b64_tr_b16 v[214:215], v27 offset:1184
    ds_read_b64_tr_b16 v[152:153], v27 offset:16384
    ds_read_b64_tr_b16 v[154:155], v27 offset:16512
    ds_read_b64_tr_b16 v[156:157], v27 offset:17408
    ds_read_b64_tr_b16 v[158:159], v27 offset:17536
    ds_read_b64_tr_b16 v[216:217], v27 offset:16416
    ds_read_b64_tr_b16 v[218:219], v27 offset:16544
    ds_read_b64_tr_b16 v[220:221], v27 offset:17440
    ds_read_b64_tr_b16 v[222:223], v27 offset:17568
    s_branch ch_rj_45
ch_rn_47:
    s_cmp_lg_u32 s4, 2
    s_cbranch_scc1 ch_rn_48
    ds_read_b64_tr_b16 v[160:161], v27 offset:0
    ds_read_b64_tr_b16 v[162:163], v27 offset:128
    ds_read_b64_tr_b16 v[164:165], v27 offset:1024
    ds_read_b64_tr_b16 v[166:167], v27 offset:1152
    ds_read_b64_tr_b16 v[224:225], v27 offset:32
    ds_read_b64_tr_b16 v[226:227], v27 offset:160
    ds_read_b64_tr_b16 v[228:229], v27 offset:1056
    ds_read_b64_tr_b16 v[230:231], v27 offset:1184
    ds_read_b64_tr_b16 v[168:169], v27 offset:16384
    ds_read_b64_tr_b16 v[170:171], v27 offset:16512
    ds_read_b64_tr_b16 v[172:173], v27 offset:17408
    ds_read_b64_tr_b16 v[174:175], v27 offset:17536
    ds_read_b64_tr_b16 v[232:233], v27 offset:16416
    ds_read_b64_tr_b16 v[234:235], v27 offset:16544
    ds_read_b64_tr_b16 v[236:237], v27 offset:17440
    ds_read_b64_tr_b16 v[238:239], v27 offset:17568
    s_branch ch_rj_45
ch_rn_48:
    ds_read_b64_tr_b16 v[176:177], v27 offset:0
    ds_read_b64_tr_b16 v[178:179], v27 offset:128
    ds_read_b64_tr_b16 v[180:181], v27 offset:1024
    ds_read_b64_tr_b16 v[182:183], v27 offset:1152
    ds_read_b64_tr_b16 v[240:241], v27 offset:32
    ds_read_b64_tr_b16 v[242:243], v27 offset:160
    ds_read_b64_tr_b16 v[244:245], v27 offset:1056
    ds_read_b64_tr_b16 v[246:247], v27 offset:1184
    ds_read_b64_tr_b16 v[184:185], v27 offset:16384
    ds_read_b64_tr_b16 v[186:187], v27 offset:16512
    ds_read_b64_tr_b16 v[188:189], v27 offset:17408
    ds_read_b64_tr_b16 v[190:191], v27 offset:17536
    ds_read_b64_tr_b16 v[248:249], v27 offset:16416
    ds_read_b64_tr_b16 v[250:251], v27 offset:16544
    ds_read_b64_tr_b16 v[252:253], v27 offset:17440
    ds_read_b64_tr_b16 v[254:255], v27 offset:17568
ch_rj_45:
    s_waitcnt lgkmcnt(0)
    s_waitcnt vmcnt(16)
    s_barrier
    s_mov_b32 s8, s30
    s_mov_b32 s9, s31
    s_mov_b32 s10, 0x400000
    s_mov_b32 s11, 0x00020000
    s_add_u32 m0, s59, 0
    s_add_u32 s55, s54, 0
    buffer_load_dwordx4 v30, s[8:11], s55 offen  lds
    s_add_u32 m0, s59, 1024
    s_add_u32 s55, s54, 8192
    buffer_load_dwordx4 v30, s[8:11], s55 offen  lds
    s_add_u32 m0, s59, 2048
    s_add_u32 s55, s54, 16384
    buffer_load_dwordx4 v30, s[8:11], s55 offen  lds
    s_add_u32 m0, s59, 3072
    s_add_u32 s55, s54, 24576
    buffer_load_dwordx4 v30, s[8:11], s55 offen  lds
    s_add_u32 m0, s59, 4096
    s_add_u32 s55, s54, 32768
    buffer_load_dwordx4 v30, s[8:11], s55 offen  lds
    s_add_u32 m0, s59, 5120
    s_add_u32 s55, s54, 40960
    buffer_load_dwordx4 v30, s[8:11], s55 offen  lds
    s_add_u32 m0, s59, 6144
    s_add_u32 s55, s54, 49152
    buffer_load_dwordx4 v30, s[8:11], s55 offen  lds
    s_add_u32 m0, s59, 7168
    s_add_u32 s55, s54, 57344
    buffer_load_dwordx4 v30, s[8:11], s55 offen  lds
    s_cmp_lg_u32 s4, 0
    s_cbranch_scc1 ch_rn_51
    ds_read_b64_tr_b16 v[144:145], v27 offset:32768
    ds_read_b64_tr_b16 v[146:147], v27 offset:32896
    ds_read_b64_tr_b16 v[148:149], v27 offset:33792
    ds_read_b64_tr_b16 v[150:151], v27 offset:33920
    ds_read_b64_tr_b16 v[208:209], v27 offset:32800
    ds_read_b64_tr_b16 v[210:211], v27 offset:32928
    ds_read_b64_tr_b16 v[212:213], v27 offset:33824
    ds_read_b64_tr_b16 v[214:215], v27 offset:33952
    ds_read_b64_tr_b16 v[152:153], v27 offset:49152
    ds_read_b64_tr_b16 v[154:155], v27 offset:49280
    ds_read_b64_tr_b16 v[156:157], v27 offset:50176
    ds_read_b64_tr_b16 v[158:159], v27 offset:50304
    ds_read_b64_tr_b16 v[216:217], v27 offset:49184
    ds_read_b64_tr_b16 v[218:219], v27 offset:49312
    ds_read_b64_tr_b16 v[220:221], v27 offset:50208
    ds_read_b64_tr_b16 v[222:223], v27 offset:50336
    s_branch ch_rj_50
ch_rn_51:
    s_cmp_lg_u32 s4, 1
    s_cbranch_scc1 ch_rn_52
    ds_read_b64_tr_b16 v[128:129], v27 offset:32768
    ds_read_b64_tr_b16 v[130:131], v27 offset:32896
    ds_read_b64_tr_b16 v[132:133], v27 offset:33792
    ds_read_b64_tr_b16 v[134:135], v27 offset:33920
    ds_read_b64_tr_b16 v[192:193], v27 offset:32800
    ds_read_b64_tr_b16 v[194:195], v27 offset:32928
    ds_read_b64_tr_b16 v[196:197], v27 offset:33824
    ds_read_b64_tr_b16 v[198:199], v27 offset:33952
    ds_read_b64_tr_b16 v[136:137], v27 offset:49152
    ds_read_b64_tr_b16 v[138:139], v27 offset:49280
    ds_read_b64_tr_b16 v[140:141], v27 offset:50176
    ds_read_b64_tr_b16 v[142:143], v27 offset:50304
    ds_read_b64_tr_b16 v[200:201], v27 offset:49184
    ds_read_b64_tr_b16 v[202:203], v27 offset:49312
    ds_read_b64_tr_b16 v[204:205], v27 offset:50208
    ds_read_b64_tr_b16 v[206:207], v27 offset:50336
    s_branch ch_rj_50
ch_rn_52:
    s_cmp_lg_u32 s4, 2
    s_cbranch_scc1 ch_rn_53
    ds_read_b64_tr_b16 v[176:177], v27 offset:32768
    ds_read_b64_tr_b16 v[178:179], v27 offset:32896
    ds_read_b64_tr_b16 v[180:181], v27 offset:33792
    ds_read_b64_tr_b16 v[182:183], v27 offset:33920
    ds_read_b64_tr_b16 v[240:241], v27 offset:32800
    ds_read_b64_tr_b16 v[242:243], v27 offset:32928
    ds_read_b64_tr_b16 v[244:245], v27 offset:33824
    ds_read_b64_tr_b16 v[246:247], v27 offset:33952
    ds_read_b64_tr_b16 v[184:185], v27 offset:49152
    ds_read_b64_tr_b16 v[186:187], v27 offset:49280
    ds_read_b64_tr_b16 v[188:189], v27 offset:50176
    ds_read_b64_tr_b16 v[190:191], v27 offset:50304
    ds_read_b64_tr_b16 v[248:249], v27 offset:49184
    ds_read_b64_tr_b16 v[250:251], v27 offset:49312
    ds_read_b64_tr_b16 v[252:253], v27 offset:50208
    ds_read_b64_tr_b16 v[254:255], v27 offset:50336
    s_branch ch_rj_50
ch_rn_53:
    ds_read_b64_tr_b16 v[160:161], v27 offset:32768
    ds_read_b64_tr_b16 v[162:163], v27 offset:32896
    ds_read_b64_tr_b16 v[164:165], v27 offset:33792
    ds_read_b64_tr_b16 v[166:167], v27 offset:33920
    ds_read_b64_tr_b16 v[224:225], v27 offset:32800
    ds_read_b64_tr_b16 v[226:227], v27 offset:32928
    ds_read_b64_tr_b16 v[228:229], v27 offset:33824
    ds_read_b64_tr_b16 v[230:231], v27 offset:33952
    ds_read_b64_tr_b16 v[168:169], v27 offset:49152
    ds_read_b64_tr_b16 v[170:171], v27 offset:49280
    ds_read_b64_tr_b16 v[172:173], v27 offset:50176
    ds_read_b64_tr_b16 v[174:175], v27 offset:50304
    ds_read_b64_tr_b16 v[232:233], v27 offset:49184
    ds_read_b64_tr_b16 v[234:235], v27 offset:49312
    ds_read_b64_tr_b16 v[236:237], v27 offset:50208
    ds_read_b64_tr_b16 v[238:239], v27 offset:50336
ch_rj_50:
    s_waitcnt lgkmcnt(0)
    v_bfe_u32 v18, v17, 2, 2
    v_lshlrev_b32 v21, 8, v18
    v_bfe_u32 v18, v17, 0, 2
    v_lshl_add_u32 v21, v18, 4, v21
    v_bfe_u32 v18, v17, 5, 1
    v_lshl_add_u32 v21, v18, 3, v21
    v_bfe_u32 v18, v17, 4, 1
    v_lshl_add_u32 v21, v18, 2, v21
    s_lshl_b32 s56, s4, 11
    s_add_u32 s56, s56, 131072
    v_add_u32_e64 v21, s56, v21
    ds_write_b16 v21, v48 offset:0
    ds_write_b16 v21, v49 offset:2
    ds_write_b16 v21, v50 offset:64
    ds_write_b16 v21, v51 offset:66
    ds_write_b16 v21, v52 offset:128
    ds_write_b16 v21, v53 offset:130
    ds_write_b16 v21, v54 offset:192
    ds_write_b16 v21, v55 offset:194
    ds_write_b16 v21, v56 offset:1024
    ds_write_b16 v21, v57 offset:1026
    ds_write_b16 v21, v58 offset:1088
    ds_write_b16 v21, v59 offset:1090
    ds_write_b16 v21, v60 offset:1152
    ds_write_b16 v21, v61 offset:1154
    ds_write_b16 v21, v62 offset:1216
    ds_write_b16 v21, v63 offset:1218
    s_waitcnt lgkmcnt(0)
    s_waitcnt vmcnt(16)
    s_barrier
    s_add_u32 m0, s59, 32768
    s_add_u32 s55, s54, 256
    buffer_load_dwordx4 v30, s[8:11], s55 offen  lds
    s_add_u32 m0, s59, 33792
    s_add_u32 s55, s54, 8448
    buffer_load_dwordx4 v30, s[8:11], s55 offen  lds
    s_add_u32 m0, s59, 34816
    s_add_u32 s55, s54, 16640
    buffer_load_dwordx4 v30, s[8:11], s55 offen  lds
    s_add_u32 m0, s59, 35840
    s_add_u32 s55, s54, 24832
    buffer_load_dwordx4 v30, s[8:11], s55 offen  lds
    s_add_u32 m0, s59, 36864
    s_add_u32 s55, s54, 33024
    buffer_load_dwordx4 v30, s[8:11], s55 offen  lds
    s_add_u32 m0, s59, 37888
    s_add_u32 s55, s54, 41216
    buffer_load_dwordx4 v30, s[8:11], s55 offen  lds
    s_add_u32 m0, s59, 38912
    s_add_u32 s55, s54, 49408
    buffer_load_dwordx4 v30, s[8:11], s55 offen  lds
    s_add_u32 m0, s59, 39936
    s_add_u32 s55, s54, 57600
    buffer_load_dwordx4 v30, s[8:11], s55 offen  lds
    s_cmp_lg_u32 s4, 0
    s_cbranch_scc1 ch_rn_56
    ds_read_b64_tr_b16 v[160:161], v26 offset:0
    ds_read_b64_tr_b16 v[162:163], v26 offset:128
    ds_read_b64_tr_b16 v[164:165], v26 offset:1024
    ds_read_b64_tr_b16 v[166:167], v26 offset:1152
    ds_read_b64_tr_b16 v[224:225], v26 offset:32
    ds_read_b64_tr_b16 v[226:227], v26 offset:160
    ds_read_b64_tr_b16 v[228:229], v26 offset:1056
    ds_read_b64_tr_b16 v[230:231], v26 offset:1184
    ds_read_b64_tr_b16 v[168:169], v26 offset:16384
    ds_read_b64_tr_b16 v[170:171], v26 offset:16512
    ds_read_b64_tr_b16 v[172:173], v26 offset:17408
    ds_read_b64_tr_b16 v[174:175], v26 offset:17536
    ds_read_b64_tr_b16 v[232:233], v26 offset:16416
    ds_read_b64_tr_b16 v[234:235], v26 offset:16544
    ds_read_b64_tr_b16 v[236:237], v26 offset:17440
    ds_read_b64_tr_b16 v[238:239], v26 offset:17568
    s_branch ch_rj_55
ch_rn_56:
    s_cmp_lg_u32 s4, 1
    s_cbranch_scc1 ch_rn_57
    ds_read_b64_tr_b16 v[176:177], v26 offset:0
    ds_read_b64_tr_b16 v[178:179], v26 offset:128
    ds_read_b64_tr_b16 v[180:181], v26 offset:1024
    ds_read_b64_tr_b16 v[182:183], v26 offset:1152
    ds_read_b64_tr_b16 v[240:241], v26 offset:32
    ds_read_b64_tr_b16 v[242:243], v26 offset:160
    ds_read_b64_tr_b16 v[244:245], v26 offset:1056
    ds_read_b64_tr_b16 v[246:247], v26 offset:1184
    ds_read_b64_tr_b16 v[184:185], v26 offset:16384
    ds_read_b64_tr_b16 v[186:187], v26 offset:16512
    ds_read_b64_tr_b16 v[188:189], v26 offset:17408
    ds_read_b64_tr_b16 v[190:191], v26 offset:17536
    ds_read_b64_tr_b16 v[248:249], v26 offset:16416
    ds_read_b64_tr_b16 v[250:251], v26 offset:16544
    ds_read_b64_tr_b16 v[252:253], v26 offset:17440
    ds_read_b64_tr_b16 v[254:255], v26 offset:17568
    s_branch ch_rj_55
ch_rn_57:
    s_cmp_lg_u32 s4, 2
    s_cbranch_scc1 ch_rn_58
    ds_read_b64_tr_b16 v[128:129], v26 offset:0
    ds_read_b64_tr_b16 v[130:131], v26 offset:128
    ds_read_b64_tr_b16 v[132:133], v26 offset:1024
    ds_read_b64_tr_b16 v[134:135], v26 offset:1152
    ds_read_b64_tr_b16 v[192:193], v26 offset:32
    ds_read_b64_tr_b16 v[194:195], v26 offset:160
    ds_read_b64_tr_b16 v[196:197], v26 offset:1056
    ds_read_b64_tr_b16 v[198:199], v26 offset:1184
    ds_read_b64_tr_b16 v[136:137], v26 offset:16384
    ds_read_b64_tr_b16 v[138:139], v26 offset:16512
    ds_read_b64_tr_b16 v[140:141], v26 offset:17408
    ds_read_b64_tr_b16 v[142:143], v26 offset:17536
    ds_read_b64_tr_b16 v[200:201], v26 offset:16416
    ds_read_b64_tr_b16 v[202:203], v26 offset:16544
    ds_read_b64_tr_b16 v[204:205], v26 offset:17440
    ds_read_b64_tr_b16 v[206:207], v26 offset:17568
    s_branch ch_rj_55
ch_rn_58:
    ds_read_b64_tr_b16 v[144:145], v26 offset:0
    ds_read_b64_tr_b16 v[146:147], v26 offset:128
    ds_read_b64_tr_b16 v[148:149], v26 offset:1024
    ds_read_b64_tr_b16 v[150:151], v26 offset:1152
    ds_read_b64_tr_b16 v[208:209], v26 offset:32
    ds_read_b64_tr_b16 v[210:211], v26 offset:160
    ds_read_b64_tr_b16 v[212:213], v26 offset:1056
    ds_read_b64_tr_b16 v[214:215], v26 offset:1184
    ds_read_b64_tr_b16 v[152:153], v26 offset:16384
    ds_read_b64_tr_b16 v[154:155], v26 offset:16512
    ds_read_b64_tr_b16 v[156:157], v26 offset:17408
    ds_read_b64_tr_b16 v[158:159], v26 offset:17536
    ds_read_b64_tr_b16 v[216:217], v26 offset:16416
    ds_read_b64_tr_b16 v[218:219], v26 offset:16544
    ds_read_b64_tr_b16 v[220:221], v26 offset:17440
    ds_read_b64_tr_b16 v[222:223], v26 offset:17568
ch_rj_55:
    s_waitcnt lgkmcnt(0)
    v_readfirstlane_b32 s48, v23
    s_nop 0
    s_cmp_ge_u32 s48, 1
    s_cbranch_scc1 ch_ini_60
    s_mov_b32 s49, 0
sp_61:
    buffer_load_dword v20, off, s[16:19], 0 offset:196 sc1
    s_waitcnt vmcnt(0)
    v_readfirstlane_b32 s48, v20
    s_nop 0
    s_cmp_ge_u32 s48, 1
    s_cbranch_scc1 spd_62
    s_add_u32 s49, s49, 1
    s_sleep 1
    s_cmp_lt_u32 s49, 32768
    s_cbranch_scc1 sp_61
spd_62:
ch_ini_60:
    s_waitcnt vmcnt(16)
    s_barrier
    s_add_u32 m0, s59, 65536
    s_add_u32 s55, s54, 512
    buffer_load_dwordx4 v30, s[8:11], s55 offen  lds
    s_add_u32 m0, s59, 66560
    s_add_u32 s55, s54, 8704
    buffer_load_dwordx4 v30, s[8:11], s55 offen  lds
    s_add_u32 m0, s59, 67584
    s_add_u32 s55, s54, 16896
    buffer_load_dwordx4 v30, s[8:11], s55 offen  lds
    s_add_u32 m0, s59, 68608
    s_add_u32 s55, s54, 25088
    buffer_load_dwordx4 v30, s[8:11], s55 offen  lds
    s_add_u32 m0, s59, 69632
    s_add_u32 s55, s54, 33280
    buffer_load_dwordx4 v30, s[8:11], s55 offen  lds
    s_add_u32 m0, s59, 70656
    s_add_u32 s55, s54, 41472
    buffer_load_dwordx4 v30, s[8:11], s55 offen  lds
    s_add_u32 m0, s59, 71680
    s_add_u32 s55, s54, 49664
    buffer_load_dwordx4 v30, s[8:11], s55 offen  lds
    s_add_u32 m0, s59, 72704
    s_add_u32 s55, s54, 57856
    buffer_load_dwordx4 v30, s[8:11], s55 offen  lds
    s_cmp_lg_u32 s4, 0
    s_cbranch_scc1 ch_rn_64
    ds_read_b64_tr_b16 v[176:177], v26 offset:32768
    ds_read_b64_tr_b16 v[178:179], v26 offset:32896
    ds_read_b64_tr_b16 v[180:181], v26 offset:33792
    ds_read_b64_tr_b16 v[182:183], v26 offset:33920
    ds_read_b64_tr_b16 v[240:241], v26 offset:32800
    ds_read_b64_tr_b16 v[242:243], v26 offset:32928
    ds_read_b64_tr_b16 v[244:245], v26 offset:33824
    ds_read_b64_tr_b16 v[246:247], v26 offset:33952
    ds_read_b64_tr_b16 v[184:185], v26 offset:49152
    ds_read_b64_tr_b16 v[186:187], v26 offset:49280
    ds_read_b64_tr_b16 v[188:189], v26 offset:50176
    ds_read_b64_tr_b16 v[190:191], v26 offset:50304
    ds_read_b64_tr_b16 v[248:249], v26 offset:49184
    ds_read_b64_tr_b16 v[250:251], v26 offset:49312
    ds_read_b64_tr_b16 v[252:253], v26 offset:50208
    ds_read_b64_tr_b16 v[254:255], v26 offset:50336
    s_branch ch_rj_63
ch_rn_64:
    s_cmp_lg_u32 s4, 1
    s_cbranch_scc1 ch_rn_65
    ds_read_b64_tr_b16 v[160:161], v26 offset:32768
    ds_read_b64_tr_b16 v[162:163], v26 offset:32896
    ds_read_b64_tr_b16 v[164:165], v26 offset:33792
    ds_read_b64_tr_b16 v[166:167], v26 offset:33920
    ds_read_b64_tr_b16 v[224:225], v26 offset:32800
    ds_read_b64_tr_b16 v[226:227], v26 offset:32928
    ds_read_b64_tr_b16 v[228:229], v26 offset:33824
    ds_read_b64_tr_b16 v[230:231], v26 offset:33952
    ds_read_b64_tr_b16 v[168:169], v26 offset:49152
    ds_read_b64_tr_b16 v[170:171], v26 offset:49280
    ds_read_b64_tr_b16 v[172:173], v26 offset:50176
    ds_read_b64_tr_b16 v[174:175], v26 offset:50304
    ds_read_b64_tr_b16 v[232:233], v26 offset:49184
    ds_read_b64_tr_b16 v[234:235], v26 offset:49312
    ds_read_b64_tr_b16 v[236:237], v26 offset:50208
    ds_read_b64_tr_b16 v[238:239], v26 offset:50336
    s_branch ch_rj_63
ch_rn_65:
    s_cmp_lg_u32 s4, 2
    s_cbranch_scc1 ch_rn_66
    ds_read_b64_tr_b16 v[144:145], v26 offset:32768
    ds_read_b64_tr_b16 v[146:147], v26 offset:32896
    ds_read_b64_tr_b16 v[148:149], v26 offset:33792
    ds_read_b64_tr_b16 v[150:151], v26 offset:33920
    ds_read_b64_tr_b16 v[208:209], v26 offset:32800
    ds_read_b64_tr_b16 v[210:211], v26 offset:32928
    ds_read_b64_tr_b16 v[212:213], v26 offset:33824
    ds_read_b64_tr_b16 v[214:215], v26 offset:33952
    ds_read_b64_tr_b16 v[152:153], v26 offset:49152
    ds_read_b64_tr_b16 v[154:155], v26 offset:49280
    ds_read_b64_tr_b16 v[156:157], v26 offset:50176
    ds_read_b64_tr_b16 v[158:159], v26 offset:50304
    ds_read_b64_tr_b16 v[216:217], v26 offset:49184
    ds_read_b64_tr_b16 v[218:219], v26 offset:49312
    ds_read_b64_tr_b16 v[220:221], v26 offset:50208
    ds_read_b64_tr_b16 v[222:223], v26 offset:50336
    s_branch ch_rj_63
ch_rn_66:
    ds_read_b64_tr_b16 v[128:129], v26 offset:32768
    ds_read_b64_tr_b16 v[130:131], v26 offset:32896
    ds_read_b64_tr_b16 v[132:133], v26 offset:33792
    ds_read_b64_tr_b16 v[134:135], v26 offset:33920
    ds_read_b64_tr_b16 v[192:193], v26 offset:32800
    ds_read_b64_tr_b16 v[194:195], v26 offset:32928
    ds_read_b64_tr_b16 v[196:197], v26 offset:33824
    ds_read_b64_tr_b16 v[198:199], v26 offset:33952
    ds_read_b64_tr_b16 v[136:137], v26 offset:49152
    ds_read_b64_tr_b16 v[138:139], v26 offset:49280
    ds_read_b64_tr_b16 v[140:141], v26 offset:50176
    ds_read_b64_tr_b16 v[142:143], v26 offset:50304
    ds_read_b64_tr_b16 v[200:201], v26 offset:49184
    ds_read_b64_tr_b16 v[202:203], v26 offset:49312
    ds_read_b64_tr_b16 v[204:205], v26 offset:50208
    ds_read_b64_tr_b16 v[206:207], v26 offset:50336
ch_rj_63:
    s_waitcnt lgkmcnt(0)
    s_barrier
    s_add_u32 m0, s59, 98304
    s_add_u32 s55, s54, 768
    buffer_load_dwordx4 v30, s[8:11], s55 offen  lds
    s_add_u32 m0, s59, 99328
    s_add_u32 s55, s54, 8960
    buffer_load_dwordx4 v30, s[8:11], s55 offen  lds
    s_add_u32 m0, s59, 100352
    s_add_u32 s55, s54, 17152
    buffer_load_dwordx4 v30, s[8:11], s55 offen  lds
    s_add_u32 m0, s59, 101376
    s_add_u32 s55, s54, 25344
    buffer_load_dwordx4 v30, s[8:11], s55 offen  lds
    s_add_u32 m0, s59, 102400
    s_add_u32 s55, s54, 33536
    buffer_load_dwordx4 v30, s[8:11], s55 offen  lds
    s_add_u32 m0, s59, 103424
    s_add_u32 s55, s54, 41728
    buffer_load_dwordx4 v30, s[8:11], s55 offen  lds
    s_add_u32 m0, s59, 104448
    s_add_u32 s55, s54, 49920
    buffer_load_dwordx4 v30, s[8:11], s55 offen  lds
    s_add_u32 m0, s59, 105472
    s_add_u32 s55, s54, 58112
    buffer_load_dwordx4 v30, s[8:11], s55 offen  lds
    s_lshl_b32 s49, s3, 19
    s_lshl_b32 s48, s4, 11
    s_add_u32 s25, s49, s48
    s_add_u32 s26, s25, 33554432
    s_add_u32 s25, s25, 16777216
    s_add_u32 s27, s48, 147456
    s_add_u32 s28, s48, 155648
    s_lshl_b32 s29, s3, 13
    s_add_u32 s29, s29, s48
    s_add_u32 s29, s29, 144572416
    s_and_b32 s48, s4, 1
    s_lshl_b32 s48, s48, 12
    s_add_u32 s24, s49, s48
    s_lshr_b32 s48, s4, 1
    s_mul_i32 s48, s48, 16777216
    s_add_u32 s24, s24, s48
    s_add_u32 s24, s24, 16261120
    s_lshl_b32 s23, s3, 12
    s_add_u32 s23, s23, 135135232
    s_mov_b32 s21, 144703488
    s_mov_b32 s22, 144736256
    s_lshl_b32 s33, s4, 6
    s_add_u32 s33, s33, s53
    s_add_u32 s33, s33, 145752064
    s_lshl_b32 s36, s3, 7
    s_add_u32 s37, s36, 146804736
    s_add_u32 s36, s36, 146800640
    s_cmp_lg_u32 s4, 0
    s_cselect_b32 s37, 0x80000000, s37
    v_mov_b32 v121, 0
    s_mov_b32 s49, 0
sp_68:
    buffer_load_dwordx2 v[20:21], off, s[16:19], 0 offset:0 sc1
    buffer_load_dword v22, off, s[12:15], s36 sc1
    s_waitcnt vmcnt(0)
    v_readfirstlane_b32 s48, v21
    s_nop 0
    s_cmp_ge_u32 s48, 128
    s_cbranch_scc1 spd_69
    s_add_u32 s49, s49, 1
    s_sleep 1
    s_cmp_lt_u32 s49, 32768
    s_cbranch_scc1 sp_68
spd_69:
    v_readfirstlane_b32 s60, v20
    s_barrier
    buffer_load_dword v23, off, s[12:15], s36 sc1
    s_mov_b32 m0, s27
    s_nop 0
    buffer_load_dwordx4 v8, s[12:15], s25 offen sc1 lds
    s_add_u32 m0, s27, 896
    s_nop 0
    buffer_load_dwordx4 v8, s[12:15], s25 offen offset:128 sc1 lds
    s_mov_b32 m0, s28
    s_nop 0
    buffer_load_dwordx4 v9, s[12:15], s26 offen sc1 lds
    s_add_u32 m0, s28, 768
    s_nop 0
    buffer_load_dwordx4 v9, s[12:15], s26 offen offset:256 sc1 lds
    v_mov_b32 v24, 1
    buffer_store_dword v24, off, s[12:15], s37 offset:64 sc1
    ds_read_b64_tr_b16 a[0:1], v31 offset:0
    ds_read_b64_tr_b16 a[2:3], v31 offset:256
    ds_read_b64_tr_b16 a[4:5], v31 offset:1024
    ds_read_b64_tr_b16 a[6:7], v31 offset:1280
    ds_read_b64_tr_b16 a[8:9], v31 offset:4096
    ds_read_b64_tr_b16 a[10:11], v31 offset:4352
    ds_read_b64_tr_b16 a[12:13], v31 offset:5120
    ds_read_b64_tr_b16 a[14:15], v31 offset:5376
    ds_read_b64_tr_b16 a[16:17], v31 offset:8192
    ds_read_b64_tr_b16 a[18:19], v31 offset:8448
    ds_read_b64_tr_b16 a[20:21], v31 offset:9216
    ds_read_b64_tr_b16 a[22:23], v31 offset:9472
    ds_read_b64_tr_b16 a[64:65], v31 offset:12288
    ds_read_b64_tr_b16 a[66:67], v31 offset:12544
    ds_read_b64_tr_b16 a[68:69], v31 offset:13312
    ds_read_b64_tr_b16 a[70:71], v31 offset:13568
    ds_read_b64_tr_b16 a[72:73], v31 offset:64
    ds_read_b64_tr_b16 a[74:75], v31 offset:320
    ds_read_b64_tr_b16 a[76:77], v31 offset:1088
    ds_read_b64_tr_b16 a[78:79], v31 offset:1344
    ds_read_b64_tr_b16 a[80:81], v31 offset:4160
    ds_read_b64_tr_b16 a[82:83], v31 offset:4416
    ds_read_b64_tr_b16 a[84:85], v31 offset:5184
    ds_read_b64_tr_b16 a[86:87], v31 offset:5440
    ds_read_b64_tr_b16 v[32:33], v31 offset:8256
    ds_read_b64_tr_b16 v[34:35], v31 offset:8512
    ds_read_b64_tr_b16 v[36:37], v31 offset:9280
    ds_read_b64_tr_b16 v[38:39], v31 offset:9536
    ds_read_b64_tr_b16 v[40:41], v31 offset:12352
    ds_read_b64_tr_b16 v[42:43], v31 offset:12608
    ds_read_b64_tr_b16 v[44:45], v31 offset:13376
    ds_read_b64_tr_b16 v[46:47], v31 offset:13632
    s_waitcnt lgkmcnt(0)
    ds_write_b128 v7, v[32:35] offset:0
    ds_write_b128 v7, v[36:39] offset:1024
    ds_write_b128 v7, v[40:43] offset:2048
    ds_write_b128 v7, v[44:47] offset:3072
    s_waitcnt lgkmcnt(0)
    v_readfirstlane_b32 s61, v22
    s_nop 0
    s_cmp_ge_u32 s61, 2
    s_cbranch_scc1 ch_k2_70
    s_waitcnt vmcnt(0)
    v_readfirstlane_b32 s61, v23
    s_mov_b32 m0, s27
    s_nop 0
    buffer_load_dwordx4 v8, s[12:15], s25 offen sc1 lds
    s_add_u32 m0, s27, 896
    s_nop 0
    buffer_load_dwordx4 v8, s[12:15], s25 offen offset:128 sc1 lds
    s_mov_b32 m0, s28
    s_nop 0
    buffer_load_dwordx4 v9, s[12:15], s26 offen sc1 lds
    s_add_u32 m0, s28, 768
    s_nop 0
    buffer_load_dwordx4 v9, s[12:15], s26 offen offset:256 sc1 lds
ch_k2_70:
    ds_read_b64_tr_b16 v[32:33], v31 offset:16384
    ds_read_b64_tr_b16 v[34:35], v31 offset:16640
    ds_read_b64_tr_b16 v[36:37], v31 offset:17408
    ds_read_b64_tr_b16 v[38:39], v31 offset:17664
    ds_read_b64_tr_b16 v[40:41], v31 offset:20480
    ds_read_b64_tr_b16 v[42:43], v31 offset:20736
    ds_read_b64_tr_b16 v[44:45], v31 offset:21504
    ds_read_b64_tr_b16 v[46:47], v31 offset:21760
    ds_read_b64_tr_b16 v[48:49], v31 offset:24576
    ds_read_b64_tr_b16 v[50:51], v31 offset:24832
    ds_read_b64_tr_b16 v[52:53], v31 offset:25600
    ds_read_b64_tr_b16 v[54:55], v31 offset:25856
    ds_read_b64_tr_b16 v[56:57], v31 offset:28672
    ds_read_b64_tr_b16 v[58:59], v31 offset:28928
    ds_read_b64_tr_b16 v[60:61], v31 offset:29696
    ds_read_b64_tr_b16 v[62:63], v31 offset:29952
    s_waitcnt lgkmcnt(0)
    ds_write_b128 v7, v[32:35] offset:4096
    ds_write_b128 v7, v[36:39] offset:5120
    ds_write_b128 v7, v[40:43] offset:6144
    ds_write_b128 v7, v[44:47] offset:7168
    ds_write_b128 v7, v[48:51] offset:8192
    ds_write_b128 v7, v[52:55] offset:9216
    ds_write_b128 v7, v[56:59] offset:10240
    ds_write_b128 v7, v[60:63] offset:11264
    s_waitcnt lgkmcnt(0)
    ds_read_b64_tr_b16 v[32:33], v31 offset:16448
    ds_read_b64_tr_b16 v[34:35], v31 offset:16704
    ds_read_b64_tr_b16 v[36:37], v31 offset:17472
    ds_read_b64_tr_b16 v[38:39], v31 offset:17728
    ds_read_b64_tr_b16 v[40:41], v31 offset:20544
    ds_read_b64_tr_b16 v[42:43], v31 offset:20800
    ds_read_b64_tr_b16 v[44:45], v31 offset:21568
    ds_read_b64_tr_b16 v[46:47], v31 offset:21824
    ds_read_b64_tr_b16 v[48:49], v31 offset:24640
    ds_read_b64_tr_b16 v[50:51], v31 offset:24896
    ds_read_b64_tr_b16 v[52:53], v31 offset:25664
    ds_read_b64_tr_b16 v[54:55], v31 offset:25920
    ds_read_b64_tr_b16 v[56:57], v31 offset:28736
    ds_read_b64_tr_b16 v[58:59], v31 offset:28992
    ds_read_b64_tr_b16 v[60:61], v31 offset:29760
    ds_read_b64_tr_b16 v[62:63], v31 offset:30016
    s_waitcnt lgkmcnt(0)
    ds_write_b128 v7, v[32:35] offset:12288
    ds_write_b128 v7, v[36:39] offset:13312
    ds_write_b128 v7, v[40:43] offset:14336
    ds_write_b128 v7, v[44:47] offset:15360
    ds_write_b128 v7, v[48:51] offset:16384
    ds_write_b128 v7, v[52:55] offset:17408
    ds_write_b128 v7, v[56:59] offset:18432
    ds_write_b128 v7, v[60:63] offset:19456
    s_waitcnt lgkmcnt(0)
    ds_write_b128 v7, v[88:91] offset:20480
    ds_write_b128 v7, v[92:95] offset:21504
    ds_write_b128 v7, v[96:99] offset:22528
    ds_write_b128 v7, v[100:103] offset:23552
    ds_write_b128 v7, v[104:107] offset:24576
    ds_write_b128 v7, v[108:111] offset:25600
    ds_write_b128 v7, v[112:115] offset:26624
    ds_write_b128 v7, v[116:119] offset:27648
    ds_write_b128 v7, v[72:75] offset:28672
    ds_write_b128 v7, v[76:79] offset:29696
    ds_write_b128 v7, v[80:83] offset:30720
    ds_write_b128 v7, v[84:87] offset:31744
    s_waitcnt lgkmcnt(0)
    s_cmp_ge_u32 s61, 2
    s_cbranch_scc1 ch_k3_71
    s_mov_b32 s49, 0
sp_72:
    buffer_load_dword v20, off, s[12:15], s36 offset:0 sc1
    s_waitcnt vmcnt(0)
    v_readfirstlane_b32 s48, v20
    s_nop 0
    s_cmp_ge_u32 s48, 2
    s_cbranch_scc1 spd_73
    s_add_u32 s49, s49, 1
    s_sleep 1
    s_cmp_lt_u32 s49, 32768
    s_cbranch_scc1 sp_72
spd_73:
    s_mov_b32 m0, s27
    s_nop 0
    buffer_load_dwordx4 v8, s[12:15], s25 offen sc1 lds
    s_add_u32 m0, s27, 896
    s_nop 0
    buffer_load_dwordx4 v8, s[12:15], s25 offen offset:128 sc1 lds
    s_mov_b32 m0, s28
    s_nop 0
    buffer_load_dwordx4 v9, s[12:15], s26 offen sc1 lds
    s_add_u32 m0, s28, 768
    s_nop 0
    buffer_load_dwordx4 v9, s[12:15], s26 offen offset:256 sc1 lds
ch_k3_71:
    s_add_u32 s25, s25, 8192
    s_add_u32 s26, s26, 8192
    s_mov_b32 s20, 0
    v_mov_b64 v[48:49], 0
    v_mov_b64 v[50:51], 0
    v_mov_b64 v[52:53], 0
    v_mov_b64 v[54:55], 0
    v_lshlrev_b32 v120, 2, v3
    s_waitcnt vmcnt(0) lgkmcnt(0)
    s_cmp_lt_u32 s60, 32
    s_cbranch_scc1 ch_slow_75
    s_lshr_b32 s34, s3, 1
    s_lshl_b32 s34, s34, 7
    s_add_u32 s34, s34, 146808832
    s_bitcmp1_b32 s3, 2
    s_cselect_b64 s[38:39], -1, 1
    s_mov_b32 s51, 0x80000000
    s_mov_b32 s58, 0x80000000
    v_xor_b32 v122, 2048, v2
    v_xor_b32 v123, 4096, v2
    v_xor_b32 v47, 6144, v2
    s_sub_u32 s54, s36, s24
    v_writelane_b32 v120, s54, 1
    s_cmp_eq_u32 s4, 0
    s_cselect_b32 s62, 4, 0
    s_or_b32 s60, s40, s62
    s_mov_b32 s61, s41
    s_mov_b32 s62, 0
    s_mov_b32 s63, 0
    s_branch ch_first_77
.p2align 6
ch_loop_76:
    s_sub_u32 s51, s23, 65536
    s_lshr_b32 s58, s35, 0
    s_add_u32 s58, s58, s23
    s_sub_u32 s58, s58, 138752
    v_mov_b64 v[48:49], 0
    v_mov_b64 v[50:51], 0
    v_mov_b64 v[52:53], 0
    v_mov_b64 v[54:55], 0
    v_mov_b64 v[42:43], -1
    v_lshlrev_b32 v120, 2, v3
    v_and_b32 v120, 0xffffff80, v120
    s_xor_b32 s48, s52, 16384
    s_add_u32 s48, s48, s33
    ds_read_b128 v[88:91], v7 offset:20480
    s_waitcnt lgkmcnt(0)
    ds_read_b128 v[92:95], v7 offset:21504
    s_waitcnt lgkmcnt(0)
    ds_read_b128 v[96:99], v7 offset:22528
    s_waitcnt lgkmcnt(0)
    buffer_load_dwordx4 v[20:23], v3, s[12:15], s29 offen offset:0 sc1
    buffer_load_dwordx4 v[24:27], v3, s[12:15], s29 offen offset:1024 sc1
    v_xor_b32 v122, 2048, v2
    v_xor_b32 v123, 4096, v2
    v_xor_b32 v47, 6144, v2
    ds_read_b128 v[100:103], v7 offset:23552
    s_waitcnt lgkmcnt(0)
    ds_read_b128 v[104:107], v7 offset:24576
    s_waitcnt lgkmcnt(0)
    v_not_b32 v28, s32
    s_mov_b64 exec, s[38:39]
    buffer_load_dwordx4 v[28:31], v3, s[12:15], s29 offen offset:0 sc1
    buffer_load_dwordx4 v[32:35], v3, s[12:15], s29 offen offset:1024 sc1
    s_mov_b64 exec, -1
    s_waitcnt vmcnt(3)
    v_mfma_f32_16x16x32_bf16 v[36:39], v[12:15], v[20:23], 0
    s_waitcnt vmcnt(2)
    v_mfma_f32_16x16x32_bf16 v[36:39], v[12:15], v[24:27], v[36:39]
    v_bitop3_b32 v40, v20, v24, s32 bitop3:0x7e
    v_and_b32 v40, 1, v40
    v_cmp_ne_u32 vcc, 0, v40
    s_cbranch_vccnz ch_red_rt_80
ch_red_ok_79:
    s_nop 3
    v_add_f32_dpp v36, v36, v36 row_ror:4 row_mask:0xf bank_mask:0xf
    v_add_f32_dpp v37, v37, v37 row_ror:4 row_mask:0xf bank_mask:0xf
    v_add_f32_dpp v38, v38, v38 row_ror:4 row_mask:0xf bank_mask:0xf
    v_add_f32_dpp v39, v39, v39 row_ror:4 row_mask:0xf bank_mask:0xf
    v_add_f32_dpp v36, v36, v36 row_ror:8 row_mask:0xf bank_mask:0xf
    v_add_f32_dpp v37, v37, v37 row_ror:8 row_mask:0xf bank_mask:0xf
    v_add_f32_dpp v38, v38, v38 row_ror:8 row_mask:0xf bank_mask:0xf
    v_add_f32_dpp v39, v39, v39 row_ror:8 row_mask:0xf bank_mask:0xf
    v_cvt_pk_bf16_f32 v36, v36, v37
    v_cvt_pk_bf16_f32 v37, v38, v39
    s_mov_b64 exec, 0x000f000f
    buffer_store_dwordx2 v[36:37], v126, s[12:15], s31 offen
ch_red_af_82:
    buffer_store_dwordx2 v[42:43], v126, s[12:15], s48 offen
    s_mov_b64 exec, -1
    v_readlane_b32 s55, v127, 1
    s_add_u32 s53, s20, 2
    s_min_u32 s53, s53, 64
    s_sub_u32 s54, s20, 1
    v_mov_b32 v121, s54
    s_mov_b32 s63, s54
    s_sub_u32 s62, s37, s58
    s_cmp_lt_u32 s55, s53
    s_cbranch_scc1 ch_fw_83
ch_fb_84:
    s_cmp_eq_u32 s53, 51
    s_cselect_b32 s54, 4, 0
    s_add_u32 s36, s36, s54
    s_cmp_eq_u32 s20, 62
    s_cselect_b32 s36, s34, s36
    s_sub_u32 s54, s36, s24
    v_writelane_b32 v120, s54, 1
    s_cmp_eq_u32 s20, 63
    s_cbranch_scc1 ch_last_78
    ds_read_b128 v[108:111], v7 offset:25600
    s_waitcnt lgkmcnt(0)
    ds_read_b128 v[112:115], v7 offset:26624
    s_waitcnt lgkmcnt(0)
    buffer_load_dwordx4 v[64:67], v0, s[12:15], s30 offen offset:0 sc1
    buffer_load_dwordx4 v[68:71], v0, s[12:15], s30 offen offset:1024 sc1
    ds_read_b128 v[116:119], v7 offset:27648
    ds_read_b128 v[72:75], v7 offset:28672
    s_waitcnt lgkmcnt(0)
    ds_read_b128 v[76:79], v7 offset:29696
    ds_read_b128 v[80:83], v7 offset:30720
    ds_read_b128 v[84:87], v7 offset:31744
    s_waitcnt lgkmcnt(0)
    buffer_load_dwordx4 v[56:59], v0, s[12:15], s30 offen offset:0 sc1
    buffer_load_dwordx4 v[60:63], v0, s[12:15], s30 offen offset:1024 sc1
    s_waitcnt vmcnt(3)
    ds_write_b128 v0, v[64:67] offset:0
    s_waitcnt vmcnt(2)
    ds_write_b128 v0, v[68:71] offset:1024
    ds_read_b64_tr_b16 v[16:17], v2 offset:0
    ds_read_b64_tr_b16 v[18:19], v2 offset:512
    ds_read_b64_tr_b16 v[20:21], v2 offset:1024
    ds_read_b64_tr_b16 v[22:23], v2 offset:1536
    v_max3_u32 v40, v64, v66, v68
    v_max_u32 v40, v40, v70
    v_cmp_eq_u32 vcc, -1, v40
    s_cbranch_vccnz ch_pl_rt_86
ch_pl_ok_85:
ch_pl_af_88:
ch_j1_89:
    s_waitcnt lgkmcnt(2)
    v_smfmac_f32_16x16x64_bf16 v[48:51], v[16:19], v[88:95], v1
    s_barrier
    ds_read_b64_tr_b16 v[24:25], v122 offset:0
    ds_read_b64_tr_b16 v[26:27], v122 offset:512
    v_smfmac_f32_16x16x64_bf16 v[52:55], v[16:19], v[96:103], v1
    s_waitcnt lgkmcnt(2)
    ds_read_b64_tr_b16 v[28:29], v122 offset:1024
    ds_read_b64_tr_b16 v[30:31], v122 offset:1536
    ds_read_b64_tr_b16 v[32:33], v123 offset:0
    v_smfmac_f32_16x16x64_bf16 v[48:51], v[20:23], v[104:111], v1
    s_add_u32 s52, s20, 1
    ds_read_b64_tr_b16 v[34:35], v123 offset:512
    ds_read_b64_tr_b16 v[36:37], v123 offset:1024
    v_smfmac_f32_16x16x64_bf16 v[52:55], v[20:23], v[112:119], v1
    s_waitcnt lgkmcnt(5)
    ds_read_b64_tr_b16 v[38:39], v123 offset:1536
    ds_read_b64_tr_b16 v[40:41], v47 offset:0
    buffer_load_dword v127, v120, s[12:15], s24 offen sc1
    v_smfmac_f32_16x16x64_bf16 v[48:51], v[24:27], v[72:79], v1
    s_waitcnt vmcnt(1)
    ds_read_b64_tr_b16 v[42:43], v47 offset:512
    v_mov_b64 v[56:57], 0
    v_smfmac_f32_16x16x64_bf16 v[52:55], v[24:27], v[80:87], v1
    s_waitcnt lgkmcnt(6)
    ds_read_b64_tr_b16 v[44:45], v47 offset:1024
    v_mov_b64 v[58:59], 0
    v_smfmac_f32_16x16x64_bf16 v[48:51], v[28:31], a[24:31], v1
    s_and_b32 s52, s52, 3
    ds_read_b64_tr_b16 v[46:47], v47 offset:1536
    v_mov_b64 v[60:61], 0
    v_smfmac_f32_16x16x64_bf16 v[52:55], v[28:31], a[88:95], v1
    s_waitcnt lgkmcnt(6)
    v_mov_b64 v[62:63], 0
    v_smfmac_f32_16x16x64_bf16 v[48:51], v[32:35], a[32:39], v1
    s_waitcnt lgkmcnt(4)
    ds_read_b128 v[88:91], v3 offset:16384
    v_mov_b64 v[64:65], 0
    v_smfmac_f32_16x16x64_bf16 v[48:51], v[36:39], a[40:47], v1
    s_waitcnt lgkmcnt(3)
    ds_read_b128 v[92:95], v3 offset:17408
    v_mov_b64 v[66:67], 0
    v_smfmac_f32_16x16x64_bf16 v[48:51], v[40:43], a[48:55], v1
    s_waitcnt lgkmcnt(2)
    ds_read_b128 v[96:99], v3 offset:18432
    v_mov_b64 v[68:69], 0
    v_smfmac_f32_16x16x64_bf16 v[48:51], v[44:47], a[56:63], v1
    s_lshl_b32 s52, s52, 13
    ds_read_b128 v[100:103], v3 offset:19456
    v_mov_b64 v[70:71], 0
    v_smfmac_f32_16x16x64_bf16 v[52:55], v[32:35], a[96:103], v1
    s_add_u32 s30, s52, 145620992
    ds_read_b128 v[104:107], v3 offset:20480
    v_add_u32 v76, s35, v5
    v_smfmac_f32_16x16x64_bf16 v[52:55], v[36:39], a[104:111], v1
    s_add_u32 s31, s52, s33
    ds_read_b128 v[108:111], v3 offset:21504
    v_add_f32 v48, v48, v50
    v_smfmac_f32_16x16x64_bf16 v[52:55], v[40:43], a[112:119], v1
    s_and_b32 s32, s20, 1
    ds_read_b128 v[112:115], v3 offset:22528
    v_add_f32 v49, v49, v51
    v_smfmac_f32_16x16x64_bf16 v[52:55], v[44:47], a[120:127], v1
    s_add_u32 s23, s23, 131072
    ds_read_b128 v[116:119], v3 offset:23552
    v_mul_f32 v48, s46, v48
    v_mul_f32 v49, s46, v49
    v_smfmac_f32_16x16x64_bf16 v[56:59], v[16:19], a[128:135], v1
    ds_read_b64_tr_b16 v[72:73], v76 offset:12288
    v_cvt_pk_bf16_f32 v50, v48, v49
    v_smfmac_f32_16x16x64_bf16 v[60:63], v[16:19], a[192:199], v1
    ds_write2_b32 v4, v50, v50 offset0:0 offset1:1
    v_add_f32 v52, v52, v54
    v_add_f32 v53, v53, v55
    v_mul_f32 v52, s46, v52
    v_smfmac_f32_16x16x64_bf16 v[56:59], v[20:23], a[136:143], v1
    ds_read_b64_tr_b16 v[74:75], v76 offset:12544
    v_mul_f32 v53, s46, v53
    v_cvt_pk_bf16_f32 v54, v52, v53
    v_smfmac_f32_16x16x64_bf16 v[60:63], v[20:23], a[200:207], v1
    ds_write2_b32 v4, v54, v54 offset0:64 offset1:65
    v_lshrrev_b32 v77, 1, v0
    v_smfmac_f32_16x16x64_bf16 v[56:59], v[24:27], a[144:151], v1
    buffer_store_dwordx2 v[124:125], v77, s[12:15], s51 offen sc1
    v_mov_b32 v78, v11
    v_smfmac_f32_16x16x64_bf16 v[60:63], v[24:27], a[208:215], v1
    s_add_u32 s24, s24, 8192
    v_writelane_b32 v78, s62, 2
    v_smfmac_f32_16x16x64_bf16 v[56:59], v[28:31], a[152:159], v1
    s_waitcnt lgkmcnt(3)
    s_mov_b64 exec, s[60:61]
    v_writelane_b32 v72, s63, 2
    v_smfmac_f32_16x16x64_bf16 v[60:63], v[28:31], a[216:223], v1
    s_waitcnt lgkmcnt(0)
    buffer_store_dwordx4 v[72:75], v78, s[12:15], s58 offen sc1
    v_smfmac_f32_16x16x64_bf16 v[56:59], v[32:35], a[160:167], v1
    s_mov_b64 exec, -1
    v_smfmac_f32_16x16x64_bf16 v[56:59], v[36:39], a[168:175], v1
    s_barrier
    ds_read_b64_tr_b16 v[72:73], v5 offset:8192
    v_smfmac_f32_16x16x64_bf16 v[56:59], v[40:43], a[176:183], v1
    ds_read_b64_tr_b16 v[74:75], v5 offset:8448
    v_smfmac_f32_16x16x64_bf16 v[56:59], v[44:47], a[184:191], v1
    ds_read_b64_tr_b16 v[76:77], v5 offset:9216
    v_smfmac_f32_16x16x64_bf16 v[60:63], v[32:35], a[224:231], v1
    ds_read_b64_tr_b16 v[78:79], v5 offset:9472
    v_smfmac_f32_16x16x64_bf16 v[60:63], v[36:39], a[232:239], v1
    s_nop 0
    ds_read_b64_tr_b16 v[80:81], v5 offset:10240
    v_add_f32 v56, v56, v58
    v_smfmac_f32_16x16x64_bf16 v[60:63], v[40:43], a[240:247], v1
    ds_read_b64_tr_b16 v[82:83], v5 offset:10496
    v_add_f32 v57, v57, v59
    v_smfmac_f32_16x16x64_bf16 v[60:63], v[44:47], a[248:255], v1
    s_waitcnt lgkmcnt(4)
    ds_read_b64_tr_b16 v[84:85], v5 offset:11264
    v_cvt_pk_bf16_f32 v58, v56, v57
    v_mfma_f32_16x16x32_bf16 v[48:51], v[88:91], v[72:75], 0
    ds_read_b64_tr_b16 v[86:87], v5 offset:11520
    ds_write_b32 v4, v58 offset:4096
    v_mfma_f32_16x16x32_bf16 v[52:55], v[92:95], v[72:75], 0
    s_waitcnt lgkmcnt(5)
    v_add_f32 v60, v60, v62
    v_add_f32 v61, v61, v63
    v_cvt_pk_bf16_f32 v62, v60, v61
    v_mfma_f32_16x16x32_bf16 v[48:51], v[96:99], v[76:79], v[48:51]
    ds_write_b32 v4, v62 offset:4352
    v_mfma_f32_16x16x32_bf16 v[52:55], v[100:103], v[76:79], v[52:55]
    s_waitcnt lgkmcnt(4)
    v_mfma_f32_16x16x32_bf16 v[48:51], v[104:107], v[80:83], v[48:51]
    v_mfma_f32_16x16x32_bf16 v[52:55], v[108:111], v[80:83], v[52:55]
    s_waitcnt lgkmcnt(2)
    v_mfma_f32_16x16x32_bf16 v[48:51], v[112:115], v[84:87], v[48:51]
    v_mfma_f32_16x16x32_bf16 v[52:55], v[116:119], v[84:87], v[52:55]
    v_smfmac_f32_16x16x64_bf16 v[64:67], v[16:19], v[128:135], v1
    s_waitcnt lgkmcnt(0)
    s_barrier
    ds_read_b64_tr_b16 v[88:89], v5 offset:12288
    v_mov_b64 v[116:117], s[44:45]
    v_smfmac_f32_16x16x64_bf16 v[68:71], v[16:19], v[192:199], v1
    ds_read_b64_tr_b16 v[90:91], v5 offset:12544
    ds_read_b64_tr_b16 v[92:93], v5 offset:13312
    v_mov_b64 v[118:119], s[44:45]
    v_smfmac_f32_16x16x64_bf16 v[64:67], v[20:23], v[136:143], v1
    s_mov_b64 exec, s[42:43]
    v_mov_b64 v[48:49], v[52:53]
    v_mov_b64 v[50:51], v[54:55]
    v_smfmac_f32_16x16x64_bf16 v[68:71], v[20:23], v[200:207], v1
    s_mov_b64 exec, -1
    ds_read_b64_tr_b16 v[94:95], v5 offset:13568
    ds_read_b64_tr_b16 v[96:97], v5 offset:14336
    v_max3_f32 v56, |v48|, |v49|, |v50|
    v_smfmac_f32_16x16x64_bf16 v[64:67], v[24:27], v[144:151], v1
    ds_read_b64_tr_b16 v[98:99], v5 offset:14592
    v_exp_f32 v52, v48
    v_smfmac_f32_16x16x64_bf16 v[68:71], v[24:27], v[208:215], v1
    ds_read_b64_tr_b16 v[100:101], v5 offset:15360
    v_max_f32 v56, |v51|, v56
    v_smfmac_f32_16x16x64_bf16 v[64:67], v[28:31], v[152:159], v1
    ds_read_b64_tr_b16 v[102:103], v5 offset:15616
    v_exp_f32 v53, v49
    v_smfmac_f32_16x16x64_bf16 v[68:71], v[28:31], v[216:223], v1
    s_waitcnt lgkmcnt(6)
    ds_read_b128 v[104:107], v0 offset:24576
    v_cvt_pk_bf16_f32 v112, v52, v53
    v_mfma_f32_16x16x32_bf16 v[120:123], v[88:91], v[72:75], 0
    s_waitcnt lgkmcnt(5)
    v_exp_f32 v54, v50
    v_mfma_f32_16x16x32_bf16 v[120:123], v[92:95], v[76:79], v[120:123]
    s_waitcnt lgkmcnt(3)
    v_exp_f32 v55, v51
    v_mfma_f32_16x16x32_bf16 v[120:123], v[96:99], v[80:83], v[120:123]
    s_waitcnt lgkmcnt(1)
    ds_read_b64 v[110:111], v0 offset:25600
    v_cvt_pk_bf16_f32 v113, v54, v55
    v_mfma_f32_16x16x32_bf16 v[120:123], v[100:103], v[84:87], v[120:123]
    ds_read_b64 v[108:109], v0 offset:25608
    v_mov_b32_dpp v114, v112 quad_perm:[2,3,0,1] row_mask:0xf bank_mask:0xf
    v_smfmac_f32_16x16x64_bf16 v[64:67], v[32:35], v[160:167], v1
    ds_read_b128 v[72:75], v7 offset:0
    v_mov_b32_dpp v115, v113 quad_perm:[2,3,0,1] row_mask:0xf bank_mask:0xf
    v_smfmac_f32_16x16x64_bf16 v[64:67], v[36:39], v[168:175], v1
    s_nop 0
    ds_read_b128 v[76:79], v7 offset:1024
    v_max3_f32 v56, |v120|, |v121|, v56
    v_smfmac_f32_16x16x64_bf16 v[64:67], v[40:43], v[176:183], v1
    ds_read_b128 v[80:83], v7 offset:2048
    v_cmp_nge_f32 vcc, s47, v56
    v_exp_f32_e64 v122, v120
    v_smfmac_f32_16x16x64_bf16 v[64:67], v[44:47], v[184:191], v1
    v_exp_f32_e64 v123, v121
    v_smfmac_f32_16x16x64_bf16 v[68:71], v[32:35], v[224:231], v1
    s_waitcnt lgkmcnt(3)
    s_cbranch_vccnz ch_rare_90
s_ch_back_91:
    v_mfma_f32_16x16x32_bf16 v[48:51], v[116:119], v[112:115], 0
    v_cvt_pk_bf16_f32 v121, v122, v123
    v_cndmask_b32 v120, 0, v121, s[40:41]
    v_mfma_f32_16x16x32_bf16 v[56:59], v[104:107], v[112:115], 0
    v_cndmask_b32 v121, 0, v121, s[42:43]
    v_add_f32 v64, v64, v66
    v_mfma_f32_16x16x32_bf16 v[60:63], v[108:111], v[112:115], 0
    v_add_f32 v65, v65, v67
    v_cvt_pk_bf16_f32 v124, v64, v65
    v_smfmac_f32_16x16x64_bf16 v[68:71], v[36:39], v[232:239], v1
    ds_read_b128 v[84:87], v7 offset:3072
    v_mov_b64 v[16:17], 0
    v_mfma_f32_16x16x16_bf16 v[48:51], v[116:117], v[120:121], v[48:51]
    s_mov_b32 m0, s27
    ds_read_b128 v[88:91], v7 offset:4096
    v_mov_b64 v[18:19], 0
    v_smfmac_f32_16x16x64_bf16 v[68:71], v[40:43], v[240:247], v1
    s_mov_b64 exec, s[42:43]
    v_mov_b64 v[56:57], v[60:61]
    v_mov_b64 v[58:59], v[62:63]
    v_smfmac_f32_16x16x64_bf16 v[68:71], v[44:47], v[248:255], v1
    s_mov_b64 exec, -1
    ds_read_b128 v[92:95], v7 offset:5120
    v_mov_b64 v[20:21], 0
    v_mov_b64 v[22:23], 0
    v_mov_b64 v[24:25], 0
    v_mov_b64 v[26:27], 0
    v_rcp_f32 v52, v48
    s_nop 0
    v_add_f32 v68, v68, v70
    v_add_f32 v69, v69, v71
    v_cvt_pk_bf16_f32 v125, v68, v69
    v_mov_b64 v[28:29], 0
    v_mov_b64 v[30:31], 0
    v_mfma_f32_16x16x16_bf16 v[56:59], v[124:125], v[120:121], v[56:59]
    ds_read_b128 v[96:99], v7 offset:6144
    ds_read_b128 v[100:103], v7 offset:7168
    s_nop 5
    v_mul_f32 v56, v56, v52
    v_mul_f32 v57, v57, v52
    v_mul_f32 v58, v58, v52
    v_mul_f32 v59, v59, v52
    v_cvt_pk_bf16_f32 v56, v56, v57
    v_cvt_pk_bf16_f32 v57, v58, v59
    ds_write_b64 v6, v[56:57]
    buffer_load_dwordx4 v8, s[12:15], s25 offen sc1 lds
    s_add_u32 m0, s27, 896
    s_nop 0
    buffer_load_dwordx4 v8, s[12:15], s25 offen offset:128 sc1 lds
    s_mov_b32 m0, s28
    s_add_u32 s25, s25, 8192
    buffer_load_dwordx4 v9, s[12:15], s26 offen sc1 lds
    s_add_u32 m0, s28, 768
    s_waitcnt lgkmcnt(0)
    s_barrier
    ds_read_b128 v[32:35], v11 offset:0
    ds_read_b128 v[36:39], v11 offset:512
    ds_read_b128 v[40:43], v11 offset:1024
    ds_read_b128 v[44:47], v11 offset:1536
    buffer_load_dwordx4 v9, s[12:15], s26 offen offset:256 sc1 lds
    s_add_u32 s26, s26, 8192
    ds_read_b128 v[104:107], v7 offset:8192
    ds_read_b128 v[108:111], v7 offset:9216
    s_waitcnt lgkmcnt(5)
    v_smfmac_f32_16x16x64_bf16 v[16:19], v[32:35], a[0:7], v1
    s_waitcnt lgkmcnt(4)
    ds_read_b128 v[112:115], v7 offset:10240
    v_smfmac_f32_16x16x64_bf16 v[16:19], v[36:39], a[8:15], v1
    s_waitcnt lgkmcnt(4)
    ds_read_b128 v[116:119], v7 offset:11264
    v_smfmac_f32_16x16x64_bf16 v[16:19], v[40:43], a[16:23], v1
    s_waitcnt lgkmcnt(4)
    ds_read_b128 v[64:67], v7 offset:12288
    v_smfmac_f32_16x16x64_bf16 v[16:19], v[44:47], a[64:71], v1
    ds_read_b128 v[68:71], v7 offset:13312
    v_smfmac_f32_16x16x64_bf16 v[20:23], v[32:35], a[72:79], v1
    ds_read_b128 v[48:51], v7 offset:14336
    v_smfmac_f32_16x16x64_bf16 v[20:23], v[36:39], a[80:87], v1
    ds_read_b128 v[52:55], v7 offset:15360
    v_smfmac_f32_16x16x64_bf16 v[20:23], v[40:43], v[72:79], v1
    ds_read_b128 v[56:59], v7 offset:16384
    v_cvt_pk_bf16_f32 v120, v16, v17
    v_smfmac_f32_16x16x64_bf16 v[20:23], v[44:47], v[80:87], v1
    ds_read_b128 v[60:63], v7 offset:17408
    v_cvt_pk_bf16_f32 v121, v18, v19
    v_smfmac_f32_16x16x64_bf16 v[24:27], v[32:35], v[88:95], v1
    ds_read_b128 v[72:75], v7 offset:18432
    v_and_or_b32 v120, v120, -2, s32
    v_smfmac_f32_16x16x64_bf16 v[24:27], v[36:39], v[96:103], v1
    s_waitcnt lgkmcnt(9)
    ds_read_b128 v[76:79], v7 offset:19456
    v_cvt_pk_bf16_f32 v122, v20, v21
    v_cvt_pk_bf16_f32 v123, v22, v23
    v_smfmac_f32_16x16x64_bf16 v[24:27], v[40:43], v[104:111], v1
    s_waitcnt lgkmcnt(8)
    buffer_store_dwordx4 v[120:123], v10, s[12:15], s21 offen
    v_smfmac_f32_16x16x64_bf16 v[24:27], v[44:47], v[112:119], v1
    s_waitcnt lgkmcnt(6)
    v_smfmac_f32_16x16x64_bf16 v[28:31], v[32:35], v[64:71], v1
    s_waitcnt lgkmcnt(4)
    v_smfmac_f32_16x16x64_bf16 v[28:31], v[36:39], v[48:55], v1
    s_waitcnt lgkmcnt(2)
    s_nop 0
    v_cvt_pk_bf16_f32 v16, v24, v25
    v_smfmac_f32_16x16x64_bf16 v[28:31], v[40:43], v[56:63], v1
    s_waitcnt lgkmcnt(0)
    v_cvt_pk_bf16_f32 v17, v26, v27
    v_smfmac_f32_16x16x64_bf16 v[28:31], v[44:47], v[72:79], v1
    v_and_or_b32 v16, v16, -2, s32
    s_add_u32 s20, s20, 1
    s_nop 5
    v_cvt_pk_bf16_f32 v18, v28, v29
    v_cvt_pk_bf16_f32 v19, v30, v31
    buffer_store_dwordx4 v[16:19], v10, s[12:15], s22 offen
    s_branch ch_loop_76
ch_last_78:
    v_add_u32 v76, s35, v5
    v_lshrrev_b32 v77, 1, v0
    ds_read_b64_tr_b16 v[72:73], v76 offset:12288
    ds_read_b64_tr_b16 v[74:75], v76 offset:12544
    s_waitcnt lgkmcnt(0)
    buffer_load_dwordx4 v[64:67], v0, s[12:15], s30 offen offset:0 sc1
    buffer_load_dwordx4 v[68:71], v0, s[12:15], s30 offen offset:1024 sc1
    s_waitcnt lgkmcnt(0)
    buffer_load_dwordx4 v[56:59], v0, s[12:15], s30 offen offset:0 sc1
    buffer_load_dwordx4 v[60:63], v0, s[12:15], s30 offen offset:1024 sc1
    s_waitcnt vmcnt(3)
    ds_write_b128 v0, v[64:67] offset:0
    s_waitcnt vmcnt(2)
    ds_write_b128 v0, v[68:71] offset:1024
    ds_read_b64_tr_b16 v[16:17], v2 offset:0
    ds_read_b64_tr_b16 v[18:19], v2 offset:512
    ds_read_b64_tr_b16 v[20:21], v2 offset:1024
    ds_read_b64_tr_b16 v[22:23], v2 offset:1536
    v_max3_u32 v40, v64, v66, v68
    v_max_u32 v40, v40, v70
    v_cmp_eq_u32_e64 vcc, -1, v40
    s_cbranch_vccnz ch_pz_rt_93
ch_pz_ok_92:
ch_pz_af_95:
    s_waitcnt lgkmcnt(0)
    s_barrier
    ds_read_b64_tr_b16 v[16:17], v2 offset:0
    ds_read_b64_tr_b16 v[18:19], v2 offset:512
    ds_read_b64_tr_b16 v[20:21], v2 offset:1024
    ds_read_b64_tr_b16 v[22:23], v2 offset:1536
    ds_read_b64_tr_b16 v[24:25], v122 offset:0
    ds_read_b64_tr_b16 v[26:27], v122 offset:512
    ds_read_b64_tr_b16 v[28:29], v122 offset:1024
    ds_read_b64_tr_b16 v[30:31], v122 offset:1536
    ds_read_b64_tr_b16 v[32:33], v123 offset:0
    ds_read_b64_tr_b16 v[34:35], v123 offset:512
    ds_read_b64_tr_b16 v[36:37], v123 offset:1024
    ds_read_b64_tr_b16 v[38:39], v123 offset:1536
    ds_read_b64_tr_b16 v[40:41], v47 offset:0
    ds_read_b64_tr_b16 v[42:43], v47 offset:512
    ds_read_b64_tr_b16 v[44:45], v47 offset:1024
    ds_read_b64_tr_b16 v[46:47], v47 offset:1536
    s_waitcnt vmcnt(0)
    v_mov_b64 v[56:57], 0
    v_mov_b64 v[58:59], 0
    v_mov_b64 v[60:61], 0
    v_mov_b64 v[62:63], 0
    v_mov_b64 v[64:65], 0
    v_mov_b64 v[66:67], 0
    v_mov_b64 v[68:69], 0
    v_mov_b64 v[70:71], 0
    buffer_store_dwordx2 v[124:125], v77, s[12:15], s51 offen
    s_mov_b64 exec, s[40:41]
    buffer_store_dwordx4 v[72:75], v11, s[12:15], s58 offen
    s_mov_b64 exec, -1
    s_add_u32 s23, s23, 131072
    s_waitcnt lgkmcnt(0)
    s_sub_u32 s20, 63, s4
    s_lshl_b32 s21, s3, 6
    s_add_u32 s21, s21, s20
    s_lshl_b32 s21, s21, 13
    s_cmp_ge_u32 s4, 3
    s_cselect_b32 s21, 0x40000000, s21
    v_subrev_u32 v127, 131072, v3
    v_smfmac_f32_16x16x64_bf16 v[56:59], v[16:19], a[128:135], v1
    s_add_u32 s22, s21, 0
    buffer_load_dwordx4 a[0:3], v127, s[12:15], s22 offen offset:0 sc1
    v_smfmac_f32_16x16x64_bf16 v[60:63], v[16:19], a[192:199], v1
    buffer_load_dwordx4 a[4:7], v127, s[12:15], s22 offen offset:1024 sc1
    v_smfmac_f32_16x16x64_bf16 v[56:59], v[20:23], a[136:143], v1
    buffer_load_dwordx4 a[8:11], v127, s[12:15], s22 offen offset:2048 sc1
    v_smfmac_f32_16x16x64_bf16 v[60:63], v[20:23], a[200:207], v1
    buffer_load_dwordx4 a[12:15], v127, s[12:15], s22 offen offset:3072 sc1
    v_smfmac_f32_16x16x64_bf16 v[56:59], v[24:27], a[144:151], v1
    s_add_u32 s22, s21, 4096
    buffer_load_dwordx4 a[16:19], v127, s[12:15], s22 offen offset:0 sc1
    v_smfmac_f32_16x16x64_bf16 v[60:63], v[24:27], a[208:215], v1
    buffer_load_dwordx4 a[20:23], v127, s[12:15], s22 offen offset:1024 sc1
    v_smfmac_f32_16x16x64_bf16 v[56:59], v[28:31], a[152:159], v1
    buffer_load_dwordx4 a[24:27], v127, s[12:15], s22 offen offset:2048 sc1
    v_smfmac_f32_16x16x64_bf16 v[60:63], v[28:31], a[216:223], v1
    buffer_load_dwordx4 a[28:31], v127, s[12:15], s22 offen offset:3072 sc1
    v_smfmac_f32_16x16x64_bf16 v[56:59], v[32:35], a[160:167], v1
    s_add_u32 s22, s21, 16777216
    buffer_load_dwordx4 a[32:35], v127, s[12:15], s22 offen offset:0 sc1
    v_smfmac_f32_16x16x64_bf16 v[60:63], v[32:35], a[224:231], v1
    buffer_load_dwordx4 a[36:39], v127, s[12:15], s22 offen offset:1024 sc1
    v_smfmac_f32_16x16x64_bf16 v[56:59], v[36:39], a[168:175], v1
    buffer_load_dwordx4 a[40:43], v127, s[12:15], s22 offen offset:2048 sc1
    v_smfmac_f32_16x16x64_bf16 v[60:63], v[36:39], a[232:239], v1
    buffer_load_dwordx4 a[44:47], v127, s[12:15], s22 offen offset:3072 sc1
    v_smfmac_f32_16x16x64_bf16 v[56:59], v[40:43], a[176:183], v1
    s_add_u32 s22, s21, 16781312
    buffer_load_dwordx4 a[48:51], v127, s[12:15], s22 offen offset:0 sc1
    v_smfmac_f32_16x16x64_bf16 v[60:63], v[40:43], a[240:247], v1
    buffer_load_dwordx4 a[52:55], v127, s[12:15], s22 offen offset:1024 sc1
    v_smfmac_f32_16x16x64_bf16 v[56:59], v[44:47], a[184:191], v1
    buffer_load_dwordx4 a[56:59], v127, s[12:15], s22 offen offset:2048 sc1
    v_smfmac_f32_16x16x64_bf16 v[60:63], v[44:47], a[248:255], v1
    buffer_load_dwordx4 a[60:63], v127, s[12:15], s22 offen offset:3072 sc1
    v_smfmac_f32_16x16x64_bf16 v[64:67], v[16:19], v[128:135], v1
    s_add_u32 s22, s21, 33554432
    buffer_load_dwordx4 a[64:67], v127, s[12:15], s22 offen offset:0 sc1
    v_smfmac_f32_16x16x64_bf16 v[68:71], v[16:19], v[192:199], v1
    buffer_load_dwordx4 a[68:71], v127, s[12:15], s22 offen offset:1024 sc1
    v_smfmac_f32_16x16x64_bf16 v[64:67], v[20:23], v[136:143], v1
    buffer_load_dwordx4 a[72:75], v127, s[12:15], s22 offen offset:2048 sc1
    v_add_f32 v56, v56, v58
    v_add_f32 v57, v57, v59
    v_cvt_pk_bf16_f32 v58, v56, v57
    v_smfmac_f32_16x16x64_bf16 v[68:71], v[20:23], v[200:207], v1
    buffer_load_dwordx4 a[76:79], v127, s[12:15], s22 offen offset:3072 sc1
    v_add_f32 v60, v60, v62
    v_add_f32 v61, v61, v63
    v_cvt_pk_bf16_f32 v62, v60, v61
    v_smfmac_f32_16x16x64_bf16 v[64:67], v[24:27], v[144:151], v1
    s_add_u32 s22, s21, 33558528
    ds_write_b32 v4, v58 offset:4096
    ds_write_b32 v4, v62 offset:4352
    buffer_load_dwordx4 a[80:83], v127, s[12:15], s22 offen offset:0 sc1
    v_smfmac_f32_16x16x64_bf16 v[68:71], v[24:27], v[208:215], v1
    buffer_load_dwordx4 a[84:87], v127, s[12:15], s22 offen offset:1024 sc1
    v_smfmac_f32_16x16x64_bf16 v[64:67], v[28:31], v[152:159], v1
    buffer_load_dwordx4 a[88:91], v127, s[12:15], s22 offen offset:2048 sc1
    v_smfmac_f32_16x16x64_bf16 v[68:71], v[28:31], v[216:223], v1
    buffer_load_dwordx4 a[92:95], v127, s[12:15], s22 offen offset:3072 sc1
    v_smfmac_f32_16x16x64_bf16 v[64:67], v[32:35], v[160:167], v1
    v_smfmac_f32_16x16x64_bf16 v[68:71], v[32:35], v[224:231], v1
    v_smfmac_f32_16x16x64_bf16 v[64:67], v[36:39], v[168:175], v1
    v_smfmac_f32_16x16x64_bf16 v[68:71], v[36:39], v[232:239], v1
    v_smfmac_f32_16x16x64_bf16 v[64:67], v[40:43], v[176:183], v1
    v_smfmac_f32_16x16x64_bf16 v[68:71], v[40:43], v[240:247], v1
    v_smfmac_f32_16x16x64_bf16 v[64:67], v[44:47], v[184:191], v1
    v_smfmac_f32_16x16x64_bf16 v[68:71], v[44:47], v[248:255], v1
    s_sub_u32 s51, s23, 65536
    s_lshr_b32 s58, s35, 0
    s_add_u32 s58, s58, s23
    s_sub_u32 s58, s58, 138752
    ds_read_b64_tr_b16 v[72:73], v76 offset:12288
    ds_read_b64_tr_b16 v[74:75], v76 offset:12544
    v_add_f32 v64, v64, v66
    v_add_f32 v65, v65, v67
    v_add_f32 v68, v68, v70
    v_add_f32 v69, v69, v71
    v_cvt_pk_bf16_f32 v124, v64, v65
    v_cvt_pk_bf16_f32 v125, v68, v69
    s_waitcnt lgkmcnt(0)
    buffer_store_dwordx2 v[124:125], v77, s[12:15], s51 offen
    s_mov_b64 exec, s[40:41]
    buffer_store_dwordx4 v[72:75], v11, s[12:15], s58 offen
    s_mov_b64 exec, -1
    s_add_u32 s23, s23, 131072
    s_branch ch_end_74
.p2align 5
ch_red_rt_80:
    buffer_load_dwordx4 v[20:23], v3, s[12:15], s29 offen offset:0 sc1
    buffer_load_dwordx4 v[24:27], v3, s[12:15], s29 offen offset:1024 sc1
    s_waitcnt vmcnt(3)
    v_mfma_f32_16x16x32_bf16 v[36:39], v[12:15], v[28:31], 0
    s_waitcnt vmcnt(2)
    v_mfma_f32_16x16x32_bf16 v[36:39], v[12:15], v[32:35], v[36:39]
    v_bitop3_b32 v40, v28, v32, s32 bitop3:0x7e
    v_and_b32_e64 v40, 1, v40
    v_cmp_ne_u32_e64 vcc, 0, v40
    s_cbranch_vccnz ch_red_go_81
    s_nop 3
    v_add_f32_dpp v36, v36, v36 row_ror:4 row_mask:0xf bank_mask:0xf
    v_add_f32_dpp v37, v37, v37 row_ror:4 row_mask:0xf bank_mask:0xf
    v_add_f32_dpp v38, v38, v38 row_ror:4 row_mask:0xf bank_mask:0xf
    v_add_f32_dpp v39, v39, v39 row_ror:4 row_mask:0xf bank_mask:0xf
    v_add_f32_dpp v36, v36, v36 row_ror:8 row_mask:0xf bank_mask:0xf
    v_add_f32_dpp v37, v37, v37 row_ror:8 row_mask:0xf bank_mask:0xf
    v_add_f32_dpp v38, v38, v38 row_ror:8 row_mask:0xf bank_mask:0xf
    v_add_f32_dpp v39, v39, v39 row_ror:8 row_mask:0xf bank_mask:0xf
    v_cvt_pk_bf16_f32 v36, v36, v37
    v_cvt_pk_bf16_f32 v37, v38, v39
    s_mov_b64 exec, 0x000f000f
    buffer_store_dwordx2 v[36:37], v126, s[12:15], s31 offen
    s_branch ch_red_af_82
ch_red_go_81:
    s_mov_b32 s50, 0
ch_red_rt_80l:
    buffer_load_dwordx4 v[28:31], v3, s[12:15], s29 offen offset:0 sc1
    buffer_load_dwordx4 v[32:35], v3, s[12:15], s29 offen offset:1024 sc1
    s_waitcnt vmcnt(3)
    v_mfma_f32_16x16x32_bf16 v[36:39], v[12:15], v[20:23], 0
    s_waitcnt vmcnt(2)
    v_mfma_f32_16x16x32_bf16 v[36:39], v[12:15], v[24:27], v[36:39]
    v_bitop3_b32 v40, v20, v24, s32 bitop3:0x7e
    v_and_b32 v40, 1, v40
    v_cmp_ne_u32 vcc, 0, v40
    s_cbranch_vccz ch_red_ok_79
    buffer_load_dwordx4 v[20:23], v3, s[12:15], s29 offen offset:0 sc1
    buffer_load_dwordx4 v[24:27], v3, s[12:15], s29 offen offset:1024 sc1
    s_waitcnt vmcnt(3)
    v_mfma_f32_16x16x32_bf16 v[36:39], v[12:15], v[28:31], 0
    s_waitcnt vmcnt(2)
    v_mfma_f32_16x16x32_bf16 v[36:39], v[12:15], v[32:35], v[36:39]
    v_bitop3_b32 v40, v28, v32, s32 bitop3:0x7e
    v_and_b32 v40, 1, v40
    v_cmp_ne_u32 vcc, 0, v40
    s_cbranch_vccz ch_red_ok_79
    s_add_u32 s50, s50, 1
    s_cmp_lt_u32 s50, 32768
    s_cbranch_scc1 ch_red_rt_80l
    s_branch ch_red_ok_79
ch_fw_83:
    s_mov_b32 s57, 0
sp_585:
    buffer_load_dword v127, off, s[12:15], s36 offset:0 sc1
    s_waitcnt vmcnt(0)
    v_readfirstlane_b32 s56, v127
    s_nop 0
    s_cmp_ge_u32 s56, s53
    s_cbranch_scc1 spd_586
    s_add_u32 s57, s57, 1
    s_sleep 1
    s_cmp_lt_u32 s57, 32768
    s_cbranch_scc1 sp_585
spd_586:
    s_branch ch_fb_84
.p2align 5
ch_pl_rt_86:
    buffer_load_dwordx4 v[64:67], v0, s[12:15], s30 offen offset:0 sc1
    buffer_load_dwordx4 v[68:71], v0, s[12:15], s30 offen offset:1024 sc1
    s_waitcnt vmcnt(3)
    ds_write_b128 v0, v[56:59] offset:0
    s_waitcnt vmcnt(2)
    ds_write_b128 v0, v[60:63] offset:1024
    ds_read_b64_tr_b16 v[16:17], v2 offset:0
    ds_read_b64_tr_b16 v[18:19], v2 offset:512
    ds_read_b64_tr_b16 v[20:21], v2 offset:1024
    ds_read_b64_tr_b16 v[22:23], v2 offset:1536
    v_max3_u32 v40, v56, v58, v60
    v_max_u32_e64 v40, v40, v62
    v_cmp_eq_u32_e64 vcc, -1, v40
    s_cbranch_vccnz ch_pl_go_87
    s_branch ch_pl_af_88
ch_pl_go_87:
    s_mov_b32 s50, 0
ch_pl_rt_86l:
    buffer_load_dwordx4 v[56:59], v0, s[12:15], s30 offen offset:0 sc1
    buffer_load_dwordx4 v[60:63], v0, s[12:15], s30 offen offset:1024 sc1
    s_waitcnt vmcnt(3)
    ds_write_b128 v0, v[64:67] offset:0
    s_waitcnt vmcnt(2)
    ds_write_b128 v0, v[68:71] offset:1024
    ds_read_b64_tr_b16 v[16:17], v2 offset:0
    ds_read_b64_tr_b16 v[18:19], v2 offset:512
    ds_read_b64_tr_b16 v[20:21], v2 offset:1024
    ds_read_b64_tr_b16 v[22:23], v2 offset:1536
    v_max3_u32 v40, v64, v66, v68
    v_max_u32 v40, v40, v70
    v_cmp_eq_u32 vcc, -1, v40
    s_cbranch_vccz ch_pl_ok_85
    buffer_load_dwordx4 v[64:67], v0, s[12:15], s30 offen offset:0 sc1
    buffer_load_dwordx4 v[68:71], v0, s[12:15], s30 offen offset:1024 sc1
    s_waitcnt vmcnt(3)
    ds_write_b128 v0, v[56:59] offset:0
    s_waitcnt vmcnt(2)
    ds_write_b128 v0, v[60:63] offset:1024
    ds_read_b64_tr_b16 v[16:17], v2 offset:0
    ds_read_b64_tr_b16 v[18:19], v2 offset:512
    ds_read_b64_tr_b16 v[20:21], v2 offset:1024
    ds_read_b64_tr_b16 v[22:23], v2 offset:1536
    v_max3_u32 v40, v56, v58, v60
    v_max_u32 v40, v40, v62
    v_cmp_eq_u32 vcc, -1, v40
    s_cbranch_vccz ch_pl_ok_85
    s_add_u32 s50, s50, 1
    s_cmp_lt_u32 s50, 32768
    s_cbranch_scc1 ch_pl_rt_86l
    s_branch ch_pl_ok_85
ch_first_77:
    ds_read_b64_tr_b16 v[16:17], v2 offset:0
    ds_read_b64_tr_b16 v[18:19], v2 offset:512
    ds_read_b64_tr_b16 v[20:21], v2 offset:1024
    ds_read_b64_tr_b16 v[22:23], v2 offset:1536
    s_branch ch_j1_89
ch_rare_90:
    v_max3_f32 v56, v48, v49, v50
    v_max3_f32 v56, v56, v51, v120
    v_max_f32 v56, v56, v121
    s_nop 1
    v_max_f32_dpp v56, v56, v56 quad_perm:[2,3,0,1] row_mask:0xf bank_mask:0xf
    v_mov_b32 v57, v56
    s_nop 1
    v_permlane16_swap_b32 v56, v57
    v_max_f32 v56, v56, v57
    v_mov_b32 v57, v56
    s_nop 1
    v_permlane32_swap_b32 v56, v57
    v_max_f32 v56, v56, v57
    v_sub_f32 v52, v48, v56
    v_sub_f32 v53, v49, v56
    v_sub_f32 v54, v50, v56
    v_sub_f32 v55, v51, v56
    v_sub_f32 v122, v120, v56
    v_sub_f32 v123, v121, v56
    v_exp_f32 v52, v52
    v_exp_f32 v53, v53
    v_exp_f32 v54, v54
    v_exp_f32 v55, v55
    v_exp_f32 v122, v122
    v_exp_f32 v123, v123
    v_cvt_pk_bf16_f32 v112, v52, v53
    v_cvt_pk_bf16_f32 v113, v54, v55
    s_nop 0
    v_mov_b32_dpp v114, v112 quad_perm:[2,3,0,1] row_mask:0xf bank_mask:0xf
    v_mov_b32_dpp v115, v113 quad_perm:[2,3,0,1] row_mask:0xf bank_mask:0xf
    s_nop 1
    s_branch s_ch_back_91
.p2align 5
ch_pz_rt_93:
    buffer_load_dwordx4 v[64:67], v0, s[12:15], s30 offen offset:0 sc1
    buffer_load_dwordx4 v[68:71], v0, s[12:15], s30 offen offset:1024 sc1
    s_waitcnt vmcnt(3)
    ds_write_b128 v0, v[56:59] offset:0
    s_waitcnt vmcnt(2)
    ds_write_b128 v0, v[60:63] offset:1024
    ds_read_b64_tr_b16 v[16:17], v2 offset:0
    ds_read_b64_tr_b16 v[18:19], v2 offset:512
    ds_read_b64_tr_b16 v[20:21], v2 offset:1024
    ds_read_b64_tr_b16 v[22:23], v2 offset:1536
    v_max3_u32 v40, v56, v58, v60
    v_max_u32_e64 v40, v40, v62
    v_cmp_eq_u32_e64 vcc, -1, v40
    s_cbranch_vccnz ch_pz_go_94
    s_branch ch_pz_af_95
ch_pz_go_94:
    s_mov_b32 s50, 0
ch_pz_rt_93l:
    buffer_load_dwordx4 v[56:59], v0, s[12:15], s30 offen offset:0 sc1
    buffer_load_dwordx4 v[60:63], v0, s[12:15], s30 offen offset:1024 sc1
    s_waitcnt vmcnt(3)
    ds_write_b128 v0, v[64:67] offset:0
    s_waitcnt vmcnt(2)
    ds_write_b128 v0, v[68:71] offset:1024
    ds_read_b64_tr_b16 v[16:17], v2 offset:0
    ds_read_b64_tr_b16 v[18:19], v2 offset:512
    ds_read_b64_tr_b16 v[20:21], v2 offset:1024
    ds_read_b64_tr_b16 v[22:23], v2 offset:1536
    v_max3_u32 v40, v64, v66, v68
    v_max_u32 v40, v40, v70
    v_cmp_eq_u32 vcc, -1, v40
    s_cbranch_vccz ch_pz_ok_92
    buffer_load_dwordx4 v[64:67], v0, s[12:15], s30 offen offset:0 sc1
    buffer_load_dwordx4 v[68:71], v0, s[12:15], s30 offen offset:1024 sc1
    s_waitcnt vmcnt(3)
    ds_write_b128 v0, v[56:59] offset:0
    s_waitcnt vmcnt(2)
    ds_write_b128 v0, v[60:63] offset:1024
    ds_read_b64_tr_b16 v[16:17], v2 offset:0
    ds_read_b64_tr_b16 v[18:19], v2 offset:512
    ds_read_b64_tr_b16 v[20:21], v2 offset:1024
    ds_read_b64_tr_b16 v[22:23], v2 offset:1536
    v_max3_u32 v40, v56, v58, v60
    v_max_u32 v40, v40, v62
    v_cmp_eq_u32 vcc, -1, v40
    s_cbranch_vccz ch_pz_ok_92
    s_add_u32 s50, s50, 1
    s_cmp_lt_u32 s50, 32768
    s_cbranch_scc1 ch_pz_rt_93l
    s_branch ch_pz_ok_92
ch_slow_75:
    s_lshr_b32 s34, s3, 1
    s_lshl_b32 s34, s34, 7
    s_add_u32 s34, s34, 146808832
    s_bitcmp1_b32 s3, 2
    s_cselect_b64 s[38:39], -1, 1
    s_mov_b32 s51, 0x80000000
    s_mov_b32 s58, 0x80000000
    v_xor_b32 v122, 2048, v2
    v_xor_b32 v123, 4096, v2
    v_xor_b32 v47, 6144, v2
    s_sub_u32 s54, s36, s24
    v_writelane_b32 v120, s54, 1
    s_cmp_eq_u32 s4, 0
    s_cselect_b32 s62, 4, 0
    s_or_b32 s60, s40, s62
    s_mov_b32 s61, s41
    s_mov_b32 s62, 0
    s_mov_b32 s63, 0
    s_branch ch_first_97
.p2align 6
ch_loop_96:
    s_sub_u32 s51, s23, 65536
    s_lshr_b32 s58, s35, 0
    s_add_u32 s58, s58, s23
    s_sub_u32 s58, s58, 138752
    v_mov_b64 v[48:49], 0
    v_mov_b64 v[50:51], 0
    v_mov_b64 v[52:53], 0
    v_mov_b64 v[54:55], 0
    v_mov_b64 v[42:43], -1
    v_lshlrev_b32 v120, 2, v3
    v_and_b32 v120, 0xffffff80, v120
    s_xor_b32 s48, s52, 16384
    s_add_u32 s48, s48, s33
    ds_read_b128 v[88:91], v7 offset:20480
    s_waitcnt lgkmcnt(0)
    ds_read_b128 v[92:95], v7 offset:21504
    s_waitcnt lgkmcnt(0)
    ds_read_b128 v[96:99], v7 offset:22528
    s_waitcnt lgkmcnt(0)
    buffer_load_dwordx4 v[20:23], v3, s[12:15], s29 offen offset:0 sc1
    buffer_load_dwordx4 v[24:27], v3, s[12:15], s29 offen offset:1024 sc1
    v_xor_b32 v122, 2048, v2
    v_xor_b32 v123, 4096, v2
    v_xor_b32 v47, 6144, v2
    ds_read_b128 v[100:103], v7 offset:23552
    s_waitcnt lgkmcnt(0)
    ds_read_b128 v[104:107], v7 offset:24576
    s_waitcnt lgkmcnt(0)
    v_not_b32 v28, s32
    s_mov_b64 exec, s[38:39]
    buffer_load_dwordx4 v[28:31], v3, s[12:15], s29 offen offset:0 sc1
    buffer_load_dwordx4 v[32:35], v3, s[12:15], s29 offen offset:1024 sc1
    s_mov_b64 exec, -1
    s_waitcnt vmcnt(3)
    v_mfma_f32_16x16x32_bf16 v[36:39], v[12:15], v[20:23], 0
    s_waitcnt vmcnt(2)
    v_mfma_f32_16x16x32_bf16 v[36:39], v[12:15], v[24:27], v[36:39]
    v_bitop3_b32 v40, v20, v24, s32 bitop3:0x7e
    v_and_b32 v40, 1, v40
    v_cmp_ne_u32 vcc, 0, v40
    s_cbranch_vccnz ch_red_rt_100
ch_red_ok_99:
    s_nop 3
    v_add_f32_dpp v36, v36, v36 row_ror:4 row_mask:0xf bank_mask:0xf
    v_add_f32_dpp v37, v37, v37 row_ror:4 row_mask:0xf bank_mask:0xf
    v_add_f32_dpp v38, v38, v38 row_ror:4 row_mask:0xf bank_mask:0xf
    v_add_f32_dpp v39, v39, v39 row_ror:4 row_mask:0xf bank_mask:0xf
    v_add_f32_dpp v36, v36, v36 row_ror:8 row_mask:0xf bank_mask:0xf
    v_add_f32_dpp v37, v37, v37 row_ror:8 row_mask:0xf bank_mask:0xf
    v_add_f32_dpp v38, v38, v38 row_ror:8 row_mask:0xf bank_mask:0xf
    v_add_f32_dpp v39, v39, v39 row_ror:8 row_mask:0xf bank_mask:0xf
    v_cvt_pk_bf16_f32 v36, v36, v37
    v_cvt_pk_bf16_f32 v37, v38, v39
    s_mov_b64 exec, 0x000f000f
    buffer_store_dwordx2 v[36:37], v126, s[12:15], s31 offen sc1
ch_red_af_102:
    buffer_store_dwordx2 v[42:43], v126, s[12:15], s48 offen sc1
    s_mov_b64 exec, -1
    v_readlane_b32 s55, v127, 1
    s_add_u32 s53, s20, 2
    s_min_u32 s53, s53, 64
    s_sub_u32 s54, s20, 1
    v_mov_b32 v121, s54
    s_mov_b32 s63, s54
    s_sub_u32 s62, s37, s58
    s_cmp_lt_u32 s55, s53
    s_cbranch_scc1 ch_fw_103
ch_fb_104:
    s_cmp_eq_u32 s53, 51
    s_cselect_b32 s54, 4, 0
    s_add_u32 s36, s36, s54
    s_cmp_eq_u32 s20, 62
    s_cselect_b32 s36, s34, s36
    s_sub_u32 s54, s36, s24
    v_writelane_b32 v120, s54, 1
    s_cmp_eq_u32 s20, 63
    s_cbranch_scc1 ch_last_98
    ds_read_b128 v[108:111], v7 offset:25600
    s_waitcnt lgkmcnt(0)
    ds_read_b128 v[112:115], v7 offset:26624
    s_waitcnt lgkmcnt(0)
    buffer_load_dwordx4 v[64:67], v0, s[12:15], s30 offen offset:0 sc1
    buffer_load_dwordx4 v[68:71], v0, s[12:15], s30 offen offset:1024 sc1
    ds_read_b128 v[116:119], v7 offset:27648
    ds_read_b128 v[72:75], v7 offset:28672
    s_waitcnt lgkmcnt(0)
    ds_read_b128 v[76:79], v7 offset:29696
    ds_read_b128 v[80:83], v7 offset:30720
    ds_read_b128 v[84:87], v7 offset:31744
    s_waitcnt lgkmcnt(0)
    buffer_load_dwordx4 v[56:59], v0, s[12:15], s30 offen offset:0 sc1
    buffer_load_dwordx4 v[60:63], v0, s[12:15], s30 offen offset:1024 sc1
    s_waitcnt vmcnt(3)
    ds_write_b128 v0, v[64:67] offset:0
    s_waitcnt vmcnt(2)
    ds_write_b128 v0, v[68:71] offset:1024
    ds_read_b64_tr_b16 v[16:17], v2 offset:0
    ds_read_b64_tr_b16 v[18:19], v2 offset:512
    ds_read_b64_tr_b16 v[20:21], v2 offset:1024
    ds_read_b64_tr_b16 v[22:23], v2 offset:1536
    v_max3_u32 v40, v64, v66, v68
    v_max_u32 v40, v40, v70
    v_cmp_eq_u32 vcc, -1, v40
    s_cbranch_vccnz ch_pl_rt_106
ch_pl_ok_105:
ch_pl_af_108:
ch_j1_109:
    s_waitcnt lgkmcnt(2)
    v_smfmac_f32_16x16x64_bf16 v[48:51], v[16:19], v[88:95], v1
    s_barrier
    ds_read_b64_tr_b16 v[24:25], v122 offset:0
    ds_read_b64_tr_b16 v[26:27], v122 offset:512
    v_smfmac_f32_16x16x64_bf16 v[52:55], v[16:19], v[96:103], v1
    s_waitcnt lgkmcnt(2)
    ds_read_b64_tr_b16 v[28:29], v122 offset:1024
    ds_read_b64_tr_b16 v[30:31], v122 offset:1536
    ds_read_b64_tr_b16 v[32:33], v123 offset:0
    v_smfmac_f32_16x16x64_bf16 v[48:51], v[20:23], v[104:111], v1
    s_add_u32 s52, s20, 1
    ds_read_b64_tr_b16 v[34:35], v123 offset:512
    ds_read_b64_tr_b16 v[36:37], v123 offset:1024
    v_smfmac_f32_16x16x64_bf16 v[52:55], v[20:23], v[112:119], v1
    s_waitcnt lgkmcnt(5)
    ds_read_b64_tr_b16 v[38:39], v123 offset:1536
    ds_read_b64_tr_b16 v[40:41], v47 offset:0
    buffer_load_dword v127, v120, s[12:15], s24 offen sc1
    v_smfmac_f32_16x16x64_bf16 v[48:51], v[24:27], v[72:79], v1
    s_waitcnt vmcnt(1)
    ds_read_b64_tr_b16 v[42:43], v47 offset:512
    v_mov_b64 v[56:57], 0
    v_smfmac_f32_16x16x64_bf16 v[52:55], v[24:27], v[80:87], v1
    s_waitcnt lgkmcnt(6)
    ds_read_b64_tr_b16 v[44:45], v47 offset:1024
    v_mov_b64 v[58:59], 0
    v_smfmac_f32_16x16x64_bf16 v[48:51], v[28:31], a[24:31], v1
    s_and_b32 s52, s52, 3
    ds_read_b64_tr_b16 v[46:47], v47 offset:1536
    v_mov_b64 v[60:61], 0
    v_smfmac_f32_16x16x64_bf16 v[52:55], v[28:31], a[88:95], v1
    s_waitcnt lgkmcnt(6)
    v_mov_b64 v[62:63], 0
    v_smfmac_f32_16x16x64_bf16 v[48:51], v[32:35], a[32:39], v1
    s_waitcnt lgkmcnt(4)
    ds_read_b128 v[88:91], v3 offset:16384
    v_mov_b64 v[64:65], 0
    v_smfmac_f32_16x16x64_bf16 v[48:51], v[36:39], a[40:47], v1
    s_waitcnt lgkmcnt(3)
    ds_read_b128 v[92:95], v3 offset:17408
    v_mov_b64 v[66:67], 0
    v_smfmac_f32_16x16x64_bf16 v[48:51], v[40:43], a[48:55], v1
    s_waitcnt lgkmcnt(2)
    ds_read_b128 v[96:99], v3 offset:18432
    v_mov_b64 v[68:69], 0
    v_smfmac_f32_16x16x64_bf16 v[48:51], v[44:47], a[56:63], v1
    s_lshl_b32 s52, s52, 13
    ds_read_b128 v[100:103], v3 offset:19456
    v_mov_b64 v[70:71], 0
    v_smfmac_f32_16x16x64_bf16 v[52:55], v[32:35], a[96:103], v1
    s_add_u32 s30, s52, 145620992
    ds_read_b128 v[104:107], v3 offset:20480
    v_add_u32 v76, s35, v5
    v_smfmac_f32_16x16x64_bf16 v[52:55], v[36:39], a[104:111], v1
    s_add_u32 s31, s52, s33
    ds_read_b128 v[108:111], v3 offset:21504
    v_add_f32 v48, v48, v50
    v_smfmac_f32_16x16x64_bf16 v[52:55], v[40:43], a[112:119], v1
    s_and_b32 s32, s20, 1
    ds_read_b128 v[112:115], v3 offset:22528
    v_add_f32 v49, v49, v51
    v_smfmac_f32_16x16x64_bf16 v[52:55], v[44:47], a[120:127], v1
    s_add_u32 s23, s23, 131072
    ds_read_b128 v[116:119], v3 offset:23552
    v_mul_f32 v48, s46, v48
    v_mul_f32 v49, s46, v49
    v_smfmac_f32_16x16x64_bf16 v[56:59], v[16:19], a[128:135], v1
    ds_read_b64_tr_b16 v[72:73], v76 offset:12288
    v_cvt_pk_bf16_f32 v50, v48, v49
    v_smfmac_f32_16x16x64_bf16 v[60:63], v[16:19], a[192:199], v1
    ds_write2_b32 v4, v50, v50 offset0:0 offset1:1
    v_add_f32 v52, v52, v54
    v_add_f32 v53, v53, v55
    v_mul_f32 v52, s46, v52
    v_smfmac_f32_16x16x64_bf16 v[56:59], v[20:23], a[136:143], v1
    ds_read_b64_tr_b16 v[74:75], v76 offset:12544
    v_mul_f32 v53, s46, v53
    v_cvt_pk_bf16_f32 v54, v52, v53
    v_smfmac_f32_16x16x64_bf16 v[60:63], v[20:23], a[200:207], v1
    ds_write2_b32 v4, v54, v54 offset0:64 offset1:65
    v_lshrrev_b32 v77, 1, v0
    v_smfmac_f32_16x16x64_bf16 v[56:59], v[24:27], a[144:151], v1
    buffer_store_dwordx2 v[124:125], v77, s[12:15], s51 offen sc1
    v_mov_b32 v78, v11
    v_smfmac_f32_16x16x64_bf16 v[60:63], v[24:27], a[208:215], v1
    s_add_u32 s24, s24, 8192
    v_writelane_b32 v78, s62, 2
    v_smfmac_f32_16x16x64_bf16 v[56:59], v[28:31], a[152:159], v1
    s_waitcnt lgkmcnt(3)
    s_mov_b64 exec, s[60:61]
    v_writelane_b32 v72, s63, 2
    v_smfmac_f32_16x16x64_bf16 v[60:63], v[28:31], a[216:223], v1
    s_waitcnt lgkmcnt(0)
    buffer_store_dwordx4 v[72:75], v78, s[12:15], s58 offen sc1
    v_smfmac_f32_16x16x64_bf16 v[56:59], v[32:35], a[160:167], v1
    s_mov_b64 exec, -1
    v_smfmac_f32_16x16x64_bf16 v[56:59], v[36:39], a[168:175], v1
    s_barrier
    ds_read_b64_tr_b16 v[72:73], v5 offset:8192
    v_smfmac_f32_16x16x64_bf16 v[56:59], v[40:43], a[176:183], v1
    ds_read_b64_tr_b16 v[74:75], v5 offset:8448
    v_smfmac_f32_16x16x64_bf16 v[56:59], v[44:47], a[184:191], v1
    ds_read_b64_tr_b16 v[76:77], v5 offset:9216
    v_smfmac_f32_16x16x64_bf16 v[60:63], v[32:35], a[224:231], v1
    ds_read_b64_tr_b16 v[78:79], v5 offset:9472
    v_smfmac_f32_16x16x64_bf16 v[60:63], v[36:39], a[232:239], v1
    s_nop 0
    ds_read_b64_tr_b16 v[80:81], v5 offset:10240
    v_add_f32 v56, v56, v58
    v_smfmac_f32_16x16x64_bf16 v[60:63], v[40:43], a[240:247], v1
    ds_read_b64_tr_b16 v[82:83], v5 offset:10496
    v_add_f32 v57, v57, v59
    v_smfmac_f32_16x16x64_bf16 v[60:63], v[44:47], a[248:255], v1
    s_waitcnt lgkmcnt(4)
    ds_read_b64_tr_b16 v[84:85], v5 offset:11264
    v_cvt_pk_bf16_f32 v58, v56, v57
    v_mfma_f32_16x16x32_bf16 v[48:51], v[88:91], v[72:75], 0
    ds_read_b64_tr_b16 v[86:87], v5 offset:11520
    ds_write_b32 v4, v58 offset:4096
    v_mfma_f32_16x16x32_bf16 v[52:55], v[92:95], v[72:75], 0
    s_waitcnt lgkmcnt(5)
    v_add_f32 v60, v60, v62
    v_add_f32 v61, v61, v63
    v_cvt_pk_bf16_f32 v62, v60, v61
    v_mfma_f32_16x16x32_bf16 v[48:51], v[96:99], v[76:79], v[48:51]
    ds_write_b32 v4, v62 offset:4352
    v_mfma_f32_16x16x32_bf16 v[52:55], v[100:103], v[76:79], v[52:55]
    s_waitcnt lgkmcnt(4)
    v_mfma_f32_16x16x32_bf16 v[48:51], v[104:107], v[80:83], v[48:51]
    v_mfma_f32_16x16x32_bf16 v[52:55], v[108:111], v[80:83], v[52:55]
    s_waitcnt lgkmcnt(2)
    v_mfma_f32_16x16x32_bf16 v[48:51], v[112:115], v[84:87], v[48:51]
    v_mfma_f32_16x16x32_bf16 v[52:55], v[116:119], v[84:87], v[52:55]
    v_smfmac_f32_16x16x64_bf16 v[64:67], v[16:19], v[128:135], v1
    s_waitcnt lgkmcnt(0)
    s_barrier
    ds_read_b64_tr_b16 v[88:89], v5 offset:12288
    v_mov_b64 v[116:117], s[44:45]
    v_smfmac_f32_16x16x64_bf16 v[68:71], v[16:19], v[192:199], v1
    ds_read_b64_tr_b16 v[90:91], v5 offset:12544
    ds_read_b64_tr_b16 v[92:93], v5 offset:13312
    v_mov_b64 v[118:119], s[44:45]
    v_smfmac_f32_16x16x64_bf16 v[64:67], v[20:23], v[136:143], v1
    s_mov_b64 exec, s[42:43]
    v_mov_b64 v[48:49], v[52:53]
    v_mov_b64 v[50:51], v[54:55]
    v_smfmac_f32_16x16x64_bf16 v[68:71], v[20:23], v[200:207], v1
    s_mov_b64 exec, -1
    ds_read_b64_tr_b16 v[94:95], v5 offset:13568
    ds_read_b64_tr_b16 v[96:97], v5 offset:14336
    v_max3_f32 v56, |v48|, |v49|, |v50|
    v_smfmac_f32_16x16x64_bf16 v[64:67], v[24:27], v[144:151], v1
    ds_read_b64_tr_b16 v[98:99], v5 offset:14592
    v_exp_f32 v52, v48
    v_smfmac_f32_16x16x64_bf16 v[68:71], v[24:27], v[208:215], v1
    ds_read_b64_tr_b16 v[100:101], v5 offset:15360
    v_max_f32 v56, |v51|, v56
    v_smfmac_f32_16x16x64_bf16 v[64:67], v[28:31], v[152:159], v1
    ds_read_b64_tr_b16 v[102:103], v5 offset:15616
    v_exp_f32 v53, v49
    v_smfmac_f32_16x16x64_bf16 v[68:71], v[28:31], v[216:223], v1
    s_waitcnt lgkmcnt(6)
    ds_read_b128 v[104:107], v0 offset:24576
    v_cvt_pk_bf16_f32 v112, v52, v53
    v_mfma_f32_16x16x32_bf16 v[120:123], v[88:91], v[72:75], 0
    s_waitcnt lgkmcnt(5)
    v_exp_f32 v54, v50
    v_mfma_f32_16x16x32_bf16 v[120:123], v[92:95], v[76:79], v[120:123]
    s_waitcnt lgkmcnt(3)
    v_exp_f32 v55, v51
    v_mfma_f32_16x16x32_bf16 v[120:123], v[96:99], v[80:83], v[120:123]
    s_waitcnt lgkmcnt(1)
    ds_read_b64 v[110:111], v0 offset:25600
    v_cvt_pk_bf16_f32 v113, v54, v55
    v_mfma_f32_16x16x32_bf16 v[120:123], v[100:103], v[84:87], v[120:123]
    ds_read_b64 v[108:109], v0 offset:25608
    v_mov_b32_dpp v114, v112 quad_perm:[2,3,0,1] row_mask:0xf bank_mask:0xf
    v_smfmac_f32_16x16x64_bf16 v[64:67], v[32:35], v[160:167], v1
    ds_read_b128 v[72:75], v7 offset:0
    v_mov_b32_dpp v115, v113 quad_perm:[2,3,0,1] row_mask:0xf bank_mask:0xf
    v_smfmac_f32_16x16x64_bf16 v[64:67], v[36:39], v[168:175], v1
    s_nop 0
    ds_read_b128 v[76:79], v7 offset:1024
    v_max3_f32 v56, |v120|, |v121|, v56
    v_smfmac_f32_16x16x64_bf16 v[64:67], v[40:43], v[176:183], v1
    ds_read_b128 v[80:83], v7 offset:2048
    v_cmp_nge_f32 vcc, s47, v56
    v_exp_f32_e64 v122, v120
    v_smfmac_f32_16x16x64_bf16 v[64:67], v[44:47], v[184:191], v1
    v_exp_f32_e64 v123, v121
    v_smfmac_f32_16x16x64_bf16 v[68:71], v[32:35], v[224:231], v1
    s_waitcnt lgkmcnt(3)
    s_cbranch_vccnz ch_rare_110
s_ch_back_111:
    v_mfma_f32_16x16x32_bf16 v[48:51], v[116:119], v[112:115], 0
    v_cvt_pk_bf16_f32 v121, v122, v123
    v_cndmask_b32 v120, 0, v121, s[40:41]
    v_mfma_f32_16x16x32_bf16 v[56:59], v[104:107], v[112:115], 0
    v_cndmask_b32 v121, 0, v121, s[42:43]
    v_add_f32 v64, v64, v66
    v_mfma_f32_16x16x32_bf16 v[60:63], v[108:111], v[112:115], 0
    v_add_f32 v65, v65, v67
    v_cvt_pk_bf16_f32 v124, v64, v65
    v_smfmac_f32_16x16x64_bf16 v[68:71], v[36:39], v[232:239], v1
    ds_read_b128 v[84:87], v7 offset:3072
    v_mov_b64 v[16:17], 0
    v_mfma_f32_16x16x16_bf16 v[48:51], v[116:117], v[120:121], v[48:51]
    s_mov_b32 m0, s27
    ds_read_b128 v[88:91], v7 offset:4096
    v_mov_b64 v[18:19], 0
    v_smfmac_f32_16x16x64_bf16 v[68:71], v[40:43], v[240:247], v1
    s_mov_b64 exec, s[42:43]
    v_mov_b64 v[56:57], v[60:61]
    v_mov_b64 v[58:59], v[62:63]
    v_smfmac_f32_16x16x64_bf16 v[68:71], v[44:47], v[248:255], v1
    s_mov_b64 exec, -1
    ds_read_b128 v[92:95], v7 offset:5120
    v_mov_b64 v[20:21], 0
    v_mov_b64 v[22:23], 0
    v_mov_b64 v[24:25], 0
    v_mov_b64 v[26:27], 0
    v_rcp_f32 v52, v48
    s_nop 0
    v_add_f32 v68, v68, v70
    v_add_f32 v69, v69, v71
    v_cvt_pk_bf16_f32 v125, v68, v69
    v_mov_b64 v[28:29], 0
    v_mov_b64 v[30:31], 0
    v_mfma_f32_16x16x16_bf16 v[56:59], v[124:125], v[120:121], v[56:59]
    ds_read_b128 v[96:99], v7 offset:6144
    ds_read_b128 v[100:103], v7 offset:7168
    s_nop 5
    v_mul_f32 v56, v56, v52
    v_mul_f32 v57, v57, v52
    v_mul_f32 v58, v58, v52
    v_mul_f32 v59, v59, v52
    v_cvt_pk_bf16_f32 v56, v56, v57
    v_cvt_pk_bf16_f32 v57, v58, v59
    ds_write_b64 v6, v[56:57]
    buffer_load_dwordx4 v8, s[12:15], s25 offen sc1 lds
    s_add_u32 m0, s27, 896
    s_nop 0
    buffer_load_dwordx4 v8, s[12:15], s25 offen offset:128 sc1 lds
    s_mov_b32 m0, s28
    s_add_u32 s25, s25, 8192
    buffer_load_dwordx4 v9, s[12:15], s26 offen sc1 lds
    s_add_u32 m0, s28, 768
    s_waitcnt lgkmcnt(0)
    s_barrier
    ds_read_b128 v[32:35], v11 offset:0
    ds_read_b128 v[36:39], v11 offset:512
    ds_read_b128 v[40:43], v11 offset:1024
    ds_read_b128 v[44:47], v11 offset:1536
    buffer_load_dwordx4 v9, s[12:15], s26 offen offset:256 sc1 lds
    s_add_u32 s26, s26, 8192
    ds_read_b128 v[104:107], v7 offset:8192
    ds_read_b128 v[108:111], v7 offset:9216
    s_waitcnt lgkmcnt(5)
    v_smfmac_f32_16x16x64_bf16 v[16:19], v[32:35], a[0:7], v1
    s_waitcnt lgkmcnt(4)
    ds_read_b128 v[112:115], v7 offset:10240
    v_smfmac_f32_16x16x64_bf16 v[16:19], v[36:39], a[8:15], v1
    s_waitcnt lgkmcnt(4)
    ds_read_b128 v[116:119], v7 offset:11264
    v_smfmac_f32_16x16x64_bf16 v[16:19], v[40:43], a[16:23], v1
    s_waitcnt lgkmcnt(4)
    ds_read_b128 v[64:67], v7 offset:12288
    v_smfmac_f32_16x16x64_bf16 v[16:19], v[44:47], a[64:71], v1
    ds_read_b128 v[68:71], v7 offset:13312
    v_smfmac_f32_16x16x64_bf16 v[20:23], v[32:35], a[72:79], v1
    ds_read_b128 v[48:51], v7 offset:14336
    v_smfmac_f32_16x16x64_bf16 v[20:23], v[36:39], a[80:87], v1
    ds_read_b128 v[52:55], v7 offset:15360
    v_smfmac_f32_16x16x64_bf16 v[20:23], v[40:43], v[72:79], v1
    ds_read_b128 v[56:59], v7 offset:16384
    v_cvt_pk_bf16_f32 v120, v16, v17
    v_smfmac_f32_16x16x64_bf16 v[20:23], v[44:47], v[80:87], v1
    ds_read_b128 v[60:63], v7 offset:17408
    v_cvt_pk_bf16_f32 v121, v18, v19
    v_smfmac_f32_16x16x64_bf16 v[24:27], v[32:35], v[88:95], v1
    ds_read_b128 v[72:75], v7 offset:18432
    v_and_or_b32 v120, v120, -2, s32
    v_smfmac_f32_16x16x64_bf16 v[24:27], v[36:39], v[96:103], v1
    s_waitcnt lgkmcnt(9)
    ds_read_b128 v[76:79], v7 offset:19456
    v_cvt_pk_bf16_f32 v122, v20, v21
    v_cvt_pk_bf16_f32 v123, v22, v23
    v_smfmac_f32_16x16x64_bf16 v[24:27], v[40:43], v[104:111], v1
    s_waitcnt lgkmcnt(8)
    buffer_store_dwordx4 v[120:123], v10, s[12:15], s21 offen sc1
    v_smfmac_f32_16x16x64_bf16 v[24:27], v[44:47], v[112:119], v1
    s_waitcnt lgkmcnt(6)
    v_smfmac_f32_16x16x64_bf16 v[28:31], v[32:35], v[64:71], v1
    s_waitcnt lgkmcnt(4)
    v_smfmac_f32_16x16x64_bf16 v[28:31], v[36:39], v[48:55], v1
    s_waitcnt lgkmcnt(2)
    s_nop 0
    v_cvt_pk_bf16_f32 v16, v24, v25
    v_smfmac_f32_16x16x64_bf16 v[28:31], v[40:43], v[56:63], v1
    s_waitcnt lgkmcnt(0)
    v_cvt_pk_bf16_f32 v17, v26, v27
    v_smfmac_f32_16x16x64_bf16 v[28:31], v[44:47], v[72:79], v1
    v_and_or_b32 v16, v16, -2, s32
    s_add_u32 s20, s20, 1
    s_nop 5
    v_cvt_pk_bf16_f32 v18, v28, v29
    v_cvt_pk_bf16_f32 v19, v30, v31
    buffer_store_dwordx4 v[16:19], v10, s[12:15], s22 offen sc1
    s_branch ch_loop_96
ch_last_98:
    v_add_u32 v76, s35, v5
    v_lshrrev_b32 v77, 1, v0
    ds_read_b64_tr_b16 v[72:73], v76 offset:12288
    ds_read_b64_tr_b16 v[74:75], v76 offset:12544
    s_waitcnt lgkmcnt(0)
    buffer_load_dwordx4 v[64:67], v0, s[12:15], s30 offen offset:0 sc1
    buffer_load_dwordx4 v[68:71], v0, s[12:15], s30 offen offset:1024 sc1
    s_waitcnt lgkmcnt(0)
    buffer_load_dwordx4 v[56:59], v0, s[12:15], s30 offen offset:0 sc1
    buffer_load_dwordx4 v[60:63], v0, s[12:15], s30 offen offset:1024 sc1
    s_waitcnt vmcnt(3)
    ds_write_b128 v0, v[64:67] offset:0
    s_waitcnt vmcnt(2)
    ds_write_b128 v0, v[68:71] offset:1024
    ds_read_b64_tr_b16 v[16:17], v2 offset:0
    ds_read_b64_tr_b16 v[18:19], v2 offset:512
    ds_read_b64_tr_b16 v[20:21], v2 offset:1024
    ds_read_b64_tr_b16 v[22:23], v2 offset:1536
    v_max3_u32 v40, v64, v66, v68
    v_max_u32 v40, v40, v70
    v_cmp_eq_u32_e64 vcc, -1, v40
    s_cbranch_vccnz ch_pz_rt_113
ch_pz_ok_112:
ch_pz_af_115:
    s_waitcnt lgkmcnt(0)
    s_barrier
    ds_read_b64_tr_b16 v[16:17], v2 offset:0
    ds_read_b64_tr_b16 v[18:19], v2 offset:512
    ds_read_b64_tr_b16 v[20:21], v2 offset:1024
    ds_read_b64_tr_b16 v[22:23], v2 offset:1536
    ds_read_b64_tr_b16 v[24:25], v122 offset:0
    ds_read_b64_tr_b16 v[26:27], v122 offset:512
    ds_read_b64_tr_b16 v[28:29], v122 offset:1024
    ds_read_b64_tr_b16 v[30:31], v122 offset:1536
    ds_read_b64_tr_b16 v[32:33], v123 offset:0
    ds_read_b64_tr_b16 v[34:35], v123 offset:512
    ds_read_b64_tr_b16 v[36:37], v123 offset:1024
    ds_read_b64_tr_b16 v[38:39], v123 offset:1536
    ds_read_b64_tr_b16 v[40:41], v47 offset:0
    ds_read_b64_tr_b16 v[42:43], v47 offset:512
    ds_read_b64_tr_b16 v[44:45], v47 offset:1024
    ds_read_b64_tr_b16 v[46:47], v47 offset:1536
    s_waitcnt vmcnt(0)
    v_mov_b64 v[56:57], 0
    v_mov_b64 v[58:59], 0
    v_mov_b64 v[60:61], 0
    v_mov_b64 v[62:63], 0
    v_mov_b64 v[64:65], 0
    v_mov_b64 v[66:67], 0
    v_mov_b64 v[68:69], 0
    v_mov_b64 v[70:71], 0
    buffer_store_dwordx2 v[124:125], v77, s[12:15], s51 offen
    s_mov_b64 exec, s[40:41]
    buffer_store_dwordx4 v[72:75], v11, s[12:15], s58 offen
    s_mov_b64 exec, -1
    s_add_u32 s23, s23, 131072
    s_waitcnt lgkmcnt(0)
    s_sub_u32 s20, 63, s4
    s_lshl_b32 s21, s3, 6
    s_add_u32 s21, s21, s20
    s_lshl_b32 s21, s21, 13
    s_cmp_ge_u32 s4, 3
    s_cselect_b32 s21, 0x40000000, s21
    v_subrev_u32 v127, 131072, v3
    v_smfmac_f32_16x16x64_bf16 v[56:59], v[16:19], a[128:135], v1
    s_add_u32 s22, s21, 0
    buffer_load_dwordx4 a[0:3], v127, s[12:15], s22 offen offset:0 sc1
    v_smfmac_f32_16x16x64_bf16 v[60:63], v[16:19], a[192:199], v1
    buffer_load_dwordx4 a[4:7], v127, s[12:15], s22 offen offset:1024 sc1
    v_smfmac_f32_16x16x64_bf16 v[56:59], v[20:23], a[136:143], v1
    buffer_load_dwordx4 a[8:11], v127, s[12:15], s22 offen offset:2048 sc1
    v_smfmac_f32_16x16x64_bf16 v[60:63], v[20:23], a[200:207], v1
    buffer_load_dwordx4 a[12:15], v127, s[12:15], s22 offen offset:3072 sc1
    v_smfmac_f32_16x16x64_bf16 v[56:59], v[24:27], a[144:151], v1
    s_add_u32 s22, s21, 4096
    buffer_load_dwordx4 a[16:19], v127, s[12:15], s22 offen offset:0 sc1
    v_smfmac_f32_16x16x64_bf16 v[60:63], v[24:27], a[208:215], v1
    buffer_load_dwordx4 a[20:23], v127, s[12:15], s22 offen offset:1024 sc1
    v_smfmac_f32_16x16x64_bf16 v[56:59], v[28:31], a[152:159], v1
    buffer_load_dwordx4 a[24:27], v127, s[12:15], s22 offen offset:2048 sc1
    v_smfmac_f32_16x16x64_bf16 v[60:63], v[28:31], a[216:223], v1
    buffer_load_dwordx4 a[28:31], v127, s[12:15], s22 offen offset:3072 sc1
    v_smfmac_f32_16x16x64_bf16 v[56:59], v[32:35], a[160:167], v1
    s_add_u32 s22, s21, 16777216
    buffer_load_dwordx4 a[32:35], v127, s[12:15], s22 offen offset:0 sc1
    v_smfmac_f32_16x16x64_bf16 v[60:63], v[32:35], a[224:231], v1
    buffer_load_dwordx4 a[36:39], v127, s[12:15], s22 offen offset:1024 sc1
    v_smfmac_f32_16x16x64_bf16 v[56:59], v[36:39], a[168:175], v1
    buffer_load_dwordx4 a[40:43], v127, s[12:15], s22 offen offset:2048 sc1
    v_smfmac_f32_16x16x64_bf16 v[60:63], v[36:39], a[232:239], v1
    buffer_load_dwordx4 a[44:47], v127, s[12:15], s22 offen offset:3072 sc1
    v_smfmac_f32_16x16x64_bf16 v[56:59], v[40:43], a[176:183], v1
    s_add_u32 s22, s21, 16781312
    buffer_load_dwordx4 a[48:51], v127, s[12:15], s22 offen offset:0 sc1
    v_smfmac_f32_16x16x64_bf16 v[60:63], v[40:43], a[240:247], v1
    buffer_load_dwordx4 a[52:55], v127, s[12:15], s22 offen offset:1024 sc1
    v_smfmac_f32_16x16x64_bf16 v[56:59], v[44:47], a[184:191], v1
    buffer_load_dwordx4 a[56:59], v127, s[12:15], s22 offen offset:2048 sc1
    v_smfmac_f32_16x16x64_bf16 v[60:63], v[44:47], a[248:255], v1
    buffer_load_dwordx4 a[60:63], v127, s[12:15], s22 offen offset:3072 sc1
    v_smfmac_f32_16x16x64_bf16 v[64:67], v[16:19], v[128:135], v1
    s_add_u32 s22, s21, 33554432
    buffer_load_dwordx4 a[64:67], v127, s[12:15], s22 offen offset:0 sc1
    v_smfmac_f32_16x16x64_bf16 v[68:71], v[16:19], v[192:199], v1
    buffer_load_dwordx4 a[68:71], v127, s[12:15], s22 offen offset:1024 sc1
    v_smfmac_f32_16x16x64_bf16 v[64:67], v[20:23], v[136:143], v1
    buffer_load_dwordx4 a[72:75], v127, s[12:15], s22 offen offset:2048 sc1
    v_add_f32 v56, v56, v58
    v_add_f32 v57, v57, v59
    v_cvt_pk_bf16_f32 v58, v56, v57
    v_smfmac_f32_16x16x64_bf16 v[68:71], v[20:23], v[200:207], v1
    buffer_load_dwordx4 a[76:79], v127, s[12:15], s22 offen offset:3072 sc1
    v_add_f32 v60, v60, v62
    v_add_f32 v61, v61, v63
    v_cvt_pk_bf16_f32 v62, v60, v61
    v_smfmac_f32_16x16x64_bf16 v[64:67], v[24:27], v[144:151], v1
    s_add_u32 s22, s21, 33558528
    ds_write_b32 v4, v58 offset:4096
    ds_write_b32 v4, v62 offset:4352
    buffer_load_dwordx4 a[80:83], v127, s[12:15], s22 offen offset:0 sc1
    v_smfmac_f32_16x16x64_bf16 v[68:71], v[24:27], v[208:215], v1
    buffer_load_dwordx4 a[84:87], v127, s[12:15], s22 offen offset:1024 sc1
    v_smfmac_f32_16x16x64_bf16 v[64:67], v[28:31], v[152:159], v1
    buffer_load_dwordx4 a[88:91], v127, s[12:15], s22 offen offset:2048 sc1
    v_smfmac_f32_16x16x64_bf16 v[68:71], v[28:31], v[216:223], v1
    buffer_load_dwordx4 a[92:95], v127, s[12:15], s22 offen offset:3072 sc1
    v_smfmac_f32_16x16x64_bf16 v[64:67], v[32:35], v[160:167], v1
    v_smfmac_f32_16x16x64_bf16 v[68:71], v[32:35], v[224:231], v1
    v_smfmac_f32_16x16x64_bf16 v[64:67], v[36:39], v[168:175], v1
    v_smfmac_f32_16x16x64_bf16 v[68:71], v[36:39], v[232:239], v1
    v_smfmac_f32_16x16x64_bf16 v[64:67], v[40:43], v[176:183], v1
    v_smfmac_f32_16x16x64_bf16 v[68:71], v[40:43], v[240:247], v1
    v_smfmac_f32_16x16x64_bf16 v[64:67], v[44:47], v[184:191], v1
    v_smfmac_f32_16x16x64_bf16 v[68:71], v[44:47], v[248:255], v1
    s_sub_u32 s51, s23, 65536
    s_lshr_b32 s58, s35, 0
    s_add_u32 s58, s58, s23
    s_sub_u32 s58, s58, 138752
    ds_read_b64_tr_b16 v[72:73], v76 offset:12288
    ds_read_b64_tr_b16 v[74:75], v76 offset:12544
    v_add_f32 v64, v64, v66
    v_add_f32 v65, v65, v67
    v_add_f32 v68, v68, v70
    v_add_f32 v69, v69, v71
    v_cvt_pk_bf16_f32 v124, v64, v65
    v_cvt_pk_bf16_f32 v125, v68, v69
    s_waitcnt lgkmcnt(0)
    buffer_store_dwordx2 v[124:125], v77, s[12:15], s51 offen
    s_mov_b64 exec, s[40:41]
    buffer_store_dwordx4 v[72:75], v11, s[12:15], s58 offen
    s_mov_b64 exec, -1
    s_add_u32 s23, s23, 131072
    s_branch ch_end_74
.p2align 5
ch_red_rt_100:
    buffer_load_dwordx4 v[20:23], v3, s[12:15], s29 offen offset:0 sc1
    buffer_load_dwordx4 v[24:27], v3, s[12:15], s29 offen offset:1024 sc1
    s_waitcnt vmcnt(3)
    v_mfma_f32_16x16x32_bf16 v[36:39], v[12:15], v[28:31], 0
    s_waitcnt vmcnt(2)
    v_mfma_f32_16x16x32_bf16 v[36:39], v[12:15], v[32:35], v[36:39]
    v_bitop3_b32 v40, v28, v32, s32 bitop3:0x7e
    v_and_b32_e64 v40, 1, v40
    v_cmp_ne_u32_e64 vcc, 0, v40
    s_cbranch_vccnz ch_red_go_101
    s_nop 3
    v_add_f32_dpp v36, v36, v36 row_ror:4 row_mask:0xf bank_mask:0xf
    v_add_f32_dpp v37, v37, v37 row_ror:4 row_mask:0xf bank_mask:0xf
    v_add_f32_dpp v38, v38, v38 row_ror:4 row_mask:0xf bank_mask:0xf
    v_add_f32_dpp v39, v39, v39 row_ror:4 row_mask:0xf bank_mask:0xf
    v_add_f32_dpp v36, v36, v36 row_ror:8 row_mask:0xf bank_mask:0xf
    v_add_f32_dpp v37, v37, v37 row_ror:8 row_mask:0xf bank_mask:0xf
    v_add_f32_dpp v38, v38, v38 row_ror:8 row_mask:0xf bank_mask:0xf
    v_add_f32_dpp v39, v39, v39 row_ror:8 row_mask:0xf bank_mask:0xf
    v_cvt_pk_bf16_f32 v36, v36, v37
    v_cvt_pk_bf16_f32 v37, v38, v39
    s_mov_b64 exec, 0x000f000f
    buffer_store_dwordx2 v[36:37], v126, s[12:15], s31 offen sc1
    s_branch ch_red_af_102
ch_red_go_101:
    s_mov_b32 s50, 0
ch_red_rt_100l:
    buffer_load_dwordx4 v[28:31], v3, s[12:15], s29 offen offset:0 sc1
    buffer_load_dwordx4 v[32:35], v3, s[12:15], s29 offen offset:1024 sc1
    s_waitcnt vmcnt(3)
    v_mfma_f32_16x16x32_bf16 v[36:39], v[12:15], v[20:23], 0
    s_waitcnt vmcnt(2)
    v_mfma_f32_16x16x32_bf16 v[36:39], v[12:15], v[24:27], v[36:39]
    v_bitop3_b32 v40, v20, v24, s32 bitop3:0x7e
    v_and_b32 v40, 1, v40
    v_cmp_ne_u32 vcc, 0, v40
    s_cbranch_vccz ch_red_ok_99
    buffer_load_dwordx4 v[20:23], v3, s[12:15], s29 offen offset:0 sc1
    buffer_load_dwordx4 v[24:27], v3, s[12:15], s29 offen offset:1024 sc1
    s_waitcnt vmcnt(3)
    v_mfma_f32_16x16x32_bf16 v[36:39], v[12:15], v[28:31], 0
    s_waitcnt vmcnt(2)
    v_mfma_f32_16x16x32_bf16 v[36:39], v[12:15], v[32:35], v[36:39]
    v_bitop3_b32 v40, v28, v32, s32 bitop3:0x7e
    v_and_b32 v40, 1, v40
    v_cmp_ne_u32 vcc, 0, v40
    s_cbranch_vccz ch_red_ok_99
    s_add_u32 s50, s50, 1
    s_cmp_lt_u32 s50, 32768
    s_cbranch_scc1 ch_red_rt_100l
    s_branch ch_red_ok_99
ch_fw_103:
    s_mov_b32 s57, 0
sp_1105:
    buffer_load_dword v127, off, s[12:15], s36 offset:0 sc1
    s_waitcnt vmcnt(0)
    v_readfirstlane_b32 s56, v127
    s_nop 0
    s_cmp_ge_u32 s56, s53
    s_cbranch_scc1 spd_1106
    s_add_u32 s57, s57, 1
    s_sleep 1
    s_cmp_lt_u32 s57, 32768
    s_cbranch_scc1 sp_1105
spd_1106:
    s_branch ch_fb_104
.p2align 5
ch_pl_rt_106:
    buffer_load_dwordx4 v[64:67], v0, s[12:15], s30 offen offset:0 sc1
    buffer_load_dwordx4 v[68:71], v0, s[12:15], s30 offen offset:1024 sc1
    s_waitcnt vmcnt(3)
    ds_write_b128 v0, v[56:59] offset:0
    s_waitcnt vmcnt(2)
    ds_write_b128 v0, v[60:63] offset:1024
    ds_read_b64_tr_b16 v[16:17], v2 offset:0
    ds_read_b64_tr_b16 v[18:19], v2 offset:512
    ds_read_b64_tr_b16 v[20:21], v2 offset:1024
    ds_read_b64_tr_b16 v[22:23], v2 offset:1536
    v_max3_u32 v40, v56, v58, v60
    v_max_u32_e64 v40, v40, v62
    v_cmp_eq_u32_e64 vcc, -1, v40
    s_cbranch_vccnz ch_pl_go_107
    s_branch ch_pl_af_108
ch_pl_go_107:
    s_mov_b32 s50, 0
ch_pl_rt_106l:
    buffer_load_dwordx4 v[56:59], v0, s[12:15], s30 offen offset:0 sc1
    buffer_load_dwordx4 v[60:63], v0, s[12:15], s30 offen offset:1024 sc1
    s_waitcnt vmcnt(3)
    ds_write_b128 v0, v[64:67] offset:0
    s_waitcnt vmcnt(2)
    ds_write_b128 v0, v[68:71] offset:1024
    ds_read_b64_tr_b16 v[16:17], v2 offset:0
    ds_read_b64_tr_b16 v[18:19], v2 offset:512
    ds_read_b64_tr_b16 v[20:21], v2 offset:1024
    ds_read_b64_tr_b16 v[22:23], v2 offset:1536
    v_max3_u32 v40, v64, v66, v68
    v_max_u32 v40, v40, v70
    v_cmp_eq_u32 vcc, -1, v40
    s_cbranch_vccz ch_pl_ok_105
    buffer_load_dwordx4 v[64:67], v0, s[12:15], s30 offen offset:0 sc1
    buffer_load_dwordx4 v[68:71], v0, s[12:15], s30 offen offset:1024 sc1
    s_waitcnt vmcnt(3)
    ds_write_b128 v0, v[56:59] offset:0
    s_waitcnt vmcnt(2)
    ds_write_b128 v0, v[60:63] offset:1024
    ds_read_b64_tr_b16 v[16:17], v2 offset:0
    ds_read_b64_tr_b16 v[18:19], v2 offset:512
    ds_read_b64_tr_b16 v[20:21], v2 offset:1024
    ds_read_b64_tr_b16 v[22:23], v2 offset:1536
    v_max3_u32 v40, v56, v58, v60
    v_max_u32 v40, v40, v62
    v_cmp_eq_u32 vcc, -1, v40
    s_cbranch_vccz ch_pl_ok_105
    s_add_u32 s50, s50, 1
    s_cmp_lt_u32 s50, 32768
    s_cbranch_scc1 ch_pl_rt_106l
    s_branch ch_pl_ok_105
ch_first_97:
    ds_read_b64_tr_b16 v[16:17], v2 offset:0
    ds_read_b64_tr_b16 v[18:19], v2 offset:512
    ds_read_b64_tr_b16 v[20:21], v2 offset:1024
    ds_read_b64_tr_b16 v[22:23], v2 offset:1536
    s_branch ch_j1_109
ch_rare_110:
    v_max3_f32 v56, v48, v49, v50
    v_max3_f32 v56, v56, v51, v120
    v_max_f32 v56, v56, v121
    s_nop 1
    v_max_f32_dpp v56, v56, v56 quad_perm:[2,3,0,1] row_mask:0xf bank_mask:0xf
    v_mov_b32 v57, v56
    s_nop 1
    v_permlane16_swap_b32 v56, v57
    v_max_f32 v56, v56, v57
    v_mov_b32 v57, v56
    s_nop 1
    v_permlane32_swap_b32 v56, v57
    v_max_f32 v56, v56, v57
    v_sub_f32 v52, v48, v56
    v_sub_f32 v53, v49, v56
    v_sub_f32 v54, v50, v56
    v_sub_f32 v55, v51, v56
    v_sub_f32 v122, v120, v56
    v_sub_f32 v123, v121, v56
    v_exp_f32 v52, v52
    v_exp_f32 v53, v53
    v_exp_f32 v54, v54
    v_exp_f32 v55, v55
    v_exp_f32 v122, v122
    v_exp_f32 v123, v123
    v_cvt_pk_bf16_f32 v112, v52, v53
    v_cvt_pk_bf16_f32 v113, v54, v55
    s_nop 0
    v_mov_b32_dpp v114, v112 quad_perm:[2,3,0,1] row_mask:0xf bank_mask:0xf
    v_mov_b32_dpp v115, v113 quad_perm:[2,3,0,1] row_mask:0xf bank_mask:0xf
    s_nop 1
    s_branch s_ch_back_111
.p2align 5
ch_pz_rt_113:
    buffer_load_dwordx4 v[64:67], v0, s[12:15], s30 offen offset:0 sc1
    buffer_load_dwordx4 v[68:71], v0, s[12:15], s30 offen offset:1024 sc1
    s_waitcnt vmcnt(3)
    ds_write_b128 v0, v[56:59] offset:0
    s_waitcnt vmcnt(2)
    ds_write_b128 v0, v[60:63] offset:1024
    ds_read_b64_tr_b16 v[16:17], v2 offset:0
    ds_read_b64_tr_b16 v[18:19], v2 offset:512
    ds_read_b64_tr_b16 v[20:21], v2 offset:1024
    ds_read_b64_tr_b16 v[22:23], v2 offset:1536
    v_max3_u32 v40, v56, v58, v60
    v_max_u32_e64 v40, v40, v62
    v_cmp_eq_u32_e64 vcc, -1, v40
    s_cbranch_vccnz ch_pz_go_114
    s_branch ch_pz_af_115
ch_pz_go_114:
    s_mov_b32 s50, 0
ch_pz_rt_113l:
    buffer_load_dwordx4 v[56:59], v0, s[12:15], s30 offen offset:0 sc1
    buffer_load_dwordx4 v[60:63], v0, s[12:15], s30 offen offset:1024 sc1
    s_waitcnt vmcnt(3)
    ds_write_b128 v0, v[64:67] offset:0
    s_waitcnt vmcnt(2)
    ds_write_b128 v0, v[68:71] offset:1024
    ds_read_b64_tr_b16 v[16:17], v2 offset:0
    ds_read_b64_tr_b16 v[18:19], v2 offset:512
    ds_read_b64_tr_b16 v[20:21], v2 offset:1024
    ds_read_b64_tr_b16 v[22:23], v2 offset:1536
    v_max3_u32 v40, v64, v66, v68
    v_max_u32 v40, v40, v70
    v_cmp_eq_u32 vcc, -1, v40
    s_cbranch_vccz ch_pz_ok_112
    buffer_load_dwordx4 v[64:67], v0, s[12:15], s30 offen offset:0 sc1
    buffer_load_dwordx4 v[68:71], v0, s[12:15], s30 offen offset:1024 sc1
    s_waitcnt vmcnt(3)
    ds_write_b128 v0, v[56:59] offset:0
    s_waitcnt vmcnt(2)
    ds_write_b128 v0, v[60:63] offset:1024
    ds_read_b64_tr_b16 v[16:17], v2 offset:0
    ds_read_b64_tr_b16 v[18:19], v2 offset:512
    ds_read_b64_tr_b16 v[20:21], v2 offset:1024
    ds_read_b64_tr_b16 v[22:23], v2 offset:1536
    v_max3_u32 v40, v56, v58, v60
    v_max_u32 v40, v40, v62
    v_cmp_eq_u32 vcc, -1, v40
    s_cbranch_vccz ch_pz_ok_112
    s_add_u32 s50, s50, 1
    s_cmp_lt_u32 s50, 32768
    s_cbranch_scc1 ch_pz_rt_113l
    s_branch ch_pz_ok_112
ch_end_74:
    v_mov_b32 v252, v3
    v_lshrrev_b32 v0, 4, v127
    s_mov_b32 s21, s3
    v_lshlrev_b32 v1, 4, v0
    v_bfe_u32 v4, v0, 5, 1
    v_lshlrev_b32 v2, 7, v4
    v_bfe_u32 v4, v0, 0, 3
    v_lshl_add_u32 v2, v4, 4, v2
    v_bfe_u32 v4, v0, 5, 1
    v_lshlrev_b32 v3, 8, v4
    v_bfe_u32 v4, v0, 0, 4
    v_lshl_add_u32 v3, v4, 3, v3
    v_bfe_u32 v4, v0, 4, 1
    v_lshl_add_u32 v3, v4, 2, v3
    v_and_b32 v4, 31, v0
    v_lshrrev_b32 v5, 5, v0
    v_lshlrev_b32 v5, 2, v5
    v_sub_u32 v4, v4, v5
    v_mov_b32 v5, 0xff800000
    v_cmp_gt_i32 vcc, 0, v4
    s_nop 1
    v_cndmask_b32 v16, 0, v5, vcc
    v_cmp_gt_i32 vcc, 1, v4
    s_nop 1
    v_cndmask_b32 v17, 0, v5, vcc
    v_cmp_gt_i32 vcc, 2, v4
    s_nop 1
    v_cndmask_b32 v18, 0, v5, vcc
    v_cmp_gt_i32 vcc, 3, v4
    s_nop 1
    v_cndmask_b32 v19, 0, v5, vcc
    v_cmp_gt_i32 vcc, 8, v4
    s_nop 1
    v_cndmask_b32 v20, 0, v5, vcc
    v_cmp_gt_i32 vcc, 9, v4
    s_nop 1
    v_cndmask_b32 v21, 0, v5, vcc
    v_cmp_gt_i32 vcc, 10, v4
    s_nop 1
    v_cndmask_b32 v22, 0, v5, vcc
    v_cmp_gt_i32 vcc, 11, v4
    s_nop 1
    v_cndmask_b32 v23, 0, v5, vcc
    v_cmp_gt_i32 vcc, 16, v4
    s_nop 1
    v_cndmask_b32 v24, 0, v5, vcc
    v_cmp_gt_i32 vcc, 17, v4
    s_nop 1
    v_cndmask_b32 v25, 0, v5, vcc
    v_cmp_gt_i32 vcc, 18, v4
    s_nop 1
    v_cndmask_b32 v26, 0, v5, vcc
    v_cmp_gt_i32 vcc, 19, v4
    s_nop 1
    v_cndmask_b32 v27, 0, v5, vcc
    v_cmp_gt_i32 vcc, 24, v4
    s_nop 1
    v_cndmask_b32 v28, 0, v5, vcc
    v_cmp_gt_i32 vcc, 25, v4
    s_nop 1
    v_cndmask_b32 v29, 0, v5, vcc
    v_cmp_gt_i32 vcc, 26, v4
    s_nop 1
    v_cndmask_b32 v30, 0, v5, vcc
    v_cmp_gt_i32 vcc, 27, v4
    s_nop 1
    v_cndmask_b32 v31, 0, v5, vcc
    v_mov_b64 v[74:75], 0
    v_mov_b64 v[78:79], 0
    v_mov_b64_e64 v[82:83], 0
    v_mov_b64_e64 v[86:87], 0
    v_mov_b64_e64 v[90:91], 0
    s_lshl_b32 s36, s21, 6
    s_add_u32 s36, s36, s20
    s_lshl_b32 s36, s36, 13
    s_lshl_b32 s37, s20, 5
    s_add_u32 s37, s37, s21
    s_lshl_b32 s38, s37, 12
    s_add_u32 s38, s38, 135266304
    s_lshl_b32 s37, s37, 13
    s_add_u32 s37, s37, 100663296
    s_waitcnt vmcnt(0)
    s_barrier
    s_cmp_ge_u32 s4, 3
    s_cbranch_scc1 ch_fe_116
    buffer_load_dwordx4 a[96:99], v2, s[12:15], s38 offen offset:512 sc1
    buffer_load_dwordx4 a[100:103], v2, s[12:15], s38 offen offset:768 sc1
    buffer_load_dwordx4 a[104:107], v2, s[12:15], s38 offen offset:1536 sc1
    buffer_load_dwordx4 a[108:111], v2, s[12:15], s38 offen offset:1792 sc1
    buffer_load_dwordx4 a[112:115], v2, s[12:15], s38 offen offset:2560 sc1
    buffer_load_dwordx4 a[116:119], v2, s[12:15], s38 offen offset:2816 sc1
    buffer_load_dwordx4 a[120:123], v2, s[12:15], s38 offen offset:3584 sc1
    buffer_load_dwordx4 a[124:127], v2, s[12:15], s38 offen offset:3840 sc1
    buffer_load_dword v76, v3, s[12:15], s38 offen offset:0 sc1
    buffer_load_dword v77, v3, s[12:15], s38 offen offset:128 sc1
    buffer_load_dword v80, v3, s[12:15], s38 offen offset:1024 sc1
    buffer_load_dword v81, v3, s[12:15], s38 offen offset:1152 sc1
    buffer_load_dword v84, v3, s[12:15], s38 offen offset:2048 sc1
    buffer_load_dword v85, v3, s[12:15], s38 offen offset:2176 sc1
    buffer_load_dword v88, v3, s[12:15], s38 offen offset:3072 sc1
    buffer_load_dword v89, v3, s[12:15], s38 offen offset:3200 sc1
    s_waitcnt vmcnt(24)
    v_mfma_f32_32x32x16_bf16 v[32:47], a[32:35], a[0:3], v[16:31]
    v_mfma_f32_32x32x16_bf16 v[32:47], a[36:39], a[4:7], v[32:47]
    v_mfma_f32_32x32x16_bf16 v[32:47], a[40:43], a[8:11], v[32:47]
    v_mfma_f32_32x32x16_bf16 v[32:47], a[44:47], a[12:15], v[32:47]
    v_mfma_f32_32x32x16_bf16 v[32:47], a[48:51], a[16:19], v[32:47]
    v_mfma_f32_32x32x16_bf16 v[32:47], a[52:55], a[20:23], v[32:47]
    v_mfma_f32_32x32x16_bf16 v[32:47], a[56:59], a[24:27], v[32:47]
    v_mfma_f32_32x32x16_bf16 v[32:47], a[60:63], a[28:31], v[32:47]
    s_waitcnt vmcnt(8)
    v_mfma_f32_32x32x16_bf16 v[48:63], a[96:99], a[0:3], 0
    v_mfma_f32_32x32x16_bf16 v[48:63], a[100:103], a[4:7], v[48:63]
    v_mfma_f32_32x32x16_bf16 v[48:63], a[104:107], a[8:11], v[48:63]
    v_mfma_f32_32x32x16_bf16 v[48:63], a[108:111], a[12:15], v[48:63]
    v_mfma_f32_32x32x16_bf16 v[48:63], a[112:115], a[16:19], v[48:63]
    v_mfma_f32_32x32x16_bf16 v[48:63], a[116:119], a[20:23], v[48:63]
    v_mfma_f32_32x32x16_bf16 v[48:63], a[120:123], a[24:27], v[48:63]
    v_mfma_f32_32x32x16_bf16 v[48:63], a[124:127], a[28:31], v[48:63]
    v_max3_f32 v4, v32, v33, v34
    v_max3_f32 v4, v4, v35, v36
    v_max3_f32 v4, v4, v37, v38
    v_max3_f32 v4, v4, v39, v40
    v_max3_f32 v4, v4, v41, v42
    v_max3_f32 v4, v4, v43, v44
    v_max3_f32 v4, v4, v45, v46
    s_nop 4
    v_max3_f32 v4, v4, v47, v48
    v_max3_f32 v4, v4, v49, v50
    v_max_f32 v4, v4, v51
    v_mov_b32 v5, v4
    s_nop 1
    v_permlane32_swap_b32 v4, v5
    v_max_f32 v4, v4, v5
    v_sub_f32 v32, v32, v4
    v_sub_f32 v33, v33, v4
    v_sub_f32 v34, v34, v4
    v_sub_f32 v35, v35, v4
    v_sub_f32 v36, v36, v4
    v_sub_f32 v37, v37, v4
    v_sub_f32 v38, v38, v4
    v_sub_f32 v39, v39, v4
    v_sub_f32 v40, v40, v4
    v_sub_f32 v41, v41, v4
    v_sub_f32 v42, v42, v4
    v_sub_f32 v43, v43, v4
    v_sub_f32 v44, v44, v4
    v_sub_f32 v45, v45, v4
    v_sub_f32 v46, v46, v4
    v_sub_f32 v47, v47, v4
    v_sub_f32 v48, v48, v4
    v_sub_f32 v49, v49, v4
    v_sub_f32 v50, v50, v4
    v_sub_f32 v51, v51, v4
    v_exp_f32 v32, v32
    v_exp_f32 v33, v33
    v_exp_f32 v34, v34
    v_exp_f32 v35, v35
    v_exp_f32 v36, v36
    v_exp_f32 v37, v37
    v_exp_f32 v38, v38
    v_exp_f32 v39, v39
    v_exp_f32 v40, v40
    v_exp_f32 v41, v41
    v_exp_f32 v42, v42
    v_exp_f32 v43, v43
    v_exp_f32 v44, v44
    v_exp_f32 v45, v45
    v_exp_f32 v46, v46
    v_exp_f32 v47, v47
    v_exp_f32 v48, v48
    v_exp_f32 v49, v49
    v_exp_f32 v50, v50
    v_exp_f32 v51, v51
    v_cvt_pk_bf16_f32 v64, v32, v33
    v_cvt_pk_bf16_f32 v65, v34, v35
    v_cvt_pk_bf16_f32 v66, v36, v37
    v_cvt_pk_bf16_f32 v67, v38, v39
    v_cvt_pk_bf16_f32 v68, v40, v41
    v_cvt_pk_bf16_f32 v69, v42, v43
    v_cvt_pk_bf16_f32 v70, v44, v45
    v_cvt_pk_bf16_f32 v71, v46, v47
    v_cvt_pk_bf16_f32 v72, v48, v49
    v_cvt_pk_bf16_f32 v73, v50, v51
    s_waitcnt vmcnt(0)
    v_mfma_f32_32x32x16_bf16 v[96:111], a[64:67], v[64:67], 0
    v_add_f32 v6, v32, v33
    v_add_f32 v6, v6, v34
    v_add_f32 v6, v6, v35
    v_add_f32 v6, v6, v36
    v_add_f32 v6, v6, v37
    v_add_f32 v6, v6, v38
    v_mfma_f32_32x32x16_bf16 v[96:111], a[68:71], v[68:71], v[96:111]
    v_add_f32 v6, v6, v39
    v_add_f32 v6, v6, v40
    v_add_f32 v6, v6, v41
    v_add_f32 v6, v6, v42
    v_add_f32 v6, v6, v43
    v_add_f32 v6, v6, v44
    v_mfma_f32_32x32x16_bf16 v[96:111], v[76:79], v[72:75], v[96:111]
    v_add_f32 v6, v6, v45
    v_add_f32 v6, v6, v46
    v_add_f32 v6, v6, v47
    v_add_f32 v6, v6, v48
    v_add_f32 v6, v6, v49
    v_add_f32 v6, v6, v50
    v_mfma_f32_32x32x16_bf16 v[112:127], a[72:75], v[64:67], 0
    v_add_f32 v6, v6, v51
    v_mov_b32 v5, v6
    s_nop 1
    v_permlane32_swap_b32 v6, v5
    v_add_f32 v6, v6, v5
    v_rcp_f32 v6, v6
    v_mfma_f32_32x32x16_bf16 v[112:127], a[76:79], v[68:71], v[112:127]
    v_mul_f32 v96, v96, v6
    v_mul_f32 v97, v97, v6
    v_mul_f32 v98, v98, v6
    v_mul_f32 v99, v99, v6
    v_mul_f32 v100, v100, v6
    v_mul_f32 v101, v101, v6
    v_mfma_f32_32x32x16_bf16 v[112:127], v[80:83], v[72:75], v[112:127]
    v_mul_f32 v102, v102, v6
    v_mul_f32 v103, v103, v6
    v_cvt_pk_bf16_f32 v160, v96, v97
    v_cvt_pk_bf16_f32 v161, v98, v99
    v_cvt_pk_bf16_f32 v162, v100, v101
    v_cvt_pk_bf16_f32 v163, v102, v103
    v_mfma_f32_32x32x16_bf16 v[128:143], a[80:83], v[64:67], 0
    buffer_store_dwordx4 v[160:163], v1, s[12:15], s37 offen offset:0 sc1
    v_mul_f32 v104, v104, v6
    v_mul_f32 v105, v105, v6
    v_mul_f32 v106, v106, v6
    v_mul_f32 v107, v107, v6
    v_mul_f32 v108, v108, v6
    v_mfma_f32_32x32x16_bf16 v[128:143], a[84:87], v[68:71], v[128:143]
    v_mul_f32 v109, v109, v6
    v_mul_f32 v110, v110, v6
    v_mul_f32 v111, v111, v6
    v_cvt_pk_bf16_f32 v164, v104, v105
    v_cvt_pk_bf16_f32 v165, v106, v107
    v_cvt_pk_bf16_f32 v166, v108, v109
    v_mfma_f32_32x32x16_bf16 v[128:143], v[84:87], v[72:75], v[128:143]
    v_cvt_pk_bf16_f32 v167, v110, v111
    buffer_store_dwordx4 v[164:167], v1, s[12:15], s37 offen offset:1024 sc1
    v_mul_f32 v112, v112, v6
    v_mul_f32 v113, v113, v6
    v_mul_f32 v114, v114, v6
    v_mul_f32 v115, v115, v6
    v_mfma_f32_32x32x16_bf16 v[144:159], a[88:91], v[64:67], 0
    v_mul_f32 v116, v116, v6
    v_mul_f32 v117, v117, v6
    v_mul_f32 v118, v118, v6
    v_mul_f32 v119, v119, v6
    v_cvt_pk_bf16_f32 v168, v112, v113
    v_cvt_pk_bf16_f32 v169, v114, v115
    v_mfma_f32_32x32x16_bf16 v[144:159], a[92:95], v[68:71], v[144:159]
    v_cvt_pk_bf16_f32 v170, v116, v117
    v_cvt_pk_bf16_f32 v171, v118, v119
    buffer_store_dwordx4 v[168:171], v1, s[12:15], s37 offen offset:2048 sc1
    v_mul_f32 v120, v120, v6
    v_mul_f32 v121, v121, v6
    v_mul_f32 v122, v122, v6
    v_mfma_f32_32x32x16_bf16 v[144:159], v[88:91], v[72:75], v[144:159]
    v_mul_f32 v123, v123, v6
    v_mul_f32 v124, v124, v6
    v_mul_f32 v125, v125, v6
    v_mul_f32 v126, v126, v6
    v_mul_f32 v127, v127, v6
    v_cvt_pk_bf16_f32 v172, v120, v121
    v_cvt_pk_bf16_f32 v173, v122, v123
    v_cvt_pk_bf16_f32 v174, v124, v125
    v_cvt_pk_bf16_f32 v175, v126, v127
    buffer_store_dwordx4 v[172:175], v1, s[12:15], s37 offen offset:3072 sc1
    v_mul_f32 v128, v128, v6
    v_mul_f32 v129, v129, v6
    v_mul_f32 v130, v130, v6
    v_mul_f32 v131, v131, v6
    v_mul_f32 v132, v132, v6
    v_mul_f32 v133, v133, v6
    v_mul_f32 v134, v134, v6
    v_mul_f32 v135, v135, v6
    v_cvt_pk_bf16_f32 v176, v128, v129
    v_cvt_pk_bf16_f32 v177, v130, v131
    v_cvt_pk_bf16_f32 v178, v132, v133
    v_cvt_pk_bf16_f32 v179, v134, v135
    s_add_u32 s37, s37, 4096
    buffer_store_dwordx4 v[176:179], v1, s[12:15], s37 offen offset:0 sc1
    v_mul_f32 v136, v136, v6
    v_mul_f32 v137, v137, v6
    v_mul_f32 v138, v138, v6
    v_mul_f32 v139, v139, v6
    v_mul_f32 v140, v140, v6
    v_mul_f32 v141, v141, v6
    v_mul_f32 v142, v142, v6
    v_mul_f32 v143, v143, v6
    v_cvt_pk_bf16_f32 v180, v136, v137
    v_cvt_pk_bf16_f32 v181, v138, v139
    v_cvt_pk_bf16_f32 v182, v140, v141
    v_cvt_pk_bf16_f32 v183, v142, v143
    buffer_store_dwordx4 v[180:183], v1, s[12:15], s37 offen offset:1024 sc1
    v_mul_f32 v144, v144, v6
    v_mul_f32 v145, v145, v6
    v_mul_f32 v146, v146, v6
    v_mul_f32 v147, v147, v6
    v_mul_f32 v148, v148, v6
    v_mul_f32 v149, v149, v6
    v_mul_f32 v150, v150, v6
    v_mul_f32 v151, v151, v6
    v_cvt_pk_bf16_f32 v184, v144, v145
    v_cvt_pk_bf16_f32 v185, v146, v147
    v_cvt_pk_bf16_f32 v186, v148, v149
    v_cvt_pk_bf16_f32 v187, v150, v151
    buffer_store_dwordx4 v[184:187], v1, s[12:15], s37 offen offset:2048 sc1
    v_mul_f32 v152, v152, v6
    v_mul_f32 v153, v153, v6
    v_mul_f32 v154, v154, v6
    v_mul_f32 v155, v155, v6
    v_mul_f32 v156, v156, v6
    v_mul_f32 v157, v157, v6
    v_mul_f32 v158, v158, v6
    v_mul_f32 v159, v159, v6
    v_cvt_pk_bf16_f32 v188, v152, v153
    v_cvt_pk_bf16_f32 v189, v154, v155
    v_cvt_pk_bf16_f32 v190, v156, v157
    v_cvt_pk_bf16_f32 v191, v158, v159
    buffer_store_dwordx4 v[188:191], v1, s[12:15], s37 offen offset:3072 sc1
    s_lshl_b32 s22, s20, 5
    s_add_u32 s22, s22, s21
    s_lshl_b32 s22, s22, 2
    s_add_u32 s22, s22, 146821120
    v_mov_b32 v4, 1
    s_waitcnt vmcnt(0)
    buffer_store_dword v4, off, s[12:15], s22 sc1
ch_fe_116:
    v_mov_b32 v3, v252
    s_endpgm
mn_zero:
    v_lshrrev_b32 v1, 6, v0
    s_load_dwordx2 s[40:41], s[0:1], 120
    s_load_dwordx2 s[42:43], s[0:1], 112
    v_readfirstlane_b32 s4, v1
    s_waitcnt lgkmcnt(0)
    s_mov_b32 s12, s40
    s_mov_b32 s13, s41
    s_mov_b32 s14, 0x10000000
    s_mov_b32 s15, 0x00020000
    s_mov_b32 s16, s42
    s_mov_b32 s17, s43
    s_mov_b32 s18, 0x100
    s_mov_b32 s19, 0x00020000
    s_cmp_lg_u32 s4, 3
    s_cbranch_scc1 mn_noz
    v_and_b32 v1, 63, v0
    v_lshlrev_b32 v1, 4, v1
    v_mov_b64 v[4:5], 0
    v_mov_b64 v[6:7], 0
    s_mov_b32 s44, 146800640
    buffer_store_dwordx4 v[4:7], v1, s[12:15], s44 offen offset:0 sc1
    buffer_store_dwordx4 v[4:7], v1, s[12:15], s44 offen offset:1024 sc1
    buffer_store_dwordx4 v[4:7], v1, s[12:15], s44 offen offset:2048 sc1
    buffer_store_dwordx4 v[4:7], v1, s[12:15], s44 offen offset:3072 sc1
    s_mov_b32 s44, 146804736
    buffer_store_dwordx4 v[4:7], v1, s[12:15], s44 offen offset:0 sc1
    buffer_store_dwordx4 v[4:7], v1, s[12:15], s44 offen offset:1024 sc1
    buffer_store_dwordx4 v[4:7], v1, s[12:15], s44 offen offset:2048 sc1
    buffer_store_dwordx4 v[4:7], v1, s[12:15], s44 offen offset:3072 sc1
    s_mov_b32 s44, 146808832
    buffer_store_dwordx4 v[4:7], v1, s[12:15], s44 offen offset:0 sc1
    buffer_store_dwordx4 v[4:7], v1, s[12:15], s44 offen offset:1024 sc1
    buffer_store_dwordx4 v[4:7], v1, s[12:15], s44 offen offset:2048 sc1
    buffer_store_dwordx4 v[4:7], v1, s[12:15], s44 offen offset:3072 sc1
    s_mov_b32 s44, 146812928
    buffer_store_dwordx4 v[4:7], v1, s[12:15], s44 offen offset:0 sc1
    buffer_store_dwordx4 v[4:7], v1, s[12:15], s44 offen offset:1024 sc1
    buffer_store_dwordx4 v[4:7], v1, s[12:15], s44 offen offset:2048 sc1
    buffer_store_dwordx4 v[4:7], v1, s[12:15], s44 offen offset:3072 sc1
    s_mov_b32 s44, 146817024
    buffer_store_dwordx4 v[4:7], v1, s[12:15], s44 offen offset:0 sc1
    buffer_store_dwordx4 v[4:7], v1, s[12:15], s44 offen offset:1024 sc1
    buffer_store_dwordx4 v[4:7], v1, s[12:15], s44 offen offset:2048 sc1
    buffer_store_dwordx4 v[4:7], v1, s[12:15], s44 offen offset:3072 sc1
    s_mov_b32 s44, 146821120
    buffer_store_dwordx4 v[4:7], v1, s[12:15], s44 offen offset:0 sc1
    buffer_store_dwordx4 v[4:7], v1, s[12:15], s44 offen offset:1024 sc1
    buffer_store_dwordx4 v[4:7], v1, s[12:15], s44 offen offset:2048 sc1
    buffer_store_dwordx4 v[4:7], v1, s[12:15], s44 offen offset:3072 sc1
    s_mov_b32 s44, 146825216
    buffer_store_dwordx4 v[4:7], v1, s[12:15], s44 offen offset:0 sc1
    buffer_store_dwordx4 v[4:7], v1, s[12:15], s44 offen offset:1024 sc1
    buffer_store_dwordx4 v[4:7], v1, s[12:15], s44 offen offset:2048 sc1
    buffer_store_dwordx4 v[4:7], v1, s[12:15], s44 offen offset:3072 sc1
    s_mov_b32 s44, 146829312
    buffer_store_dwordx4 v[4:7], v1, s[12:15], s44 offen offset:0 sc1
    buffer_store_dwordx4 v[4:7], v1, s[12:15], s44 offen offset:1024 sc1
    buffer_store_dwordx4 v[4:7], v1, s[12:15], s44 offen offset:2048 sc1
    buffer_store_dwordx4 v[4:7], v1, s[12:15], s44 offen offset:3072 sc1
    s_mov_b32 s44, 146833408
    buffer_store_dwordx4 v[4:7], v1, s[12:15], s44 offen offset:0 sc1
    buffer_store_dwordx4 v[4:7], v1, s[12:15], s44 offen offset:1024 sc1
    buffer_store_dwordx4 v[4:7], v1, s[12:15], s44 offen offset:2048 sc1
    buffer_store_dwordx4 v[4:7], v1, s[12:15], s44 offen offset:3072 sc1
    s_mov_b32 s44, 146837504
    buffer_store_dwordx4 v[4:7], v1, s[12:15], s44 offen offset:0 sc1
    buffer_store_dwordx4 v[4:7], v1, s[12:15], s44 offen offset:1024 sc1
    buffer_store_dwordx4 v[4:7], v1, s[12:15], s44 offen offset:2048 sc1
    buffer_store_dwordx4 v[4:7], v1, s[12:15], s44 offen offset:3072 sc1
    s_mov_b32 s44, 146841600
    buffer_store_dwordx4 v[4:7], v1, s[12:15], s44 offen offset:0 sc1
    buffer_store_dwordx4 v[4:7], v1, s[12:15], s44 offen offset:1024 sc1
    buffer_store_dwordx4 v[4:7], v1, s[12:15], s44 offen offset:2048 sc1
    buffer_store_dwordx4 v[4:7], v1, s[12:15], s44 offen offset:3072 sc1
    s_mov_b32 s44, 146845696
    buffer_store_dwordx4 v[4:7], v1, s[12:15], s44 offen offset:0 sc1
    buffer_store_dwordx4 v[4:7], v1, s[12:15], s44 offen offset:1024 sc1
    buffer_store_dwordx4 v[4:7], v1, s[12:15], s44 offen offset:2048 sc1
    buffer_store_dwordx4 v[4:7], v1, s[12:15], s44 offen offset:3072 sc1
    s_mov_b32 s44, 146849792
    buffer_store_dwordx4 v[4:7], v1, s[12:15], s44 offen offset:0 sc1
    buffer_store_dwordx4 v[4:7], v1, s[12:15], s44 offen offset:1024 sc1
    buffer_store_dwordx4 v[4:7], v1, s[12:15], s44 offen offset:2048 sc1
    buffer_store_dwordx4 v[4:7], v1, s[12:15], s44 offen offset:3072 sc1
    s_waitcnt vmcnt(0)
    s_nop 0
    v_mov_b32 v4, 1
    buffer_store_dword v4, off, s[16:19], 0 offset:196 sc1
    s_branch mn_noz
rl_ovf_1:
    s_mov_b64 exec, 0x1ff
    v_lshlrev_b32 v4, 5, v0
    v_cmp_eq_u32_e64 vcc, 8, v0
    v_mov_b32 v5, 132
    s_nop 0
    v_cndmask_b32_e64 v4, v4, v5, vcc
    s_mov_b32 s46, 0
sp_90001:
    buffer_load_dword v5, v4, s[16:19], 0 offen sc1
    s_waitcnt vmcnt(0)
    v_readlane_b32 s47, v5, 8
    v_readlane_b32 s48, v5, 0
    s_nop 0
    s_add_u32 s47, s47, s48
    v_readlane_b32 s48, v5, 1
    s_nop 0
    s_add_u32 s47, s47, s48
    v_readlane_b32 s48, v5, 2
    s_nop 0
    s_add_u32 s47, s47, s48
    v_readlane_b32 s48, v5, 3
    s_nop 0
    s_add_u32 s47, s47, s48
    v_readlane_b32 s48, v5, 4
    s_nop 0
    s_add_u32 s47, s47, s48
    v_readlane_b32 s48, v5, 5
    s_nop 0
    s_add_u32 s47, s47, s48
    v_readlane_b32 s48, v5, 6
    s_nop 0
    s_add_u32 s47, s47, s48
    v_readlane_b32 s48, v5, 7
    s_nop 0
    s_add_u32 s47, s47, s48
    s_cmp_ge_u32 s47, 256
    s_cbranch_scc1 spd_90002
    s_add_u32 s46, s46, 1
    s_sleep 4
    s_cmp_lt_u32 s46, 32768
    s_cbranch_scc1 sp_90001
spd_90002:
    s_mov_b64 exec, 1
    v_mov_b32_e64 v3, 1
    buffer_atomic_add v3, off, s[16:19], 0 offset:136 sc0
    s_waitcnt vmcnt(0)
    v_readfirstlane_b32 s46, v3
    s_mov_b32 s45, 256
    s_mov_b32 s48, 0
    v_readlane_b32 s47, v5, 0
    s_nop 0
    s_min_u32 s47, s47, 32
    s_add_u32 s49, s47, s46
    s_add_u32 s49, s49, 0
    s_sub_u32 s47, 32, s47
    s_cmp_lt_u32 s46, s47
    s_cselect_b32 s50, 1, 0
    s_andn2_b32 s50, s50, s48
    s_cmp_lg_u32 s50, 0
    s_cselect_b32 s45, s49, s45
    s_or_b32 s48, s48, s50
    s_sub_u32 s46, s46, s47
    v_readlane_b32 s47, v5, 1
    s_nop 0
    s_min_u32 s47, s47, 32
    s_add_u32 s49, s47, s46
    s_add_u32 s49, s49, 32
    s_sub_u32 s47, 32, s47
    s_cmp_lt_u32 s46, s47
    s_cselect_b32 s50, 1, 0
    s_andn2_b32 s50, s50, s48
    s_cmp_lg_u32 s50, 0
    s_cselect_b32 s45, s49, s45
    s_or_b32 s48, s48, s50
    s_sub_u32 s46, s46, s47
    v_readlane_b32 s47, v5, 2
    s_nop 0
    s_min_u32 s47, s47, 32
    s_add_u32 s49, s47, s46
    s_add_u32 s49, s49, 64
    s_sub_u32 s47, 32, s47
    s_cmp_lt_u32 s46, s47
    s_cselect_b32 s50, 1, 0
    s_andn2_b32 s50, s50, s48
    s_cmp_lg_u32 s50, 0
    s_cselect_b32 s45, s49, s45
    s_or_b32 s48, s48, s50
    s_sub_u32 s46, s46, s47
    v_readlane_b32 s47, v5, 3
    s_nop 0
    s_min_u32 s47, s47, 32
    s_add_u32 s49, s47, s46
    s_add_u32 s49, s49, 96
    s_sub_u32 s47, 32, s47
    s_cmp_lt_u32 s46, s47
    s_cselect_b32 s50, 1, 0
    s_andn2_b32 s50, s50, s48
    s_cmp_lg_u32 s50, 0
    s_cselect_b32 s45, s49, s45
    s_or_b32 s48, s48, s50
    s_sub_u32 s46, s46, s47
    v_readlane_b32 s47, v5, 4
    s_nop 0
    s_min_u32 s47, s47, 32
    s_add_u32 s49, s47, s46
    s_add_u32 s49, s49, 128
    s_sub_u32 s47, 32, s47
    s_cmp_lt_u32 s46, s47
    s_cselect_b32 s50, 1, 0
    s_andn2_b32 s50, s50, s48
    s_cmp_lg_u32 s50, 0
    s_cselect_b32 s45, s49, s45
    s_or_b32 s48, s48, s50
    s_sub_u32 s46, s46, s47
    v_readlane_b32 s47, v5, 5
    s_nop 0
    s_min_u32 s47, s47, 32
    s_add_u32 s49, s47, s46
    s_add_u32 s49, s49, 160
    s_sub_u32 s47, 32, s47
    s_cmp_lt_u32 s46, s47
    s_cselect_b32 s50, 1, 0
    s_andn2_b32 s50, s50, s48
    s_cmp_lg_u32 s50, 0
    s_cselect_b32 s45, s49, s45
    s_or_b32 s48, s48, s50
    s_sub_u32 s46, s46, s47
    v_readlane_b32 s47, v5, 6
    s_nop 0
    s_min_u32 s47, s47, 32
    s_add_u32 s49, s47, s46
    s_add_u32 s49, s49, 192
    s_sub_u32 s47, 32, s47
    s_cmp_lt_u32 s46, s47
    s_cselect_b32 s50, 1, 0
    s_andn2_b32 s50, s50, s48
    s_cmp_lg_u32 s50, 0
    s_cselect_b32 s45, s49, s45
    s_or_b32 s48, s48, s50
    s_sub_u32 s46, s46, s47
    v_readlane_b32 s47, v5, 7
    s_nop 0
    s_min_u32 s47, s47, 32
    s_add_u32 s49, s47, s46
    s_add_u32 s49, s49, 224
    s_sub_u32 s47, 32, s47
    s_cmp_lt_u32 s46, s47
    s_cselect_b32 s50, 1, 0
    s_andn2_b32 s50, s50, s48
    s_cmp_lg_u32 s50, 0
    s_cselect_b32 s45, s49, s45
    s_or_b32 s48, s48, s50
    s_sub_u32 s46, s46, s47
    s_branch rl_got_2
mn_bulk:
    s_load_dwordx2 s[40:41], s[0:1], 120
    s_load_dwordx8 s[84:91], s[0:1], 16
    s_lshr_b32 s6, s5, 5
    s_and_b32 s7, s5, 31
    s_sub_u32 s61, s5, 32
    s_mov_b32 s34, 0
    s_cmp_ge_u32 s61, 80
    s_cbranch_scc1 mn_pb
    s_cmp_lg_u32 s6, 1
    s_cbranch_scc1 mn_pa
    s_waitcnt lgkmcnt(0)
    s_mov_b32 s12, s40
    s_mov_b32 s13, s41
    s_mov_b32 s14, 0x10000000
    s_mov_b32 s15, 0x00020000
    s_load_dwordx2 s[46:47], s[0:1], 112
    s_waitcnt lgkmcnt(0)
    s_mov_b32 s48, s46
    s_mov_b32 s49, s47
    s_mov_b32 s50, 0x100
    s_mov_b32 s51, 0x00020000
    s_mov_b32 s45, 0
sp_117:
    buffer_load_dword v4, off, s[48:51], 0 offset:196 sc1
    s_waitcnt vmcnt(0)
    v_readfirstlane_b32 s44, v4
    s_nop 0
    s_cmp_ge_u32 s44, 1
    s_cbranch_scc1 spd_118
    s_add_u32 s45, s45, 1
    s_sleep 4
    s_cmp_lt_u32 s45, 32768
    s_cbranch_scc1 sp_117
spd_118:
    s_lshl_b32 s60, s7, 7
    s_add_u32 s60, s60, 146804800
    s_mov_b32 s63, 0
sp_119:
    buffer_load_dword v4, off, s[12:15], s60 offset:0 sc1
    s_waitcnt vmcnt(0)
    v_readfirstlane_b32 s62, v4
    s_nop 0
    s_cmp_ge_u32 s62, 1
    s_cbranch_scc1 spd_120
    s_add_u32 s63, s63, 1
    s_sleep 16
    s_cmp_lt_u32 s63, 32768
    s_cbranch_scc1 sp_119
spd_120:
mn_pa:
    s_mov_b32 s22, 1
    s_lshl_b32 s27, s7, 7
    s_cmp_eq_u32 s6, 1
    s_cselect_b32 s21, 51, 0
    s_cselect_b32 s23, 13, 51
    s_cselect_b32 s62, 4, 0
    s_mov_b32 s34, s21
    s_cmp_eq_u32 s6, 3
    s_cselect_b32 s23, 64, s23
    s_cselect_b32 s62, 8192, s62
    s_cselect_b32 s61, 32, 0
    s_add_u32 s61, s61, s7
    s_add_u32 s27, s27, s62
    s_add_u32 s27, s27, 146800640
    s_cmp_ge_u32 s61, 48
    s_cselect_b32 s42, 1, 0
    s_cselect_b32 s43, 48, 0
    s_sub_u32 s61, s61, s43
    s_cmp_ge_u32 s61, 32
    s_cselect_b32 s43, 1, 0
    s_cselect_b32 s44, 56, 64
    s_cmp_eq_u32 s42, 0
    s_cselect_b32 s44, 0, s44
    s_lshr_b32 s45, s4, 1
    s_add_u32 s46, s45, 1
    s_cmp_eq_u32 s43, 1
    s_cselect_b32 s46, 0, s46
    s_sub_u32 s47, s61, 32
    s_lshl_b32 s47, s47, 1
    s_add_u32 s47, s47, s45
    s_cmp_eq_u32 s43, 1
    s_cselect_b32 s47, s47, s61
    s_cselect_b32 s26, 0x3e0293ee, 1.0
    s_cmp_eq_u32 s46, 2
    s_cselect_b32 s25, 1, 0
    s_mul_i32 s48, s42, 56
    s_lshl_b32 s49, s46, 3
    s_add_u32 s48, s48, s49
    s_add_u32 s48, s48, 16
    s_load_dwordx2 s[50:51], s[0:1], s48
    s_load_dwordx2 s[52:53], s[0:1], s44
    s_and_b32 s45, s4, 1
    s_lshl_b32 s20, s47, 8
    s_lshl_b32 s49, s45, 7
    s_add_u32 s20, s20, s49
    s_mul_i32 s48, s42, 3
    s_add_u32 s48, s48, s46
    s_lshl_b32 s24, s48, 24
    s_lshl_b32 s49, s47, 19
    s_add_u32 s24, s24, s49
    s_lshl_b32 s49, s45, 12
    s_add_u32 s24, s24, s49
    s_waitcnt lgkmcnt(0)
    s_mov_b32 s12, s40
    s_mov_b32 s13, s41
    s_mov_b32 s14, 0x10000000
    s_mov_b32 s15, 0x00020000
    s_mov_b32 s16, s52
    s_mov_b32 s17, s53
    s_mov_b32 s18, 0x200000
    s_mov_b32 s19, 0x00020000
    s_mov_b32 s8, s50
    s_mov_b32 s9, s51
    s_mov_b32 s10, 0x400000
    s_mov_b32 s11, 0x00020000
    v_lshlrev_b32 v1, 4, v0
    s_lshl_b32 s31, s22, 15
    s_lshl_b32 s32, s22, 13
    s_lshl_b32 s28, s21, 15
    s_lshl_b32 s36, s4, 13
    s_add_u32 s28, s28, s36
    s_mul_i32 s30, s4, 8320
    s_lshr_b32 s36, s4, 1
    s_lshl_b32 s36, s36, 7
    s_add_u32 s30, s30, s36
    v_bfe_u32 v4, v0, 3, 3
    v_lshlrev_b32 v5, 13, v4
    v_bfe_u32 v4, v0, 0, 3
    v_lshl_add_u32 v5, v4, 4, v5
    v_bfe_u32 v4, v0, 4, 2
    v_lshlrev_b32 v6, 10, v4
    v_bfe_u32 v4, v0, 2, 2
    v_lshl_add_u32 v6, v4, 7, v6
    v_bfe_u32 v4, v0, 1, 1
    v_lshl_add_u32 v6, v4, 5, v6
    v_bfe_u32 v4, v0, 0, 1
    v_lshl_add_u32 v6, v4, 3, v6
    s_lshl_b32 s38, s4, 14
    s_add_u32 s38, s38, 66816
    v_add_u32 v6, s38, v6
    s_cmp_lg_u32 s25, 0
    s_cselect_b32 s41, 8448, 0
    s_add_u32 s41, s41, 8320
    s_sub_u32 s42, 25088, s41
    v_and_b32 v4, 7, v0
    v_mul_u32_u24 v2, 1040, v4
    v_bfe_u32 v4, v0, 3, 1
    v_mul_lo_u32 v4, v4, s41
    v_add_u32 v2, v2, v4
    v_lshrrev_b32 v4, 4, v0
    v_lshl_add_u32 v2, v4, 8, v2
    v_add_u32 v10, s42, v2
    s_load_dwordx2 s[46:47], s[0:1], 112
    s_add_u32 m0, s38, 0
    s_add_u32 s39, s20, 0
    buffer_load_dwordx4 v5, s[8:11], s39 offen  lds
    s_add_u32 m0, s38, 1024
    s_add_u32 s39, s20, 1048576
    buffer_load_dwordx4 v5, s[8:11], s39 offen  lds
    s_add_u32 m0, s38, 2048
    s_add_u32 s39, s20, 2097152
    buffer_load_dwordx4 v5, s[8:11], s39 offen  lds
    s_add_u32 m0, s38, 3072
    s_add_u32 s39, s20, 3145728
    buffer_load_dwordx4 v5, s[8:11], s39 offen  lds
    s_add_u32 m0, s30, 0
    s_nop 0
    buffer_load_dwordx4 v1, s[16:19], s28 offen offset:0 lds
    s_add_u32 m0, s30, 16
    s_nop 0
    buffer_load_dwordx4 v1, s[16:19], s28 offen offset:1024 lds
    s_add_u32 m0, s30, 32
    s_nop 0
    buffer_load_dwordx4 v1, s[16:19], s28 offen offset:2048 lds
    s_add_u32 m0, s30, 48
    s_nop 0
    buffer_load_dwordx4 v1, s[16:19], s28 offen offset:3072 lds
    s_add_u32 s37, s28, 4096
    s_add_u32 m0, s30, 4160
    s_nop 0
    buffer_load_dwordx4 v1, s[16:19], s37 offen offset:0 lds
    s_add_u32 m0, s30, 4176
    s_nop 0
    buffer_load_dwordx4 v1, s[16:19], s37 offen offset:1024 lds
    s_add_u32 m0, s30, 4192
    s_nop 0
    buffer_load_dwordx4 v1, s[16:19], s37 offen offset:2048 lds
    s_add_u32 m0, s30, 4208
    s_nop 0
    buffer_load_dwordx4 v1, s[16:19], s37 offen offset:3072 lds
    s_add_u32 s28, s28, s31
    s_add_u32 s30, s30, 33408
    s_cmp_ge_u32 s30, 133632
    s_cselect_b32 s37, 133632, 0
    s_sub_u32 s30, s30, s37
    s_add_u32 m0, s30, 0
    s_nop 0
    buffer_load_dwordx4 v1, s[16:19], s28 offen offset:0 lds
    s_add_u32 m0, s30, 16
    s_nop 0
    buffer_load_dwordx4 v1, s[16:19], s28 offen offset:1024 lds
    s_add_u32 m0, s30, 32
    s_nop 0
    buffer_load_dwordx4 v1, s[16:19], s28 offen offset:2048 lds
    s_add_u32 m0, s30, 48
    s_nop 0
    buffer_load_dwordx4 v1, s[16:19], s28 offen offset:3072 lds
    s_add_u32 s37, s28, 4096
    s_add_u32 m0, s30, 4160
    s_nop 0
    buffer_load_dwordx4 v1, s[16:19], s37 offen offset:0 lds
    s_add_u32 m0, s30, 4176
    s_nop 0
    buffer_load_dwordx4 v1, s[16:19], s37 offen offset:1024 lds
    s_add_u32 m0, s30, 4192
    s_nop 0
    buffer_load_dwordx4 v1, s[16:19], s37 offen offset:2048 lds
    s_add_u32 m0, s30, 4208
    s_nop 0
    buffer_load_dwordx4 v1, s[16:19], s37 offen offset:3072 lds
    s_add_u32 s28, s28, s31
    s_add_u32 s30, s30, 33408
    s_cmp_ge_u32 s30, 133632
    s_cselect_b32 s37, 133632, 0
    s_sub_u32 s30, s30, s37
    s_add_u32 m0, s38, 4096
    s_add_u32 s39, s20, 65536
    buffer_load_dwordx4 v5, s[8:11], s39 offen  lds
    s_add_u32 m0, s38, 5120
    s_add_u32 s39, s20, 1114112
    buffer_load_dwordx4 v5, s[8:11], s39 offen  lds
    s_add_u32 m0, s38, 6144
    s_add_u32 s39, s20, 2162688
    buffer_load_dwordx4 v5, s[8:11], s39 offen  lds
    s_add_u32 m0, s38, 7168
    s_add_u32 s39, s20, 3211264
    buffer_load_dwordx4 v5, s[8:11], s39 offen  lds
    s_add_u32 m0, s38, 8192
    s_add_u32 s39, s20, 131072
    buffer_load_dwordx4 v5, s[8:11], s39 offen  lds
    s_add_u32 m0, s38, 9216
    s_add_u32 s39, s20, 1179648
    buffer_load_dwordx4 v5, s[8:11], s39 offen  lds
    s_add_u32 m0, s38, 10240
    s_add_u32 s39, s20, 2228224
    buffer_load_dwordx4 v5, s[8:11], s39 offen  lds
    s_add_u32 m0, s38, 11264
    s_add_u32 s39, s20, 3276800
    buffer_load_dwordx4 v5, s[8:11], s39 offen  lds
    s_add_u32 m0, s38, 12288
    s_add_u32 s39, s20, 196608
    buffer_load_dwordx4 v5, s[8:11], s39 offen  lds
    s_add_u32 m0, s38, 13312
    s_add_u32 s39, s20, 1245184
    buffer_load_dwordx4 v5, s[8:11], s39 offen  lds
    s_add_u32 m0, s38, 14336
    s_add_u32 s39, s20, 2293760
    buffer_load_dwordx4 v5, s[8:11], s39 offen  lds
    s_add_u32 m0, s38, 15360
    s_add_u32 s39, s20, 3342336
    buffer_load_dwordx4 v5, s[8:11], s39 offen  lds
    s_waitcnt lgkmcnt(0)
    s_mov_b32 s48, s46
    s_mov_b32 s49, s47
    s_mov_b32 s50, 0x100
    s_mov_b32 s51, 0x00020000
    s_waitcnt vmcnt(12)
    s_barrier
    ds_read_b128 v[16:19], v2 offset:0
    ds_read_b128 v[20:23], v10 offset:0
    ds_read_b128 v[24:27], v2 offset:33408
    ds_read_b128 v[28:31], v10 offset:33408
    ds_read_b64_tr_b16 a[0:1], v6 offset:0
    ds_read_b64_tr_b16 a[2:3], v6 offset:512
    ds_read_b64_tr_b16 a[4:5], v6 offset:16
    ds_read_b64_tr_b16 a[6:7], v6 offset:528
    ds_read_b64_tr_b16 a[8:9], v6 offset:64
    ds_read_b64_tr_b16 a[10:11], v6 offset:576
    ds_read_b64_tr_b16 a[12:13], v6 offset:80
    ds_read_b64_tr_b16 a[14:15], v6 offset:592
    s_waitcnt lgkmcnt(0)
    s_add_u32 m0, s38, 0
    s_add_u32 s39, s20, 262144
    buffer_load_dwordx4 v5, s[8:11], s39 offen  lds
    s_add_u32 m0, s38, 1024
    s_add_u32 s39, s20, 1310720
    buffer_load_dwordx4 v5, s[8:11], s39 offen  lds
    s_add_u32 m0, s38, 2048
    s_add_u32 s39, s20, 2359296
    buffer_load_dwordx4 v5, s[8:11], s39 offen  lds
    s_add_u32 m0, s38, 3072
    s_add_u32 s39, s20, 3407872
    buffer_load_dwordx4 v5, s[8:11], s39 offen  lds
    s_cmp_lg_u32 s25, 0
    s_cbranch_scc1 pj_hv_121
    v_mfma_f32_16x16x32_bf16 v[64:67], a[0:3], v[16:19], 0
    v_mfma_f32_16x16x32_bf16 v[68:71], a[4:7], v[16:19], 0
    v_mfma_f32_16x16x32_bf16 v[72:75], a[8:11], v[16:19], 0
    v_mfma_f32_16x16x32_bf16 v[76:79], a[12:15], v[16:19], 0
    v_mfma_f32_16x16x32_bf16 v[80:83], a[0:3], v[20:23], 0
    v_mfma_f32_16x16x32_bf16 v[84:87], a[4:7], v[20:23], 0
    v_mfma_f32_16x16x32_bf16 v[88:91], a[8:11], v[20:23], 0
    v_mfma_f32_16x16x32_bf16 v[92:95], a[12:15], v[20:23], 0
    v_mfma_f32_16x16x32_bf16 v[96:99], a[0:3], v[24:27], 0
    v_mfma_f32_16x16x32_bf16 v[100:103], a[4:7], v[24:27], 0
    v_mfma_f32_16x16x32_bf16 v[104:107], a[8:11], v[24:27], 0
    v_mfma_f32_16x16x32_bf16 v[108:111], a[12:15], v[24:27], 0
    v_mfma_f32_16x16x32_bf16 v[112:115], a[0:3], v[28:31], 0
    v_mfma_f32_16x16x32_bf16 v[116:119], a[4:7], v[28:31], 0
    v_mfma_f32_16x16x32_bf16 v[120:123], a[8:11], v[28:31], 0
    v_mfma_f32_16x16x32_bf16 v[124:127], a[12:15], v[28:31], 0
    s_branch pj_hj_122
pj_hv_121:
    v_mfma_f32_16x16x32_bf16 v[64:67], v[16:19], a[0:3], 0
    v_mfma_f32_16x16x32_bf16 v[68:71], v[16:19], a[4:7], 0
    v_mfma_f32_16x16x32_bf16 v[72:75], v[16:19], a[8:11], 0
    v_mfma_f32_16x16x32_bf16 v[76:79], v[16:19], a[12:15], 0
    v_mfma_f32_16x16x32_bf16 v[80:83], v[20:23], a[0:3], 0
    v_mfma_f32_16x16x32_bf16 v[84:87], v[20:23], a[4:7], 0
    v_mfma_f32_16x16x32_bf16 v[88:91], v[20:23], a[8:11], 0
    v_mfma_f32_16x16x32_bf16 v[92:95], v[20:23], a[12:15], 0
    v_mfma_f32_16x16x32_bf16 v[96:99], v[24:27], a[0:3], 0
    v_mfma_f32_16x16x32_bf16 v[100:103], v[24:27], a[4:7], 0
    v_mfma_f32_16x16x32_bf16 v[104:107], v[24:27], a[8:11], 0
    v_mfma_f32_16x16x32_bf16 v[108:111], v[24:27], a[12:15], 0
    v_mfma_f32_16x16x32_bf16 v[112:115], v[28:31], a[0:3], 0
    v_mfma_f32_16x16x32_bf16 v[116:119], v[28:31], a[4:7], 0
    v_mfma_f32_16x16x32_bf16 v[120:123], v[28:31], a[8:11], 0
    v_mfma_f32_16x16x32_bf16 v[124:127], v[28:31], a[12:15], 0
    s_nop 0
pj_hj_122:
    s_waitcnt vmcnt(12)
    ds_read_b128 v[32:35], v2 offset:16
    ds_read_b128 v[36:39], v10 offset:16
    ds_read_b128 v[40:43], v2 offset:33424
    ds_read_b128 v[44:47], v10 offset:33424
    ds_read_b64_tr_b16 a[16:17], v6 offset:4096
    ds_read_b64_tr_b16 a[18:19], v6 offset:4608
    ds_read_b64_tr_b16 a[20:21], v6 offset:4112
    ds_read_b64_tr_b16 a[22:23], v6 offset:4624
    ds_read_b64_tr_b16 a[24:25], v6 offset:4160
    ds_read_b64_tr_b16 a[26:27], v6 offset:4672
    ds_read_b64_tr_b16 a[28:29], v6 offset:4176
    ds_read_b64_tr_b16 a[30:31], v6 offset:4688
    s_waitcnt lgkmcnt(0)
    s_add_u32 m0, s38, 4096
    s_add_u32 s39, s20, 327680
    buffer_load_dwordx4 v5, s[8:11], s39 offen  lds
    s_add_u32 m0, s38, 5120
    s_add_u32 s39, s20, 1376256
    buffer_load_dwordx4 v5, s[8:11], s39 offen  lds
    s_add_u32 m0, s38, 6144
    s_add_u32 s39, s20, 2424832
    buffer_load_dwordx4 v5, s[8:11], s39 offen  lds
    s_add_u32 m0, s38, 7168
    s_add_u32 s39, s20, 3473408
    buffer_load_dwordx4 v5, s[8:11], s39 offen  lds
    s_cmp_lg_u32 s25, 0
    s_cbranch_scc1 pj_hv_123
    v_mfma_f32_16x16x32_bf16 v[64:67], a[16:19], v[32:35], v[64:67]
    v_mfma_f32_16x16x32_bf16 v[68:71], a[20:23], v[32:35], v[68:71]
    v_mfma_f32_16x16x32_bf16 v[72:75], a[24:27], v[32:35], v[72:75]
    v_mfma_f32_16x16x32_bf16 v[76:79], a[28:31], v[32:35], v[76:79]
    v_mfma_f32_16x16x32_bf16 v[80:83], a[16:19], v[36:39], v[80:83]
    v_mfma_f32_16x16x32_bf16 v[84:87], a[20:23], v[36:39], v[84:87]
    v_mfma_f32_16x16x32_bf16 v[88:91], a[24:27], v[36:39], v[88:91]
    v_mfma_f32_16x16x32_bf16 v[92:95], a[28:31], v[36:39], v[92:95]
    v_mfma_f32_16x16x32_bf16 v[96:99], a[16:19], v[40:43], v[96:99]
    v_mfma_f32_16x16x32_bf16 v[100:103], a[20:23], v[40:43], v[100:103]
    v_mfma_f32_16x16x32_bf16 v[104:107], a[24:27], v[40:43], v[104:107]
    v_mfma_f32_16x16x32_bf16 v[108:111], a[28:31], v[40:43], v[108:111]
    v_mfma_f32_16x16x32_bf16 v[112:115], a[16:19], v[44:47], v[112:115]
    v_mfma_f32_16x16x32_bf16 v[116:119], a[20:23], v[44:47], v[116:119]
    v_mfma_f32_16x16x32_bf16 v[120:123], a[24:27], v[44:47], v[120:123]
    v_mfma_f32_16x16x32_bf16 v[124:127], a[28:31], v[44:47], v[124:127]
    s_branch pj_hj_124
pj_hv_123:
    v_mfma_f32_16x16x32_bf16 v[64:67], v[32:35], a[16:19], v[64:67]
    v_mfma_f32_16x16x32_bf16 v[68:71], v[32:35], a[20:23], v[68:71]
    v_mfma_f32_16x16x32_bf16 v[72:75], v[32:35], a[24:27], v[72:75]
    v_mfma_f32_16x16x32_bf16 v[76:79], v[32:35], a[28:31], v[76:79]
    v_mfma_f32_16x16x32_bf16 v[80:83], v[36:39], a[16:19], v[80:83]
    v_mfma_f32_16x16x32_bf16 v[84:87], v[36:39], a[20:23], v[84:87]
    v_mfma_f32_16x16x32_bf16 v[88:91], v[36:39], a[24:27], v[88:91]
    v_mfma_f32_16x16x32_bf16 v[92:95], v[36:39], a[28:31], v[92:95]
    v_mfma_f32_16x16x32_bf16 v[96:99], v[40:43], a[16:19], v[96:99]
    v_mfma_f32_16x16x32_bf16 v[100:103], v[40:43], a[20:23], v[100:103]
    v_mfma_f32_16x16x32_bf16 v[104:107], v[40:43], a[24:27], v[104:107]
    v_mfma_f32_16x16x32_bf16 v[108:111], v[40:43], a[28:31], v[108:111]
    v_mfma_f32_16x16x32_bf16 v[112:115], v[44:47], a[16:19], v[112:115]
    v_mfma_f32_16x16x32_bf16 v[116:119], v[44:47], a[20:23], v[116:119]
    s_nop 0
    v_mfma_f32_16x16x32_bf16 v[120:123], v[44:47], a[24:27], v[120:123]
    s_nop 0
    v_mfma_f32_16x16x32_bf16 v[124:127], v[44:47], a[28:31], v[124:127]
    s_nop 0
pj_hj_124:
    s_waitcnt vmcnt(12)
    ds_read_b128 v[16:19], v2 offset:32
    ds_read_b128 v[20:23], v10 offset:32
    ds_read_b128 v[24:27], v2 offset:33440
    ds_read_b128 v[28:31], v10 offset:33440
    ds_read_b64_tr_b16 a[32:33], v6 offset:8192
    ds_read_b64_tr_b16 a[34:35], v6 offset:8704
    ds_read_b64_tr_b16 a[36:37], v6 offset:8208
    ds_read_b64_tr_b16 a[38:39], v6 offset:8720
    ds_read_b64_tr_b16 a[40:41], v6 offset:8256
    ds_read_b64_tr_b16 a[42:43], v6 offset:8768
    ds_read_b64_tr_b16 a[44:45], v6 offset:8272
    ds_read_b64_tr_b16 a[46:47], v6 offset:8784
    s_waitcnt lgkmcnt(0)
    s_add_u32 m0, s38, 8192
    s_add_u32 s39, s20, 393216
    buffer_load_dwordx4 v5, s[8:11], s39 offen  lds
    s_add_u32 m0, s38, 9216
    s_add_u32 s39, s20, 1441792
    buffer_load_dwordx4 v5, s[8:11], s39 offen  lds
    s_add_u32 m0, s38, 10240
    s_add_u32 s39, s20, 2490368
    buffer_load_dwordx4 v5, s[8:11], s39 offen  lds
    s_add_u32 m0, s38, 11264
    s_add_u32 s39, s20, 3538944
    buffer_load_dwordx4 v5, s[8:11], s39 offen  lds
    s_cmp_lg_u32 s25, 0
    s_cbranch_scc1 pj_hv_125
    v_mfma_f32_16x16x32_bf16 v[64:67], a[32:35], v[16:19], v[64:67]
    v_mfma_f32_16x16x32_bf16 v[68:71], a[36:39], v[16:19], v[68:71]
    v_mfma_f32_16x16x32_bf16 v[72:75], a[40:43], v[16:19], v[72:75]
    v_mfma_f32_16x16x32_bf16 v[76:79], a[44:47], v[16:19], v[76:79]
    v_mfma_f32_16x16x32_bf16 v[80:83], a[32:35], v[20:23], v[80:83]
    v_mfma_f32_16x16x32_bf16 v[84:87], a[36:39], v[20:23], v[84:87]
    v_mfma_f32_16x16x32_bf16 v[88:91], a[40:43], v[20:23], v[88:91]
    v_mfma_f32_16x16x32_bf16 v[92:95], a[44:47], v[20:23], v[92:95]
    v_mfma_f32_16x16x32_bf16 v[96:99], a[32:35], v[24:27], v[96:99]
    v_mfma_f32_16x16x32_bf16 v[100:103], a[36:39], v[24:27], v[100:103]
    v_mfma_f32_16x16x32_bf16 v[104:107], a[40:43], v[24:27], v[104:107]
    v_mfma_f32_16x16x32_bf16 v[108:111], a[44:47], v[24:27], v[108:111]
    v_mfma_f32_16x16x32_bf16 v[112:115], a[32:35], v[28:31], v[112:115]
    v_mfma_f32_16x16x32_bf16 v[116:119], a[36:39], v[28:31], v[116:119]
    v_mfma_f32_16x16x32_bf16 v[120:123], a[40:43], v[28:31], v[120:123]
    v_mfma_f32_16x16x32_bf16 v[124:127], a[44:47], v[28:31], v[124:127]
    s_branch pj_hj_126
pj_hv_125:
    v_mfma_f32_16x16x32_bf16 v[64:67], v[16:19], a[32:35], v[64:67]
    v_mfma_f32_16x16x32_bf16 v[68:71], v[16:19], a[36:39], v[68:71]
    v_mfma_f32_16x16x32_bf16 v[72:75], v[16:19], a[40:43], v[72:75]
    v_mfma_f32_16x16x32_bf16 v[76:79], v[16:19], a[44:47], v[76:79]
    v_mfma_f32_16x16x32_bf16 v[80:83], v[20:23], a[32:35], v[80:83]
    v_mfma_f32_16x16x32_bf16 v[84:87], v[20:23], a[36:39], v[84:87]
    v_mfma_f32_16x16x32_bf16 v[88:91], v[20:23], a[40:43], v[88:91]
    v_mfma_f32_16x16x32_bf16 v[92:95], v[20:23], a[44:47], v[92:95]
    v_mfma_f32_16x16x32_bf16 v[96:99], v[24:27], a[32:35], v[96:99]
    v_mfma_f32_16x16x32_bf16 v[100:103], v[24:27], a[36:39], v[100:103]
    v_mfma_f32_16x16x32_bf16 v[104:107], v[24:27], a[40:43], v[104:107]
    v_mfma_f32_16x16x32_bf16 v[108:111], v[24:27], a[44:47], v[108:111]
    v_mfma_f32_16x16x32_bf16 v[112:115], v[28:31], a[32:35], v[112:115]
    v_mfma_f32_16x16x32_bf16 v[116:119], v[28:31], a[36:39], v[116:119]
    s_nop 0
    v_mfma_f32_16x16x32_bf16 v[120:123], v[28:31], a[40:43], v[120:123]
    s_nop 0
    v_mfma_f32_16x16x32_bf16 v[124:127], v[28:31], a[44:47], v[124:127]
    s_nop 0
pj_hj_126:
    s_waitcnt vmcnt(12)
    ds_read_b128 v[32:35], v2 offset:48
    ds_read_b128 v[36:39], v10 offset:48
    ds_read_b128 v[40:43], v2 offset:33456
    ds_read_b128 v[44:47], v10 offset:33456
    ds_read_b64_tr_b16 a[48:49], v6 offset:12288
    ds_read_b64_tr_b16 a[50:51], v6 offset:12800
    ds_read_b64_tr_b16 a[52:53], v6 offset:12304
    ds_read_b64_tr_b16 a[54:55], v6 offset:12816
    ds_read_b64_tr_b16 a[56:57], v6 offset:12352
    ds_read_b64_tr_b16 a[58:59], v6 offset:12864
    ds_read_b64_tr_b16 a[60:61], v6 offset:12368
    ds_read_b64_tr_b16 a[62:63], v6 offset:12880
    s_waitcnt lgkmcnt(0)
    s_add_u32 m0, s38, 12288
    s_add_u32 s39, s20, 458752
    buffer_load_dwordx4 v5, s[8:11], s39 offen  lds
    s_add_u32 m0, s38, 13312
    s_add_u32 s39, s20, 1507328
    buffer_load_dwordx4 v5, s[8:11], s39 offen  lds
    s_add_u32 m0, s38, 14336
    s_add_u32 s39, s20, 2555904
    buffer_load_dwordx4 v5, s[8:11], s39 offen  lds
    s_add_u32 m0, s38, 15360
    s_add_u32 s39, s20, 3604480
    buffer_load_dwordx4 v5, s[8:11], s39 offen  lds
    s_cmp_lg_u32 s25, 0
    s_cbranch_scc1 pj_hv_127
    v_mfma_f32_16x16x32_bf16 v[64:67], a[48:51], v[32:35], v[64:67]
    v_mfma_f32_16x16x32_bf16 v[68:71], a[52:55], v[32:35], v[68:71]
    v_mfma_f32_16x16x32_bf16 v[72:75], a[56:59], v[32:35], v[72:75]
    v_mfma_f32_16x16x32_bf16 v[76:79], a[60:63], v[32:35], v[76:79]
    v_mfma_f32_16x16x32_bf16 v[80:83], a[48:51], v[36:39], v[80:83]
    v_mfma_f32_16x16x32_bf16 v[84:87], a[52:55], v[36:39], v[84:87]
    v_mfma_f32_16x16x32_bf16 v[88:91], a[56:59], v[36:39], v[88:91]
    v_mfma_f32_16x16x32_bf16 v[92:95], a[60:63], v[36:39], v[92:95]
    v_mfma_f32_16x16x32_bf16 v[96:99], a[48:51], v[40:43], v[96:99]
    v_mfma_f32_16x16x32_bf16 v[100:103], a[52:55], v[40:43], v[100:103]
    v_mfma_f32_16x16x32_bf16 v[104:107], a[56:59], v[40:43], v[104:107]
    v_mfma_f32_16x16x32_bf16 v[108:111], a[60:63], v[40:43], v[108:111]
    v_mfma_f32_16x16x32_bf16 v[112:115], a[48:51], v[44:47], v[112:115]
    v_mfma_f32_16x16x32_bf16 v[116:119], a[52:55], v[44:47], v[116:119]
    v_mfma_f32_16x16x32_bf16 v[120:123], a[56:59], v[44:47], v[120:123]
    v_mfma_f32_16x16x32_bf16 v[124:127], a[60:63], v[44:47], v[124:127]
    s_branch pj_hj_128
pj_hv_127:
    v_mfma_f32_16x16x32_bf16 v[64:67], v[32:35], a[48:51], v[64:67]
    v_mfma_f32_16x16x32_bf16 v[68:71], v[32:35], a[52:55], v[68:71]
    v_mfma_f32_16x16x32_bf16 v[72:75], v[32:35], a[56:59], v[72:75]
    v_mfma_f32_16x16x32_bf16 v[76:79], v[32:35], a[60:63], v[76:79]
    v_mfma_f32_16x16x32_bf16 v[80:83], v[36:39], a[48:51], v[80:83]
    v_mfma_f32_16x16x32_bf16 v[84:87], v[36:39], a[52:55], v[84:87]
    v_mfma_f32_16x16x32_bf16 v[88:91], v[36:39], a[56:59], v[88:91]
    v_mfma_f32_16x16x32_bf16 v[92:95], v[36:39], a[60:63], v[92:95]
    v_mfma_f32_16x16x32_bf16 v[96:99], v[40:43], a[48:51], v[96:99]
    v_mfma_f32_16x16x32_bf16 v[100:103], v[40:43], a[52:55], v[100:103]
    v_mfma_f32_16x16x32_bf16 v[104:107], v[40:43], a[56:59], v[104:107]
    v_mfma_f32_16x16x32_bf16 v[108:111], v[40:43], a[60:63], v[108:111]
    v_mfma_f32_16x16x32_bf16 v[112:115], v[44:47], a[48:51], v[112:115]
    s_nop 0
    v_mfma_f32_16x16x32_bf16 v[116:119], v[44:47], a[52:55], v[116:119]
    s_nop 0
    v_mfma_f32_16x16x32_bf16 v[120:123], v[44:47], a[56:59], v[120:123]
    s_nop 0
    v_mfma_f32_16x16x32_bf16 v[124:127], v[44:47], a[60:63], v[124:127]
    s_nop 0
pj_hj_128:
    s_waitcnt vmcnt(12)
    ds_read_b128 v[16:19], v2 offset:64
    ds_read_b128 v[20:23], v10 offset:64
    ds_read_b128 v[24:27], v2 offset:33472
    ds_read_b128 v[28:31], v10 offset:33472
    ds_read_b64_tr_b16 a[64:65], v6 offset:0
    ds_read_b64_tr_b16 a[66:67], v6 offset:512
    ds_read_b64_tr_b16 a[68:69], v6 offset:16
    ds_read_b64_tr_b16 a[70:71], v6 offset:528
    ds_read_b64_tr_b16 a[72:73], v6 offset:64
    ds_read_b64_tr_b16 a[74:75], v6 offset:576
    ds_read_b64_tr_b16 a[76:77], v6 offset:80
    ds_read_b64_tr_b16 a[78:79], v6 offset:592
    s_waitcnt lgkmcnt(0)
    s_add_u32 m0, s38, 0
    s_add_u32 s39, s20, 524288
    buffer_load_dwordx4 v5, s[8:11], s39 offen  lds
    s_add_u32 m0, s38, 1024
    s_add_u32 s39, s20, 1572864
    buffer_load_dwordx4 v5, s[8:11], s39 offen  lds
    s_add_u32 m0, s38, 2048
    s_add_u32 s39, s20, 2621440
    buffer_load_dwordx4 v5, s[8:11], s39 offen  lds
    s_add_u32 m0, s38, 3072
    s_add_u32 s39, s20, 3670016
    buffer_load_dwordx4 v5, s[8:11], s39 offen  lds
    s_cmp_lg_u32 s25, 0
    s_cbranch_scc1 pj_hv_129
    v_mfma_f32_16x16x32_bf16 v[64:67], a[64:67], v[16:19], v[64:67]
    v_mfma_f32_16x16x32_bf16 v[68:71], a[68:71], v[16:19], v[68:71]
    v_mfma_f32_16x16x32_bf16 v[72:75], a[72:75], v[16:19], v[72:75]
    v_mfma_f32_16x16x32_bf16 v[76:79], a[76:79], v[16:19], v[76:79]
    v_mfma_f32_16x16x32_bf16 v[80:83], a[64:67], v[20:23], v[80:83]
    v_mfma_f32_16x16x32_bf16 v[84:87], a[68:71], v[20:23], v[84:87]
    v_mfma_f32_16x16x32_bf16 v[88:91], a[72:75], v[20:23], v[88:91]
    v_mfma_f32_16x16x32_bf16 v[92:95], a[76:79], v[20:23], v[92:95]
    v_mfma_f32_16x16x32_bf16 v[96:99], a[64:67], v[24:27], v[96:99]
    v_mfma_f32_16x16x32_bf16 v[100:103], a[68:71], v[24:27], v[100:103]
    v_mfma_f32_16x16x32_bf16 v[104:107], a[72:75], v[24:27], v[104:107]
    v_mfma_f32_16x16x32_bf16 v[108:111], a[76:79], v[24:27], v[108:111]
    v_mfma_f32_16x16x32_bf16 v[112:115], a[64:67], v[28:31], v[112:115]
    v_mfma_f32_16x16x32_bf16 v[116:119], a[68:71], v[28:31], v[116:119]
    v_mfma_f32_16x16x32_bf16 v[120:123], a[72:75], v[28:31], v[120:123]
    v_mfma_f32_16x16x32_bf16 v[124:127], a[76:79], v[28:31], v[124:127]
    s_branch pj_hj_130
pj_hv_129:
    v_mfma_f32_16x16x32_bf16 v[64:67], v[16:19], a[64:67], v[64:67]
    v_mfma_f32_16x16x32_bf16 v[68:71], v[16:19], a[68:71], v[68:71]
    v_mfma_f32_16x16x32_bf16 v[72:75], v[16:19], a[72:75], v[72:75]
    v_mfma_f32_16x16x32_bf16 v[76:79], v[16:19], a[76:79], v[76:79]
    v_mfma_f32_16x16x32_bf16 v[80:83], v[20:23], a[64:67], v[80:83]
    v_mfma_f32_16x16x32_bf16 v[84:87], v[20:23], a[68:71], v[84:87]
    v_mfma_f32_16x16x32_bf16 v[88:91], v[20:23], a[72:75], v[88:91]
    v_mfma_f32_16x16x32_bf16 v[92:95], v[20:23], a[76:79], v[92:95]
    v_mfma_f32_16x16x32_bf16 v[96:99], v[24:27], a[64:67], v[96:99]
    v_mfma_f32_16x16x32_bf16 v[100:103], v[24:27], a[68:71], v[100:103]
    v_mfma_f32_16x16x32_bf16 v[104:107], v[24:27], a[72:75], v[104:107]
    v_mfma_f32_16x16x32_bf16 v[108:111], v[24:27], a[76:79], v[108:111]
    v_mfma_f32_16x16x32_bf16 v[112:115], v[28:31], a[64:67], v[112:115]
    v_mfma_f32_16x16x32_bf16 v[116:119], v[28:31], a[68:71], v[116:119]
    s_nop 0
    v_mfma_f32_16x16x32_bf16 v[120:123], v[28:31], a[72:75], v[120:123]
    s_nop 0
    v_mfma_f32_16x16x32_bf16 v[124:127], v[28:31], a[76:79], v[124:127]
    s_nop 0
pj_hj_130:
    s_waitcnt vmcnt(12)
    ds_read_b128 v[32:35], v2 offset:80
    ds_read_b128 v[36:39], v10 offset:80
    ds_read_b128 v[40:43], v2 offset:33488
    ds_read_b128 v[44:47], v10 offset:33488
    ds_read_b64_tr_b16 a[80:81], v6 offset:4096
    ds_read_b64_tr_b16 a[82:83], v6 offset:4608
    ds_read_b64_tr_b16 a[84:85], v6 offset:4112
    ds_read_b64_tr_b16 a[86:87], v6 offset:4624
    ds_read_b64_tr_b16 a[88:89], v6 offset:4160
    ds_read_b64_tr_b16 a[90:91], v6 offset:4672
    ds_read_b64_tr_b16 a[92:93], v6 offset:4176
    ds_read_b64_tr_b16 a[94:95], v6 offset:4688
    s_waitcnt lgkmcnt(0)
    s_add_u32 m0, s38, 4096
    s_add_u32 s39, s20, 589824
    buffer_load_dwordx4 v5, s[8:11], s39 offen  lds
    s_add_u32 m0, s38, 5120
    s_add_u32 s39, s20, 1638400
    buffer_load_dwordx4 v5, s[8:11], s39 offen  lds
    s_add_u32 m0, s38, 6144
    s_add_u32 s39, s20, 2686976
    buffer_load_dwordx4 v5, s[8:11], s39 offen  lds
    s_add_u32 m0, s38, 7168
    s_add_u32 s39, s20, 3735552
    buffer_load_dwordx4 v5, s[8:11], s39 offen  lds
    s_cmp_lg_u32 s25, 0
    s_cbranch_scc1 pj_hv_131
    v_mfma_f32_16x16x32_bf16 v[64:67], a[80:83], v[32:35], v[64:67]
    v_mfma_f32_16x16x32_bf16 v[68:71], a[84:87], v[32:35], v[68:71]
    v_mfma_f32_16x16x32_bf16 v[72:75], a[88:91], v[32:35], v[72:75]
    v_mfma_f32_16x16x32_bf16 v[76:79], a[92:95], v[32:35], v[76:79]
    v_mfma_f32_16x16x32_bf16 v[80:83], a[80:83], v[36:39], v[80:83]
    v_mfma_f32_16x16x32_bf16 v[84:87], a[84:87], v[36:39], v[84:87]
    v_mfma_f32_16x16x32_bf16 v[88:91], a[88:91], v[36:39], v[88:91]
    v_mfma_f32_16x16x32_bf16 v[92:95], a[92:95], v[36:39], v[92:95]
    v_mfma_f32_16x16x32_bf16 v[96:99], a[80:83], v[40:43], v[96:99]
    v_mfma_f32_16x16x32_bf16 v[100:103], a[84:87], v[40:43], v[100:103]
    v_mfma_f32_16x16x32_bf16 v[104:107], a[88:91], v[40:43], v[104:107]
    v_mfma_f32_16x16x32_bf16 v[108:111], a[92:95], v[40:43], v[108:111]
    v_mfma_f32_16x16x32_bf16 v[112:115], a[80:83], v[44:47], v[112:115]
    v_mfma_f32_16x16x32_bf16 v[116:119], a[84:87], v[44:47], v[116:119]
    v_mfma_f32_16x16x32_bf16 v[120:123], a[88:91], v[44:47], v[120:123]
    v_mfma_f32_16x16x32_bf16 v[124:127], a[92:95], v[44:47], v[124:127]
    s_branch pj_hj_132
pj_hv_131:
    v_mfma_f32_16x16x32_bf16 v[64:67], v[32:35], a[80:83], v[64:67]
    v_mfma_f32_16x16x32_bf16 v[68:71], v[32:35], a[84:87], v[68:71]
    v_mfma_f32_16x16x32_bf16 v[72:75], v[32:35], a[88:91], v[72:75]
    v_mfma_f32_16x16x32_bf16 v[76:79], v[32:35], a[92:95], v[76:79]
    v_mfma_f32_16x16x32_bf16 v[80:83], v[36:39], a[80:83], v[80:83]
    v_mfma_f32_16x16x32_bf16 v[84:87], v[36:39], a[84:87], v[84:87]
    v_mfma_f32_16x16x32_bf16 v[88:91], v[36:39], a[88:91], v[88:91]
    v_mfma_f32_16x16x32_bf16 v[92:95], v[36:39], a[92:95], v[92:95]
    v_mfma_f32_16x16x32_bf16 v[96:99], v[40:43], a[80:83], v[96:99]
    v_mfma_f32_16x16x32_bf16 v[100:103], v[40:43], a[84:87], v[100:103]
    v_mfma_f32_16x16x32_bf16 v[104:107], v[40:43], a[88:91], v[104:107]
    v_mfma_f32_16x16x32_bf16 v[108:111], v[40:43], a[92:95], v[108:111]
    v_mfma_f32_16x16x32_bf16 v[112:115], v[44:47], a[80:83], v[112:115]
    v_mfma_f32_16x16x32_bf16 v[116:119], v[44:47], a[84:87], v[116:119]
    s_nop 0
    v_mfma_f32_16x16x32_bf16 v[120:123], v[44:47], a[88:91], v[120:123]
    s_nop 0
    v_mfma_f32_16x16x32_bf16 v[124:127], v[44:47], a[92:95], v[124:127]
    s_nop 0
pj_hj_132:
    s_waitcnt vmcnt(12)
    ds_read_b128 v[16:19], v2 offset:96
    ds_read_b128 v[20:23], v10 offset:96
    ds_read_b128 v[24:27], v2 offset:33504
    ds_read_b128 v[28:31], v10 offset:33504
    ds_read_b64_tr_b16 a[96:97], v6 offset:8192
    ds_read_b64_tr_b16 a[98:99], v6 offset:8704
    ds_read_b64_tr_b16 a[100:101], v6 offset:8208
    ds_read_b64_tr_b16 a[102:103], v6 offset:8720
    ds_read_b64_tr_b16 a[104:105], v6 offset:8256
    ds_read_b64_tr_b16 a[106:107], v6 offset:8768
    ds_read_b64_tr_b16 a[108:109], v6 offset:8272
    ds_read_b64_tr_b16 a[110:111], v6 offset:8784
    s_waitcnt lgkmcnt(0)
    s_add_u32 m0, s38, 8192
    s_add_u32 s39, s20, 655360
    buffer_load_dwordx4 v5, s[8:11], s39 offen  lds
    s_add_u32 m0, s38, 9216
    s_add_u32 s39, s20, 1703936
    buffer_load_dwordx4 v5, s[8:11], s39 offen  lds
    s_add_u32 m0, s38, 10240
    s_add_u32 s39, s20, 2752512
    buffer_load_dwordx4 v5, s[8:11], s39 offen  lds
    s_add_u32 m0, s38, 11264
    s_add_u32 s39, s20, 3801088
    buffer_load_dwordx4 v5, s[8:11], s39 offen  lds
    s_cmp_lg_u32 s25, 0
    s_cbranch_scc1 pj_hv_133
    v_mfma_f32_16x16x32_bf16 v[64:67], a[96:99], v[16:19], v[64:67]
    v_mfma_f32_16x16x32_bf16 v[68:71], a[100:103], v[16:19], v[68:71]
    v_mfma_f32_16x16x32_bf16 v[72:75], a[104:107], v[16:19], v[72:75]
    v_mfma_f32_16x16x32_bf16 v[76:79], a[108:111], v[16:19], v[76:79]
    v_mfma_f32_16x16x32_bf16 v[80:83], a[96:99], v[20:23], v[80:83]
    v_mfma_f32_16x16x32_bf16 v[84:87], a[100:103], v[20:23], v[84:87]
    v_mfma_f32_16x16x32_bf16 v[88:91], a[104:107], v[20:23], v[88:91]
    v_mfma_f32_16x16x32_bf16 v[92:95], a[108:111], v[20:23], v[92:95]
    v_mfma_f32_16x16x32_bf16 v[96:99], a[96:99], v[24:27], v[96:99]
    v_mfma_f32_16x16x32_bf16 v[100:103], a[100:103], v[24:27], v[100:103]
    v_mfma_f32_16x16x32_bf16 v[104:107], a[104:107], v[24:27], v[104:107]
    v_mfma_f32_16x16x32_bf16 v[108:111], a[108:111], v[24:27], v[108:111]
    v_mfma_f32_16x16x32_bf16 v[112:115], a[96:99], v[28:31], v[112:115]
    v_mfma_f32_16x16x32_bf16 v[116:119], a[100:103], v[28:31], v[116:119]
    v_mfma_f32_16x16x32_bf16 v[120:123], a[104:107], v[28:31], v[120:123]
    v_mfma_f32_16x16x32_bf16 v[124:127], a[108:111], v[28:31], v[124:127]
    s_branch pj_hj_134
pj_hv_133:
    v_mfma_f32_16x16x32_bf16 v[64:67], v[16:19], a[96:99], v[64:67]
    v_mfma_f32_16x16x32_bf16 v[68:71], v[16:19], a[100:103], v[68:71]
    v_mfma_f32_16x16x32_bf16 v[72:75], v[16:19], a[104:107], v[72:75]
    v_mfma_f32_16x16x32_bf16 v[76:79], v[16:19], a[108:111], v[76:79]
    v_mfma_f32_16x16x32_bf16 v[80:83], v[20:23], a[96:99], v[80:83]
    v_mfma_f32_16x16x32_bf16 v[84:87], v[20:23], a[100:103], v[84:87]
    v_mfma_f32_16x16x32_bf16 v[88:91], v[20:23], a[104:107], v[88:91]
    v_mfma_f32_16x16x32_bf16 v[92:95], v[20:23], a[108:111], v[92:95]
    v_mfma_f32_16x16x32_bf16 v[96:99], v[24:27], a[96:99], v[96:99]
    v_mfma_f32_16x16x32_bf16 v[100:103], v[24:27], a[100:103], v[100:103]
    v_mfma_f32_16x16x32_bf16 v[104:107], v[24:27], a[104:107], v[104:107]
    v_mfma_f32_16x16x32_bf16 v[108:111], v[24:27], a[108:111], v[108:111]
    v_mfma_f32_16x16x32_bf16 v[112:115], v[28:31], a[96:99], v[112:115]
    v_mfma_f32_16x16x32_bf16 v[116:119], v[28:31], a[100:103], v[116:119]
    s_nop 0
    v_mfma_f32_16x16x32_bf16 v[120:123], v[28:31], a[104:107], v[120:123]
    s_nop 0
    v_mfma_f32_16x16x32_bf16 v[124:127], v[28:31], a[108:111], v[124:127]
    s_nop 0
pj_hj_134:
    s_waitcnt vmcnt(12)
    ds_read_b128 v[32:35], v2 offset:112
    ds_read_b128 v[36:39], v10 offset:112
    ds_read_b128 v[40:43], v2 offset:33520
    ds_read_b128 v[44:47], v10 offset:33520
    ds_read_b64_tr_b16 a[112:113], v6 offset:12288
    ds_read_b64_tr_b16 a[114:115], v6 offset:12800
    ds_read_b64_tr_b16 a[116:117], v6 offset:12304
    ds_read_b64_tr_b16 a[118:119], v6 offset:12816
    ds_read_b64_tr_b16 a[120:121], v6 offset:12352
    ds_read_b64_tr_b16 a[122:123], v6 offset:12864
    ds_read_b64_tr_b16 a[124:125], v6 offset:12368
    ds_read_b64_tr_b16 a[126:127], v6 offset:12880
    s_waitcnt lgkmcnt(0)
    s_add_u32 m0, s38, 12288
    s_add_u32 s39, s20, 720896
    buffer_load_dwordx4 v5, s[8:11], s39 offen  lds
    s_add_u32 m0, s38, 13312
    s_add_u32 s39, s20, 1769472
    buffer_load_dwordx4 v5, s[8:11], s39 offen  lds
    s_add_u32 m0, s38, 14336
    s_add_u32 s39, s20, 2818048
    buffer_load_dwordx4 v5, s[8:11], s39 offen  lds
    s_add_u32 m0, s38, 15360
    s_add_u32 s39, s20, 3866624
    buffer_load_dwordx4 v5, s[8:11], s39 offen  lds
    s_cmp_lg_u32 s25, 0
    s_cbranch_scc1 pj_hv_135
    v_mfma_f32_16x16x32_bf16 v[64:67], a[112:115], v[32:35], v[64:67]
    v_mfma_f32_16x16x32_bf16 v[68:71], a[116:119], v[32:35], v[68:71]
    v_mfma_f32_16x16x32_bf16 v[72:75], a[120:123], v[32:35], v[72:75]
    v_mfma_f32_16x16x32_bf16 v[76:79], a[124:127], v[32:35], v[76:79]
    v_mfma_f32_16x16x32_bf16 v[80:83], a[112:115], v[36:39], v[80:83]
    v_mfma_f32_16x16x32_bf16 v[84:87], a[116:119], v[36:39], v[84:87]
    v_mfma_f32_16x16x32_bf16 v[88:91], a[120:123], v[36:39], v[88:91]
    v_mfma_f32_16x16x32_bf16 v[92:95], a[124:127], v[36:39], v[92:95]
    v_mfma_f32_16x16x32_bf16 v[96:99], a[112:115], v[40:43], v[96:99]
    v_mfma_f32_16x16x32_bf16 v[100:103], a[116:119], v[40:43], v[100:103]
    v_mfma_f32_16x16x32_bf16 v[104:107], a[120:123], v[40:43], v[104:107]
    v_mfma_f32_16x16x32_bf16 v[108:111], a[124:127], v[40:43], v[108:111]
    v_mfma_f32_16x16x32_bf16 v[112:115], a[112:115], v[44:47], v[112:115]
    v_mfma_f32_16x16x32_bf16 v[116:119], a[116:119], v[44:47], v[116:119]
    v_mfma_f32_16x16x32_bf16 v[120:123], a[120:123], v[44:47], v[120:123]
    v_mfma_f32_16x16x32_bf16 v[124:127], a[124:127], v[44:47], v[124:127]
    s_branch pj_hj_136
pj_hv_135:
    v_mfma_f32_16x16x32_bf16 v[64:67], v[32:35], a[112:115], v[64:67]
    v_mfma_f32_16x16x32_bf16 v[68:71], v[32:35], a[116:119], v[68:71]
    v_mfma_f32_16x16x32_bf16 v[72:75], v[32:35], a[120:123], v[72:75]
    v_mfma_f32_16x16x32_bf16 v[76:79], v[32:35], a[124:127], v[76:79]
    v_mfma_f32_16x16x32_bf16 v[80:83], v[36:39], a[112:115], v[80:83]
    v_mfma_f32_16x16x32_bf16 v[84:87], v[36:39], a[116:119], v[84:87]
    v_mfma_f32_16x16x32_bf16 v[88:91], v[36:39], a[120:123], v[88:91]
    v_mfma_f32_16x16x32_bf16 v[92:95], v[36:39], a[124:127], v[92:95]
    v_mfma_f32_16x16x32_bf16 v[96:99], v[40:43], a[112:115], v[96:99]
    v_mfma_f32_16x16x32_bf16 v[100:103], v[40:43], a[116:119], v[100:103]
    v_mfma_f32_16x16x32_bf16 v[104:107], v[40:43], a[120:123], v[104:107]
    v_mfma_f32_16x16x32_bf16 v[108:111], v[40:43], a[124:127], v[108:111]
    v_mfma_f32_16x16x32_bf16 v[112:115], v[44:47], a[112:115], v[112:115]
    v_mfma_f32_16x16x32_bf16 v[116:119], v[44:47], a[116:119], v[116:119]
    v_mfma_f32_16x16x32_bf16 v[120:123], v[44:47], a[120:123], v[120:123]
    s_nop 0
    v_mfma_f32_16x16x32_bf16 v[124:127], v[44:47], a[124:127], v[124:127]
    s_nop 0
pj_hj_136:
    s_waitcnt vmcnt(12)
    buffer_load_dword v11, off, s[48:51], 0 offset:196 sc1
    ds_read_b128 v[16:19], v2 offset:128
    ds_read_b128 v[20:23], v10 offset:128
    ds_read_b128 v[24:27], v2 offset:33536
    ds_read_b128 v[28:31], v10 offset:33536
    ds_read_b64_tr_b16 a[128:129], v6 offset:0
    ds_read_b64_tr_b16 a[130:131], v6 offset:512
    ds_read_b64_tr_b16 a[132:133], v6 offset:16
    ds_read_b64_tr_b16 a[134:135], v6 offset:528
    ds_read_b64_tr_b16 a[136:137], v6 offset:64
    ds_read_b64_tr_b16 a[138:139], v6 offset:576
    ds_read_b64_tr_b16 a[140:141], v6 offset:80
    ds_read_b64_tr_b16 a[142:143], v6 offset:592
    s_waitcnt lgkmcnt(0)
    s_add_u32 m0, s38, 0
    s_add_u32 s39, s20, 786432
    buffer_load_dwordx4 v5, s[8:11], s39 offen  lds
    s_add_u32 m0, s38, 1024
    s_add_u32 s39, s20, 1835008
    buffer_load_dwordx4 v5, s[8:11], s39 offen  lds
    s_add_u32 m0, s38, 2048
    s_add_u32 s39, s20, 2883584
    buffer_load_dwordx4 v5, s[8:11], s39 offen  lds
    s_add_u32 m0, s38, 3072
    s_add_u32 s39, s20, 3932160
    buffer_load_dwordx4 v5, s[8:11], s39 offen  lds
    s_cmp_lg_u32 s25, 0
    s_cbranch_scc1 pj_hv_137
    v_mfma_f32_16x16x32_bf16 v[64:67], a[128:131], v[16:19], v[64:67]
    v_mfma_f32_16x16x32_bf16 v[68:71], a[132:135], v[16:19], v[68:71]
    v_mfma_f32_16x16x32_bf16 v[72:75], a[136:139], v[16:19], v[72:75]
    v_mfma_f32_16x16x32_bf16 v[76:79], a[140:143], v[16:19], v[76:79]
    v_mfma_f32_16x16x32_bf16 v[80:83], a[128:131], v[20:23], v[80:83]
    v_mfma_f32_16x16x32_bf16 v[84:87], a[132:135], v[20:23], v[84:87]
    v_mfma_f32_16x16x32_bf16 v[88:91], a[136:139], v[20:23], v[88:91]
    v_mfma_f32_16x16x32_bf16 v[92:95], a[140:143], v[20:23], v[92:95]
    v_mfma_f32_16x16x32_bf16 v[96:99], a[128:131], v[24:27], v[96:99]
    v_mfma_f32_16x16x32_bf16 v[100:103], a[132:135], v[24:27], v[100:103]
    v_mfma_f32_16x16x32_bf16 v[104:107], a[136:139], v[24:27], v[104:107]
    v_mfma_f32_16x16x32_bf16 v[108:111], a[140:143], v[24:27], v[108:111]
    v_mfma_f32_16x16x32_bf16 v[112:115], a[128:131], v[28:31], v[112:115]
    v_mfma_f32_16x16x32_bf16 v[116:119], a[132:135], v[28:31], v[116:119]
    v_mfma_f32_16x16x32_bf16 v[120:123], a[136:139], v[28:31], v[120:123]
    v_mfma_f32_16x16x32_bf16 v[124:127], a[140:143], v[28:31], v[124:127]
    s_branch pj_hj_138
pj_hv_137:
    v_mfma_f32_16x16x32_bf16 v[64:67], v[16:19], a[128:131], v[64:67]
    v_mfma_f32_16x16x32_bf16 v[68:71], v[16:19], a[132:135], v[68:71]
    v_mfma_f32_16x16x32_bf16 v[72:75], v[16:19], a[136:139], v[72:75]
    v_mfma_f32_16x16x32_bf16 v[76:79], v[16:19], a[140:143], v[76:79]
    v_mfma_f32_16x16x32_bf16 v[80:83], v[20:23], a[128:131], v[80:83]
    v_mfma_f32_16x16x32_bf16 v[84:87], v[20:23], a[132:135], v[84:87]
    v_mfma_f32_16x16x32_bf16 v[88:91], v[20:23], a[136:139], v[88:91]
    v_mfma_f32_16x16x32_bf16 v[92:95], v[20:23], a[140:143], v[92:95]
    v_mfma_f32_16x16x32_bf16 v[96:99], v[24:27], a[128:131], v[96:99]
    v_mfma_f32_16x16x32_bf16 v[100:103], v[24:27], a[132:135], v[100:103]
    v_mfma_f32_16x16x32_bf16 v[104:107], v[24:27], a[136:139], v[104:107]
    v_mfma_f32_16x16x32_bf16 v[108:111], v[24:27], a[140:143], v[108:111]
    v_mfma_f32_16x16x32_bf16 v[112:115], v[28:31], a[128:131], v[112:115]
    v_mfma_f32_16x16x32_bf16 v[116:119], v[28:31], a[132:135], v[116:119]
    v_mfma_f32_16x16x32_bf16 v[120:123], v[28:31], a[136:139], v[120:123]
    v_mfma_f32_16x16x32_bf16 v[124:127], v[28:31], a[140:143], v[124:127]
pj_hj_138:
    s_waitcnt vmcnt(13)
    ds_read_b128 v[32:35], v2 offset:144
    ds_read_b128 v[36:39], v10 offset:144
    ds_read_b128 v[40:43], v2 offset:33552
    ds_read_b128 v[44:47], v10 offset:33552
    ds_read_b64_tr_b16 a[144:145], v6 offset:4096
    ds_read_b64_tr_b16 a[146:147], v6 offset:4608
    ds_read_b64_tr_b16 a[148:149], v6 offset:4112
    ds_read_b64_tr_b16 a[150:151], v6 offset:4624
    ds_read_b64_tr_b16 a[152:153], v6 offset:4160
    ds_read_b64_tr_b16 a[154:155], v6 offset:4672
    ds_read_b64_tr_b16 a[156:157], v6 offset:4176
    ds_read_b64_tr_b16 a[158:159], v6 offset:4688
    s_waitcnt lgkmcnt(0)
    s_add_u32 m0, s38, 4096
    s_add_u32 s39, s20, 851968
    buffer_load_dwordx4 v5, s[8:11], s39 offen  lds
    s_add_u32 m0, s38, 5120
    s_add_u32 s39, s20, 1900544
    buffer_load_dwordx4 v5, s[8:11], s39 offen  lds
    s_add_u32 m0, s38, 6144
    s_add_u32 s39, s20, 2949120
    buffer_load_dwordx4 v5, s[8:11], s39 offen  lds
    s_add_u32 m0, s38, 7168
    s_add_u32 s39, s20, 3997696
    buffer_load_dwordx4 v5, s[8:11], s39 offen  lds
    s_and_b32 s41, s7, 15
    s_lshl_b32 s41, s41, 17
    s_lshl_b32 s42, s4, 15
    s_add_u32 s41, s41, s42
    v_lshlrev_b32 v7, 3, v1
    buffer_load_dword v8, v7, s[16:19], s41 offen
    s_add_u32 s41, s41, 8192
    buffer_load_dword v8, v7, s[16:19], s41 offen
    s_add_u32 s41, s41, 8192
    buffer_load_dword v8, v7, s[16:19], s41 offen
    s_add_u32 s41, s41, 8192
    buffer_load_dword v8, v7, s[16:19], s41 offen
    s_add_u32 s41, s41, 8192
    s_cmp_lg_u32 s25, 0
    s_cbranch_scc1 pj_hv_139
    v_mfma_f32_16x16x32_bf16 v[64:67], a[144:147], v[32:35], v[64:67]
    v_mfma_f32_16x16x32_bf16 v[68:71], a[148:151], v[32:35], v[68:71]
    v_mfma_f32_16x16x32_bf16 v[72:75], a[152:155], v[32:35], v[72:75]
    v_mfma_f32_16x16x32_bf16 v[76:79], a[156:159], v[32:35], v[76:79]
    v_mfma_f32_16x16x32_bf16 v[80:83], a[144:147], v[36:39], v[80:83]
    v_mfma_f32_16x16x32_bf16 v[84:87], a[148:151], v[36:39], v[84:87]
    v_mfma_f32_16x16x32_bf16 v[88:91], a[152:155], v[36:39], v[88:91]
    v_mfma_f32_16x16x32_bf16 v[92:95], a[156:159], v[36:39], v[92:95]
    v_mfma_f32_16x16x32_bf16 v[96:99], a[144:147], v[40:43], v[96:99]
    v_mfma_f32_16x16x32_bf16 v[100:103], a[148:151], v[40:43], v[100:103]
    v_mfma_f32_16x16x32_bf16 v[104:107], a[152:155], v[40:43], v[104:107]
    v_mfma_f32_16x16x32_bf16 v[108:111], a[156:159], v[40:43], v[108:111]
    v_mfma_f32_16x16x32_bf16 v[112:115], a[144:147], v[44:47], v[112:115]
    v_mfma_f32_16x16x32_bf16 v[116:119], a[148:151], v[44:47], v[116:119]
    v_mfma_f32_16x16x32_bf16 v[120:123], a[152:155], v[44:47], v[120:123]
    v_mfma_f32_16x16x32_bf16 v[124:127], a[156:159], v[44:47], v[124:127]
    s_branch pj_hj_140
pj_hv_139:
    v_mfma_f32_16x16x32_bf16 v[64:67], v[32:35], a[144:147], v[64:67]
    v_mfma_f32_16x16x32_bf16 v[68:71], v[32:35], a[148:151], v[68:71]
    v_mfma_f32_16x16x32_bf16 v[72:75], v[32:35], a[152:155], v[72:75]
    v_mfma_f32_16x16x32_bf16 v[76:79], v[32:35], a[156:159], v[76:79]
    v_mfma_f32_16x16x32_bf16 v[80:83], v[36:39], a[144:147], v[80:83]
    v_mfma_f32_16x16x32_bf16 v[84:87], v[36:39], a[148:151], v[84:87]
    v_mfma_f32_16x16x32_bf16 v[88:91], v[36:39], a[152:155], v[88:91]
    v_mfma_f32_16x16x32_bf16 v[92:95], v[36:39], a[156:159], v[92:95]
    v_mfma_f32_16x16x32_bf16 v[96:99], v[40:43], a[144:147], v[96:99]
    v_mfma_f32_16x16x32_bf16 v[100:103], v[40:43], a[148:151], v[100:103]
    v_mfma_f32_16x16x32_bf16 v[104:107], v[40:43], a[152:155], v[104:107]
    v_mfma_f32_16x16x32_bf16 v[108:111], v[40:43], a[156:159], v[108:111]
    v_mfma_f32_16x16x32_bf16 v[112:115], v[44:47], a[144:147], v[112:115]
    v_mfma_f32_16x16x32_bf16 v[116:119], v[44:47], a[148:151], v[116:119]
    v_mfma_f32_16x16x32_bf16 v[120:123], v[44:47], a[152:155], v[120:123]
    v_mfma_f32_16x16x32_bf16 v[124:127], v[44:47], a[156:159], v[124:127]
    s_nop 0
pj_hj_140:
    s_waitcnt vmcnt(17)
    ds_read_b128 v[16:19], v2 offset:160
    ds_read_b128 v[20:23], v10 offset:160
    ds_read_b128 v[24:27], v2 offset:33568
    ds_read_b128 v[28:31], v10 offset:33568
    ds_read_b64_tr_b16 a[160:161], v6 offset:8192
    ds_read_b64_tr_b16 a[162:163], v6 offset:8704
    ds_read_b64_tr_b16 a[164:165], v6 offset:8208
    ds_read_b64_tr_b16 a[166:167], v6 offset:8720
    ds_read_b64_tr_b16 a[168:169], v6 offset:8256
    ds_read_b64_tr_b16 a[170:171], v6 offset:8768
    ds_read_b64_tr_b16 a[172:173], v6 offset:8272
    ds_read_b64_tr_b16 a[174:175], v6 offset:8784
    s_waitcnt lgkmcnt(0)
    s_add_u32 m0, s38, 8192
    s_add_u32 s39, s20, 917504
    buffer_load_dwordx4 v5, s[8:11], s39 offen  lds
    s_add_u32 m0, s38, 9216
    s_add_u32 s39, s20, 1966080
    buffer_load_dwordx4 v5, s[8:11], s39 offen  lds
    s_add_u32 m0, s38, 10240
    s_add_u32 s39, s20, 3014656
    buffer_load_dwordx4 v5, s[8:11], s39 offen  lds
    s_add_u32 m0, s38, 11264
    s_add_u32 s39, s20, 4063232
    buffer_load_dwordx4 v5, s[8:11], s39 offen  lds
    s_cmp_lg_u32 s25, 0
    s_cbranch_scc1 pj_hv_141
    v_mfma_f32_16x16x32_bf16 v[64:67], a[160:163], v[16:19], v[64:67]
    v_mfma_f32_16x16x32_bf16 v[68:71], a[164:167], v[16:19], v[68:71]
    v_mfma_f32_16x16x32_bf16 v[72:75], a[168:171], v[16:19], v[72:75]
    v_mfma_f32_16x16x32_bf16 v[76:79], a[172:175], v[16:19], v[76:79]
    v_mfma_f32_16x16x32_bf16 v[80:83], a[160:163], v[20:23], v[80:83]
    v_mfma_f32_16x16x32_bf16 v[84:87], a[164:167], v[20:23], v[84:87]
    v_mfma_f32_16x16x32_bf16 v[88:91], a[168:171], v[20:23], v[88:91]
    v_mfma_f32_16x16x32_bf16 v[92:95], a[172:175], v[20:23], v[92:95]
    v_mfma_f32_16x16x32_bf16 v[96:99], a[160:163], v[24:27], v[96:99]
    v_mfma_f32_16x16x32_bf16 v[100:103], a[164:167], v[24:27], v[100:103]
    v_mfma_f32_16x16x32_bf16 v[104:107], a[168:171], v[24:27], v[104:107]
    v_mfma_f32_16x16x32_bf16 v[108:111], a[172:175], v[24:27], v[108:111]
    v_mfma_f32_16x16x32_bf16 v[112:115], a[160:163], v[28:31], v[112:115]
    v_mfma_f32_16x16x32_bf16 v[116:119], a[164:167], v[28:31], v[116:119]
    v_mfma_f32_16x16x32_bf16 v[120:123], a[168:171], v[28:31], v[120:123]
    v_mfma_f32_16x16x32_bf16 v[124:127], a[172:175], v[28:31], v[124:127]
    s_branch pj_hj_142
pj_hv_141:
    v_mfma_f32_16x16x32_bf16 v[64:67], v[16:19], a[160:163], v[64:67]
    v_mfma_f32_16x16x32_bf16 v[68:71], v[16:19], a[164:167], v[68:71]
    v_mfma_f32_16x16x32_bf16 v[72:75], v[16:19], a[168:171], v[72:75]
    v_mfma_f32_16x16x32_bf16 v[76:79], v[16:19], a[172:175], v[76:79]
    v_mfma_f32_16x16x32_bf16 v[80:83], v[20:23], a[160:163], v[80:83]
    v_mfma_f32_16x16x32_bf16 v[84:87], v[20:23], a[164:167], v[84:87]
    v_mfma_f32_16x16x32_bf16 v[88:91], v[20:23], a[168:171], v[88:91]
    v_mfma_f32_16x16x32_bf16 v[92:95], v[20:23], a[172:175], v[92:95]
    v_mfma_f32_16x16x32_bf16 v[96:99], v[24:27], a[160:163], v[96:99]
    v_mfma_f32_16x16x32_bf16 v[100:103], v[24:27], a[164:167], v[100:103]
    v_mfma_f32_16x16x32_bf16 v[104:107], v[24:27], a[168:171], v[104:107]
    v_mfma_f32_16x16x32_bf16 v[108:111], v[24:27], a[172:175], v[108:111]
    v_mfma_f32_16x16x32_bf16 v[112:115], v[28:31], a[160:163], v[112:115]
    v_mfma_f32_16x16x32_bf16 v[116:119], v[28:31], a[164:167], v[116:119]
    s_nop 0
    v_mfma_f32_16x16x32_bf16 v[120:123], v[28:31], a[168:171], v[120:123]
    s_nop 0
    v_mfma_f32_16x16x32_bf16 v[124:127], v[28:31], a[172:175], v[124:127]
    s_nop 0
pj_hj_142:
    s_waitcnt vmcnt(17)
    ds_read_b128 v[32:35], v2 offset:176
    ds_read_b128 v[36:39], v10 offset:176
    ds_read_b128 v[40:43], v2 offset:33584
    ds_read_b128 v[44:47], v10 offset:33584
    ds_read_b64_tr_b16 a[176:177], v6 offset:12288
    ds_read_b64_tr_b16 a[178:179], v6 offset:12800
    ds_read_b64_tr_b16 a[180:181], v6 offset:12304
    ds_read_b64_tr_b16 a[182:183], v6 offset:12816
    ds_read_b64_tr_b16 a[184:185], v6 offset:12352
    ds_read_b64_tr_b16 a[186:187], v6 offset:12864
    ds_read_b64_tr_b16 a[188:189], v6 offset:12368
    ds_read_b64_tr_b16 a[190:191], v6 offset:12880
    s_waitcnt lgkmcnt(0)
    s_add_u32 m0, s38, 12288
    s_add_u32 s39, s20, 983040
    buffer_load_dwordx4 v5, s[8:11], s39 offen  lds
    s_add_u32 m0, s38, 13312
    s_add_u32 s39, s20, 2031616
    buffer_load_dwordx4 v5, s[8:11], s39 offen  lds
    s_add_u32 m0, s38, 14336
    s_add_u32 s39, s20, 3080192
    buffer_load_dwordx4 v5, s[8:11], s39 offen  lds
    s_add_u32 m0, s38, 15360
    s_add_u32 s39, s20, 4128768
    buffer_load_dwordx4 v5, s[8:11], s39 offen  lds
    s_cmp_lg_u32 s25, 0
    s_cbranch_scc1 pj_hv_143
    v_mfma_f32_16x16x32_bf16 v[64:67], a[176:179], v[32:35], v[64:67]
    v_mfma_f32_16x16x32_bf16 v[68:71], a[180:183], v[32:35], v[68:71]
    v_mfma_f32_16x16x32_bf16 v[72:75], a[184:187], v[32:35], v[72:75]
    v_mfma_f32_16x16x32_bf16 v[76:79], a[188:191], v[32:35], v[76:79]
    v_mfma_f32_16x16x32_bf16 v[80:83], a[176:179], v[36:39], v[80:83]
    v_mfma_f32_16x16x32_bf16 v[84:87], a[180:183], v[36:39], v[84:87]
    v_mfma_f32_16x16x32_bf16 v[88:91], a[184:187], v[36:39], v[88:91]
    v_mfma_f32_16x16x32_bf16 v[92:95], a[188:191], v[36:39], v[92:95]
    v_mfma_f32_16x16x32_bf16 v[96:99], a[176:179], v[40:43], v[96:99]
    v_mfma_f32_16x16x32_bf16 v[100:103], a[180:183], v[40:43], v[100:103]
    v_mfma_f32_16x16x32_bf16 v[104:107], a[184:187], v[40:43], v[104:107]
    v_mfma_f32_16x16x32_bf16 v[108:111], a[188:191], v[40:43], v[108:111]
    v_mfma_f32_16x16x32_bf16 v[112:115], a[176:179], v[44:47], v[112:115]
    v_mfma_f32_16x16x32_bf16 v[116:119], a[180:183], v[44:47], v[116:119]
    v_mfma_f32_16x16x32_bf16 v[120:123], a[184:187], v[44:47], v[120:123]
    v_mfma_f32_16x16x32_bf16 v[124:127], a[188:191], v[44:47], v[124:127]
    s_branch pj_hj_144
pj_hv_143:
    v_mfma_f32_16x16x32_bf16 v[64:67], v[32:35], a[176:179], v[64:67]
    v_mfma_f32_16x16x32_bf16 v[68:71], v[32:35], a[180:183], v[68:71]
    v_mfma_f32_16x16x32_bf16 v[72:75], v[32:35], a[184:187], v[72:75]
    v_mfma_f32_16x16x32_bf16 v[76:79], v[32:35], a[188:191], v[76:79]
    v_mfma_f32_16x16x32_bf16 v[80:83], v[36:39], a[176:179], v[80:83]
    v_mfma_f32_16x16x32_bf16 v[84:87], v[36:39], a[180:183], v[84:87]
    v_mfma_f32_16x16x32_bf16 v[88:91], v[36:39], a[184:187], v[88:91]
    v_mfma_f32_16x16x32_bf16 v[92:95], v[36:39], a[188:191], v[92:95]
    v_mfma_f32_16x16x32_bf16 v[96:99], v[40:43], a[176:179], v[96:99]
    v_mfma_f32_16x16x32_bf16 v[100:103], v[40:43], a[180:183], v[100:103]
    v_mfma_f32_16x16x32_bf16 v[104:107], v[40:43], a[184:187], v[104:107]
    v_mfma_f32_16x16x32_bf16 v[108:111], v[40:43], a[188:191], v[108:111]
    v_mfma_f32_16x16x32_bf16 v[112:115], v[44:47], a[176:179], v[112:115]
    v_mfma_f32_16x16x32_bf16 v[116:119], v[44:47], a[180:183], v[116:119]
    s_nop 0
    v_mfma_f32_16x16x32_bf16 v[120:123], v[44:47], a[184:187], v[120:123]
    s_nop 0
    v_mfma_f32_16x16x32_bf16 v[124:127], v[44:47], a[188:191], v[124:127]
    s_nop 0
pj_hj_144:
    s_waitcnt vmcnt(16)
    ds_read_b128 v[16:19], v2 offset:192
    ds_read_b128 v[20:23], v10 offset:192
    ds_read_b128 v[24:27], v2 offset:33600
    ds_read_b128 v[28:31], v10 offset:33600
    ds_read_b64_tr_b16 a[192:193], v6 offset:0
    ds_read_b64_tr_b16 a[194:195], v6 offset:512
    ds_read_b64_tr_b16 a[196:197], v6 offset:16
    ds_read_b64_tr_b16 a[198:199], v6 offset:528
    ds_read_b64_tr_b16 a[200:201], v6 offset:64
    ds_read_b64_tr_b16 a[202:203], v6 offset:576
    ds_read_b64_tr_b16 a[204:205], v6 offset:80
    ds_read_b64_tr_b16 a[206:207], v6 offset:592
    s_waitcnt lgkmcnt(0)
    s_cmp_lg_u32 s25, 0
    s_cbranch_scc1 pj_hv_145
    v_mfma_f32_16x16x32_bf16 v[64:67], a[192:195], v[16:19], v[64:67]
    v_mfma_f32_16x16x32_bf16 v[68:71], a[196:199], v[16:19], v[68:71]
    v_mfma_f32_16x16x32_bf16 v[72:75], a[200:203], v[16:19], v[72:75]
    v_mfma_f32_16x16x32_bf16 v[76:79], a[204:207], v[16:19], v[76:79]
    v_mfma_f32_16x16x32_bf16 v[80:83], a[192:195], v[20:23], v[80:83]
    v_mfma_f32_16x16x32_bf16 v[84:87], a[196:199], v[20:23], v[84:87]
    v_mfma_f32_16x16x32_bf16 v[88:91], a[200:203], v[20:23], v[88:91]
    v_mfma_f32_16x16x32_bf16 v[92:95], a[204:207], v[20:23], v[92:95]
    v_mfma_f32_16x16x32_bf16 v[96:99], a[192:195], v[24:27], v[96:99]
    v_mfma_f32_16x16x32_bf16 v[100:103], a[196:199], v[24:27], v[100:103]
    v_mfma_f32_16x16x32_bf16 v[104:107], a[200:203], v[24:27], v[104:107]
    v_mfma_f32_16x16x32_bf16 v[108:111], a[204:207], v[24:27], v[108:111]
    v_mfma_f32_16x16x32_bf16 v[112:115], a[192:195], v[28:31], v[112:115]
    v_mfma_f32_16x16x32_bf16 v[116:119], a[196:199], v[28:31], v[116:119]
    v_mfma_f32_16x16x32_bf16 v[120:123], a[200:203], v[28:31], v[120:123]
    v_mfma_f32_16x16x32_bf16 v[124:127], a[204:207], v[28:31], v[124:127]
    s_branch pj_hj_146
pj_hv_145:
    v_mfma_f32_16x16x32_bf16 v[64:67], v[16:19], a[192:195], v[64:67]
    v_mfma_f32_16x16x32_bf16 v[68:71], v[16:19], a[196:199], v[68:71]
    v_mfma_f32_16x16x32_bf16 v[72:75], v[16:19], a[200:203], v[72:75]
    v_mfma_f32_16x16x32_bf16 v[76:79], v[16:19], a[204:207], v[76:79]
    v_mfma_f32_16x16x32_bf16 v[80:83], v[20:23], a[192:195], v[80:83]
    v_mfma_f32_16x16x32_bf16 v[84:87], v[20:23], a[196:199], v[84:87]
    v_mfma_f32_16x16x32_bf16 v[88:91], v[20:23], a[200:203], v[88:91]
    v_mfma_f32_16x16x32_bf16 v[92:95], v[20:23], a[204:207], v[92:95]
    v_mfma_f32_16x16x32_bf16 v[96:99], v[24:27], a[192:195], v[96:99]
    v_mfma_f32_16x16x32_bf16 v[100:103], v[24:27], a[196:199], v[100:103]
    v_mfma_f32_16x16x32_bf16 v[104:107], v[24:27], a[200:203], v[104:107]
    v_mfma_f32_16x16x32_bf16 v[108:111], v[24:27], a[204:207], v[108:111]
    v_mfma_f32_16x16x32_bf16 v[112:115], v[28:31], a[192:195], v[112:115]
    v_mfma_f32_16x16x32_bf16 v[116:119], v[28:31], a[196:199], v[116:119]
    s_nop 0
    v_mfma_f32_16x16x32_bf16 v[120:123], v[28:31], a[200:203], v[120:123]
    s_nop 0
    v_mfma_f32_16x16x32_bf16 v[124:127], v[28:31], a[204:207], v[124:127]
    s_nop 0
pj_hj_146:
    s_waitcnt vmcnt(12)
    ds_read_b128 v[32:35], v2 offset:208
    ds_read_b128 v[36:39], v10 offset:208
    ds_read_b128 v[40:43], v2 offset:33616
    ds_read_b128 v[44:47], v10 offset:33616
    ds_read_b64_tr_b16 a[208:209], v6 offset:4096
    ds_read_b64_tr_b16 a[210:211], v6 offset:4608
    ds_read_b64_tr_b16 a[212:213], v6 offset:4112
    ds_read_b64_tr_b16 a[214:215], v6 offset:4624
    ds_read_b64_tr_b16 a[216:217], v6 offset:4160
    ds_read_b64_tr_b16 a[218:219], v6 offset:4672
    ds_read_b64_tr_b16 a[220:221], v6 offset:4176
    ds_read_b64_tr_b16 a[222:223], v6 offset:4688
    s_waitcnt lgkmcnt(0)
    s_cmp_lg_u32 s25, 0
    s_cbranch_scc1 pj_hv_147
    v_mfma_f32_16x16x32_bf16 v[64:67], a[208:211], v[32:35], v[64:67]
    v_mfma_f32_16x16x32_bf16 v[68:71], a[212:215], v[32:35], v[68:71]
    v_mfma_f32_16x16x32_bf16 v[72:75], a[216:219], v[32:35], v[72:75]
    v_mfma_f32_16x16x32_bf16 v[76:79], a[220:223], v[32:35], v[76:79]
    v_mfma_f32_16x16x32_bf16 v[80:83], a[208:211], v[36:39], v[80:83]
    v_mfma_f32_16x16x32_bf16 v[84:87], a[212:215], v[36:39], v[84:87]
    v_mfma_f32_16x16x32_bf16 v[88:91], a[216:219], v[36:39], v[88:91]
    v_mfma_f32_16x16x32_bf16 v[92:95], a[220:223], v[36:39], v[92:95]
    v_mfma_f32_16x16x32_bf16 v[96:99], a[208:211], v[40:43], v[96:99]
    v_mfma_f32_16x16x32_bf16 v[100:103], a[212:215], v[40:43], v[100:103]
    v_mfma_f32_16x16x32_bf16 v[104:107], a[216:219], v[40:43], v[104:107]
    v_mfma_f32_16x16x32_bf16 v[108:111], a[220:223], v[40:43], v[108:111]
    v_mfma_f32_16x16x32_bf16 v[112:115], a[208:211], v[44:47], v[112:115]
    v_mfma_f32_16x16x32_bf16 v[116:119], a[212:215], v[44:47], v[116:119]
    v_mfma_f32_16x16x32_bf16 v[120:123], a[216:219], v[44:47], v[120:123]
    v_mfma_f32_16x16x32_bf16 v[124:127], a[220:223], v[44:47], v[124:127]
    s_branch pj_hj_148
pj_hv_147:
    v_mfma_f32_16x16x32_bf16 v[64:67], v[32:35], a[208:211], v[64:67]
    v_mfma_f32_16x16x32_bf16 v[68:71], v[32:35], a[212:215], v[68:71]
    v_mfma_f32_16x16x32_bf16 v[72:75], v[32:35], a[216:219], v[72:75]
    v_mfma_f32_16x16x32_bf16 v[76:79], v[32:35], a[220:223], v[76:79]
    v_mfma_f32_16x16x32_bf16 v[80:83], v[36:39], a[208:211], v[80:83]
    v_mfma_f32_16x16x32_bf16 v[84:87], v[36:39], a[212:215], v[84:87]
    v_mfma_f32_16x16x32_bf16 v[88:91], v[36:39], a[216:219], v[88:91]
    v_mfma_f32_16x16x32_bf16 v[92:95], v[36:39], a[220:223], v[92:95]
    v_mfma_f32_16x16x32_bf16 v[96:99], v[40:43], a[208:211], v[96:99]
    v_mfma_f32_16x16x32_bf16 v[100:103], v[40:43], a[212:215], v[100:103]
    v_mfma_f32_16x16x32_bf16 v[104:107], v[40:43], a[216:219], v[104:107]
    v_mfma_f32_16x16x32_bf16 v[108:111], v[40:43], a[220:223], v[108:111]
    v_mfma_f32_16x16x32_bf16 v[112:115], v[44:47], a[208:211], v[112:115]
    v_mfma_f32_16x16x32_bf16 v[116:119], v[44:47], a[212:215], v[116:119]
    s_nop 0
    v_mfma_f32_16x16x32_bf16 v[120:123], v[44:47], a[216:219], v[120:123]
    s_nop 0
    v_mfma_f32_16x16x32_bf16 v[124:127], v[44:47], a[220:223], v[124:127]
    s_nop 0
pj_hj_148:
    s_waitcnt vmcnt(4)
    ds_read_b128 v[16:19], v2 offset:224
    ds_read_b128 v[20:23], v10 offset:224
    ds_read_b128 v[24:27], v2 offset:33632
    ds_read_b128 v[28:31], v10 offset:33632
    ds_read_b64_tr_b16 a[224:225], v6 offset:8192
    ds_read_b64_tr_b16 a[226:227], v6 offset:8704
    ds_read_b64_tr_b16 a[228:229], v6 offset:8208
    ds_read_b64_tr_b16 a[230:231], v6 offset:8720
    ds_read_b64_tr_b16 a[232:233], v6 offset:8256
    ds_read_b64_tr_b16 a[234:235], v6 offset:8768
    ds_read_b64_tr_b16 a[236:237], v6 offset:8272
    ds_read_b64_tr_b16 a[238:239], v6 offset:8784
    s_waitcnt lgkmcnt(0)
    s_cmp_lg_u32 s25, 0
    s_cbranch_scc1 pj_hv_149
    v_mfma_f32_16x16x32_bf16 v[64:67], a[224:227], v[16:19], v[64:67]
    v_mfma_f32_16x16x32_bf16 v[68:71], a[228:231], v[16:19], v[68:71]
    v_mfma_f32_16x16x32_bf16 v[72:75], a[232:235], v[16:19], v[72:75]
    v_mfma_f32_16x16x32_bf16 v[76:79], a[236:239], v[16:19], v[76:79]
    v_mfma_f32_16x16x32_bf16 v[80:83], a[224:227], v[20:23], v[80:83]
    v_mfma_f32_16x16x32_bf16 v[84:87], a[228:231], v[20:23], v[84:87]
    v_mfma_f32_16x16x32_bf16 v[88:91], a[232:235], v[20:23], v[88:91]
    v_mfma_f32_16x16x32_bf16 v[92:95], a[236:239], v[20:23], v[92:95]
    v_mfma_f32_16x16x32_bf16 v[96:99], a[224:227], v[24:27], v[96:99]
    v_mfma_f32_16x16x32_bf16 v[100:103], a[228:231], v[24:27], v[100:103]
    v_mfma_f32_16x16x32_bf16 v[104:107], a[232:235], v[24:27], v[104:107]
    v_mfma_f32_16x16x32_bf16 v[108:111], a[236:239], v[24:27], v[108:111]
    v_mfma_f32_16x16x32_bf16 v[112:115], a[224:227], v[28:31], v[112:115]
    v_mfma_f32_16x16x32_bf16 v[116:119], a[228:231], v[28:31], v[116:119]
    v_mfma_f32_16x16x32_bf16 v[120:123], a[232:235], v[28:31], v[120:123]
    v_mfma_f32_16x16x32_bf16 v[124:127], a[236:239], v[28:31], v[124:127]
    s_branch pj_hj_150
pj_hv_149:
    v_mfma_f32_16x16x32_bf16 v[64:67], v[16:19], a[224:227], v[64:67]
    v_mfma_f32_16x16x32_bf16 v[68:71], v[16:19], a[228:231], v[68:71]
    v_mfma_f32_16x16x32_bf16 v[72:75], v[16:19], a[232:235], v[72:75]
    v_mfma_f32_16x16x32_bf16 v[76:79], v[16:19], a[236:239], v[76:79]
    v_mfma_f32_16x16x32_bf16 v[80:83], v[20:23], a[224:227], v[80:83]
    v_mfma_f32_16x16x32_bf16 v[84:87], v[20:23], a[228:231], v[84:87]
    v_mfma_f32_16x16x32_bf16 v[88:91], v[20:23], a[232:235], v[88:91]
    v_mfma_f32_16x16x32_bf16 v[92:95], v[20:23], a[236:239], v[92:95]
    v_mfma_f32_16x16x32_bf16 v[96:99], v[24:27], a[224:227], v[96:99]
    v_mfma_f32_16x16x32_bf16 v[100:103], v[24:27], a[228:231], v[100:103]
    v_mfma_f32_16x16x32_bf16 v[104:107], v[24:27], a[232:235], v[104:107]
    v_mfma_f32_16x16x32_bf16 v[108:111], v[24:27], a[236:239], v[108:111]
    v_mfma_f32_16x16x32_bf16 v[112:115], v[28:31], a[224:227], v[112:115]
    v_mfma_f32_16x16x32_bf16 v[116:119], v[28:31], a[228:231], v[116:119]
    s_nop 0
    v_mfma_f32_16x16x32_bf16 v[120:123], v[28:31], a[232:235], v[120:123]
    s_nop 0
    v_mfma_f32_16x16x32_bf16 v[124:127], v[28:31], a[236:239], v[124:127]
    s_nop 0
pj_hj_150:
    s_waitcnt vmcnt(0)
    ds_read_b128 v[32:35], v2 offset:240
    ds_read_b128 v[36:39], v10 offset:240
    ds_read_b128 v[40:43], v2 offset:33648
    ds_read_b128 v[44:47], v10 offset:33648
    ds_read_b64_tr_b16 a[240:241], v6 offset:12288
    ds_read_b64_tr_b16 a[242:243], v6 offset:12800
    ds_read_b64_tr_b16 a[244:245], v6 offset:12304
    ds_read_b64_tr_b16 a[246:247], v6 offset:12816
    ds_read_b64_tr_b16 a[248:249], v6 offset:12352
    ds_read_b64_tr_b16 a[250:251], v6 offset:12864
    ds_read_b64_tr_b16 a[252:253], v6 offset:12368
    ds_read_b64_tr_b16 a[254:255], v6 offset:12880
    s_waitcnt lgkmcnt(0)
    s_cmp_lg_u32 s25, 0
    s_cbranch_scc1 pj_hv_151
    v_mfma_f32_16x16x32_bf16 v[64:67], a[240:243], v[32:35], v[64:67]
    v_mfma_f32_16x16x32_bf16 v[68:71], a[244:247], v[32:35], v[68:71]
    v_mfma_f32_16x16x32_bf16 v[72:75], a[248:251], v[32:35], v[72:75]
    v_mfma_f32_16x16x32_bf16 v[76:79], a[252:255], v[32:35], v[76:79]
    v_mfma_f32_16x16x32_bf16 v[80:83], a[240:243], v[36:39], v[80:83]
    v_mfma_f32_16x16x32_bf16 v[84:87], a[244:247], v[36:39], v[84:87]
    v_mfma_f32_16x16x32_bf16 v[88:91], a[248:251], v[36:39], v[88:91]
    v_mfma_f32_16x16x32_bf16 v[92:95], a[252:255], v[36:39], v[92:95]
    v_mfma_f32_16x16x32_bf16 v[96:99], a[240:243], v[40:43], v[96:99]
    v_mfma_f32_16x16x32_bf16 v[100:103], a[244:247], v[40:43], v[100:103]
    v_mfma_f32_16x16x32_bf16 v[104:107], a[248:251], v[40:43], v[104:107]
    v_mfma_f32_16x16x32_bf16 v[108:111], a[252:255], v[40:43], v[108:111]
    v_mfma_f32_16x16x32_bf16 v[112:115], a[240:243], v[44:47], v[112:115]
    v_mfma_f32_16x16x32_bf16 v[116:119], a[244:247], v[44:47], v[116:119]
    v_mfma_f32_16x16x32_bf16 v[120:123], a[248:251], v[44:47], v[120:123]
    v_mfma_f32_16x16x32_bf16 v[124:127], a[252:255], v[44:47], v[124:127]
    s_branch pj_hj_152
pj_hv_151:
    v_mfma_f32_16x16x32_bf16 v[64:67], v[32:35], a[240:243], v[64:67]
    v_mfma_f32_16x16x32_bf16 v[68:71], v[32:35], a[244:247], v[68:71]
    v_mfma_f32_16x16x32_bf16 v[72:75], v[32:35], a[248:251], v[72:75]
    v_mfma_f32_16x16x32_bf16 v[76:79], v[32:35], a[252:255], v[76:79]
    v_mfma_f32_16x16x32_bf16 v[80:83], v[36:39], a[240:243], v[80:83]
    v_mfma_f32_16x16x32_bf16 v[84:87], v[36:39], a[244:247], v[84:87]
    v_mfma_f32_16x16x32_bf16 v[88:91], v[36:39], a[248:251], v[88:91]
    v_mfma_f32_16x16x32_bf16 v[92:95], v[36:39], a[252:255], v[92:95]
    v_mfma_f32_16x16x32_bf16 v[96:99], v[40:43], a[240:243], v[96:99]
    v_mfma_f32_16x16x32_bf16 v[100:103], v[40:43], a[244:247], v[100:103]
    v_mfma_f32_16x16x32_bf16 v[104:107], v[40:43], a[248:251], v[104:107]
    v_mfma_f32_16x16x32_bf16 v[108:111], v[40:43], a[252:255], v[108:111]
    v_mfma_f32_16x16x32_bf16 v[112:115], v[44:47], a[240:243], v[112:115]
    v_mfma_f32_16x16x32_bf16 v[116:119], v[44:47], a[244:247], v[116:119]
    v_mfma_f32_16x16x32_bf16 v[120:123], v[44:47], a[248:251], v[120:123]
    v_mfma_f32_16x16x32_bf16 v[124:127], v[44:47], a[252:255], v[124:127]
pj_hj_152:
    s_mov_b32 s59, 0x40000000
    s_branch mn_pgo
mn_pb:
    s_sub_u32 s60, s61, 80
    s_waitcnt lgkmcnt(0)
    s_lshl_b32 s62, s60, 2
    s_add_u32 s62, s62, s4
    s_lshl_b32 s62, s62, 13
    v_lshlrev_b32 v1, 7, v0
    s_mov_b32 s8, s90
    s_mov_b32 s9, s91
    s_mov_b32 s10, 0x400000
    s_mov_b32 s11, 0x00020000
    buffer_load_dword v15, v1, s[8:11], s62 offen
    s_mul_i32 s61, s60, 171
    s_lshr_b32 s61, s61, 9
    s_mul_i32 s62, s61, 3
    s_sub_u32 s63, s60, s62
    s_cmp_eq_u32 s63, 0
    s_cselect_b32 s23, 22, 21
    s_sub_u32 s62, 63, s63
    s_cmp_lt_u32 s61, 16
    s_cselect_b32 s21, s62, s63
    s_cselect_b32 s22, -3, 3
    s_cselect_b32 s62, 32, -16
    s_add_u32 s61, s61, s62
    s_lshl_b32 s27, s61, 4
    s_lshl_b32 s62, s63, 2
    s_add_u32 s27, s27, s62
    s_add_u32 s27, s27, 146810880
    s_add_u32 s61, s61, 48
    s_cmp_ge_u32 s61, 48
    s_cselect_b32 s42, 1, 0
    s_cselect_b32 s43, 48, 0
    s_sub_u32 s61, s61, s43
    s_cmp_ge_u32 s61, 32
    s_cselect_b32 s43, 1, 0
    s_cselect_b32 s44, 56, 64
    s_cmp_eq_u32 s42, 0
    s_cselect_b32 s44, 0, s44
    s_lshr_b32 s45, s4, 1
    s_add_u32 s46, s45, 1
    s_cmp_eq_u32 s43, 1
    s_cselect_b32 s46, 0, s46
    s_sub_u32 s47, s61, 32
    s_lshl_b32 s47, s47, 1
    s_add_u32 s47, s47, s45
    s_cmp_eq_u32 s43, 1
    s_cselect_b32 s47, s47, s61
    s_cselect_b32 s26, 0x3e0293ee, 1.0
    s_cmp_eq_u32 s46, 2
    s_cselect_b32 s25, 1, 0
    s_mul_i32 s48, s42, 56
    s_lshl_b32 s49, s46, 3
    s_add_u32 s48, s48, s49
    s_add_u32 s48, s48, 16
    s_load_dwordx2 s[50:51], s[0:1], s48
    s_load_dwordx2 s[52:53], s[0:1], s44
    s_and_b32 s45, s4, 1
    s_lshl_b32 s20, s47, 8
    s_lshl_b32 s49, s45, 7
    s_add_u32 s20, s20, s49
    s_mul_i32 s48, s42, 3
    s_add_u32 s48, s48, s46
    s_lshl_b32 s24, s48, 24
    s_lshl_b32 s49, s47, 19
    s_add_u32 s24, s24, s49
    s_lshl_b32 s49, s45, 12
    s_add_u32 s24, s24, s49
    s_waitcnt lgkmcnt(0)
    s_mov_b32 s12, s40
    s_mov_b32 s13, s41
    s_mov_b32 s14, 0x10000000
    s_mov_b32 s15, 0x00020000
    s_mov_b32 s16, s52
    s_mov_b32 s17, s53
    s_mov_b32 s18, 0x200000
    s_mov_b32 s19, 0x00020000
    s_mov_b32 s8, s50
    s_mov_b32 s9, s51
    s_mov_b32 s10, 0x400000
    s_mov_b32 s11, 0x00020000
    v_lshlrev_b32 v1, 4, v0
    s_lshl_b32 s31, s22, 15
    s_lshl_b32 s32, s22, 13
    s_lshl_b32 s28, s21, 15
    s_lshl_b32 s36, s4, 13
    s_add_u32 s28, s28, s36
    s_mul_i32 s30, s4, 8320
    s_lshr_b32 s36, s4, 1
    s_lshl_b32 s36, s36, 7
    s_add_u32 s30, s30, s36
    v_bfe_u32 v4, v0, 3, 3
    v_lshlrev_b32 v5, 13, v4
    v_bfe_u32 v4, v0, 0, 3
    v_lshl_add_u32 v5, v4, 4, v5
    v_bfe_u32 v4, v0, 4, 2
    v_lshlrev_b32 v6, 10, v4
    v_bfe_u32 v4, v0, 2, 2
    v_lshl_add_u32 v6, v4, 7, v6
    v_bfe_u32 v4, v0, 1, 1
    v_lshl_add_u32 v6, v4, 5, v6
    v_bfe_u32 v4, v0, 0, 1
    v_lshl_add_u32 v6, v4, 3, v6
    s_lshl_b32 s38, s4, 14
    s_add_u32 s38, s38, 66816
    v_add_u32 v6, s38, v6
    s_cmp_lg_u32 s25, 0
    s_cselect_b32 s41, 8448, 0
    s_add_u32 s41, s41, 8320
    s_sub_u32 s42, 25088, s41
    v_and_b32 v4, 7, v0
    v_mul_u32_u24 v2, 1040, v4
    v_bfe_u32 v4, v0, 3, 1
    v_mul_lo_u32 v4, v4, s41
    v_add_u32 v2, v2, v4
    v_lshrrev_b32 v4, 4, v0
    v_lshl_add_u32 v2, v4, 8, v2
    v_add_u32 v10, s42, v2
    s_load_dwordx2 s[46:47], s[0:1], 112
    s_add_u32 m0, s38, 0
    s_add_u32 s39, s20, 0
    buffer_load_dwordx4 v5, s[8:11], s39 offen nt lds
    s_add_u32 m0, s38, 1024
    s_add_u32 s39, s20, 1048576
    buffer_load_dwordx4 v5, s[8:11], s39 offen nt lds
    s_add_u32 m0, s38, 2048
    s_add_u32 s39, s20, 2097152
    buffer_load_dwordx4 v5, s[8:11], s39 offen nt lds
    s_add_u32 m0, s38, 3072
    s_add_u32 s39, s20, 3145728
    buffer_load_dwordx4 v5, s[8:11], s39 offen nt lds
    s_add_u32 m0, s30, 0
    s_nop 0
    buffer_load_dwordx4 v1, s[16:19], s28 offen offset:0 lds
    s_add_u32 m0, s30, 16
    s_nop 0
    buffer_load_dwordx4 v1, s[16:19], s28 offen offset:1024 lds
    s_add_u32 m0, s30, 32
    s_nop 0
    buffer_load_dwordx4 v1, s[16:19], s28 offen offset:2048 lds
    s_add_u32 m0, s30, 48
    s_nop 0
    buffer_load_dwordx4 v1, s[16:19], s28 offen offset:3072 lds
    s_add_u32 s37, s28, 4096
    s_add_u32 m0, s30, 4160
    s_nop 0
    buffer_load_dwordx4 v1, s[16:19], s37 offen offset:0 lds
    s_add_u32 m0, s30, 4176
    s_nop 0
    buffer_load_dwordx4 v1, s[16:19], s37 offen offset:1024 lds
    s_add_u32 m0, s30, 4192
    s_nop 0
    buffer_load_dwordx4 v1, s[16:19], s37 offen offset:2048 lds
    s_add_u32 m0, s30, 4208
    s_nop 0
    buffer_load_dwordx4 v1, s[16:19], s37 offen offset:3072 lds
    s_add_u32 s28, s28, s31
    s_add_u32 s30, s30, 33408
    s_cmp_ge_u32 s30, 133632
    s_cselect_b32 s37, 133632, 0
    s_sub_u32 s30, s30, s37
    s_add_u32 m0, s30, 0
    s_nop 0
    buffer_load_dwordx4 v1, s[16:19], s28 offen offset:0 lds
    s_add_u32 m0, s30, 16
    s_nop 0
    buffer_load_dwordx4 v1, s[16:19], s28 offen offset:1024 lds
    s_add_u32 m0, s30, 32
    s_nop 0
    buffer_load_dwordx4 v1, s[16:19], s28 offen offset:2048 lds
    s_add_u32 m0, s30, 48
    s_nop 0
    buffer_load_dwordx4 v1, s[16:19], s28 offen offset:3072 lds
    s_add_u32 s37, s28, 4096
    s_add_u32 m0, s30, 4160
    s_nop 0
    buffer_load_dwordx4 v1, s[16:19], s37 offen offset:0 lds
    s_add_u32 m0, s30, 4176
    s_nop 0
    buffer_load_dwordx4 v1, s[16:19], s37 offen offset:1024 lds
    s_add_u32 m0, s30, 4192
    s_nop 0
    buffer_load_dwordx4 v1, s[16:19], s37 offen offset:2048 lds
    s_add_u32 m0, s30, 4208
    s_nop 0
    buffer_load_dwordx4 v1, s[16:19], s37 offen offset:3072 lds
    s_add_u32 s28, s28, s31
    s_add_u32 s30, s30, 33408
    s_cmp_ge_u32 s30, 133632
    s_cselect_b32 s37, 133632, 0
    s_sub_u32 s30, s30, s37
    s_add_u32 m0, s38, 4096
    s_add_u32 s39, s20, 65536
    buffer_load_dwordx4 v5, s[8:11], s39 offen nt lds
    s_add_u32 m0, s38, 5120
    s_add_u32 s39, s20, 1114112
    buffer_load_dwordx4 v5, s[8:11], s39 offen nt lds
    s_add_u32 m0, s38, 6144
    s_add_u32 s39, s20, 2162688
    buffer_load_dwordx4 v5, s[8:11], s39 offen nt lds
    s_add_u32 m0, s38, 7168
    s_add_u32 s39, s20, 3211264
    buffer_load_dwordx4 v5, s[8:11], s39 offen nt lds
    s_waitcnt lgkmcnt(0)
    s_mov_b32 s48, s46
    s_mov_b32 s49, s47
    s_mov_b32 s50, 0x100
    s_mov_b32 s51, 0x00020000
    s_waitcnt vmcnt(4)
    s_barrier
    ds_read_b128 v[16:19], v2 offset:0
    ds_read_b128 v[20:23], v10 offset:0
    ds_read_b128 v[24:27], v2 offset:33408
    ds_read_b128 v[28:31], v10 offset:33408
    ds_read_b64_tr_b16 a[0:1], v6 offset:0
    ds_read_b64_tr_b16 a[2:3], v6 offset:512
    ds_read_b64_tr_b16 a[4:5], v6 offset:16
    ds_read_b64_tr_b16 a[6:7], v6 offset:528
    ds_read_b64_tr_b16 a[8:9], v6 offset:64
    ds_read_b64_tr_b16 a[10:11], v6 offset:576
    ds_read_b64_tr_b16 a[12:13], v6 offset:80
    ds_read_b64_tr_b16 a[14:15], v6 offset:592
    s_waitcnt lgkmcnt(0)
    s_add_u32 m0, s38, 8192
    s_add_u32 s39, s20, 131072
    buffer_load_dwordx4 v5, s[8:11], s39 offen nt lds
    s_add_u32 m0, s38, 9216
    s_add_u32 s39, s20, 1179648
    buffer_load_dwordx4 v5, s[8:11], s39 offen nt lds
    s_add_u32 m0, s38, 10240
    s_add_u32 s39, s20, 2228224
    buffer_load_dwordx4 v5, s[8:11], s39 offen nt lds
    s_add_u32 m0, s38, 11264
    s_add_u32 s39, s20, 3276800
    buffer_load_dwordx4 v5, s[8:11], s39 offen nt lds
    s_cmp_lg_u32 s25, 0
    s_cbranch_scc1 pj_hv_153
    v_mfma_f32_16x16x32_bf16 v[64:67], a[0:3], v[16:19], 0
    v_mfma_f32_16x16x32_bf16 v[68:71], a[4:7], v[16:19], 0
    v_mfma_f32_16x16x32_bf16 v[72:75], a[8:11], v[16:19], 0
    v_mfma_f32_16x16x32_bf16 v[76:79], a[12:15], v[16:19], 0
    v_mfma_f32_16x16x32_bf16 v[80:83], a[0:3], v[20:23], 0
    v_mfma_f32_16x16x32_bf16 v[84:87], a[4:7], v[20:23], 0
    v_mfma_f32_16x16x32_bf16 v[88:91], a[8:11], v[20:23], 0
    v_mfma_f32_16x16x32_bf16 v[92:95], a[12:15], v[20:23], 0
    v_mfma_f32_16x16x32_bf16 v[96:99], a[0:3], v[24:27], 0
    v_mfma_f32_16x16x32_bf16 v[100:103], a[4:7], v[24:27], 0
    v_mfma_f32_16x16x32_bf16 v[104:107], a[8:11], v[24:27], 0
    v_mfma_f32_16x16x32_bf16 v[108:111], a[12:15], v[24:27], 0
    v_mfma_f32_16x16x32_bf16 v[112:115], a[0:3], v[28:31], 0
    v_mfma_f32_16x16x32_bf16 v[116:119], a[4:7], v[28:31], 0
    v_mfma_f32_16x16x32_bf16 v[120:123], a[8:11], v[28:31], 0
    v_mfma_f32_16x16x32_bf16 v[124:127], a[12:15], v[28:31], 0
    s_branch pj_hj_154
pj_hv_153:
    v_mfma_f32_16x16x32_bf16 v[64:67], v[16:19], a[0:3], 0
    v_mfma_f32_16x16x32_bf16 v[68:71], v[16:19], a[4:7], 0
    v_mfma_f32_16x16x32_bf16 v[72:75], v[16:19], a[8:11], 0
    v_mfma_f32_16x16x32_bf16 v[76:79], v[16:19], a[12:15], 0
    v_mfma_f32_16x16x32_bf16 v[80:83], v[20:23], a[0:3], 0
    v_mfma_f32_16x16x32_bf16 v[84:87], v[20:23], a[4:7], 0
    v_mfma_f32_16x16x32_bf16 v[88:91], v[20:23], a[8:11], 0
    v_mfma_f32_16x16x32_bf16 v[92:95], v[20:23], a[12:15], 0
    v_mfma_f32_16x16x32_bf16 v[96:99], v[24:27], a[0:3], 0
    v_mfma_f32_16x16x32_bf16 v[100:103], v[24:27], a[4:7], 0
    v_mfma_f32_16x16x32_bf16 v[104:107], v[24:27], a[8:11], 0
    v_mfma_f32_16x16x32_bf16 v[108:111], v[24:27], a[12:15], 0
    v_mfma_f32_16x16x32_bf16 v[112:115], v[28:31], a[0:3], 0
    v_mfma_f32_16x16x32_bf16 v[116:119], v[28:31], a[4:7], 0
    v_mfma_f32_16x16x32_bf16 v[120:123], v[28:31], a[8:11], 0
    s_nop 0
    v_mfma_f32_16x16x32_bf16 v[124:127], v[28:31], a[12:15], 0
    s_nop 0
pj_hj_154:
    s_waitcnt vmcnt(4)
    ds_read_b128 v[32:35], v2 offset:16
    ds_read_b128 v[36:39], v10 offset:16
    ds_read_b128 v[40:43], v2 offset:33424
    ds_read_b128 v[44:47], v10 offset:33424
    ds_read_b64_tr_b16 a[16:17], v6 offset:4096
    ds_read_b64_tr_b16 a[18:19], v6 offset:4608
    ds_read_b64_tr_b16 a[20:21], v6 offset:4112
    ds_read_b64_tr_b16 a[22:23], v6 offset:4624
    ds_read_b64_tr_b16 a[24:25], v6 offset:4160
    ds_read_b64_tr_b16 a[26:27], v6 offset:4672
    ds_read_b64_tr_b16 a[28:29], v6 offset:4176
    ds_read_b64_tr_b16 a[30:31], v6 offset:4688
    s_waitcnt lgkmcnt(0)
    s_add_u32 m0, s38, 12288
    s_add_u32 s39, s20, 196608
    buffer_load_dwordx4 v5, s[8:11], s39 offen nt lds
    s_add_u32 m0, s38, 13312
    s_add_u32 s39, s20, 1245184
    buffer_load_dwordx4 v5, s[8:11], s39 offen nt lds
    s_add_u32 m0, s38, 14336
    s_add_u32 s39, s20, 2293760
    buffer_load_dwordx4 v5, s[8:11], s39 offen nt lds
    s_add_u32 m0, s38, 15360
    s_add_u32 s39, s20, 3342336
    buffer_load_dwordx4 v5, s[8:11], s39 offen nt lds
    s_cmp_lg_u32 s25, 0
    s_cbranch_scc1 pj_hv_155
    v_mfma_f32_16x16x32_bf16 v[64:67], a[16:19], v[32:35], v[64:67]
    v_mfma_f32_16x16x32_bf16 v[68:71], a[20:23], v[32:35], v[68:71]
    v_mfma_f32_16x16x32_bf16 v[72:75], a[24:27], v[32:35], v[72:75]
    v_mfma_f32_16x16x32_bf16 v[76:79], a[28:31], v[32:35], v[76:79]
    v_mfma_f32_16x16x32_bf16 v[80:83], a[16:19], v[36:39], v[80:83]
    v_mfma_f32_16x16x32_bf16 v[84:87], a[20:23], v[36:39], v[84:87]
    v_mfma_f32_16x16x32_bf16 v[88:91], a[24:27], v[36:39], v[88:91]
    v_mfma_f32_16x16x32_bf16 v[92:95], a[28:31], v[36:39], v[92:95]
    v_mfma_f32_16x16x32_bf16 v[96:99], a[16:19], v[40:43], v[96:99]
    v_mfma_f32_16x16x32_bf16 v[100:103], a[20:23], v[40:43], v[100:103]
    v_mfma_f32_16x16x32_bf16 v[104:107], a[24:27], v[40:43], v[104:107]
    v_mfma_f32_16x16x32_bf16 v[108:111], a[28:31], v[40:43], v[108:111]
    v_mfma_f32_16x16x32_bf16 v[112:115], a[16:19], v[44:47], v[112:115]
    v_mfma_f32_16x16x32_bf16 v[116:119], a[20:23], v[44:47], v[116:119]
    v_mfma_f32_16x16x32_bf16 v[120:123], a[24:27], v[44:47], v[120:123]
    v_mfma_f32_16x16x32_bf16 v[124:127], a[28:31], v[44:47], v[124:127]
    s_branch pj_hj_156
pj_hv_155:
    v_mfma_f32_16x16x32_bf16 v[64:67], v[32:35], a[16:19], v[64:67]
    v_mfma_f32_16x16x32_bf16 v[68:71], v[32:35], a[20:23], v[68:71]
    v_mfma_f32_16x16x32_bf16 v[72:75], v[32:35], a[24:27], v[72:75]
    v_mfma_f32_16x16x32_bf16 v[76:79], v[32:35], a[28:31], v[76:79]
    v_mfma_f32_16x16x32_bf16 v[80:83], v[36:39], a[16:19], v[80:83]
    v_mfma_f32_16x16x32_bf16 v[84:87], v[36:39], a[20:23], v[84:87]
    v_mfma_f32_16x16x32_bf16 v[88:91], v[36:39], a[24:27], v[88:91]
    v_mfma_f32_16x16x32_bf16 v[92:95], v[36:39], a[28:31], v[92:95]
    v_mfma_f32_16x16x32_bf16 v[96:99], v[40:43], a[16:19], v[96:99]
    v_mfma_f32_16x16x32_bf16 v[100:103], v[40:43], a[20:23], v[100:103]
    v_mfma_f32_16x16x32_bf16 v[104:107], v[40:43], a[24:27], v[104:107]
    v_mfma_f32_16x16x32_bf16 v[108:111], v[40:43], a[28:31], v[108:111]
    v_mfma_f32_16x16x32_bf16 v[112:115], v[44:47], a[16:19], v[112:115]
    s_nop 0
    v_mfma_f32_16x16x32_bf16 v[116:119], v[44:47], a[20:23], v[116:119]
    s_nop 0
    v_mfma_f32_16x16x32_bf16 v[120:123], v[44:47], a[24:27], v[120:123]
    s_nop 0
    v_mfma_f32_16x16x32_bf16 v[124:127], v[44:47], a[28:31], v[124:127]
    s_nop 0
pj_hj_156:
    s_waitcnt vmcnt(4)
    ds_read_b128 v[16:19], v2 offset:32
    ds_read_b128 v[20:23], v10 offset:32
    ds_read_b128 v[24:27], v2 offset:33440
    ds_read_b128 v[28:31], v10 offset:33440
    ds_read_b64_tr_b16 a[32:33], v6 offset:8192
    ds_read_b64_tr_b16 a[34:35], v6 offset:8704
    ds_read_b64_tr_b16 a[36:37], v6 offset:8208
    ds_read_b64_tr_b16 a[38:39], v6 offset:8720
    ds_read_b64_tr_b16 a[40:41], v6 offset:8256
    ds_read_b64_tr_b16 a[42:43], v6 offset:8768
    ds_read_b64_tr_b16 a[44:45], v6 offset:8272
    ds_read_b64_tr_b16 a[46:47], v6 offset:8784
    s_waitcnt lgkmcnt(0)
    s_add_u32 m0, s38, 0
    s_add_u32 s39, s20, 262144
    buffer_load_dwordx4 v5, s[8:11], s39 offen nt lds
    s_add_u32 m0, s38, 1024
    s_add_u32 s39, s20, 1310720
    buffer_load_dwordx4 v5, s[8:11], s39 offen nt lds
    s_add_u32 m0, s38, 2048
    s_add_u32 s39, s20, 2359296
    buffer_load_dwordx4 v5, s[8:11], s39 offen nt lds
    s_add_u32 m0, s38, 3072
    s_add_u32 s39, s20, 3407872
    buffer_load_dwordx4 v5, s[8:11], s39 offen nt lds
    s_cmp_lg_u32 s25, 0
    s_cbranch_scc1 pj_hv_157
    v_mfma_f32_16x16x32_bf16 v[64:67], a[32:35], v[16:19], v[64:67]
    v_mfma_f32_16x16x32_bf16 v[68:71], a[36:39], v[16:19], v[68:71]
    v_mfma_f32_16x16x32_bf16 v[72:75], a[40:43], v[16:19], v[72:75]
    v_mfma_f32_16x16x32_bf16 v[76:79], a[44:47], v[16:19], v[76:79]
    v_mfma_f32_16x16x32_bf16 v[80:83], a[32:35], v[20:23], v[80:83]
    v_mfma_f32_16x16x32_bf16 v[84:87], a[36:39], v[20:23], v[84:87]
    v_mfma_f32_16x16x32_bf16 v[88:91], a[40:43], v[20:23], v[88:91]
    v_mfma_f32_16x16x32_bf16 v[92:95], a[44:47], v[20:23], v[92:95]
    v_mfma_f32_16x16x32_bf16 v[96:99], a[32:35], v[24:27], v[96:99]
    v_mfma_f32_16x16x32_bf16 v[100:103], a[36:39], v[24:27], v[100:103]
    v_mfma_f32_16x16x32_bf16 v[104:107], a[40:43], v[24:27], v[104:107]
    v_mfma_f32_16x16x32_bf16 v[108:111], a[44:47], v[24:27], v[108:111]
    v_mfma_f32_16x16x32_bf16 v[112:115], a[32:35], v[28:31], v[112:115]
    v_mfma_f32_16x16x32_bf16 v[116:119], a[36:39], v[28:31], v[116:119]
    v_mfma_f32_16x16x32_bf16 v[120:123], a[40:43], v[28:31], v[120:123]
    v_mfma_f32_16x16x32_bf16 v[124:127], a[44:47], v[28:31], v[124:127]
    s_branch pj_hj_158
pj_hv_157:
    v_mfma_f32_16x16x32_bf16 v[64:67], v[16:19], a[32:35], v[64:67]
    v_mfma_f32_16x16x32_bf16 v[68:71], v[16:19], a[36:39], v[68:71]
    v_mfma_f32_16x16x32_bf16 v[72:75], v[16:19], a[40:43], v[72:75]
    v_mfma_f32_16x16x32_bf16 v[76:79], v[16:19], a[44:47], v[76:79]
    v_mfma_f32_16x16x32_bf16 v[80:83], v[20:23], a[32:35], v[80:83]
    v_mfma_f32_16x16x32_bf16 v[84:87], v[20:23], a[36:39], v[84:87]
    v_mfma_f32_16x16x32_bf16 v[88:91], v[20:23], a[40:43], v[88:91]
    v_mfma_f32_16x16x32_bf16 v[92:95], v[20:23], a[44:47], v[92:95]
    v_mfma_f32_16x16x32_bf16 v[96:99], v[24:27], a[32:35], v[96:99]
    v_mfma_f32_16x16x32_bf16 v[100:103], v[24:27], a[36:39], v[100:103]
    v_mfma_f32_16x16x32_bf16 v[104:107], v[24:27], a[40:43], v[104:107]
    v_mfma_f32_16x16x32_bf16 v[108:111], v[24:27], a[44:47], v[108:111]
    v_mfma_f32_16x16x32_bf16 v[112:115], v[28:31], a[32:35], v[112:115]
    v_mfma_f32_16x16x32_bf16 v[116:119], v[28:31], a[36:39], v[116:119]
    s_nop 0
    v_mfma_f32_16x16x32_bf16 v[120:123], v[28:31], a[40:43], v[120:123]
    s_nop 0
    v_mfma_f32_16x16x32_bf16 v[124:127], v[28:31], a[44:47], v[124:127]
    s_nop 0
pj_hj_158:
    s_waitcnt vmcnt(4)
    ds_read_b128 v[32:35], v2 offset:48
    ds_read_b128 v[36:39], v10 offset:48
    ds_read_b128 v[40:43], v2 offset:33456
    ds_read_b128 v[44:47], v10 offset:33456
    ds_read_b64_tr_b16 a[48:49], v6 offset:12288
    ds_read_b64_tr_b16 a[50:51], v6 offset:12800
    ds_read_b64_tr_b16 a[52:53], v6 offset:12304
    ds_read_b64_tr_b16 a[54:55], v6 offset:12816
    ds_read_b64_tr_b16 a[56:57], v6 offset:12352
    ds_read_b64_tr_b16 a[58:59], v6 offset:12864
    ds_read_b64_tr_b16 a[60:61], v6 offset:12368
    ds_read_b64_tr_b16 a[62:63], v6 offset:12880
    s_waitcnt lgkmcnt(0)
    s_add_u32 m0, s38, 4096
    s_add_u32 s39, s20, 327680
    buffer_load_dwordx4 v5, s[8:11], s39 offen nt lds
    s_add_u32 m0, s38, 5120
    s_add_u32 s39, s20, 1376256
    buffer_load_dwordx4 v5, s[8:11], s39 offen nt lds
    s_add_u32 m0, s38, 6144
    s_add_u32 s39, s20, 2424832
    buffer_load_dwordx4 v5, s[8:11], s39 offen nt lds
    s_add_u32 m0, s38, 7168
    s_add_u32 s39, s20, 3473408
    buffer_load_dwordx4 v5, s[8:11], s39 offen nt lds
    s_cmp_lg_u32 s25, 0
    s_cbranch_scc1 pj_hv_159
    v_mfma_f32_16x16x32_bf16 v[64:67], a[48:51], v[32:35], v[64:67]
    v_mfma_f32_16x16x32_bf16 v[68:71], a[52:55], v[32:35], v[68:71]
    v_mfma_f32_16x16x32_bf16 v[72:75], a[56:59], v[32:35], v[72:75]
    v_mfma_f32_16x16x32_bf16 v[76:79], a[60:63], v[32:35], v[76:79]
    v_mfma_f32_16x16x32_bf16 v[80:83], a[48:51], v[36:39], v[80:83]
    v_mfma_f32_16x16x32_bf16 v[84:87], a[52:55], v[36:39], v[84:87]
    v_mfma_f32_16x16x32_bf16 v[88:91], a[56:59], v[36:39], v[88:91]
    v_mfma_f32_16x16x32_bf16 v[92:95], a[60:63], v[36:39], v[92:95]
    v_mfma_f32_16x16x32_bf16 v[96:99], a[48:51], v[40:43], v[96:99]
    v_mfma_f32_16x16x32_bf16 v[100:103], a[52:55], v[40:43], v[100:103]
    v_mfma_f32_16x16x32_bf16 v[104:107], a[56:59], v[40:43], v[104:107]
    v_mfma_f32_16x16x32_bf16 v[108:111], a[60:63], v[40:43], v[108:111]
    v_mfma_f32_16x16x32_bf16 v[112:115], a[48:51], v[44:47], v[112:115]
    v_mfma_f32_16x16x32_bf16 v[116:119], a[52:55], v[44:47], v[116:119]
    v_mfma_f32_16x16x32_bf16 v[120:123], a[56:59], v[44:47], v[120:123]
    v_mfma_f32_16x16x32_bf16 v[124:127], a[60:63], v[44:47], v[124:127]
    s_branch pj_hj_160
pj_hv_159:
    v_mfma_f32_16x16x32_bf16 v[64:67], v[32:35], a[48:51], v[64:67]
    v_mfma_f32_16x16x32_bf16 v[68:71], v[32:35], a[52:55], v[68:71]
    v_mfma_f32_16x16x32_bf16 v[72:75], v[32:35], a[56:59], v[72:75]
    v_mfma_f32_16x16x32_bf16 v[76:79], v[32:35], a[60:63], v[76:79]
    v_mfma_f32_16x16x32_bf16 v[80:83], v[36:39], a[48:51], v[80:83]
    v_mfma_f32_16x16x32_bf16 v[84:87], v[36:39], a[52:55], v[84:87]
    v_mfma_f32_16x16x32_bf16 v[88:91], v[36:39], a[56:59], v[88:91]
    v_mfma_f32_16x16x32_bf16 v[92:95], v[36:39], a[60:63], v[92:95]
    v_mfma_f32_16x16x32_bf16 v[96:99], v[40:43], a[48:51], v[96:99]
    v_mfma_f32_16x16x32_bf16 v[100:103], v[40:43], a[52:55], v[100:103]
    v_mfma_f32_16x16x32_bf16 v[104:107], v[40:43], a[56:59], v[104:107]
    v_mfma_f32_16x16x32_bf16 v[108:111], v[40:43], a[60:63], v[108:111]
    v_mfma_f32_16x16x32_bf16 v[112:115], v[44:47], a[48:51], v[112:115]
    v_mfma_f32_16x16x32_bf16 v[116:119], v[44:47], a[52:55], v[116:119]
    s_nop 0
    v_mfma_f32_16x16x32_bf16 v[120:123], v[44:47], a[56:59], v[120:123]
    s_nop 0
    v_mfma_f32_16x16x32_bf16 v[124:127], v[44:47], a[60:63], v[124:127]
    s_nop 0
pj_hj_160:
    s_waitcnt vmcnt(4)
    ds_read_b128 v[16:19], v2 offset:64
    ds_read_b128 v[20:23], v10 offset:64
    ds_read_b128 v[24:27], v2 offset:33472
    ds_read_b128 v[28:31], v10 offset:33472
    ds_read_b64_tr_b16 a[64:65], v6 offset:0
    ds_read_b64_tr_b16 a[66:67], v6 offset:512
    ds_read_b64_tr_b16 a[68:69], v6 offset:16
    ds_read_b64_tr_b16 a[70:71], v6 offset:528
    ds_read_b64_tr_b16 a[72:73], v6 offset:64
    ds_read_b64_tr_b16 a[74:75], v6 offset:576
    ds_read_b64_tr_b16 a[76:77], v6 offset:80
    ds_read_b64_tr_b16 a[78:79], v6 offset:592
    s_waitcnt lgkmcnt(0)
    s_add_u32 m0, s38, 8192
    s_add_u32 s39, s20, 393216
    buffer_load_dwordx4 v5, s[8:11], s39 offen nt lds
    s_add_u32 m0, s38, 9216
    s_add_u32 s39, s20, 1441792
    buffer_load_dwordx4 v5, s[8:11], s39 offen nt lds
    s_add_u32 m0, s38, 10240
    s_add_u32 s39, s20, 2490368
    buffer_load_dwordx4 v5, s[8:11], s39 offen nt lds
    s_add_u32 m0, s38, 11264
    s_add_u32 s39, s20, 3538944
    buffer_load_dwordx4 v5, s[8:11], s39 offen nt lds
    s_cmp_lg_u32 s25, 0
    s_cbranch_scc1 pj_hv_161
    v_mfma_f32_16x16x32_bf16 v[64:67], a[64:67], v[16:19], v[64:67]
    v_mfma_f32_16x16x32_bf16 v[68:71], a[68:71], v[16:19], v[68:71]
    v_mfma_f32_16x16x32_bf16 v[72:75], a[72:75], v[16:19], v[72:75]
    v_mfma_f32_16x16x32_bf16 v[76:79], a[76:79], v[16:19], v[76:79]
    v_mfma_f32_16x16x32_bf16 v[80:83], a[64:67], v[20:23], v[80:83]
    v_mfma_f32_16x16x32_bf16 v[84:87], a[68:71], v[20:23], v[84:87]
    v_mfma_f32_16x16x32_bf16 v[88:91], a[72:75], v[20:23], v[88:91]
    v_mfma_f32_16x16x32_bf16 v[92:95], a[76:79], v[20:23], v[92:95]
    v_mfma_f32_16x16x32_bf16 v[96:99], a[64:67], v[24:27], v[96:99]
    v_mfma_f32_16x16x32_bf16 v[100:103], a[68:71], v[24:27], v[100:103]
    v_mfma_f32_16x16x32_bf16 v[104:107], a[72:75], v[24:27], v[104:107]
    v_mfma_f32_16x16x32_bf16 v[108:111], a[76:79], v[24:27], v[108:111]
    v_mfma_f32_16x16x32_bf16 v[112:115], a[64:67], v[28:31], v[112:115]
    v_mfma_f32_16x16x32_bf16 v[116:119], a[68:71], v[28:31], v[116:119]
    v_mfma_f32_16x16x32_bf16 v[120:123], a[72:75], v[28:31], v[120:123]
    v_mfma_f32_16x16x32_bf16 v[124:127], a[76:79], v[28:31], v[124:127]
    s_branch pj_hj_162
pj_hv_161:
    v_mfma_f32_16x16x32_bf16 v[64:67], v[16:19], a[64:67], v[64:67]
    v_mfma_f32_16x16x32_bf16 v[68:71], v[16:19], a[68:71], v[68:71]
    v_mfma_f32_16x16x32_bf16 v[72:75], v[16:19], a[72:75], v[72:75]
    v_mfma_f32_16x16x32_bf16 v[76:79], v[16:19], a[76:79], v[76:79]
    v_mfma_f32_16x16x32_bf16 v[80:83], v[20:23], a[64:67], v[80:83]
    v_mfma_f32_16x16x32_bf16 v[84:87], v[20:23], a[68:71], v[84:87]
    v_mfma_f32_16x16x32_bf16 v[88:91], v[20:23], a[72:75], v[88:91]
    v_mfma_f32_16x16x32_bf16 v[92:95], v[20:23], a[76:79], v[92:95]
    v_mfma_f32_16x16x32_bf16 v[96:99], v[24:27], a[64:67], v[96:99]
    v_mfma_f32_16x16x32_bf16 v[100:103], v[24:27], a[68:71], v[100:103]
    v_mfma_f32_16x16x32_bf16 v[104:107], v[24:27], a[72:75], v[104:107]
    v_mfma_f32_16x16x32_bf16 v[108:111], v[24:27], a[76:79], v[108:111]
    v_mfma_f32_16x16x32_bf16 v[112:115], v[28:31], a[64:67], v[112:115]
    v_mfma_f32_16x16x32_bf16 v[116:119], v[28:31], a[68:71], v[116:119]
    s_nop 0
    v_mfma_f32_16x16x32_bf16 v[120:123], v[28:31], a[72:75], v[120:123]
    s_nop 0
    v_mfma_f32_16x16x32_bf16 v[124:127], v[28:31], a[76:79], v[124:127]
    s_nop 0
pj_hj_162:
    s_waitcnt vmcnt(4)
    ds_read_b128 v[32:35], v2 offset:80
    ds_read_b128 v[36:39], v10 offset:80
    ds_read_b128 v[40:43], v2 offset:33488
    ds_read_b128 v[44:47], v10 offset:33488
    ds_read_b64_tr_b16 a[80:81], v6 offset:4096
    ds_read_b64_tr_b16 a[82:83], v6 offset:4608
    ds_read_b64_tr_b16 a[84:85], v6 offset:4112
    ds_read_b64_tr_b16 a[86:87], v6 offset:4624
    ds_read_b64_tr_b16 a[88:89], v6 offset:4160
    ds_read_b64_tr_b16 a[90:91], v6 offset:4672
    ds_read_b64_tr_b16 a[92:93], v6 offset:4176
    ds_read_b64_tr_b16 a[94:95], v6 offset:4688
    s_waitcnt lgkmcnt(0)
    s_add_u32 m0, s38, 12288
    s_add_u32 s39, s20, 458752
    buffer_load_dwordx4 v5, s[8:11], s39 offen nt lds
    s_add_u32 m0, s38, 13312
    s_add_u32 s39, s20, 1507328
    buffer_load_dwordx4 v5, s[8:11], s39 offen nt lds
    s_add_u32 m0, s38, 14336
    s_add_u32 s39, s20, 2555904
    buffer_load_dwordx4 v5, s[8:11], s39 offen nt lds
    s_add_u32 m0, s38, 15360
    s_add_u32 s39, s20, 3604480
    buffer_load_dwordx4 v5, s[8:11], s39 offen nt lds
    s_cmp_lg_u32 s25, 0
    s_cbranch_scc1 pj_hv_163
    v_mfma_f32_16x16x32_bf16 v[64:67], a[80:83], v[32:35], v[64:67]
    v_mfma_f32_16x16x32_bf16 v[68:71], a[84:87], v[32:35], v[68:71]
    v_mfma_f32_16x16x32_bf16 v[72:75], a[88:91], v[32:35], v[72:75]
    v_mfma_f32_16x16x32_bf16 v[76:79], a[92:95], v[32:35], v[76:79]
    v_mfma_f32_16x16x32_bf16 v[80:83], a[80:83], v[36:39], v[80:83]
    v_mfma_f32_16x16x32_bf16 v[84:87], a[84:87], v[36:39], v[84:87]
    v_mfma_f32_16x16x32_bf16 v[88:91], a[88:91], v[36:39], v[88:91]
    v_mfma_f32_16x16x32_bf16 v[92:95], a[92:95], v[36:39], v[92:95]
    v_mfma_f32_16x16x32_bf16 v[96:99], a[80:83], v[40:43], v[96:99]
    v_mfma_f32_16x16x32_bf16 v[100:103], a[84:87], v[40:43], v[100:103]
    v_mfma_f32_16x16x32_bf16 v[104:107], a[88:91], v[40:43], v[104:107]
    v_mfma_f32_16x16x32_bf16 v[108:111], a[92:95], v[40:43], v[108:111]
    v_mfma_f32_16x16x32_bf16 v[112:115], a[80:83], v[44:47], v[112:115]
    v_mfma_f32_16x16x32_bf16 v[116:119], a[84:87], v[44:47], v[116:119]
    v_mfma_f32_16x16x32_bf16 v[120:123], a[88:91], v[44:47], v[120:123]
    v_mfma_f32_16x16x32_bf16 v[124:127], a[92:95], v[44:47], v[124:127]
    s_branch pj_hj_164
pj_hv_163:
    v_mfma_f32_16x16x32_bf16 v[64:67], v[32:35], a[80:83], v[64:67]
    v_mfma_f32_16x16x32_bf16 v[68:71], v[32:35], a[84:87], v[68:71]
    v_mfma_f32_16x16x32_bf16 v[72:75], v[32:35], a[88:91], v[72:75]
    v_mfma_f32_16x16x32_bf16 v[76:79], v[32:35], a[92:95], v[76:79]
    v_mfma_f32_16x16x32_bf16 v[80:83], v[36:39], a[80:83], v[80:83]
    v_mfma_f32_16x16x32_bf16 v[84:87], v[36:39], a[84:87], v[84:87]
    v_mfma_f32_16x16x32_bf16 v[88:91], v[36:39], a[88:91], v[88:91]
    v_mfma_f32_16x16x32_bf16 v[92:95], v[36:39], a[92:95], v[92:95]
    v_mfma_f32_16x16x32_bf16 v[96:99], v[40:43], a[80:83], v[96:99]
    v_mfma_f32_16x16x32_bf16 v[100:103], v[40:43], a[84:87], v[100:103]
    v_mfma_f32_16x16x32_bf16 v[104:107], v[40:43], a[88:91], v[104:107]
    v_mfma_f32_16x16x32_bf16 v[108:111], v[40:43], a[92:95], v[108:111]
    v_mfma_f32_16x16x32_bf16 v[112:115], v[44:47], a[80:83], v[112:115]
    s_nop 0
    v_mfma_f32_16x16x32_bf16 v[116:119], v[44:47], a[84:87], v[116:119]
    s_nop 0
    v_mfma_f32_16x16x32_bf16 v[120:123], v[44:47], a[88:91], v[120:123]
    s_nop 0
    v_mfma_f32_16x16x32_bf16 v[124:127], v[44:47], a[92:95], v[124:127]
    s_nop 0
pj_hj_164:
    s_waitcnt vmcnt(4)
    ds_read_b128 v[16:19], v2 offset:96
    ds_read_b128 v[20:23], v10 offset:96
    ds_read_b128 v[24:27], v2 offset:33504
    ds_read_b128 v[28:31], v10 offset:33504
    ds_read_b64_tr_b16 a[96:97], v6 offset:8192
    ds_read_b64_tr_b16 a[98:99], v6 offset:8704
    ds_read_b64_tr_b16 a[100:101], v6 offset:8208
    ds_read_b64_tr_b16 a[102:103], v6 offset:8720
    ds_read_b64_tr_b16 a[104:105], v6 offset:8256
    ds_read_b64_tr_b16 a[106:107], v6 offset:8768
    ds_read_b64_tr_b16 a[108:109], v6 offset:8272
    ds_read_b64_tr_b16 a[110:111], v6 offset:8784
    s_waitcnt lgkmcnt(0)
    s_add_u32 m0, s38, 0
    s_add_u32 s39, s20, 524288
    buffer_load_dwordx4 v5, s[8:11], s39 offen nt lds
    s_add_u32 m0, s38, 1024
    s_add_u32 s39, s20, 1572864
    buffer_load_dwordx4 v5, s[8:11], s39 offen nt lds
    s_add_u32 m0, s38, 2048
    s_add_u32 s39, s20, 2621440
    buffer_load_dwordx4 v5, s[8:11], s39 offen nt lds
    s_add_u32 m0, s38, 3072
    s_add_u32 s39, s20, 3670016
    buffer_load_dwordx4 v5, s[8:11], s39 offen nt lds
    s_cmp_lg_u32 s25, 0
    s_cbranch_scc1 pj_hv_165
    v_mfma_f32_16x16x32_bf16 v[64:67], a[96:99], v[16:19], v[64:67]
    v_mfma_f32_16x16x32_bf16 v[68:71], a[100:103], v[16:19], v[68:71]
    v_mfma_f32_16x16x32_bf16 v[72:75], a[104:107], v[16:19], v[72:75]
    v_mfma_f32_16x16x32_bf16 v[76:79], a[108:111], v[16:19], v[76:79]
    v_mfma_f32_16x16x32_bf16 v[80:83], a[96:99], v[20:23], v[80:83]
    v_mfma_f32_16x16x32_bf16 v[84:87], a[100:103], v[20:23], v[84:87]
    v_mfma_f32_16x16x32_bf16 v[88:91], a[104:107], v[20:23], v[88:91]
    v_mfma_f32_16x16x32_bf16 v[92:95], a[108:111], v[20:23], v[92:95]
    v_mfma_f32_16x16x32_bf16 v[96:99], a[96:99], v[24:27], v[96:99]
    v_mfma_f32_16x16x32_bf16 v[100:103], a[100:103], v[24:27], v[100:103]
    v_mfma_f32_16x16x32_bf16 v[104:107], a[104:107], v[24:27], v[104:107]
    v_mfma_f32_16x16x32_bf16 v[108:111], a[108:111], v[24:27], v[108:111]
    v_mfma_f32_16x16x32_bf16 v[112:115], a[96:99], v[28:31], v[112:115]
    v_mfma_f32_16x16x32_bf16 v[116:119], a[100:103], v[28:31], v[116:119]
    v_mfma_f32_16x16x32_bf16 v[120:123], a[104:107], v[28:31], v[120:123]
    v_mfma_f32_16x16x32_bf16 v[124:127], a[108:111], v[28:31], v[124:127]
    s_branch pj_hj_166
pj_hv_165:
    v_mfma_f32_16x16x32_bf16 v[64:67], v[16:19], a[96:99], v[64:67]
    v_mfma_f32_16x16x32_bf16 v[68:71], v[16:19], a[100:103], v[68:71]
    v_mfma_f32_16x16x32_bf16 v[72:75], v[16:19], a[104:107], v[72:75]
    v_mfma_f32_16x16x32_bf16 v[76:79], v[16:19], a[108:111], v[76:79]
    v_mfma_f32_16x16x32_bf16 v[80:83], v[20:23], a[96:99], v[80:83]
    v_mfma_f32_16x16x32_bf16 v[84:87], v[20:23], a[100:103], v[84:87]
    v_mfma_f32_16x16x32_bf16 v[88:91], v[20:23], a[104:107], v[88:91]
    v_mfma_f32_16x16x32_bf16 v[92:95], v[20:23], a[108:111], v[92:95]
    v_mfma_f32_16x16x32_bf16 v[96:99], v[24:27], a[96:99], v[96:99]
    v_mfma_f32_16x16x32_bf16 v[100:103], v[24:27], a[100:103], v[100:103]
    v_mfma_f32_16x16x32_bf16 v[104:107], v[24:27], a[104:107], v[104:107]
    v_mfma_f32_16x16x32_bf16 v[108:111], v[24:27], a[108:111], v[108:111]
    v_mfma_f32_16x16x32_bf16 v[112:115], v[28:31], a[96:99], v[112:115]
    v_mfma_f32_16x16x32_bf16 v[116:119], v[28:31], a[100:103], v[116:119]
    s_nop 0
    v_mfma_f32_16x16x32_bf16 v[120:123], v[28:31], a[104:107], v[120:123]
    s_nop 0
    v_mfma_f32_16x16x32_bf16 v[124:127], v[28:31], a[108:111], v[124:127]
    s_nop 0
pj_hj_166:
    s_waitcnt vmcnt(4)
    ds_read_b128 v[32:35], v2 offset:112
    ds_read_b128 v[36:39], v10 offset:112
    ds_read_b128 v[40:43], v2 offset:33520
    ds_read_b128 v[44:47], v10 offset:33520
    ds_read_b64_tr_b16 a[112:113], v6 offset:12288
    ds_read_b64_tr_b16 a[114:115], v6 offset:12800
    ds_read_b64_tr_b16 a[116:117], v6 offset:12304
    ds_read_b64_tr_b16 a[118:119], v6 offset:12816
    ds_read_b64_tr_b16 a[120:121], v6 offset:12352
    ds_read_b64_tr_b16 a[122:123], v6 offset:12864
    ds_read_b64_tr_b16 a[124:125], v6 offset:12368
    ds_read_b64_tr_b16 a[126:127], v6 offset:12880
    s_waitcnt lgkmcnt(0)
    s_add_u32 m0, s38, 4096
    s_add_u32 s39, s20, 589824
    buffer_load_dwordx4 v5, s[8:11], s39 offen nt lds
    s_add_u32 m0, s38, 5120
    s_add_u32 s39, s20, 1638400
    buffer_load_dwordx4 v5, s[8:11], s39 offen nt lds
    s_add_u32 m0, s38, 6144
    s_add_u32 s39, s20, 2686976
    buffer_load_dwordx4 v5, s[8:11], s39 offen nt lds
    s_add_u32 m0, s38, 7168
    s_add_u32 s39, s20, 3735552
    buffer_load_dwordx4 v5, s[8:11], s39 offen nt lds
    s_cmp_lg_u32 s25, 0
    s_cbranch_scc1 pj_hv_167
    v_mfma_f32_16x16x32_bf16 v[64:67], a[112:115], v[32:35], v[64:67]
    v_mfma_f32_16x16x32_bf16 v[68:71], a[116:119], v[32:35], v[68:71]
    v_mfma_f32_16x16x32_bf16 v[72:75], a[120:123], v[32:35], v[72:75]
    v_mfma_f32_16x16x32_bf16 v[76:79], a[124:127], v[32:35], v[76:79]
    v_mfma_f32_16x16x32_bf16 v[80:83], a[112:115], v[36:39], v[80:83]
    v_mfma_f32_16x16x32_bf16 v[84:87], a[116:119], v[36:39], v[84:87]
    v_mfma_f32_16x16x32_bf16 v[88:91], a[120:123], v[36:39], v[88:91]
    v_mfma_f32_16x16x32_bf16 v[92:95], a[124:127], v[36:39], v[92:95]
    v_mfma_f32_16x16x32_bf16 v[96:99], a[112:115], v[40:43], v[96:99]
    v_mfma_f32_16x16x32_bf16 v[100:103], a[116:119], v[40:43], v[100:103]
    v_mfma_f32_16x16x32_bf16 v[104:107], a[120:123], v[40:43], v[104:107]
    v_mfma_f32_16x16x32_bf16 v[108:111], a[124:127], v[40:43], v[108:111]
    v_mfma_f32_16x16x32_bf16 v[112:115], a[112:115], v[44:47], v[112:115]
    v_mfma_f32_16x16x32_bf16 v[116:119], a[116:119], v[44:47], v[116:119]
    v_mfma_f32_16x16x32_bf16 v[120:123], a[120:123], v[44:47], v[120:123]
    v_mfma_f32_16x16x32_bf16 v[124:127], a[124:127], v[44:47], v[124:127]
    s_branch pj_hj_168
pj_hv_167:
    v_mfma_f32_16x16x32_bf16 v[64:67], v[32:35], a[112:115], v[64:67]
    v_mfma_f32_16x16x32_bf16 v[68:71], v[32:35], a[116:119], v[68:71]
    v_mfma_f32_16x16x32_bf16 v[72:75], v[32:35], a[120:123], v[72:75]
    v_mfma_f32_16x16x32_bf16 v[76:79], v[32:35], a[124:127], v[76:79]
    v_mfma_f32_16x16x32_bf16 v[80:83], v[36:39], a[112:115], v[80:83]
    v_mfma_f32_16x16x32_bf16 v[84:87], v[36:39], a[116:119], v[84:87]
    v_mfma_f32_16x16x32_bf16 v[88:91], v[36:39], a[120:123], v[88:91]
    v_mfma_f32_16x16x32_bf16 v[92:95], v[36:39], a[124:127], v[92:95]
    v_mfma_f32_16x16x32_bf16 v[96:99], v[40:43], a[112:115], v[96:99]
    v_mfma_f32_16x16x32_bf16 v[100:103], v[40:43], a[116:119], v[100:103]
    v_mfma_f32_16x16x32_bf16 v[104:107], v[40:43], a[120:123], v[104:107]
    v_mfma_f32_16x16x32_bf16 v[108:111], v[40:43], a[124:127], v[108:111]
    v_mfma_f32_16x16x32_bf16 v[112:115], v[44:47], a[112:115], v[112:115]
    v_mfma_f32_16x16x32_bf16 v[116:119], v[44:47], a[116:119], v[116:119]
    v_mfma_f32_16x16x32_bf16 v[120:123], v[44:47], a[120:123], v[120:123]
    v_mfma_f32_16x16x32_bf16 v[124:127], v[44:47], a[124:127], v[124:127]
    s_nop 0
pj_hj_168:
    s_waitcnt vmcnt(4)
    buffer_load_dword v11, off, s[48:51], 0 offset:196 sc1
    ds_read_b128 v[16:19], v2 offset:128
    ds_read_b128 v[20:23], v10 offset:128
    ds_read_b128 v[24:27], v2 offset:33536
    ds_read_b128 v[28:31], v10 offset:33536
    ds_read_b64_tr_b16 a[128:129], v6 offset:0
    ds_read_b64_tr_b16 a[130:131], v6 offset:512
    ds_read_b64_tr_b16 a[132:133], v6 offset:16
    ds_read_b64_tr_b16 a[134:135], v6 offset:528
    ds_read_b64_tr_b16 a[136:137], v6 offset:64
    ds_read_b64_tr_b16 a[138:139], v6 offset:576
    ds_read_b64_tr_b16 a[140:141], v6 offset:80
    ds_read_b64_tr_b16 a[142:143], v6 offset:592
    s_waitcnt lgkmcnt(0)
    s_add_u32 m0, s38, 8192
    s_add_u32 s39, s20, 655360
    buffer_load_dwordx4 v5, s[8:11], s39 offen nt lds
    s_add_u32 m0, s38, 9216
    s_add_u32 s39, s20, 1703936
    buffer_load_dwordx4 v5, s[8:11], s39 offen nt lds
    s_add_u32 m0, s38, 10240
    s_add_u32 s39, s20, 2752512
    buffer_load_dwordx4 v5, s[8:11], s39 offen nt lds
    s_add_u32 m0, s38, 11264
    s_add_u32 s39, s20, 3801088
    buffer_load_dwordx4 v5, s[8:11], s39 offen nt lds
    s_cmp_lg_u32 s25, 0
    s_cbranch_scc1 pj_hv_169
    v_mfma_f32_16x16x32_bf16 v[64:67], a[128:131], v[16:19], v[64:67]
    v_mfma_f32_16x16x32_bf16 v[68:71], a[132:135], v[16:19], v[68:71]
    v_mfma_f32_16x16x32_bf16 v[72:75], a[136:139], v[16:19], v[72:75]
    v_mfma_f32_16x16x32_bf16 v[76:79], a[140:143], v[16:19], v[76:79]
    v_mfma_f32_16x16x32_bf16 v[80:83], a[128:131], v[20:23], v[80:83]
    v_mfma_f32_16x16x32_bf16 v[84:87], a[132:135], v[20:23], v[84:87]
    v_mfma_f32_16x16x32_bf16 v[88:91], a[136:139], v[20:23], v[88:91]
    v_mfma_f32_16x16x32_bf16 v[92:95], a[140:143], v[20:23], v[92:95]
    v_mfma_f32_16x16x32_bf16 v[96:99], a[128:131], v[24:27], v[96:99]
    v_mfma_f32_16x16x32_bf16 v[100:103], a[132:135], v[24:27], v[100:103]
    v_mfma_f32_16x16x32_bf16 v[104:107], a[136:139], v[24:27], v[104:107]
    v_mfma_f32_16x16x32_bf16 v[108:111], a[140:143], v[24:27], v[108:111]
    v_mfma_f32_16x16x32_bf16 v[112:115], a[128:131], v[28:31], v[112:115]
    v_mfma_f32_16x16x32_bf16 v[116:119], a[132:135], v[28:31], v[116:119]
    v_mfma_f32_16x16x32_bf16 v[120:123], a[136:139], v[28:31], v[120:123]
    v_mfma_f32_16x16x32_bf16 v[124:127], a[140:143], v[28:31], v[124:127]
    s_branch pj_hj_170
pj_hv_169:
    v_mfma_f32_16x16x32_bf16 v[64:67], v[16:19], a[128:131], v[64:67]
    v_mfma_f32_16x16x32_bf16 v[68:71], v[16:19], a[132:135], v[68:71]
    v_mfma_f32_16x16x32_bf16 v[72:75], v[16:19], a[136:139], v[72:75]
    v_mfma_f32_16x16x32_bf16 v[76:79], v[16:19], a[140:143], v[76:79]
    v_mfma_f32_16x16x32_bf16 v[80:83], v[20:23], a[128:131], v[80:83]
    v_mfma_f32_16x16x32_bf16 v[84:87], v[20:23], a[132:135], v[84:87]
    v_mfma_f32_16x16x32_bf16 v[88:91], v[20:23], a[136:139], v[88:91]
    v_mfma_f32_16x16x32_bf16 v[92:95], v[20:23], a[140:143], v[92:95]
    v_mfma_f32_16x16x32_bf16 v[96:99], v[24:27], a[128:131], v[96:99]
    v_mfma_f32_16x16x32_bf16 v[100:103], v[24:27], a[132:135], v[100:103]
    v_mfma_f32_16x16x32_bf16 v[104:107], v[24:27], a[136:139], v[104:107]
    v_mfma_f32_16x16x32_bf16 v[108:111], v[24:27], a[140:143], v[108:111]
    v_mfma_f32_16x16x32_bf16 v[112:115], v[28:31], a[128:131], v[112:115]
    v_mfma_f32_16x16x32_bf16 v[116:119], v[28:31], a[132:135], v[116:119]
    s_nop 0
    v_mfma_f32_16x16x32_bf16 v[120:123], v[28:31], a[136:139], v[120:123]
    s_nop 0
    v_mfma_f32_16x16x32_bf16 v[124:127], v[28:31], a[140:143], v[124:127]
    s_nop 0
pj_hj_170:
    s_waitcnt vmcnt(5)
    ds_read_b128 v[32:35], v2 offset:144
    ds_read_b128 v[36:39], v10 offset:144
    ds_read_b128 v[40:43], v2 offset:33552
    ds_read_b128 v[44:47], v10 offset:33552
    ds_read_b64_tr_b16 a[144:145], v6 offset:4096
    ds_read_b64_tr_b16 a[146:147], v6 offset:4608
    ds_read_b64_tr_b16 a[148:149], v6 offset:4112
    ds_read_b64_tr_b16 a[150:151], v6 offset:4624
    ds_read_b64_tr_b16 a[152:153], v6 offset:4160
    ds_read_b64_tr_b16 a[154:155], v6 offset:4672
    ds_read_b64_tr_b16 a[156:157], v6 offset:4176
    ds_read_b64_tr_b16 a[158:159], v6 offset:4688
    s_waitcnt lgkmcnt(0)
    s_add_u32 m0, s38, 12288
    s_add_u32 s39, s20, 720896
    buffer_load_dwordx4 v5, s[8:11], s39 offen nt lds
    s_add_u32 m0, s38, 13312
    s_add_u32 s39, s20, 1769472
    buffer_load_dwordx4 v5, s[8:11], s39 offen nt lds
    s_add_u32 m0, s38, 14336
    s_add_u32 s39, s20, 2818048
    buffer_load_dwordx4 v5, s[8:11], s39 offen nt lds
    s_add_u32 m0, s38, 15360
    s_add_u32 s39, s20, 3866624
    buffer_load_dwordx4 v5, s[8:11], s39 offen nt lds
    s_cmp_lg_u32 s25, 0
    s_cbranch_scc1 pj_hv_171
    v_mfma_f32_16x16x32_bf16 v[64:67], a[144:147], v[32:35], v[64:67]
    v_mfma_f32_16x16x32_bf16 v[68:71], a[148:151], v[32:35], v[68:71]
    v_mfma_f32_16x16x32_bf16 v[72:75], a[152:155], v[32:35], v[72:75]
    v_mfma_f32_16x16x32_bf16 v[76:79], a[156:159], v[32:35], v[76:79]
    v_mfma_f32_16x16x32_bf16 v[80:83], a[144:147], v[36:39], v[80:83]
    v_mfma_f32_16x16x32_bf16 v[84:87], a[148:151], v[36:39], v[84:87]
    v_mfma_f32_16x16x32_bf16 v[88:91], a[152:155], v[36:39], v[88:91]
    v_mfma_f32_16x16x32_bf16 v[92:95], a[156:159], v[36:39], v[92:95]
    v_mfma_f32_16x16x32_bf16 v[96:99], a[144:147], v[40:43], v[96:99]
    v_mfma_f32_16x16x32_bf16 v[100:103], a[148:151], v[40:43], v[100:103]
    v_mfma_f32_16x16x32_bf16 v[104:107], a[152:155], v[40:43], v[104:107]
    v_mfma_f32_16x16x32_bf16 v[108:111], a[156:159], v[40:43], v[108:111]
    v_mfma_f32_16x16x32_bf16 v[112:115], a[144:147], v[44:47], v[112:115]
    v_mfma_f32_16x16x32_bf16 v[116:119], a[148:151], v[44:47], v[116:119]
    v_mfma_f32_16x16x32_bf16 v[120:123], a[152:155], v[44:47], v[120:123]
    v_mfma_f32_16x16x32_bf16 v[124:127], a[156:159], v[44:47], v[124:127]
    s_branch pj_hj_172
pj_hv_171:
    v_mfma_f32_16x16x32_bf16 v[64:67], v[32:35], a[144:147], v[64:67]
    v_mfma_f32_16x16x32_bf16 v[68:71], v[32:35], a[148:151], v[68:71]
    v_mfma_f32_16x16x32_bf16 v[72:75], v[32:35], a[152:155], v[72:75]
    v_mfma_f32_16x16x32_bf16 v[76:79], v[32:35], a[156:159], v[76:79]
    v_mfma_f32_16x16x32_bf16 v[80:83], v[36:39], a[144:147], v[80:83]
    v_mfma_f32_16x16x32_bf16 v[84:87], v[36:39], a[148:151], v[84:87]
    v_mfma_f32_16x16x32_bf16 v[88:91], v[36:39], a[152:155], v[88:91]
    v_mfma_f32_16x16x32_bf16 v[92:95], v[36:39], a[156:159], v[92:95]
    v_mfma_f32_16x16x32_bf16 v[96:99], v[40:43], a[144:147], v[96:99]
    v_mfma_f32_16x16x32_bf16 v[100:103], v[40:43], a[148:151], v[100:103]
    v_mfma_f32_16x16x32_bf16 v[104:107], v[40:43], a[152:155], v[104:107]
    v_mfma_f32_16x16x32_bf16 v[108:111], v[40:43], a[156:159], v[108:111]
    v_mfma_f32_16x16x32_bf16 v[112:115], v[44:47], a[144:147], v[112:115]
    s_nop 0
    v_mfma_f32_16x16x32_bf16 v[116:119], v[44:47], a[148:151], v[116:119]
    s_nop 0
    v_mfma_f32_16x16x32_bf16 v[120:123], v[44:47], a[152:155], v[120:123]
    s_nop 0
    v_mfma_f32_16x16x32_bf16 v[124:127], v[44:47], a[156:159], v[124:127]
    s_nop 0
pj_hj_172:
    s_waitcnt vmcnt(4)
    ds_read_b128 v[16:19], v2 offset:160
    ds_read_b128 v[20:23], v10 offset:160
    ds_read_b128 v[24:27], v2 offset:33568
    ds_read_b128 v[28:31], v10 offset:33568
    ds_read_b64_tr_b16 a[160:161], v6 offset:8192
    ds_read_b64_tr_b16 a[162:163], v6 offset:8704
    ds_read_b64_tr_b16 a[164:165], v6 offset:8208
    ds_read_b64_tr_b16 a[166:167], v6 offset:8720
    ds_read_b64_tr_b16 a[168:169], v6 offset:8256
    ds_read_b64_tr_b16 a[170:171], v6 offset:8768
    ds_read_b64_tr_b16 a[172:173], v6 offset:8272
    ds_read_b64_tr_b16 a[174:175], v6 offset:8784
    s_waitcnt lgkmcnt(0)
    s_add_u32 m0, s38, 0
    s_add_u32 s39, s20, 786432
    buffer_load_dwordx4 v5, s[8:11], s39 offen nt lds
    s_add_u32 m0, s38, 1024
    s_add_u32 s39, s20, 1835008
    buffer_load_dwordx4 v5, s[8:11], s39 offen nt lds
    s_add_u32 m0, s38, 2048
    s_add_u32 s39, s20, 2883584
    buffer_load_dwordx4 v5, s[8:11], s39 offen nt lds
    s_add_u32 m0, s38, 3072
    s_add_u32 s39, s20, 3932160
    buffer_load_dwordx4 v5, s[8:11], s39 offen nt lds
    s_cmp_lg_u32 s25, 0
    s_cbranch_scc1 pj_hv_173
    v_mfma_f32_16x16x32_bf16 v[64:67], a[160:163], v[16:19], v[64:67]
    v_mfma_f32_16x16x32_bf16 v[68:71], a[164:167], v[16:19], v[68:71]
    v_mfma_f32_16x16x32_bf16 v[72:75], a[168:171], v[16:19], v[72:75]
    v_mfma_f32_16x16x32_bf16 v[76:79], a[172:175], v[16:19], v[76:79]
    v_mfma_f32_16x16x32_bf16 v[80:83], a[160:163], v[20:23], v[80:83]
    v_mfma_f32_16x16x32_bf16 v[84:87], a[164:167], v[20:23], v[84:87]
    v_mfma_f32_16x16x32_bf16 v[88:91], a[168:171], v[20:23], v[88:91]
    v_mfma_f32_16x16x32_bf16 v[92:95], a[172:175], v[20:23], v[92:95]
    v_mfma_f32_16x16x32_bf16 v[96:99], a[160:163], v[24:27], v[96:99]
    v_mfma_f32_16x16x32_bf16 v[100:103], a[164:167], v[24:27], v[100:103]
    v_mfma_f32_16x16x32_bf16 v[104:107], a[168:171], v[24:27], v[104:107]
    v_mfma_f32_16x16x32_bf16 v[108:111], a[172:175], v[24:27], v[108:111]
    v_mfma_f32_16x16x32_bf16 v[112:115], a[160:163], v[28:31], v[112:115]
    v_mfma_f32_16x16x32_bf16 v[116:119], a[164:167], v[28:31], v[116:119]
    v_mfma_f32_16x16x32_bf16 v[120:123], a[168:171], v[28:31], v[120:123]
    v_mfma_f32_16x16x32_bf16 v[124:127], a[172:175], v[28:31], v[124:127]
    s_branch pj_hj_174
pj_hv_173:
    v_mfma_f32_16x16x32_bf16 v[64:67], v[16:19], a[160:163], v[64:67]
    v_mfma_f32_16x16x32_bf16 v[68:71], v[16:19], a[164:167], v[68:71]
    v_mfma_f32_16x16x32_bf16 v[72:75], v[16:19], a[168:171], v[72:75]
    v_mfma_f32_16x16x32_bf16 v[76:79], v[16:19], a[172:175], v[76:79]
    v_mfma_f32_16x16x32_bf16 v[80:83], v[20:23], a[160:163], v[80:83]
    v_mfma_f32_16x16x32_bf16 v[84:87], v[20:23], a[164:167], v[84:87]
    v_mfma_f32_16x16x32_bf16 v[88:91], v[20:23], a[168:171], v[88:91]
    v_mfma_f32_16x16x32_bf16 v[92:95], v[20:23], a[172:175], v[92:95]
    v_mfma_f32_16x16x32_bf16 v[96:99], v[24:27], a[160:163], v[96:99]
    v_mfma_f32_16x16x32_bf16 v[100:103], v[24:27], a[164:167], v[100:103]
    v_mfma_f32_16x16x32_bf16 v[104:107], v[24:27], a[168:171], v[104:107]
    v_mfma_f32_16x16x32_bf16 v[108:111], v[24:27], a[172:175], v[108:111]
    v_mfma_f32_16x16x32_bf16 v[112:115], v[28:31], a[160:163], v[112:115]
    v_mfma_f32_16x16x32_bf16 v[116:119], v[28:31], a[164:167], v[116:119]
    s_nop 0
    v_mfma_f32_16x16x32_bf16 v[120:123], v[28:31], a[168:171], v[120:123]
    s_nop 0
    v_mfma_f32_16x16x32_bf16 v[124:127], v[28:31], a[172:175], v[124:127]
    s_nop 0
pj_hj_174:
    s_waitcnt vmcnt(4)
    ds_read_b128 v[32:35], v2 offset:176
    ds_read_b128 v[36:39], v10 offset:176
    ds_read_b128 v[40:43], v2 offset:33584
    ds_read_b128 v[44:47], v10 offset:33584
    ds_read_b64_tr_b16 a[176:177], v6 offset:12288
    ds_read_b64_tr_b16 a[178:179], v6 offset:12800
    ds_read_b64_tr_b16 a[180:181], v6 offset:12304
    ds_read_b64_tr_b16 a[182:183], v6 offset:12816
    ds_read_b64_tr_b16 a[184:185], v6 offset:12352
    ds_read_b64_tr_b16 a[186:187], v6 offset:12864
    ds_read_b64_tr_b16 a[188:189], v6 offset:12368
    ds_read_b64_tr_b16 a[190:191], v6 offset:12880
    s_waitcnt lgkmcnt(0)
    s_add_u32 m0, s38, 4096
    s_add_u32 s39, s20, 851968
    buffer_load_dwordx4 v5, s[8:11], s39 offen nt lds
    s_add_u32 m0, s38, 5120
    s_add_u32 s39, s20, 1900544
    buffer_load_dwordx4 v5, s[8:11], s39 offen nt lds
    s_add_u32 m0, s38, 6144
    s_add_u32 s39, s20, 2949120
    buffer_load_dwordx4 v5, s[8:11], s39 offen nt lds
    s_add_u32 m0, s38, 7168
    s_add_u32 s39, s20, 3997696
    buffer_load_dwordx4 v5, s[8:11], s39 offen nt lds
    s_cmp_lg_u32 s25, 0
    s_cbranch_scc1 pj_hv_175
    v_mfma_f32_16x16x32_bf16 v[64:67], a[176:179], v[32:35], v[64:67]
    v_mfma_f32_16x16x32_bf16 v[68:71], a[180:183], v[32:35], v[68:71]
    v_mfma_f32_16x16x32_bf16 v[72:75], a[184:187], v[32:35], v[72:75]
    v_mfma_f32_16x16x32_bf16 v[76:79], a[188:191], v[32:35], v[76:79]
    v_mfma_f32_16x16x32_bf16 v[80:83], a[176:179], v[36:39], v[80:83]
    v_mfma_f32_16x16x32_bf16 v[84:87], a[180:183], v[36:39], v[84:87]
    v_mfma_f32_16x16x32_bf16 v[88:91], a[184:187], v[36:39], v[88:91]
    v_mfma_f32_16x16x32_bf16 v[92:95], a[188:191], v[36:39], v[92:95]
    v_mfma_f32_16x16x32_bf16 v[96:99], a[176:179], v[40:43], v[96:99]
    v_mfma_f32_16x16x32_bf16 v[100:103], a[180:183], v[40:43], v[100:103]
    v_mfma_f32_16x16x32_bf16 v[104:107], a[184:187], v[40:43], v[104:107]
    v_mfma_f32_16x16x32_bf16 v[108:111], a[188:191], v[40:43], v[108:111]
    v_mfma_f32_16x16x32_bf16 v[112:115], a[176:179], v[44:47], v[112:115]
    v_mfma_f32_16x16x32_bf16 v[116:119], a[180:183], v[44:47], v[116:119]
    v_mfma_f32_16x16x32_bf16 v[120:123], a[184:187], v[44:47], v[120:123]
    v_mfma_f32_16x16x32_bf16 v[124:127], a[188:191], v[44:47], v[124:127]
    s_branch pj_hj_176
pj_hv_175:
    v_mfma_f32_16x16x32_bf16 v[64:67], v[32:35], a[176:179], v[64:67]
    v_mfma_f32_16x16x32_bf16 v[68:71], v[32:35], a[180:183], v[68:71]
    v_mfma_f32_16x16x32_bf16 v[72:75], v[32:35], a[184:187], v[72:75]
    v_mfma_f32_16x16x32_bf16 v[76:79], v[32:35], a[188:191], v[76:79]
    v_mfma_f32_16x16x32_bf16 v[80:83], v[36:39], a[176:179], v[80:83]
    v_mfma_f32_16x16x32_bf16 v[84:87], v[36:39], a[180:183], v[84:87]
    v_mfma_f32_16x16x32_bf16 v[88:91], v[36:39], a[184:187], v[88:91]
    v_mfma_f32_16x16x32_bf16 v[92:95], v[36:39], a[188:191], v[92:95]
    v_mfma_f32_16x16x32_bf16 v[96:99], v[40:43], a[176:179], v[96:99]
    v_mfma_f32_16x16x32_bf16 v[100:103], v[40:43], a[180:183], v[100:103]
    v_mfma_f32_16x16x32_bf16 v[104:107], v[40:43], a[184:187], v[104:107]
    v_mfma_f32_16x16x32_bf16 v[108:111], v[40:43], a[188:191], v[108:111]
    v_mfma_f32_16x16x32_bf16 v[112:115], v[44:47], a[176:179], v[112:115]
    v_mfma_f32_16x16x32_bf16 v[116:119], v[44:47], a[180:183], v[116:119]
    s_nop 0
    v_mfma_f32_16x16x32_bf16 v[120:123], v[44:47], a[184:187], v[120:123]
    s_nop 0
    v_mfma_f32_16x16x32_bf16 v[124:127], v[44:47], a[188:191], v[124:127]
    s_nop 0
pj_hj_176:
    s_waitcnt vmcnt(4)
    ds_read_b128 v[16:19], v2 offset:192
    ds_read_b128 v[20:23], v10 offset:192
    ds_read_b128 v[24:27], v2 offset:33600
    ds_read_b128 v[28:31], v10 offset:33600
    ds_read_b64_tr_b16 a[192:193], v6 offset:0
    ds_read_b64_tr_b16 a[194:195], v6 offset:512
    ds_read_b64_tr_b16 a[196:197], v6 offset:16
    ds_read_b64_tr_b16 a[198:199], v6 offset:528
    ds_read_b64_tr_b16 a[200:201], v6 offset:64
    ds_read_b64_tr_b16 a[202:203], v6 offset:576
    ds_read_b64_tr_b16 a[204:205], v6 offset:80
    ds_read_b64_tr_b16 a[206:207], v6 offset:592
    s_waitcnt lgkmcnt(0)
    s_add_u32 m0, s38, 8192
    s_add_u32 s39, s20, 917504
    buffer_load_dwordx4 v5, s[8:11], s39 offen nt lds
    s_add_u32 m0, s38, 9216
    s_add_u32 s39, s20, 1966080
    buffer_load_dwordx4 v5, s[8:11], s39 offen nt lds
    s_add_u32 m0, s38, 10240
    s_add_u32 s39, s20, 3014656
    buffer_load_dwordx4 v5, s[8:11], s39 offen nt lds
    s_add_u32 m0, s38, 11264
    s_add_u32 s39, s20, 4063232
    buffer_load_dwordx4 v5, s[8:11], s39 offen nt lds
    s_cmp_lg_u32 s25, 0
    s_cbranch_scc1 pj_hv_177
    v_mfma_f32_16x16x32_bf16 v[64:67], a[192:195], v[16:19], v[64:67]
    v_mfma_f32_16x16x32_bf16 v[68:71], a[196:199], v[16:19], v[68:71]
    v_mfma_f32_16x16x32_bf16 v[72:75], a[200:203], v[16:19], v[72:75]
    v_mfma_f32_16x16x32_bf16 v[76:79], a[204:207], v[16:19], v[76:79]
    v_mfma_f32_16x16x32_bf16 v[80:83], a[192:195], v[20:23], v[80:83]
    v_mfma_f32_16x16x32_bf16 v[84:87], a[196:199], v[20:23], v[84:87]
    v_mfma_f32_16x16x32_bf16 v[88:91], a[200:203], v[20:23], v[88:91]
    v_mfma_f32_16x16x32_bf16 v[92:95], a[204:207], v[20:23], v[92:95]
    v_mfma_f32_16x16x32_bf16 v[96:99], a[192:195], v[24:27], v[96:99]
    v_mfma_f32_16x16x32_bf16 v[100:103], a[196:199], v[24:27], v[100:103]
    v_mfma_f32_16x16x32_bf16 v[104:107], a[200:203], v[24:27], v[104:107]
    v_mfma_f32_16x16x32_bf16 v[108:111], a[204:207], v[24:27], v[108:111]
    v_mfma_f32_16x16x32_bf16 v[112:115], a[192:195], v[28:31], v[112:115]
    v_mfma_f32_16x16x32_bf16 v[116:119], a[196:199], v[28:31], v[116:119]
    v_mfma_f32_16x16x32_bf16 v[120:123], a[200:203], v[28:31], v[120:123]
    v_mfma_f32_16x16x32_bf16 v[124:127], a[204:207], v[28:31], v[124:127]
    s_branch pj_hj_178
pj_hv_177:
    v_mfma_f32_16x16x32_bf16 v[64:67], v[16:19], a[192:195], v[64:67]
    v_mfma_f32_16x16x32_bf16 v[68:71], v[16:19], a[196:199], v[68:71]
    v_mfma_f32_16x16x32_bf16 v[72:75], v[16:19], a[200:203], v[72:75]
    v_mfma_f32_16x16x32_bf16 v[76:79], v[16:19], a[204:207], v[76:79]
    v_mfma_f32_16x16x32_bf16 v[80:83], v[20:23], a[192:195], v[80:83]
    v_mfma_f32_16x16x32_bf16 v[84:87], v[20:23], a[196:199], v[84:87]
    v_mfma_f32_16x16x32_bf16 v[88:91], v[20:23], a[200:203], v[88:91]
    v_mfma_f32_16x16x32_bf16 v[92:95], v[20:23], a[204:207], v[92:95]
    v_mfma_f32_16x16x32_bf16 v[96:99], v[24:27], a[192:195], v[96:99]
    v_mfma_f32_16x16x32_bf16 v[100:103], v[24:27], a[196:199], v[100:103]
    v_mfma_f32_16x16x32_bf16 v[104:107], v[24:27], a[200:203], v[104:107]
    v_mfma_f32_16x16x32_bf16 v[108:111], v[24:27], a[204:207], v[108:111]
    v_mfma_f32_16x16x32_bf16 v[112:115], v[28:31], a[192:195], v[112:115]
    v_mfma_f32_16x16x32_bf16 v[116:119], v[28:31], a[196:199], v[116:119]
    v_mfma_f32_16x16x32_bf16 v[120:123], v[28:31], a[200:203], v[120:123]
    v_mfma_f32_16x16x32_bf16 v[124:127], v[28:31], a[204:207], v[124:127]
pj_hj_178:
    s_waitcnt vmcnt(4)
    ds_read_b128 v[32:35], v2 offset:208
    ds_read_b128 v[36:39], v10 offset:208
    ds_read_b128 v[40:43], v2 offset:33616
    ds_read_b128 v[44:47], v10 offset:33616
    ds_read_b64_tr_b16 a[208:209], v6 offset:4096
    ds_read_b64_tr_b16 a[210:211], v6 offset:4608
    ds_read_b64_tr_b16 a[212:213], v6 offset:4112
    ds_read_b64_tr_b16 a[214:215], v6 offset:4624
    ds_read_b64_tr_b16 a[216:217], v6 offset:4160
    ds_read_b64_tr_b16 a[218:219], v6 offset:4672
    ds_read_b64_tr_b16 a[220:221], v6 offset:4176
    ds_read_b64_tr_b16 a[222:223], v6 offset:4688
    s_waitcnt lgkmcnt(0)
    s_add_u32 m0, s38, 12288
    s_add_u32 s39, s20, 983040
    buffer_load_dwordx4 v5, s[8:11], s39 offen nt lds
    s_add_u32 m0, s38, 13312
    s_add_u32 s39, s20, 2031616
    buffer_load_dwordx4 v5, s[8:11], s39 offen nt lds
    s_add_u32 m0, s38, 14336
    s_add_u32 s39, s20, 3080192
    buffer_load_dwordx4 v5, s[8:11], s39 offen nt lds
    s_add_u32 m0, s38, 15360
    s_add_u32 s39, s20, 4128768
    buffer_load_dwordx4 v5, s[8:11], s39 offen nt lds
    s_and_b32 s41, s7, 15
    s_lshl_b32 s41, s41, 17
    s_lshl_b32 s42, s4, 15
    s_add_u32 s41, s41, s42
    v_lshlrev_b32 v7, 3, v1
    buffer_load_dword v8, v7, s[16:19], s41 offen
    s_add_u32 s41, s41, 8192
    buffer_load_dword v8, v7, s[16:19], s41 offen
    s_add_u32 s41, s41, 8192
    buffer_load_dword v8, v7, s[16:19], s41 offen
    s_add_u32 s41, s41, 8192
    buffer_load_dword v8, v7, s[16:19], s41 offen
    s_add_u32 s41, s41, 8192
    s_cmp_lg_u32 s25, 0
    s_cbranch_scc1 pj_hv_179
    v_mfma_f32_16x16x32_bf16 v[64:67], a[208:211], v[32:35], v[64:67]
    v_mfma_f32_16x16x32_bf16 v[68:71], a[212:215], v[32:35], v[68:71]
    v_mfma_f32_16x16x32_bf16 v[72:75], a[216:219], v[32:35], v[72:75]
    v_mfma_f32_16x16x32_bf16 v[76:79], a[220:223], v[32:35], v[76:79]
    v_mfma_f32_16x16x32_bf16 v[80:83], a[208:211], v[36:39], v[80:83]
    v_mfma_f32_16x16x32_bf16 v[84:87], a[212:215], v[36:39], v[84:87]
    v_mfma_f32_16x16x32_bf16 v[88:91], a[216:219], v[36:39], v[88:91]
    v_mfma_f32_16x16x32_bf16 v[92:95], a[220:223], v[36:39], v[92:95]
    v_mfma_f32_16x16x32_bf16 v[96:99], a[208:211], v[40:43], v[96:99]
    v_mfma_f32_16x16x32_bf16 v[100:103], a[212:215], v[40:43], v[100:103]
    v_mfma_f32_16x16x32_bf16 v[104:107], a[216:219], v[40:43], v[104:107]
    v_mfma_f32_16x16x32_bf16 v[108:111], a[220:223], v[40:43], v[108:111]
    v_mfma_f32_16x16x32_bf16 v[112:115], a[208:211], v[44:47], v[112:115]
    v_mfma_f32_16x16x32_bf16 v[116:119], a[212:215], v[44:47], v[116:119]
    v_mfma_f32_16x16x32_bf16 v[120:123], a[216:219], v[44:47], v[120:123]
    v_mfma_f32_16x16x32_bf16 v[124:127], a[220:223], v[44:47], v[124:127]
    s_branch pj_hj_180
pj_hv_179:
    v_mfma_f32_16x16x32_bf16 v[64:67], v[32:35], a[208:211], v[64:67]
    v_mfma_f32_16x16x32_bf16 v[68:71], v[32:35], a[212:215], v[68:71]
    v_mfma_f32_16x16x32_bf16 v[72:75], v[32:35], a[216:219], v[72:75]
    v_mfma_f32_16x16x32_bf16 v[76:79], v[32:35], a[220:223], v[76:79]
    v_mfma_f32_16x16x32_bf16 v[80:83], v[36:39], a[208:211], v[80:83]
    v_mfma_f32_16x16x32_bf16 v[84:87], v[36:39], a[212:215], v[84:87]
    v_mfma_f32_16x16x32_bf16 v[88:91], v[36:39], a[216:219], v[88:91]
    v_mfma_f32_16x16x32_bf16 v[92:95], v[36:39], a[220:223], v[92:95]
    v_mfma_f32_16x16x32_bf16 v[96:99], v[40:43], a[208:211], v[96:99]
    v_mfma_f32_16x16x32_bf16 v[100:103], v[40:43], a[212:215], v[100:103]
    v_mfma_f32_16x16x32_bf16 v[104:107], v[40:43], a[216:219], v[104:107]
    v_mfma_f32_16x16x32_bf16 v[108:111], v[40:43], a[220:223], v[108:111]
    v_mfma_f32_16x16x32_bf16 v[112:115], v[44:47], a[208:211], v[112:115]
    v_mfma_f32_16x16x32_bf16 v[116:119], v[44:47], a[212:215], v[116:119]
    v_mfma_f32_16x16x32_bf16 v[120:123], v[44:47], a[216:219], v[120:123]
    v_mfma_f32_16x16x32_bf16 v[124:127], v[44:47], a[220:223], v[124:127]
    s_nop 0
pj_hj_180:
    s_waitcnt vmcnt(8)
    ds_read_b128 v[16:19], v2 offset:224
    ds_read_b128 v[20:23], v10 offset:224
    ds_read_b128 v[24:27], v2 offset:33632
    ds_read_b128 v[28:31], v10 offset:33632
    ds_read_b64_tr_b16 a[224:225], v6 offset:8192
    ds_read_b64_tr_b16 a[226:227], v6 offset:8704
    ds_read_b64_tr_b16 a[228:229], v6 offset:8208
    ds_read_b64_tr_b16 a[230:231], v6 offset:8720
    ds_read_b64_tr_b16 a[232:233], v6 offset:8256
    ds_read_b64_tr_b16 a[234:235], v6 offset:8768
    ds_read_b64_tr_b16 a[236:237], v6 offset:8272
    ds_read_b64_tr_b16 a[238:239], v6 offset:8784
    s_waitcnt lgkmcnt(0)
    s_cmp_lg_u32 s25, 0
    s_cbranch_scc1 pj_hv_181
    v_mfma_f32_16x16x32_bf16 v[64:67], a[224:227], v[16:19], v[64:67]
    v_mfma_f32_16x16x32_bf16 v[68:71], a[228:231], v[16:19], v[68:71]
    v_mfma_f32_16x16x32_bf16 v[72:75], a[232:235], v[16:19], v[72:75]
    v_mfma_f32_16x16x32_bf16 v[76:79], a[236:239], v[16:19], v[76:79]
    v_mfma_f32_16x16x32_bf16 v[80:83], a[224:227], v[20:23], v[80:83]
    v_mfma_f32_16x16x32_bf16 v[84:87], a[228:231], v[20:23], v[84:87]
    v_mfma_f32_16x16x32_bf16 v[88:91], a[232:235], v[20:23], v[88:91]
    v_mfma_f32_16x16x32_bf16 v[92:95], a[236:239], v[20:23], v[92:95]
    v_mfma_f32_16x16x32_bf16 v[96:99], a[224:227], v[24:27], v[96:99]
    v_mfma_f32_16x16x32_bf16 v[100:103], a[228:231], v[24:27], v[100:103]
    v_mfma_f32_16x16x32_bf16 v[104:107], a[232:235], v[24:27], v[104:107]
    v_mfma_f32_16x16x32_bf16 v[108:111], a[236:239], v[24:27], v[108:111]
    v_mfma_f32_16x16x32_bf16 v[112:115], a[224:227], v[28:31], v[112:115]
    v_mfma_f32_16x16x32_bf16 v[116:119], a[228:231], v[28:31], v[116:119]
    v_mfma_f32_16x16x32_bf16 v[120:123], a[232:235], v[28:31], v[120:123]
    v_mfma_f32_16x16x32_bf16 v[124:127], a[236:239], v[28:31], v[124:127]
    s_branch pj_hj_182
pj_hv_181:
    v_mfma_f32_16x16x32_bf16 v[64:67], v[16:19], a[224:227], v[64:67]
    v_mfma_f32_16x16x32_bf16 v[68:71], v[16:19], a[228:231], v[68:71]
    v_mfma_f32_16x16x32_bf16 v[72:75], v[16:19], a[232:235], v[72:75]
    v_mfma_f32_16x16x32_bf16 v[76:79], v[16:19], a[236:239], v[76:79]
    v_mfma_f32_16x16x32_bf16 v[80:83], v[20:23], a[224:227], v[80:83]
    v_mfma_f32_16x16x32_bf16 v[84:87], v[20:23], a[228:231], v[84:87]
    v_mfma_f32_16x16x32_bf16 v[88:91], v[20:23], a[232:235], v[88:91]
    v_mfma_f32_16x16x32_bf16 v[92:95], v[20:23], a[236:239], v[92:95]
    v_mfma_f32_16x16x32_bf16 v[96:99], v[24:27], a[224:227], v[96:99]
    v_mfma_f32_16x16x32_bf16 v[100:103], v[24:27], a[228:231], v[100:103]
    v_mfma_f32_16x16x32_bf16 v[104:107], v[24:27], a[232:235], v[104:107]
    v_mfma_f32_16x16x32_bf16 v[108:111], v[24:27], a[236:239], v[108:111]
    v_mfma_f32_16x16x32_bf16 v[112:115], v[28:31], a[224:227], v[112:115]
    v_mfma_f32_16x16x32_bf16 v[116:119], v[28:31], a[228:231], v[116:119]
    s_nop 0
    v_mfma_f32_16x16x32_bf16 v[120:123], v[28:31], a[232:235], v[120:123]
    s_nop 0
    v_mfma_f32_16x16x32_bf16 v[124:127], v[28:31], a[236:239], v[124:127]
    s_nop 0
pj_hj_182:
    s_waitcnt vmcnt(4)
    ds_read_b128 v[32:35], v2 offset:240
    ds_read_b128 v[36:39], v10 offset:240
    ds_read_b128 v[40:43], v2 offset:33648
    ds_read_b128 v[44:47], v10 offset:33648
    ds_read_b64_tr_b16 a[240:241], v6 offset:12288
    ds_read_b64_tr_b16 a[242:243], v6 offset:12800
    ds_read_b64_tr_b16 a[244:245], v6 offset:12304
    ds_read_b64_tr_b16 a[246:247], v6 offset:12816
    ds_read_b64_tr_b16 a[248:249], v6 offset:12352
    ds_read_b64_tr_b16 a[250:251], v6 offset:12864
    ds_read_b64_tr_b16 a[252:253], v6 offset:12368
    ds_read_b64_tr_b16 a[254:255], v6 offset:12880
    s_waitcnt lgkmcnt(0)
    s_cmp_lg_u32 s25, 0
    s_cbranch_scc1 pj_hv_183
    v_mfma_f32_16x16x32_bf16 v[64:67], a[240:243], v[32:35], v[64:67]
    v_mfma_f32_16x16x32_bf16 v[68:71], a[244:247], v[32:35], v[68:71]
    v_mfma_f32_16x16x32_bf16 v[72:75], a[248:251], v[32:35], v[72:75]
    v_mfma_f32_16x16x32_bf16 v[76:79], a[252:255], v[32:35], v[76:79]
    v_mfma_f32_16x16x32_bf16 v[80:83], a[240:243], v[36:39], v[80:83]
    v_mfma_f32_16x16x32_bf16 v[84:87], a[244:247], v[36:39], v[84:87]
    v_mfma_f32_16x16x32_bf16 v[88:91], a[248:251], v[36:39], v[88:91]
    v_mfma_f32_16x16x32_bf16 v[92:95], a[252:255], v[36:39], v[92:95]
    v_mfma_f32_16x16x32_bf16 v[96:99], a[240:243], v[40:43], v[96:99]
    v_mfma_f32_16x16x32_bf16 v[100:103], a[244:247], v[40:43], v[100:103]
    v_mfma_f32_16x16x32_bf16 v[104:107], a[248:251], v[40:43], v[104:107]
    v_mfma_f32_16x16x32_bf16 v[108:111], a[252:255], v[40:43], v[108:111]
    v_mfma_f32_16x16x32_bf16 v[112:115], a[240:243], v[44:47], v[112:115]
    v_mfma_f32_16x16x32_bf16 v[116:119], a[244:247], v[44:47], v[116:119]
    v_mfma_f32_16x16x32_bf16 v[120:123], a[248:251], v[44:47], v[120:123]
    v_mfma_f32_16x16x32_bf16 v[124:127], a[252:255], v[44:47], v[124:127]
    s_branch pj_hj_184
pj_hv_183:
    v_mfma_f32_16x16x32_bf16 v[64:67], v[32:35], a[240:243], v[64:67]
    v_mfma_f32_16x16x32_bf16 v[68:71], v[32:35], a[244:247], v[68:71]
    v_mfma_f32_16x16x32_bf16 v[72:75], v[32:35], a[248:251], v[72:75]
    v_mfma_f32_16x16x32_bf16 v[76:79], v[32:35], a[252:255], v[76:79]
    v_mfma_f32_16x16x32_bf16 v[80:83], v[36:39], a[240:243], v[80:83]
    v_mfma_f32_16x16x32_bf16 v[84:87], v[36:39], a[244:247], v[84:87]
    v_mfma_f32_16x16x32_bf16 v[88:91], v[36:39], a[248:251], v[88:91]
    v_mfma_f32_16x16x32_bf16 v[92:95], v[36:39], a[252:255], v[92:95]
    v_mfma_f32_16x16x32_bf16 v[96:99], v[40:43], a[240:243], v[96:99]
    v_mfma_f32_16x16x32_bf16 v[100:103], v[40:43], a[244:247], v[100:103]
    v_mfma_f32_16x16x32_bf16 v[104:107], v[40:43], a[248:251], v[104:107]
    v_mfma_f32_16x16x32_bf16 v[108:111], v[40:43], a[252:255], v[108:111]
    v_mfma_f32_16x16x32_bf16 v[112:115], v[44:47], a[240:243], v[112:115]
    v_mfma_f32_16x16x32_bf16 v[116:119], v[44:47], a[244:247], v[116:119]
    v_mfma_f32_16x16x32_bf16 v[120:123], v[44:47], a[248:251], v[120:123]
    v_mfma_f32_16x16x32_bf16 v[124:127], v[44:47], a[252:255], v[124:127]
pj_hj_184:
    s_bfe_u32 s60, s5, 0x10006
    s_mul_i32 s61, s60, 56
    s_add_u32 s61, s61, 40
    s_load_dwordx2 s[42:43], s[0:1], s61
    s_and_b32 s59, s5, 63
    s_lshl_b32 s59, s59, 2
    s_add_u32 s59, s59, s4
    s_waitcnt lgkmcnt(0)
    s_mov_b32 s8, s42
    s_mov_b32 s9, s43
    s_mov_b32 s10, 0x400000
    s_mov_b32 s11, 0x00020000
    s_lshl_b32 s59, s59, 14
mn_pgo:
    s_lshl_b32 s36, s21, 13
    s_add_u32 s24, s24, s36
    s_mov_b32 s29, 0x80000000
    s_mov_b32 s33, 0
    s_mov_b32 s40, 66816
    s_barrier
    s_add_u32 m0, s30, 0
    s_nop 0
    buffer_load_dwordx4 v1, s[16:19], s28 offen offset:0 lds
    s_add_u32 m0, s30, 16
    s_nop 0
    buffer_load_dwordx4 v1, s[16:19], s28 offen offset:1024 lds
    s_add_u32 m0, s30, 32
    s_nop 0
    buffer_load_dwordx4 v1, s[16:19], s28 offen offset:2048 lds
    s_add_u32 m0, s30, 48
    s_nop 0
    buffer_load_dwordx4 v1, s[16:19], s28 offen offset:3072 lds
    s_add_u32 s37, s28, 4096
    s_add_u32 m0, s30, 4160
    s_nop 0
    buffer_load_dwordx4 v1, s[16:19], s37 offen offset:0 lds
    s_add_u32 m0, s30, 4176
    s_nop 0
    buffer_load_dwordx4 v1, s[16:19], s37 offen offset:1024 lds
    s_add_u32 m0, s30, 4192
    s_nop 0
    buffer_load_dwordx4 v1, s[16:19], s37 offen offset:2048 lds
    s_add_u32 m0, s30, 4208
    s_nop 0
    buffer_load_dwordx4 v1, s[16:19], s37 offen offset:3072 lds
    s_add_u32 s28, s28, s31
    s_add_u32 s30, s30, 33408
    s_cmp_ge_u32 s30, 133632
    s_cselect_b32 s37, 133632, 0
    s_sub_u32 s30, s30, s37
    s_add_u32 m0, s30, 0
    s_nop 0
    buffer_load_dwordx4 v1, s[16:19], s28 offen offset:0 lds
    s_add_u32 m0, s30, 16
    s_nop 0
    buffer_load_dwordx4 v1, s[16:19], s28 offen offset:1024 lds
    s_add_u32 m0, s30, 32
    s_nop 0
    buffer_load_dwordx4 v1, s[16:19], s28 offen offset:2048 lds
    s_add_u32 m0, s30, 48
    s_nop 0
    buffer_load_dwordx4 v1, s[16:19], s28 offen offset:3072 lds
    s_add_u32 s37, s28, 4096
    s_add_u32 m0, s30, 4160
    s_nop 0
    buffer_load_dwordx4 v1, s[16:19], s37 offen offset:0 lds
    s_add_u32 m0, s30, 4176
    s_nop 0
    buffer_load_dwordx4 v1, s[16:19], s37 offen offset:1024 lds
    s_add_u32 m0, s30, 4192
    s_nop 0
    buffer_load_dwordx4 v1, s[16:19], s37 offen offset:2048 lds
    s_add_u32 m0, s30, 4208
    s_nop 0
    buffer_load_dwordx4 v1, s[16:19], s37 offen offset:3072 lds
    s_add_u32 s28, s28, s31
    s_add_u32 s30, s30, 33408
    s_cmp_ge_u32 s30, 133632
    s_cselect_b32 s37, 133632, 0
    s_sub_u32 s30, s30, s37
    v_readfirstlane_b32 s44, v11
    s_nop 0
    s_cmp_ge_u32 s44, 1
    s_cbranch_scc1 pj_ini_185
    s_mov_b32 s45, 0
sp_186:
    buffer_load_dword v11, off, s[48:51], 0 offset:196 sc1
    s_waitcnt vmcnt(0)
    v_readfirstlane_b32 s44, v11
    s_nop 0
    s_cmp_ge_u32 s44, 1
    s_cbranch_scc1 spd_187
    s_add_u32 s45, s45, 1
    s_sleep 4
    s_cmp_lt_u32 s45, 32768
    s_cbranch_scc1 sp_186
spd_187:
pj_ini_185:
    s_cmp_lg_u32 s4, 0
    s_cselect_b32 s27, s29, s27
    s_mov_b32 s33, 2
    s_mov_b32 s40, -66816
    s_cmp_lg_u32 s25, 0
    s_cbranch_scc1 pj_v_188
    v_and_b32 v4, 15, v0
    v_mul_u32_u24 v2, 1040, v4
    v_bfe_u32 v4, v0, 4, 2
    v_lshlrev_b32 v3, 9, v4
    v_bfe_u32 v4, v0, 0, 4
    v_lshl_add_u32 v3, v4, 4, v3
    v_lshrrev_b32 v4, 4, v0
    v_lshl_add_u32 v2, v4, 8, v2
    v_add_u32 v2, 66816, v2
    s_mov_b32 s29, s24
    s_add_u32 s24, s24, s32
    v_mul_f32 v64, s26, v64
    v_mul_f32 v65, s26, v65
    v_mul_f32 v66, s26, v66
    v_mul_f32 v67, s26, v67
    v_cvt_pk_bf16_f32 v128, v64, v65
    v_cvt_pk_bf16_f32 v129, v66, v67
    v_mul_f32 v68, s26, v68
    v_mul_f32 v69, s26, v69
    v_mul_f32 v70, s26, v70
    v_mul_f32 v71, s26, v71
    v_cvt_pk_bf16_f32 v130, v68, v69
    v_cvt_pk_bf16_f32 v131, v70, v71
    buffer_store_dwordx4 v[128:131], v3, s[12:15], s29 offen offset:0 sc1
    v_mul_f32 v72, s26, v72
    v_mul_f32 v73, s26, v73
    v_mul_f32 v74, s26, v74
    v_mul_f32 v75, s26, v75
    v_cvt_pk_bf16_f32 v132, v72, v73
    v_cvt_pk_bf16_f32 v133, v74, v75
    v_mul_f32 v76, s26, v76
    v_mul_f32 v77, s26, v77
    v_mul_f32 v78, s26, v78
    v_mul_f32 v79, s26, v79
    v_cvt_pk_bf16_f32 v134, v76, v77
    v_cvt_pk_bf16_f32 v135, v78, v79
    buffer_store_dwordx4 v[132:135], v3, s[12:15], s29 offen offset:2048 sc1
    v_mul_f32 v80, s26, v80
    v_mul_f32 v81, s26, v81
    v_mul_f32 v82, s26, v82
    v_mul_f32 v83, s26, v83
    v_cvt_pk_bf16_f32 v136, v80, v81
    v_cvt_pk_bf16_f32 v137, v82, v83
    v_mul_f32 v84, s26, v84
    v_mul_f32 v85, s26, v85
    v_mul_f32 v86, s26, v86
    v_mul_f32 v87, s26, v87
    v_cvt_pk_bf16_f32 v138, v84, v85
    v_cvt_pk_bf16_f32 v139, v86, v87
    buffer_store_dwordx4 v[136:139], v3, s[12:15], s29 offen offset:256 sc1
    v_mul_f32 v88, s26, v88
    v_mul_f32 v89, s26, v89
    v_mul_f32 v90, s26, v90
    v_mul_f32 v91, s26, v91
    v_cvt_pk_bf16_f32 v140, v88, v89
    v_cvt_pk_bf16_f32 v141, v90, v91
    v_mul_f32 v92, s26, v92
    v_mul_f32 v93, s26, v93
    v_mul_f32 v94, s26, v94
    v_mul_f32 v95, s26, v95
    v_cvt_pk_bf16_f32 v142, v92, v93
    v_cvt_pk_bf16_f32 v143, v94, v95
    buffer_store_dwordx4 v[140:143], v3, s[12:15], s29 offen offset:2304 sc1
    s_mov_b32 s29, s24
    s_add_u32 s24, s24, s32
    v_mul_f32 v96, s26, v96
    v_mul_f32 v97, s26, v97
    v_mul_f32 v98, s26, v98
    v_mul_f32 v99, s26, v99
    v_cvt_pk_bf16_f32 v128, v96, v97
    v_cvt_pk_bf16_f32 v129, v98, v99
    v_mul_f32 v100, s26, v100
    v_mul_f32 v101, s26, v101
    v_mul_f32 v102, s26, v102
    v_mul_f32 v103, s26, v103
    v_cvt_pk_bf16_f32 v130, v100, v101
    v_cvt_pk_bf16_f32 v131, v102, v103
    buffer_store_dwordx4 v[128:131], v3, s[12:15], s29 offen offset:0 sc1
    v_mul_f32 v104, s26, v104
    v_mul_f32 v105, s26, v105
    v_mul_f32 v106, s26, v106
    v_mul_f32 v107, s26, v107
    v_cvt_pk_bf16_f32 v132, v104, v105
    v_cvt_pk_bf16_f32 v133, v106, v107
    v_mul_f32 v108, s26, v108
    v_mul_f32 v109, s26, v109
    v_mul_f32 v110, s26, v110
    v_mul_f32 v111, s26, v111
    v_cvt_pk_bf16_f32 v134, v108, v109
    v_cvt_pk_bf16_f32 v135, v110, v111
    buffer_store_dwordx4 v[132:135], v3, s[12:15], s29 offen offset:2048 sc1
    v_mul_f32 v112, s26, v112
    v_mul_f32 v113, s26, v113
    v_mul_f32 v114, s26, v114
    v_mul_f32 v115, s26, v115
    v_cvt_pk_bf16_f32 v136, v112, v113
    v_cvt_pk_bf16_f32 v137, v114, v115
    v_mul_f32 v116, s26, v116
    v_mul_f32 v117, s26, v117
    v_mul_f32 v118, s26, v118
    v_mul_f32 v119, s26, v119
    v_cvt_pk_bf16_f32 v138, v116, v117
    v_cvt_pk_bf16_f32 v139, v118, v119
    buffer_store_dwordx4 v[136:139], v3, s[12:15], s29 offen offset:256 sc1
    v_mul_f32 v120, s26, v120
    v_mul_f32 v121, s26, v121
    v_mul_f32 v122, s26, v122
    v_mul_f32 v123, s26, v123
    v_cvt_pk_bf16_f32 v140, v120, v121
    v_cvt_pk_bf16_f32 v141, v122, v123
    v_mul_f32 v124, s26, v124
    v_mul_f32 v125, s26, v125
    v_mul_f32 v126, s26, v126
    v_mul_f32 v127, s26, v127
    v_cvt_pk_bf16_f32 v142, v124, v125
    v_cvt_pk_bf16_f32 v143, v126, v127
    buffer_store_dwordx4 v[140:143], v3, s[12:15], s29 offen offset:2304 sc1
    s_add_u32 s41, s34, 2
    v_mov_b32 v4, s41
    s_mov_b32 s29, 0x80000000
    s_waitcnt vmcnt(0)
    s_barrier
    buffer_store_dword v4, off, s[12:15], s27 sc1
    v_lshlrev_b32 v14, 7, v0
    buffer_load_dword v15, v14, s[8:11], s59 offen
    s_add_u32 s59, s59, 8192
    buffer_load_dword v15, v14, s[8:11], s59 offen
    ds_read_b128 v[16:19], v2 offset:0
    ds_read_b128 v[20:23], v2 offset:16768
    ds_read_b128 v[24:27], v2 offset:16
    ds_read_b128 v[28:31], v2 offset:16784
    ds_read_b128 v[32:35], v2 offset:32
    ds_read_b128 v[36:39], v2 offset:16800
    s_waitcnt lgkmcnt(5)
.p2align 5
pj_loop_190:
    v_mfma_f32_16x16x32_bf16 v[64:67], a[0:3], v[16:19], 0
    ds_read_b128 v[40:43], v2 offset:48
    v_mfma_f32_16x16x32_bf16 v[68:71], a[4:7], v[16:19], 0
    s_add_u32 m0, s30, 0
    v_mfma_f32_16x16x32_bf16 v[72:75], a[8:11], v[16:19], 0
    buffer_load_dwordx4 v1, s[16:19], s28 offen offset:0 lds
    v_mfma_f32_16x16x32_bf16 v[76:79], a[12:15], v[16:19], 0
    s_waitcnt lgkmcnt(5)
    v_mfma_f32_16x16x32_bf16 v[80:83], a[0:3], v[20:23], 0
    ds_read_b128 v[44:47], v2 offset:16816
    v_mfma_f32_16x16x32_bf16 v[84:87], a[4:7], v[20:23], 0
    s_add_u32 m0, s30, 16
    v_mul_f32 v96, s26, v96
    v_mul_f32 v97, s26, v97
    v_mfma_f32_16x16x32_bf16 v[88:91], a[8:11], v[20:23], 0
    buffer_load_dwordx4 v1, s[16:19], s28 offen offset:1024 lds
    v_mfma_f32_16x16x32_bf16 v[92:95], a[12:15], v[20:23], 0
    s_waitcnt lgkmcnt(5)
    v_mul_f32 v98, s26, v98
    v_mul_f32 v99, s26, v99
    v_mfma_f32_16x16x32_bf16 v[64:67], a[16:19], v[24:27], v[64:67]
    ds_read_b128 v[16:19], v2 offset:64
    v_mfma_f32_16x16x32_bf16 v[68:71], a[20:23], v[24:27], v[68:71]
    s_add_u32 m0, s30, 32
    v_cvt_pk_bf16_f32 v128, v96, v97
    v_cvt_pk_bf16_f32 v129, v98, v99
    v_mfma_f32_16x16x32_bf16 v[72:75], a[24:27], v[24:27], v[72:75]
    buffer_load_dwordx4 v1, s[16:19], s28 offen offset:2048 lds
    v_mfma_f32_16x16x32_bf16 v[76:79], a[28:31], v[24:27], v[76:79]
    s_waitcnt lgkmcnt(5)
    v_mul_f32 v100, s26, v100
    v_mul_f32 v101, s26, v101
    v_mfma_f32_16x16x32_bf16 v[80:83], a[16:19], v[28:31], v[80:83]
    ds_read_b128 v[20:23], v2 offset:16832
    v_mfma_f32_16x16x32_bf16 v[84:87], a[20:23], v[28:31], v[84:87]
    s_add_u32 m0, s30, 48
    v_mul_f32 v102, s26, v102
    v_mul_f32 v103, s26, v103
    v_mfma_f32_16x16x32_bf16 v[88:91], a[24:27], v[28:31], v[88:91]
    buffer_load_dwordx4 v1, s[16:19], s28 offen offset:3072 lds
    v_mfma_f32_16x16x32_bf16 v[92:95], a[28:31], v[28:31], v[92:95]
    s_waitcnt lgkmcnt(5)
    v_cvt_pk_bf16_f32 v130, v100, v101
    v_cvt_pk_bf16_f32 v131, v102, v103
    v_mfma_f32_16x16x32_bf16 v[64:67], a[32:35], v[32:35], v[64:67]
    ds_read_b128 v[24:27], v2 offset:80
    v_mfma_f32_16x16x32_bf16 v[68:71], a[36:39], v[32:35], v[68:71]
    s_add_u32 s37, s28, 4096
    v_mul_f32 v104, s26, v104
    v_mul_f32 v105, s26, v105
    v_mfma_f32_16x16x32_bf16 v[72:75], a[40:43], v[32:35], v[72:75]
    v_mfma_f32_16x16x32_bf16 v[76:79], a[44:47], v[32:35], v[76:79]
    s_waitcnt lgkmcnt(5)
    v_mul_f32 v106, s26, v106
    v_mul_f32 v107, s26, v107
    v_mfma_f32_16x16x32_bf16 v[80:83], a[32:35], v[36:39], v[80:83]
    ds_read_b128 v[28:31], v2 offset:16848
    v_mfma_f32_16x16x32_bf16 v[84:87], a[36:39], v[36:39], v[84:87]
    s_add_u32 m0, s30, 4160
    v_cvt_pk_bf16_f32 v132, v104, v105
    v_cvt_pk_bf16_f32 v133, v106, v107
    v_mfma_f32_16x16x32_bf16 v[88:91], a[40:43], v[36:39], v[88:91]
    buffer_load_dwordx4 v1, s[16:19], s37 offen offset:0 lds
    v_mfma_f32_16x16x32_bf16 v[92:95], a[44:47], v[36:39], v[92:95]
    s_waitcnt lgkmcnt(5)
    v_mul_f32 v108, s26, v108
    v_mul_f32 v109, s26, v109
    v_mfma_f32_16x16x32_bf16 v[64:67], a[48:51], v[40:43], v[64:67]
    ds_read_b128 v[32:35], v2 offset:96
    v_mfma_f32_16x16x32_bf16 v[68:71], a[52:55], v[40:43], v[68:71]
    s_add_u32 m0, s30, 4176
    v_mul_f32 v110, s26, v110
    v_mul_f32 v111, s26, v111
    v_mfma_f32_16x16x32_bf16 v[72:75], a[56:59], v[40:43], v[72:75]
    buffer_load_dwordx4 v1, s[16:19], s37 offen offset:1024 lds
    v_mfma_f32_16x16x32_bf16 v[76:79], a[60:63], v[40:43], v[76:79]
    s_waitcnt lgkmcnt(5)
    v_cvt_pk_bf16_f32 v134, v108, v109
    v_cvt_pk_bf16_f32 v135, v110, v111
    v_mfma_f32_16x16x32_bf16 v[80:83], a[48:51], v[44:47], v[80:83]
    ds_read_b128 v[36:39], v2 offset:16864
    v_mfma_f32_16x16x32_bf16 v[84:87], a[52:55], v[44:47], v[84:87]
    s_add_u32 m0, s30, 4192
    v_mul_f32 v112, s26, v112
    v_mul_f32 v113, s26, v113
    v_mfma_f32_16x16x32_bf16 v[88:91], a[56:59], v[44:47], v[88:91]
    buffer_load_dwordx4 v1, s[16:19], s37 offen offset:2048 lds
    v_mfma_f32_16x16x32_bf16 v[92:95], a[60:63], v[44:47], v[92:95]
    s_waitcnt lgkmcnt(5)
    v_mul_f32 v114, s26, v114
    v_mul_f32 v115, s26, v115
    v_mfma_f32_16x16x32_bf16 v[64:67], a[64:67], v[16:19], v[64:67]
    ds_read_b128 v[40:43], v2 offset:112
    v_mfma_f32_16x16x32_bf16 v[68:71], a[68:71], v[16:19], v[68:71]
    s_add_u32 m0, s30, 4208
    v_cvt_pk_bf16_f32 v136, v112, v113
    v_cvt_pk_bf16_f32 v137, v114, v115
    v_mfma_f32_16x16x32_bf16 v[72:75], a[72:75], v[16:19], v[72:75]
    buffer_load_dwordx4 v1, s[16:19], s37 offen offset:3072 lds
    v_mfma_f32_16x16x32_bf16 v[76:79], a[76:79], v[16:19], v[76:79]
    s_waitcnt lgkmcnt(5)
    v_mul_f32 v116, s26, v116
    v_mul_f32 v117, s26, v117
    v_mfma_f32_16x16x32_bf16 v[80:83], a[64:67], v[20:23], v[80:83]
    ds_read_b128 v[44:47], v2 offset:16880
    v_mfma_f32_16x16x32_bf16 v[84:87], a[68:71], v[20:23], v[84:87]
    s_add_u32 s28, s28, s31
    v_mul_f32 v118, s26, v118
    v_mul_f32 v119, s26, v119
    v_mfma_f32_16x16x32_bf16 v[88:91], a[72:75], v[20:23], v[88:91]
    v_mfma_f32_16x16x32_bf16 v[92:95], a[76:79], v[20:23], v[92:95]
    s_waitcnt lgkmcnt(5)
    v_cvt_pk_bf16_f32 v138, v116, v117
    v_cvt_pk_bf16_f32 v139, v118, v119
    v_mfma_f32_16x16x32_bf16 v[64:67], a[80:83], v[24:27], v[64:67]
    ds_read_b128 v[16:19], v2 offset:128
    v_mfma_f32_16x16x32_bf16 v[68:71], a[84:87], v[24:27], v[68:71]
    s_add_u32 s30, s30, 33408
    v_mul_f32 v120, s26, v120
    v_mul_f32 v121, s26, v121
    v_mfma_f32_16x16x32_bf16 v[72:75], a[88:91], v[24:27], v[72:75]
    v_mfma_f32_16x16x32_bf16 v[76:79], a[92:95], v[24:27], v[76:79]
    s_waitcnt lgkmcnt(5)
    v_mul_f32 v122, s26, v122
    v_mul_f32 v123, s26, v123
    v_mfma_f32_16x16x32_bf16 v[80:83], a[80:83], v[28:31], v[80:83]
    s_cmp_ge_u32 s30, 133632
    ds_read_b128 v[20:23], v2 offset:16896
    v_mfma_f32_16x16x32_bf16 v[84:87], a[84:87], v[28:31], v[84:87]
    s_cselect_b32 s37, 133632, 0
    v_cvt_pk_bf16_f32 v140, v120, v121
    v_cvt_pk_bf16_f32 v141, v122, v123
    v_mfma_f32_16x16x32_bf16 v[88:91], a[88:91], v[28:31], v[88:91]
    s_sub_u32 s30, s30, s37
    v_mfma_f32_16x16x32_bf16 v[92:95], a[92:95], v[28:31], v[92:95]
    s_waitcnt lgkmcnt(5)
    v_mul_f32 v124, s26, v124
    v_mul_f32 v125, s26, v125
    v_mfma_f32_16x16x32_bf16 v[64:67], a[96:99], v[32:35], v[64:67]
    ds_read_b128 v[24:27], v2 offset:144
    v_mfma_f32_16x16x32_bf16 v[68:71], a[100:103], v[32:35], v[68:71]
    v_mul_f32 v126, s26, v126
    v_mul_f32 v127, s26, v127
    v_mfma_f32_16x16x32_bf16 v[72:75], a[104:107], v[32:35], v[72:75]
    buffer_store_dwordx4 v[128:131], v3, s[12:15], s29 offen offset:0 sc1
    v_mfma_f32_16x16x32_bf16 v[76:79], a[108:111], v[32:35], v[76:79]
    s_waitcnt lgkmcnt(5)
    v_cvt_pk_bf16_f32 v142, v124, v125
    v_cvt_pk_bf16_f32 v143, v126, v127
    v_mfma_f32_16x16x32_bf16 v[80:83], a[96:99], v[36:39], v[80:83]
    ds_read_b128 v[28:31], v2 offset:16912
    v_mfma_f32_16x16x32_bf16 v[84:87], a[100:103], v[36:39], v[84:87]
    v_mfma_f32_16x16x32_bf16 v[88:91], a[104:107], v[36:39], v[88:91]
    buffer_store_dwordx4 v[132:135], v3, s[12:15], s29 offen offset:2048 sc1
    v_mfma_f32_16x16x32_bf16 v[92:95], a[108:111], v[36:39], v[92:95]
    s_waitcnt lgkmcnt(5)
    v_mfma_f32_16x16x32_bf16 v[64:67], a[112:115], v[40:43], v[64:67]
    ds_read_b128 v[32:35], v2 offset:160
    v_mfma_f32_16x16x32_bf16 v[68:71], a[116:119], v[40:43], v[68:71]
    v_mfma_f32_16x16x32_bf16 v[72:75], a[120:123], v[40:43], v[72:75]
    buffer_store_dwordx4 v[136:139], v3, s[12:15], s29 offen offset:256 sc1
    v_mfma_f32_16x16x32_bf16 v[76:79], a[124:127], v[40:43], v[76:79]
    s_waitcnt lgkmcnt(5)
    v_mfma_f32_16x16x32_bf16 v[80:83], a[112:115], v[44:47], v[80:83]
    ds_read_b128 v[36:39], v2 offset:16928
    v_mfma_f32_16x16x32_bf16 v[84:87], a[116:119], v[44:47], v[84:87]
    v_mfma_f32_16x16x32_bf16 v[88:91], a[120:123], v[44:47], v[88:91]
    buffer_store_dwordx4 v[140:143], v3, s[12:15], s29 offen offset:2304 sc1
    v_mfma_f32_16x16x32_bf16 v[92:95], a[124:127], v[44:47], v[92:95]
    s_waitcnt lgkmcnt(5)
    v_mfma_f32_16x16x32_bf16 v[64:67], a[128:131], v[16:19], v[64:67]
    ds_read_b128 v[40:43], v2 offset:176
    v_mfma_f32_16x16x32_bf16 v[68:71], a[132:135], v[16:19], v[68:71]
    v_mfma_f32_16x16x32_bf16 v[72:75], a[136:139], v[16:19], v[72:75]
    v_mfma_f32_16x16x32_bf16 v[76:79], a[140:143], v[16:19], v[76:79]
    s_waitcnt lgkmcnt(5)
    v_mfma_f32_16x16x32_bf16 v[80:83], a[128:131], v[20:23], v[80:83]
    ds_read_b128 v[44:47], v2 offset:16944
    v_mfma_f32_16x16x32_bf16 v[84:87], a[132:135], v[20:23], v[84:87]
    v_mfma_f32_16x16x32_bf16 v[88:91], a[136:139], v[20:23], v[88:91]
    v_mfma_f32_16x16x32_bf16 v[92:95], a[140:143], v[20:23], v[92:95]
    s_waitcnt lgkmcnt(5)
    v_mfma_f32_16x16x32_bf16 v[64:67], a[144:147], v[24:27], v[64:67]
    ds_read_b128 v[16:19], v2 offset:192
    v_mfma_f32_16x16x32_bf16 v[68:71], a[148:151], v[24:27], v[68:71]
    v_mfma_f32_16x16x32_bf16 v[72:75], a[152:155], v[24:27], v[72:75]
    v_mfma_f32_16x16x32_bf16 v[76:79], a[156:159], v[24:27], v[76:79]
    s_waitcnt lgkmcnt(5)
    v_mfma_f32_16x16x32_bf16 v[80:83], a[144:147], v[28:31], v[80:83]
    ds_read_b128 v[20:23], v2 offset:16960
    v_mfma_f32_16x16x32_bf16 v[84:87], a[148:151], v[28:31], v[84:87]
    v_mfma_f32_16x16x32_bf16 v[88:91], a[152:155], v[28:31], v[88:91]
    v_mfma_f32_16x16x32_bf16 v[92:95], a[156:159], v[28:31], v[92:95]
    s_waitcnt lgkmcnt(5)
    v_mfma_f32_16x16x32_bf16 v[64:67], a[160:163], v[32:35], v[64:67]
    ds_read_b128 v[24:27], v2 offset:208
    v_mfma_f32_16x16x32_bf16 v[68:71], a[164:167], v[32:35], v[68:71]
    v_mfma_f32_16x16x32_bf16 v[72:75], a[168:171], v[32:35], v[72:75]
    v_mfma_f32_16x16x32_bf16 v[76:79], a[172:175], v[32:35], v[76:79]
    s_waitcnt lgkmcnt(5)
    v_mfma_f32_16x16x32_bf16 v[80:83], a[160:163], v[36:39], v[80:83]
    ds_read_b128 v[28:31], v2 offset:16976
    v_mfma_f32_16x16x32_bf16 v[84:87], a[164:167], v[36:39], v[84:87]
    v_mfma_f32_16x16x32_bf16 v[88:91], a[168:171], v[36:39], v[88:91]
    v_mfma_f32_16x16x32_bf16 v[92:95], a[172:175], v[36:39], v[92:95]
    s_waitcnt lgkmcnt(5)
    v_mfma_f32_16x16x32_bf16 v[64:67], a[176:179], v[40:43], v[64:67]
    s_mov_b32 s29, s24
    ds_read_b128 v[32:35], v2 offset:224
    v_mfma_f32_16x16x32_bf16 v[68:71], a[180:183], v[40:43], v[68:71]
    v_mfma_f32_16x16x32_bf16 v[72:75], a[184:187], v[40:43], v[72:75]
    v_mfma_f32_16x16x32_bf16 v[76:79], a[188:191], v[40:43], v[76:79]
    s_waitcnt lgkmcnt(5)
    v_mfma_f32_16x16x32_bf16 v[80:83], a[176:179], v[44:47], v[80:83]
    s_add_u32 s24, s24, s32
    ds_read_b128 v[36:39], v2 offset:16992
    v_mfma_f32_16x16x32_bf16 v[84:87], a[180:183], v[44:47], v[84:87]
    v_mfma_f32_16x16x32_bf16 v[88:91], a[184:187], v[44:47], v[88:91]
    v_mfma_f32_16x16x32_bf16 v[92:95], a[188:191], v[44:47], v[92:95]
    s_waitcnt lgkmcnt(5)
    v_mfma_f32_16x16x32_bf16 v[64:67], a[192:195], v[16:19], v[64:67]
    s_sub_u32 s41, s33, 1
    ds_read_b128 v[40:43], v2 offset:240
    v_mfma_f32_16x16x32_bf16 v[68:71], a[196:199], v[16:19], v[68:71]
    s_cmp_lt_u32 s33, 10
    v_mfma_f32_16x16x32_bf16 v[72:75], a[200:203], v[16:19], v[72:75]
    s_cbranch_scc1 pj_es_193
s_pj_eb_194:
    v_mfma_f32_16x16x32_bf16 v[76:79], a[204:207], v[16:19], v[76:79]
    s_waitcnt lgkmcnt(5)
    v_mfma_f32_16x16x32_bf16 v[80:83], a[192:195], v[20:23], v[80:83]
    s_add_u32 s41, s41, s34
    ds_read_b128 v[44:47], v2 offset:17008
    v_mfma_f32_16x16x32_bf16 v[84:87], a[196:199], v[20:23], v[84:87]
    v_mov_b32 v4, s41
    v_mfma_f32_16x16x32_bf16 v[88:91], a[200:203], v[20:23], v[88:91]
    s_waitcnt vmcnt(12)
    s_barrier
    v_mfma_f32_16x16x32_bf16 v[92:95], a[204:207], v[20:23], v[92:95]
    s_waitcnt lgkmcnt(5)
    v_mfma_f32_16x16x32_bf16 v[64:67], a[208:211], v[24:27], v[64:67]
    ds_read_b128 v[16:19], v2 offset:33408
    v_mfma_f32_16x16x32_bf16 v[68:71], a[212:215], v[24:27], v[68:71]
    v_mfma_f32_16x16x32_bf16 v[72:75], a[216:219], v[24:27], v[72:75]
    buffer_store_dword v4, off, s[12:15], s27 sc1
    v_mfma_f32_16x16x32_bf16 v[76:79], a[220:223], v[24:27], v[76:79]
    s_waitcnt lgkmcnt(5)
    v_mfma_f32_16x16x32_bf16 v[80:83], a[208:211], v[28:31], v[80:83]
    ds_read_b128 v[20:23], v2 offset:50176
    v_mfma_f32_16x16x32_bf16 v[84:87], a[212:215], v[28:31], v[84:87]
    v_mfma_f32_16x16x32_bf16 v[88:91], a[216:219], v[28:31], v[88:91]
    v_mfma_f32_16x16x32_bf16 v[92:95], a[220:223], v[28:31], v[92:95]
    s_waitcnt lgkmcnt(5)
    v_mfma_f32_16x16x32_bf16 v[64:67], a[224:227], v[32:35], v[64:67]
    ds_read_b128 v[24:27], v2 offset:33424
    v_mfma_f32_16x16x32_bf16 v[68:71], a[228:231], v[32:35], v[68:71]
    v_mfma_f32_16x16x32_bf16 v[72:75], a[232:235], v[32:35], v[72:75]
    v_mfma_f32_16x16x32_bf16 v[76:79], a[236:239], v[32:35], v[76:79]
    s_waitcnt lgkmcnt(5)
    v_mfma_f32_16x16x32_bf16 v[80:83], a[224:227], v[36:39], v[80:83]
    ds_read_b128 v[28:31], v2 offset:50192
    v_mfma_f32_16x16x32_bf16 v[84:87], a[228:231], v[36:39], v[84:87]
    v_mfma_f32_16x16x32_bf16 v[88:91], a[232:235], v[36:39], v[88:91]
    v_mfma_f32_16x16x32_bf16 v[92:95], a[236:239], v[36:39], v[92:95]
    s_waitcnt lgkmcnt(5)
    v_mfma_f32_16x16x32_bf16 v[64:67], a[240:243], v[40:43], v[64:67]
    s_add_u32 s33, s33, 1
    ds_read_b128 v[32:35], v2 offset:33440
    v_mfma_f32_16x16x32_bf16 v[68:71], a[244:247], v[40:43], v[68:71]
    v_mfma_f32_16x16x32_bf16 v[72:75], a[248:251], v[40:43], v[72:75]
    v_mfma_f32_16x16x32_bf16 v[76:79], a[252:255], v[40:43], v[76:79]
    s_waitcnt lgkmcnt(5)
    v_mfma_f32_16x16x32_bf16 v[80:83], a[240:243], v[44:47], v[80:83]
    s_cmp_ge_u32 s33, s23
    ds_read_b128 v[36:39], v2 offset:50208
    v_mfma_f32_16x16x32_bf16 v[84:87], a[244:247], v[44:47], v[84:87]
    v_mfma_f32_16x16x32_bf16 v[88:91], a[248:251], v[44:47], v[88:91]
    v_mfma_f32_16x16x32_bf16 v[92:95], a[252:255], v[44:47], v[92:95]
    s_waitcnt lgkmcnt(5)
    s_cbranch_scc1 pj_fin0_191
    v_mfma_f32_16x16x32_bf16 v[96:99], a[0:3], v[16:19], 0
    ds_read_b128 v[40:43], v2 offset:33456
    v_mfma_f32_16x16x32_bf16 v[100:103], a[4:7], v[16:19], 0
    s_add_u32 m0, s30, 0
    v_mfma_f32_16x16x32_bf16 v[104:107], a[8:11], v[16:19], 0
    buffer_load_dwordx4 v1, s[16:19], s28 offen offset:0 lds
    v_mfma_f32_16x16x32_bf16 v[108:111], a[12:15], v[16:19], 0
    s_waitcnt lgkmcnt(5)
    v_mfma_f32_16x16x32_bf16 v[112:115], a[0:3], v[20:23], 0
    ds_read_b128 v[44:47], v2 offset:50224
    v_mfma_f32_16x16x32_bf16 v[116:119], a[4:7], v[20:23], 0
    s_add_u32 m0, s30, 16
    v_mul_f32 v64, s26, v64
    v_mul_f32 v65, s26, v65
    v_mfma_f32_16x16x32_bf16 v[120:123], a[8:11], v[20:23], 0
    buffer_load_dwordx4 v1, s[16:19], s28 offen offset:1024 lds
    v_mfma_f32_16x16x32_bf16 v[124:127], a[12:15], v[20:23], 0
    s_waitcnt lgkmcnt(5)
    v_mul_f32 v66, s26, v66
    v_mul_f32 v67, s26, v67
    v_mfma_f32_16x16x32_bf16 v[96:99], a[16:19], v[24:27], v[96:99]
    ds_read_b128 v[16:19], v2 offset:33472
    v_mfma_f32_16x16x32_bf16 v[100:103], a[20:23], v[24:27], v[100:103]
    s_add_u32 m0, s30, 32
    v_cvt_pk_bf16_f32 v128, v64, v65
    v_cvt_pk_bf16_f32 v129, v66, v67
    v_mfma_f32_16x16x32_bf16 v[104:107], a[24:27], v[24:27], v[104:107]
    buffer_load_dwordx4 v1, s[16:19], s28 offen offset:2048 lds
    v_mfma_f32_16x16x32_bf16 v[108:111], a[28:31], v[24:27], v[108:111]
    s_waitcnt lgkmcnt(5)
    v_mul_f32 v68, s26, v68
    v_mul_f32 v69, s26, v69
    v_mfma_f32_16x16x32_bf16 v[112:115], a[16:19], v[28:31], v[112:115]
    ds_read_b128 v[20:23], v2 offset:50240
    v_mfma_f32_16x16x32_bf16 v[116:119], a[20:23], v[28:31], v[116:119]
    s_add_u32 m0, s30, 48
    v_mul_f32 v70, s26, v70
    v_mul_f32 v71, s26, v71
    v_mfma_f32_16x16x32_bf16 v[120:123], a[24:27], v[28:31], v[120:123]
    buffer_load_dwordx4 v1, s[16:19], s28 offen offset:3072 lds
    v_mfma_f32_16x16x32_bf16 v[124:127], a[28:31], v[28:31], v[124:127]
    s_waitcnt lgkmcnt(5)
    v_cvt_pk_bf16_f32 v130, v68, v69
    v_cvt_pk_bf16_f32 v131, v70, v71
    v_mfma_f32_16x16x32_bf16 v[96:99], a[32:35], v[32:35], v[96:99]
    ds_read_b128 v[24:27], v2 offset:33488
    v_mfma_f32_16x16x32_bf16 v[100:103], a[36:39], v[32:35], v[100:103]
    s_add_u32 s37, s28, 4096
    v_mul_f32 v72, s26, v72
    v_mul_f32 v73, s26, v73
    v_mfma_f32_16x16x32_bf16 v[104:107], a[40:43], v[32:35], v[104:107]
    v_mfma_f32_16x16x32_bf16 v[108:111], a[44:47], v[32:35], v[108:111]
    s_waitcnt lgkmcnt(5)
    v_mul_f32 v74, s26, v74
    v_mul_f32 v75, s26, v75
    v_mfma_f32_16x16x32_bf16 v[112:115], a[32:35], v[36:39], v[112:115]
    ds_read_b128 v[28:31], v2 offset:50256
    v_mfma_f32_16x16x32_bf16 v[116:119], a[36:39], v[36:39], v[116:119]
    s_add_u32 m0, s30, 4160
    v_cvt_pk_bf16_f32 v132, v72, v73
    v_cvt_pk_bf16_f32 v133, v74, v75
    v_mfma_f32_16x16x32_bf16 v[120:123], a[40:43], v[36:39], v[120:123]
    buffer_load_dwordx4 v1, s[16:19], s37 offen offset:0 lds
    v_mfma_f32_16x16x32_bf16 v[124:127], a[44:47], v[36:39], v[124:127]
    s_waitcnt lgkmcnt(5)
    v_mul_f32 v76, s26, v76
    v_mul_f32 v77, s26, v77
    v_mfma_f32_16x16x32_bf16 v[96:99], a[48:51], v[40:43], v[96:99]
    ds_read_b128 v[32:35], v2 offset:33504
    v_mfma_f32_16x16x32_bf16 v[100:103], a[52:55], v[40:43], v[100:103]
    s_add_u32 m0, s30, 4176
    v_mul_f32 v78, s26, v78
    v_mul_f32 v79, s26, v79
    v_mfma_f32_16x16x32_bf16 v[104:107], a[56:59], v[40:43], v[104:107]
    buffer_load_dwordx4 v1, s[16:19], s37 offen offset:1024 lds
    v_mfma_f32_16x16x32_bf16 v[108:111], a[60:63], v[40:43], v[108:111]
    s_waitcnt lgkmcnt(5)
    v_cvt_pk_bf16_f32 v134, v76, v77
    v_cvt_pk_bf16_f32 v135, v78, v79
    v_mfma_f32_16x16x32_bf16 v[112:115], a[48:51], v[44:47], v[112:115]
    ds_read_b128 v[36:39], v2 offset:50272
    v_mfma_f32_16x16x32_bf16 v[116:119], a[52:55], v[44:47], v[116:119]
    s_add_u32 m0, s30, 4192
    v_mul_f32 v80, s26, v80
    v_mul_f32 v81, s26, v81
    v_mfma_f32_16x16x32_bf16 v[120:123], a[56:59], v[44:47], v[120:123]
    buffer_load_dwordx4 v1, s[16:19], s37 offen offset:2048 lds
    v_mfma_f32_16x16x32_bf16 v[124:127], a[60:63], v[44:47], v[124:127]
    s_waitcnt lgkmcnt(5)
    v_mul_f32 v82, s26, v82
    v_mul_f32 v83, s26, v83
    v_mfma_f32_16x16x32_bf16 v[96:99], a[64:67], v[16:19], v[96:99]
    ds_read_b128 v[40:43], v2 offset:33520
    v_mfma_f32_16x16x32_bf16 v[100:103], a[68:71], v[16:19], v[100:103]
    s_add_u32 m0, s30, 4208
    v_cvt_pk_bf16_f32 v136, v80, v81
    v_cvt_pk_bf16_f32 v137, v82, v83
    v_mfma_f32_16x16x32_bf16 v[104:107], a[72:75], v[16:19], v[104:107]
    buffer_load_dwordx4 v1, s[16:19], s37 offen offset:3072 lds
    v_mfma_f32_16x16x32_bf16 v[108:111], a[76:79], v[16:19], v[108:111]
    s_waitcnt lgkmcnt(5)
    v_mul_f32 v84, s26, v84
    v_mul_f32 v85, s26, v85
    v_mfma_f32_16x16x32_bf16 v[112:115], a[64:67], v[20:23], v[112:115]
    ds_read_b128 v[44:47], v2 offset:50288
    v_mfma_f32_16x16x32_bf16 v[116:119], a[68:71], v[20:23], v[116:119]
    s_add_u32 s28, s28, s31
    v_mul_f32 v86, s26, v86
    v_mul_f32 v87, s26, v87
    v_mfma_f32_16x16x32_bf16 v[120:123], a[72:75], v[20:23], v[120:123]
    v_mfma_f32_16x16x32_bf16 v[124:127], a[76:79], v[20:23], v[124:127]
    s_waitcnt lgkmcnt(5)
    v_cvt_pk_bf16_f32 v138, v84, v85
    v_cvt_pk_bf16_f32 v139, v86, v87
    v_mfma_f32_16x16x32_bf16 v[96:99], a[80:83], v[24:27], v[96:99]
    ds_read_b128 v[16:19], v2 offset:33536
    v_mfma_f32_16x16x32_bf16 v[100:103], a[84:87], v[24:27], v[100:103]
    s_add_u32 s30, s30, 33408
    v_mul_f32 v88, s26, v88
    v_mul_f32 v89, s26, v89
    v_mfma_f32_16x16x32_bf16 v[104:107], a[88:91], v[24:27], v[104:107]
    v_mfma_f32_16x16x32_bf16 v[108:111], a[92:95], v[24:27], v[108:111]
    s_waitcnt lgkmcnt(5)
    v_mul_f32 v90, s26, v90
    v_mul_f32 v91, s26, v91
    v_mfma_f32_16x16x32_bf16 v[112:115], a[80:83], v[28:31], v[112:115]
    s_cmp_ge_u32 s30, 133632
    ds_read_b128 v[20:23], v2 offset:50304
    v_mfma_f32_16x16x32_bf16 v[116:119], a[84:87], v[28:31], v[116:119]
    s_cselect_b32 s37, 133632, 0
    v_cvt_pk_bf16_f32 v140, v88, v89
    v_cvt_pk_bf16_f32 v141, v90, v91
    v_mfma_f32_16x16x32_bf16 v[120:123], a[88:91], v[28:31], v[120:123]
    s_sub_u32 s30, s30, s37
    v_mfma_f32_16x16x32_bf16 v[124:127], a[92:95], v[28:31], v[124:127]
    s_waitcnt lgkmcnt(5)
    v_mul_f32 v92, s26, v92
    v_mul_f32 v93, s26, v93
    v_mfma_f32_16x16x32_bf16 v[96:99], a[96:99], v[32:35], v[96:99]
    ds_read_b128 v[24:27], v2 offset:33552
    v_mfma_f32_16x16x32_bf16 v[100:103], a[100:103], v[32:35], v[100:103]
    v_mul_f32_e64 v94, s26, v94
    v_mul_f32_e64 v95, s26, v95
    v_mfma_f32_16x16x32_bf16 v[104:107], a[104:107], v[32:35], v[104:107]
    buffer_store_dwordx4 v[128:131], v3, s[12:15], s29 offen offset:0 sc1
    v_mfma_f32_16x16x32_bf16 v[108:111], a[108:111], v[32:35], v[108:111]
    s_waitcnt lgkmcnt(5)
    v_cvt_pk_bf16_f32 v142, v92, v93
    v_cvt_pk_bf16_f32 v143, v94, v95
    v_mfma_f32_16x16x32_bf16 v[112:115], a[96:99], v[36:39], v[112:115]
    ds_read_b128 v[28:31], v2 offset:50320
    v_mfma_f32_16x16x32_bf16 v[116:119], a[100:103], v[36:39], v[116:119]
    v_mfma_f32_16x16x32_bf16 v[120:123], a[104:107], v[36:39], v[120:123]
    buffer_store_dwordx4 v[132:135], v3, s[12:15], s29 offen offset:2048 sc1
    v_mfma_f32_16x16x32_bf16 v[124:127], a[108:111], v[36:39], v[124:127]
    s_waitcnt lgkmcnt(5)
    v_mfma_f32_16x16x32_bf16 v[96:99], a[112:115], v[40:43], v[96:99]
    ds_read_b128 v[32:35], v2 offset:33568
    v_mfma_f32_16x16x32_bf16 v[100:103], a[116:119], v[40:43], v[100:103]
    v_mfma_f32_16x16x32_bf16 v[104:107], a[120:123], v[40:43], v[104:107]
    buffer_store_dwordx4 v[136:139], v3, s[12:15], s29 offen offset:256 sc1
    v_mfma_f32_16x16x32_bf16 v[108:111], a[124:127], v[40:43], v[108:111]
    s_waitcnt lgkmcnt(5)
    v_mfma_f32_16x16x32_bf16 v[112:115], a[112:115], v[44:47], v[112:115]
    ds_read_b128 v[36:39], v2 offset:50336
    v_mfma_f32_16x16x32_bf16 v[116:119], a[116:119], v[44:47], v[116:119]
    v_mfma_f32_16x16x32_bf16 v[120:123], a[120:123], v[44:47], v[120:123]
    buffer_store_dwordx4 v[140:143], v3, s[12:15], s29 offen offset:2304 sc1
    v_mfma_f32_16x16x32_bf16 v[124:127], a[124:127], v[44:47], v[124:127]
    s_waitcnt lgkmcnt(5)
    v_mfma_f32_16x16x32_bf16 v[96:99], a[128:131], v[16:19], v[96:99]
    ds_read_b128 v[40:43], v2 offset:33584
    v_mfma_f32_16x16x32_bf16 v[100:103], a[132:135], v[16:19], v[100:103]
    v_mfma_f32_16x16x32_bf16 v[104:107], a[136:139], v[16:19], v[104:107]
    v_mfma_f32_16x16x32_bf16 v[108:111], a[140:143], v[16:19], v[108:111]
    s_waitcnt lgkmcnt(5)
    v_mfma_f32_16x16x32_bf16 v[112:115], a[128:131], v[20:23], v[112:115]
    ds_read_b128 v[44:47], v2 offset:50352
    v_mfma_f32_16x16x32_bf16 v[116:119], a[132:135], v[20:23], v[116:119]
    v_mfma_f32_16x16x32_bf16 v[120:123], a[136:139], v[20:23], v[120:123]
    v_mfma_f32_16x16x32_bf16 v[124:127], a[140:143], v[20:23], v[124:127]
    s_waitcnt lgkmcnt(5)
    v_mfma_f32_16x16x32_bf16 v[96:99], a[144:147], v[24:27], v[96:99]
    ds_read_b128 v[16:19], v2 offset:33600
    v_mfma_f32_16x16x32_bf16 v[100:103], a[148:151], v[24:27], v[100:103]
    v_mfma_f32_16x16x32_bf16 v[104:107], a[152:155], v[24:27], v[104:107]
    v_mfma_f32_16x16x32_bf16 v[108:111], a[156:159], v[24:27], v[108:111]
    s_waitcnt lgkmcnt(5)
    v_mfma_f32_16x16x32_bf16 v[112:115], a[144:147], v[28:31], v[112:115]
    ds_read_b128 v[20:23], v2 offset:50368
    v_mfma_f32_16x16x32_bf16 v[116:119], a[148:151], v[28:31], v[116:119]
    v_mfma_f32_16x16x32_bf16 v[120:123], a[152:155], v[28:31], v[120:123]
    v_mfma_f32_16x16x32_bf16 v[124:127], a[156:159], v[28:31], v[124:127]
    s_waitcnt lgkmcnt(5)
    v_mfma_f32_16x16x32_bf16 v[96:99], a[160:163], v[32:35], v[96:99]
    ds_read_b128 v[24:27], v2 offset:33616
    v_mfma_f32_16x16x32_bf16 v[100:103], a[164:167], v[32:35], v[100:103]
    v_mfma_f32_16x16x32_bf16 v[104:107], a[168:171], v[32:35], v[104:107]
    v_mfma_f32_16x16x32_bf16 v[108:111], a[172:175], v[32:35], v[108:111]
    s_waitcnt lgkmcnt(5)
    v_mfma_f32_16x16x32_bf16 v[112:115], a[160:163], v[36:39], v[112:115]
    ds_read_b128 v[28:31], v2 offset:50384
    v_mfma_f32_16x16x32_bf16 v[116:119], a[164:167], v[36:39], v[116:119]
    v_mfma_f32_16x16x32_bf16 v[120:123], a[168:171], v[36:39], v[120:123]
    v_mfma_f32_16x16x32_bf16 v[124:127], a[172:175], v[36:39], v[124:127]
    s_waitcnt lgkmcnt(5)
    v_mfma_f32_16x16x32_bf16 v[96:99], a[176:179], v[40:43], v[96:99]
    s_mov_b32 s29, s24
    ds_read_b128 v[32:35], v2 offset:33632
    v_mfma_f32_16x16x32_bf16 v[100:103], a[180:183], v[40:43], v[100:103]
    v_mfma_f32_16x16x32_bf16 v[104:107], a[184:187], v[40:43], v[104:107]
    v_mfma_f32_16x16x32_bf16 v[108:111], a[188:191], v[40:43], v[108:111]
    s_waitcnt lgkmcnt(5)
    v_mfma_f32_16x16x32_bf16 v[112:115], a[176:179], v[44:47], v[112:115]
    s_add_u32 s24, s24, s32
    ds_read_b128 v[36:39], v2 offset:50400
    v_mfma_f32_16x16x32_bf16 v[116:119], a[180:183], v[44:47], v[116:119]
    v_mfma_f32_16x16x32_bf16 v[120:123], a[184:187], v[44:47], v[120:123]
    v_mfma_f32_16x16x32_bf16 v[124:127], a[188:191], v[44:47], v[124:127]
    s_waitcnt lgkmcnt(5)
    v_mfma_f32_16x16x32_bf16 v[96:99], a[192:195], v[16:19], v[96:99]
    s_sub_u32 s41, s33, 1
    ds_read_b128 v[40:43], v2 offset:33648
    v_mfma_f32_16x16x32_bf16 v[100:103], a[196:199], v[16:19], v[100:103]
    s_cmp_lt_u32 s33, 10
    v_mfma_f32_16x16x32_bf16 v[104:107], a[200:203], v[16:19], v[104:107]
    s_cbranch_scc1 pj_es_195
s_pj_eb_196:
    v_mfma_f32_16x16x32_bf16 v[108:111], a[204:207], v[16:19], v[108:111]
    s_waitcnt lgkmcnt(5)
    v_mfma_f32_16x16x32_bf16 v[112:115], a[192:195], v[20:23], v[112:115]
    s_add_u32 s41, s41, s34
    ds_read_b128 v[44:47], v2 offset:50416
    v_mfma_f32_16x16x32_bf16 v[116:119], a[196:199], v[20:23], v[116:119]
    v_add_u32 v2, s40, v2
    v_mov_b32 v4, s41
    v_mfma_f32_16x16x32_bf16 v[120:123], a[200:203], v[20:23], v[120:123]
    s_waitcnt vmcnt(12)
    s_barrier
    v_mfma_f32_16x16x32_bf16 v[124:127], a[204:207], v[20:23], v[124:127]
    s_waitcnt lgkmcnt(5)
    v_mfma_f32_16x16x32_bf16 v[96:99], a[208:211], v[24:27], v[96:99]
    ds_read_b128 v[16:19], v2 offset:0
    v_mfma_f32_16x16x32_bf16 v[100:103], a[212:215], v[24:27], v[100:103]
    v_mfma_f32_16x16x32_bf16 v[104:107], a[216:219], v[24:27], v[104:107]
    buffer_store_dword v4, off, s[12:15], s27 sc1
    v_mfma_f32_16x16x32_bf16 v[108:111], a[220:223], v[24:27], v[108:111]
    s_waitcnt lgkmcnt(5)
    v_mfma_f32_16x16x32_bf16 v[112:115], a[208:211], v[28:31], v[112:115]
    ds_read_b128 v[20:23], v2 offset:16768
    v_mfma_f32_16x16x32_bf16 v[116:119], a[212:215], v[28:31], v[116:119]
    v_mfma_f32_16x16x32_bf16 v[120:123], a[216:219], v[28:31], v[120:123]
    v_mfma_f32_16x16x32_bf16 v[124:127], a[220:223], v[28:31], v[124:127]
    s_waitcnt lgkmcnt(5)
    v_mfma_f32_16x16x32_bf16 v[96:99], a[224:227], v[32:35], v[96:99]
    s_sub_u32 s40, 0, s40
    ds_read_b128 v[24:27], v2 offset:16
    v_mfma_f32_16x16x32_bf16 v[100:103], a[228:231], v[32:35], v[100:103]
    v_mfma_f32_16x16x32_bf16 v[104:107], a[232:235], v[32:35], v[104:107]
    v_mfma_f32_16x16x32_bf16 v[108:111], a[236:239], v[32:35], v[108:111]
    s_waitcnt lgkmcnt(5)
    v_mfma_f32_16x16x32_bf16 v[112:115], a[224:227], v[36:39], v[112:115]
    ds_read_b128 v[28:31], v2 offset:16784
    v_mfma_f32_16x16x32_bf16 v[116:119], a[228:231], v[36:39], v[116:119]
    v_mfma_f32_16x16x32_bf16 v[120:123], a[232:235], v[36:39], v[120:123]
    v_mfma_f32_16x16x32_bf16 v[124:127], a[236:239], v[36:39], v[124:127]
    s_waitcnt lgkmcnt(5)
    v_mfma_f32_16x16x32_bf16 v[96:99], a[240:243], v[40:43], v[96:99]
    s_add_u32 s33, s33, 1
    ds_read_b128 v[32:35], v2 offset:32
    v_mfma_f32_16x16x32_bf16 v[100:103], a[244:247], v[40:43], v[100:103]
    v_mfma_f32_16x16x32_bf16 v[104:107], a[248:251], v[40:43], v[104:107]
    v_mfma_f32_16x16x32_bf16 v[108:111], a[252:255], v[40:43], v[108:111]
    s_waitcnt lgkmcnt(5)
    v_mfma_f32_16x16x32_bf16 v[112:115], a[240:243], v[44:47], v[112:115]
    s_cmp_ge_u32 s33, s23
    ds_read_b128 v[36:39], v2 offset:16800
    v_mfma_f32_16x16x32_bf16 v[116:119], a[244:247], v[44:47], v[116:119]
    v_mfma_f32_16x16x32_bf16 v[120:123], a[248:251], v[44:47], v[120:123]
    v_mfma_f32_16x16x32_bf16 v[124:127], a[252:255], v[44:47], v[124:127]
    s_waitcnt lgkmcnt(5)
    s_cbranch_scc0 pj_loop_190
pj_fin1_192:
    v_mul_f32 v96, s26, v96
    v_mul_f32 v97, s26, v97
    v_mul_f32 v98, s26, v98
    v_mul_f32 v99, s26, v99
    v_cvt_pk_bf16_f32 v128, v96, v97
    v_cvt_pk_bf16_f32 v129, v98, v99
    v_mul_f32 v100, s26, v100
    v_mul_f32 v101, s26, v101
    v_mul_f32 v102, s26, v102
    v_mul_f32 v103, s26, v103
    v_cvt_pk_bf16_f32 v130, v100, v101
    v_cvt_pk_bf16_f32 v131, v102, v103
    buffer_store_dwordx4 v[128:131], v3, s[12:15], s29 offen offset:0 sc1
    v_mul_f32 v104, s26, v104
    v_mul_f32 v105, s26, v105
    v_mul_f32 v106, s26, v106
    v_mul_f32 v107, s26, v107
    v_cvt_pk_bf16_f32 v132, v104, v105
    v_cvt_pk_bf16_f32 v133, v106, v107
    v_mul_f32 v108, s26, v108
    v_mul_f32 v109, s26, v109
    v_mul_f32 v110, s26, v110
    v_mul_f32 v111, s26, v111
    v_cvt_pk_bf16_f32 v134, v108, v109
    v_cvt_pk_bf16_f32 v135, v110, v111
    buffer_store_dwordx4 v[132:135], v3, s[12:15], s29 offen offset:2048 sc1
    v_mul_f32 v112, s26, v112
    v_mul_f32 v113, s26, v113
    v_mul_f32 v114, s26, v114
    v_mul_f32 v115, s26, v115
    v_cvt_pk_bf16_f32 v136, v112, v113
    v_cvt_pk_bf16_f32 v137, v114, v115
    v_mul_f32 v116, s26, v116
    v_mul_f32 v117, s26, v117
    v_mul_f32 v118, s26, v118
    v_mul_f32 v119, s26, v119
    v_cvt_pk_bf16_f32 v138, v116, v117
    v_cvt_pk_bf16_f32 v139, v118, v119
    buffer_store_dwordx4 v[136:139], v3, s[12:15], s29 offen offset:256 sc1
    v_mul_f32 v120, s26, v120
    v_mul_f32 v121, s26, v121
    v_mul_f32 v122, s26, v122
    v_mul_f32 v123, s26, v123
    v_cvt_pk_bf16_f32 v140, v120, v121
    v_cvt_pk_bf16_f32 v141, v122, v123
    v_mul_f32 v124, s26, v124
    v_mul_f32 v125, s26, v125
    v_mul_f32 v126, s26, v126
    v_mul_f32 v127, s26, v127
    v_cvt_pk_bf16_f32 v142, v124, v125
    v_cvt_pk_bf16_f32 v143, v126, v127
    buffer_store_dwordx4 v[140:143], v3, s[12:15], s29 offen offset:2304 sc1
    s_branch pj_end_189
pj_es_193:
    s_waitcnt vmcnt(0)
    s_mov_b32 s41, s33
    s_branch s_pj_eb_194
pj_es_195:
    s_waitcnt vmcnt(0)
    s_mov_b32 s41, s33
    s_branch s_pj_eb_196
pj_fin0_191:
    v_mul_f32 v64, s26, v64
    v_mul_f32 v65, s26, v65
    v_mul_f32 v66, s26, v66
    v_mul_f32 v67, s26, v67
    v_cvt_pk_bf16_f32 v128, v64, v65
    v_cvt_pk_bf16_f32 v129, v66, v67
    v_mul_f32 v68, s26, v68
    v_mul_f32 v69, s26, v69
    v_mul_f32 v70, s26, v70
    v_mul_f32 v71, s26, v71
    v_cvt_pk_bf16_f32 v130, v68, v69
    v_cvt_pk_bf16_f32 v131, v70, v71
    buffer_store_dwordx4 v[128:131], v3, s[12:15], s29 offen offset:0 sc1
    v_mul_f32 v72, s26, v72
    v_mul_f32 v73, s26, v73
    v_mul_f32 v74, s26, v74
    v_mul_f32 v75, s26, v75
    v_cvt_pk_bf16_f32 v132, v72, v73
    v_cvt_pk_bf16_f32 v133, v74, v75
    v_mul_f32 v76, s26, v76
    v_mul_f32 v77, s26, v77
    v_mul_f32 v78, s26, v78
    v_mul_f32 v79, s26, v79
    v_cvt_pk_bf16_f32 v134, v76, v77
    v_cvt_pk_bf16_f32 v135, v78, v79
    buffer_store_dwordx4 v[132:135], v3, s[12:15], s29 offen offset:2048 sc1
    v_mul_f32 v80, s26, v80
    v_mul_f32 v81, s26, v81
    v_mul_f32 v82, s26, v82
    v_mul_f32 v83, s26, v83
    v_cvt_pk_bf16_f32 v136, v80, v81
    v_cvt_pk_bf16_f32 v137, v82, v83
    v_mul_f32 v84, s26, v84
    v_mul_f32 v85, s26, v85
    v_mul_f32 v86, s26, v86
    v_mul_f32 v87, s26, v87
    v_cvt_pk_bf16_f32 v138, v84, v85
    v_cvt_pk_bf16_f32 v139, v86, v87
    buffer_store_dwordx4 v[136:139], v3, s[12:15], s29 offen offset:256 sc1
    v_mul_f32 v88, s26, v88
    v_mul_f32 v89, s26, v89
    v_mul_f32 v90, s26, v90
    v_mul_f32 v91, s26, v91
    v_cvt_pk_bf16_f32 v140, v88, v89
    v_cvt_pk_bf16_f32 v141, v90, v91
    v_mul_f32 v92, s26, v92
    v_mul_f32 v93, s26, v93
    v_mul_f32 v94, s26, v94
    v_mul_f32 v95, s26, v95
    v_cvt_pk_bf16_f32 v142, v92, v93
    v_cvt_pk_bf16_f32 v143, v94, v95
    buffer_store_dwordx4 v[140:143], v3, s[12:15], s29 offen offset:2304 sc1
    s_branch pj_end_189
pj_v_188:
    v_and_b32 v4, 7, v0
    v_mul_u32_u24 v2, 1040, v4
    v_bfe_u32 v4, v0, 3, 1
    v_mul_u32_u24 v4, 16768, v4
    v_add_u32 v2, v2, v4
    v_bfe_u32 v4, v0, 4, 2
    v_lshlrev_b32 v3, 9, v4
    v_bfe_u32 v4, v0, 3, 1
    v_lshl_add_u32 v3, v4, 8, v3
    v_bfe_u32 v4, v0, 0, 3
    v_lshl_add_u32 v3, v4, 4, v3
    v_lshrrev_b32 v4, 4, v0
    v_lshl_add_u32 v2, v4, 8, v2
    v_add_u32 v2, 66816, v2
    s_mov_b32 s29, s24
    s_add_u32 s24, s24, s32
    v_cvt_pk_bf16_f32 v128, v64, v65
    v_cvt_pk_bf16_f32 v129, v66, v67
    v_cvt_pk_bf16_f32 v130, v80, v81
    v_cvt_pk_bf16_f32 v131, v82, v83
    buffer_store_dwordx4 v[128:131], v3, s[12:15], s29 offen offset:0 sc1
    v_cvt_pk_bf16_f32 v132, v68, v69
    v_cvt_pk_bf16_f32 v133, v70, v71
    v_cvt_pk_bf16_f32 v134, v84, v85
    v_cvt_pk_bf16_f32 v135, v86, v87
    buffer_store_dwordx4 v[132:135], v3, s[12:15], s29 offen offset:128 sc1
    v_cvt_pk_bf16_f32 v136, v72, v73
    v_cvt_pk_bf16_f32 v137, v74, v75
    v_cvt_pk_bf16_f32 v138, v88, v89
    v_cvt_pk_bf16_f32 v139, v90, v91
    buffer_store_dwordx4 v[136:139], v3, s[12:15], s29 offen offset:2048 sc1
    v_cvt_pk_bf16_f32 v140, v76, v77
    v_cvt_pk_bf16_f32 v141, v78, v79
    v_cvt_pk_bf16_f32 v142, v92, v93
    v_cvt_pk_bf16_f32 v143, v94, v95
    buffer_store_dwordx4 v[140:143], v3, s[12:15], s29 offen offset:2176 sc1
    s_mov_b32 s29, s24
    s_add_u32 s24, s24, s32
    v_cvt_pk_bf16_f32 v128, v96, v97
    v_cvt_pk_bf16_f32 v129, v98, v99
    v_cvt_pk_bf16_f32 v130, v112, v113
    v_cvt_pk_bf16_f32 v131, v114, v115
    buffer_store_dwordx4 v[128:131], v3, s[12:15], s29 offen offset:0 sc1
    v_cvt_pk_bf16_f32 v132, v100, v101
    v_cvt_pk_bf16_f32 v133, v102, v103
    v_cvt_pk_bf16_f32 v134, v116, v117
    v_cvt_pk_bf16_f32 v135, v118, v119
    buffer_store_dwordx4 v[132:135], v3, s[12:15], s29 offen offset:128 sc1
    v_cvt_pk_bf16_f32 v136, v104, v105
    v_cvt_pk_bf16_f32 v137, v106, v107
    v_cvt_pk_bf16_f32 v138, v120, v121
    v_cvt_pk_bf16_f32 v139, v122, v123
    buffer_store_dwordx4 v[136:139], v3, s[12:15], s29 offen offset:2048 sc1
    v_cvt_pk_bf16_f32 v140, v108, v109
    v_cvt_pk_bf16_f32 v141, v110, v111
    v_cvt_pk_bf16_f32 v142, v124, v125
    v_cvt_pk_bf16_f32 v143, v126, v127
    buffer_store_dwordx4 v[140:143], v3, s[12:15], s29 offen offset:2176 sc1
    s_add_u32 s41, s34, 2
    v_mov_b32 v4, s41
    s_mov_b32 s29, 0x80000000
    s_waitcnt vmcnt(0)
    s_barrier
    buffer_store_dword v4, off, s[12:15], s27 sc1
    v_lshlrev_b32 v14, 7, v0
    buffer_load_dword v15, v14, s[8:11], s59 offen
    s_add_u32 s59, s59, 8192
    buffer_load_dword v15, v14, s[8:11], s59 offen
    ds_read_b128 v[16:19], v2 offset:0
    ds_read_b128 v[20:23], v2 offset:8320
    ds_read_b128 v[24:27], v2 offset:16
    ds_read_b128 v[28:31], v2 offset:8336
    ds_read_b128 v[32:35], v2 offset:32
    ds_read_b128 v[36:39], v2 offset:8352
    s_waitcnt lgkmcnt(5)
.p2align 5
pj_loop_197:
    v_mfma_f32_16x16x32_bf16 v[64:67], v[16:19], a[0:3], 0
    ds_read_b128 v[40:43], v2 offset:48
    v_mfma_f32_16x16x32_bf16 v[68:71], v[16:19], a[4:7], 0
    s_add_u32 m0, s30, 0
    v_mfma_f32_16x16x32_bf16 v[72:75], v[16:19], a[8:11], 0
    buffer_load_dwordx4 v1, s[16:19], s28 offen offset:0 lds
    v_mfma_f32_16x16x32_bf16 v[76:79], v[16:19], a[12:15], 0
    s_waitcnt lgkmcnt(5)
    v_mfma_f32_16x16x32_bf16 v[80:83], v[20:23], a[0:3], 0
    ds_read_b128 v[44:47], v2 offset:8368
    v_mfma_f32_16x16x32_bf16 v[84:87], v[20:23], a[4:7], 0
    s_add_u32 m0, s30, 16
    v_cvt_pk_bf16_f32 v128, v96, v97
    v_cvt_pk_bf16_f32 v129, v98, v99
    v_mfma_f32_16x16x32_bf16 v[88:91], v[20:23], a[8:11], 0
    buffer_load_dwordx4 v1, s[16:19], s28 offen offset:1024 lds
    v_mfma_f32_16x16x32_bf16 v[92:95], v[20:23], a[12:15], 0
    s_waitcnt lgkmcnt(5)
    v_cvt_pk_bf16_f32 v130, v112, v113
    v_cvt_pk_bf16_f32 v131, v114, v115
    v_mfma_f32_16x16x32_bf16 v[64:67], v[24:27], a[16:19], v[64:67]
    ds_read_b128 v[16:19], v2 offset:64
    v_mfma_f32_16x16x32_bf16 v[68:71], v[24:27], a[20:23], v[68:71]
    s_add_u32 m0, s30, 32
    v_cvt_pk_bf16_f32 v132, v100, v101
    v_cvt_pk_bf16_f32 v133, v102, v103
    v_mfma_f32_16x16x32_bf16 v[72:75], v[24:27], a[24:27], v[72:75]
    buffer_load_dwordx4 v1, s[16:19], s28 offen offset:2048 lds
    v_mfma_f32_16x16x32_bf16 v[76:79], v[24:27], a[28:31], v[76:79]
    s_waitcnt lgkmcnt(5)
    v_cvt_pk_bf16_f32 v134, v116, v117
    v_cvt_pk_bf16_f32 v135, v118, v119
    v_mfma_f32_16x16x32_bf16 v[80:83], v[28:31], a[16:19], v[80:83]
    ds_read_b128 v[20:23], v2 offset:8384
    v_mfma_f32_16x16x32_bf16 v[84:87], v[28:31], a[20:23], v[84:87]
    s_add_u32 m0, s30, 48
    v_cvt_pk_bf16_f32 v136, v104, v105
    v_cvt_pk_bf16_f32 v137, v106, v107
    v_mfma_f32_16x16x32_bf16 v[88:91], v[28:31], a[24:27], v[88:91]
    buffer_load_dwordx4 v1, s[16:19], s28 offen offset:3072 lds
    v_mfma_f32_16x16x32_bf16 v[92:95], v[28:31], a[28:31], v[92:95]
    s_waitcnt lgkmcnt(5)
    v_cvt_pk_bf16_f32 v138, v120, v121
    v_cvt_pk_bf16_f32 v139, v122, v123
    v_mfma_f32_16x16x32_bf16 v[64:67], v[32:35], a[32:35], v[64:67]
    ds_read_b128 v[24:27], v2 offset:80
    v_mfma_f32_16x16x32_bf16 v[68:71], v[32:35], a[36:39], v[68:71]
    s_add_u32 s37, s28, 4096
    v_cvt_pk_bf16_f32 v140, v108, v109
    v_cvt_pk_bf16_f32 v141, v110, v111
    v_mfma_f32_16x16x32_bf16 v[72:75], v[32:35], a[40:43], v[72:75]
    v_mfma_f32_16x16x32_bf16 v[76:79], v[32:35], a[44:47], v[76:79]
    s_waitcnt lgkmcnt(5)
    v_cvt_pk_bf16_f32 v142, v124, v125
    v_cvt_pk_bf16_f32 v143, v126, v127
    v_mfma_f32_16x16x32_bf16 v[80:83], v[36:39], a[32:35], v[80:83]
    ds_read_b128 v[28:31], v2 offset:8400
    v_mfma_f32_16x16x32_bf16 v[84:87], v[36:39], a[36:39], v[84:87]
    s_add_u32 m0, s30, 4160
    v_mfma_f32_16x16x32_bf16 v[88:91], v[36:39], a[40:43], v[88:91]
    buffer_load_dwordx4 v1, s[16:19], s37 offen offset:0 lds
    v_mfma_f32_16x16x32_bf16 v[92:95], v[36:39], a[44:47], v[92:95]
    s_waitcnt lgkmcnt(5)
    v_mfma_f32_16x16x32_bf16 v[64:67], v[40:43], a[48:51], v[64:67]
    ds_read_b128 v[32:35], v2 offset:96
    v_mfma_f32_16x16x32_bf16 v[68:71], v[40:43], a[52:55], v[68:71]
    s_add_u32 m0, s30, 4176
    v_mfma_f32_16x16x32_bf16 v[72:75], v[40:43], a[56:59], v[72:75]
    buffer_load_dwordx4 v1, s[16:19], s37 offen offset:1024 lds
    v_mfma_f32_16x16x32_bf16 v[76:79], v[40:43], a[60:63], v[76:79]
    s_waitcnt lgkmcnt(5)
    v_mfma_f32_16x16x32_bf16 v[80:83], v[44:47], a[48:51], v[80:83]
    ds_read_b128 v[36:39], v2 offset:8416
    v_mfma_f32_16x16x32_bf16 v[84:87], v[44:47], a[52:55], v[84:87]
    s_add_u32 m0, s30, 4192
    v_mfma_f32_16x16x32_bf16 v[88:91], v[44:47], a[56:59], v[88:91]
    buffer_load_dwordx4 v1, s[16:19], s37 offen offset:2048 lds
    v_mfma_f32_16x16x32_bf16 v[92:95], v[44:47], a[60:63], v[92:95]
    s_waitcnt lgkmcnt(5)
    v_mfma_f32_16x16x32_bf16 v[64:67], v[16:19], a[64:67], v[64:67]
    ds_read_b128 v[40:43], v2 offset:112
    v_mfma_f32_16x16x32_bf16 v[68:71], v[16:19], a[68:71], v[68:71]
    s_add_u32 m0, s30, 4208
    v_mfma_f32_16x16x32_bf16 v[72:75], v[16:19], a[72:75], v[72:75]
    buffer_load_dwordx4 v1, s[16:19], s37 offen offset:3072 lds
    v_mfma_f32_16x16x32_bf16 v[76:79], v[16:19], a[76:79], v[76:79]
    s_waitcnt lgkmcnt(5)
    v_mfma_f32_16x16x32_bf16 v[80:83], v[20:23], a[64:67], v[80:83]
    ds_read_b128 v[44:47], v2 offset:8432
    v_mfma_f32_16x16x32_bf16 v[84:87], v[20:23], a[68:71], v[84:87]
    s_add_u32 s28, s28, s31
    v_mfma_f32_16x16x32_bf16 v[88:91], v[20:23], a[72:75], v[88:91]
    v_mfma_f32_16x16x32_bf16 v[92:95], v[20:23], a[76:79], v[92:95]
    s_waitcnt lgkmcnt(5)
    v_mfma_f32_16x16x32_bf16 v[64:67], v[24:27], a[80:83], v[64:67]
    ds_read_b128 v[16:19], v2 offset:128
    v_mfma_f32_16x16x32_bf16 v[68:71], v[24:27], a[84:87], v[68:71]
    s_add_u32 s30, s30, 33408
    v_mfma_f32_16x16x32_bf16 v[72:75], v[24:27], a[88:91], v[72:75]
    v_mfma_f32_16x16x32_bf16 v[76:79], v[24:27], a[92:95], v[76:79]
    s_waitcnt lgkmcnt(5)
    v_mfma_f32_16x16x32_bf16 v[80:83], v[28:31], a[80:83], v[80:83]
    s_cmp_ge_u32 s30, 133632
    ds_read_b128 v[20:23], v2 offset:8448
    v_mfma_f32_16x16x32_bf16 v[84:87], v[28:31], a[84:87], v[84:87]
    s_cselect_b32 s37, 133632, 0
    v_mfma_f32_16x16x32_bf16 v[88:91], v[28:31], a[88:91], v[88:91]
    s_sub_u32 s30, s30, s37
    v_mfma_f32_16x16x32_bf16 v[92:95], v[28:31], a[92:95], v[92:95]
    s_waitcnt lgkmcnt(5)
    v_mfma_f32_16x16x32_bf16 v[64:67], v[32:35], a[96:99], v[64:67]
    ds_read_b128 v[24:27], v2 offset:144
    v_mfma_f32_16x16x32_bf16 v[68:71], v[32:35], a[100:103], v[68:71]
    v_mfma_f32_16x16x32_bf16 v[72:75], v[32:35], a[104:107], v[72:75]
    buffer_store_dwordx4 v[128:131], v3, s[12:15], s29 offen offset:0 sc1
    v_mfma_f32_16x16x32_bf16 v[76:79], v[32:35], a[108:111], v[76:79]
    s_waitcnt lgkmcnt(5)
    v_mfma_f32_16x16x32_bf16 v[80:83], v[36:39], a[96:99], v[80:83]
    ds_read_b128 v[28:31], v2 offset:8464
    v_mfma_f32_16x16x32_bf16 v[84:87], v[36:39], a[100:103], v[84:87]
    v_mfma_f32_16x16x32_bf16 v[88:91], v[36:39], a[104:107], v[88:91]
    buffer_store_dwordx4 v[132:135], v3, s[12:15], s29 offen offset:128 sc1
    v_mfma_f32_16x16x32_bf16 v[92:95], v[36:39], a[108:111], v[92:95]
    s_waitcnt lgkmcnt(5)
    v_mfma_f32_16x16x32_bf16 v[64:67], v[40:43], a[112:115], v[64:67]
    ds_read_b128 v[32:35], v2 offset:160
    v_mfma_f32_16x16x32_bf16 v[68:71], v[40:43], a[116:119], v[68:71]
    v_mfma_f32_16x16x32_bf16 v[72:75], v[40:43], a[120:123], v[72:75]
    buffer_store_dwordx4 v[136:139], v3, s[12:15], s29 offen offset:2048 sc1
    v_mfma_f32_16x16x32_bf16 v[76:79], v[40:43], a[124:127], v[76:79]
    s_waitcnt lgkmcnt(5)
    v_mfma_f32_16x16x32_bf16 v[80:83], v[44:47], a[112:115], v[80:83]
    ds_read_b128 v[36:39], v2 offset:8480
    v_mfma_f32_16x16x32_bf16 v[84:87], v[44:47], a[116:119], v[84:87]
    v_mfma_f32_16x16x32_bf16 v[88:91], v[44:47], a[120:123], v[88:91]
    buffer_store_dwordx4 v[140:143], v3, s[12:15], s29 offen offset:2176 sc1
    v_mfma_f32_16x16x32_bf16 v[92:95], v[44:47], a[124:127], v[92:95]
    s_waitcnt lgkmcnt(5)
    v_mfma_f32_16x16x32_bf16 v[64:67], v[16:19], a[128:131], v[64:67]
    ds_read_b128 v[40:43], v2 offset:176
    v_mfma_f32_16x16x32_bf16 v[68:71], v[16:19], a[132:135], v[68:71]
    v_mfma_f32_16x16x32_bf16 v[72:75], v[16:19], a[136:139], v[72:75]
    v_mfma_f32_16x16x32_bf16 v[76:79], v[16:19], a[140:143], v[76:79]
    s_waitcnt lgkmcnt(5)
    v_mfma_f32_16x16x32_bf16 v[80:83], v[20:23], a[128:131], v[80:83]
    ds_read_b128 v[44:47], v2 offset:8496
    v_mfma_f32_16x16x32_bf16 v[84:87], v[20:23], a[132:135], v[84:87]
    v_mfma_f32_16x16x32_bf16 v[88:91], v[20:23], a[136:139], v[88:91]
    v_mfma_f32_16x16x32_bf16 v[92:95], v[20:23], a[140:143], v[92:95]
    s_waitcnt lgkmcnt(5)
    v_mfma_f32_16x16x32_bf16 v[64:67], v[24:27], a[144:147], v[64:67]
    ds_read_b128 v[16:19], v2 offset:192
    v_mfma_f32_16x16x32_bf16 v[68:71], v[24:27], a[148:151], v[68:71]
    v_mfma_f32_16x16x32_bf16 v[72:75], v[24:27], a[152:155], v[72:75]
    v_mfma_f32_16x16x32_bf16 v[76:79], v[24:27], a[156:159], v[76:79]
    s_waitcnt lgkmcnt(5)
    v_mfma_f32_16x16x32_bf16 v[80:83], v[28:31], a[144:147], v[80:83]
    ds_read_b128 v[20:23], v2 offset:8512
    v_mfma_f32_16x16x32_bf16 v[84:87], v[28:31], a[148:151], v[84:87]
    v_mfma_f32_16x16x32_bf16 v[88:91], v[28:31], a[152:155], v[88:91]
    v_mfma_f32_16x16x32_bf16 v[92:95], v[28:31], a[156:159], v[92:95]
    s_waitcnt lgkmcnt(5)
    v_mfma_f32_16x16x32_bf16 v[64:67], v[32:35], a[160:163], v[64:67]
    ds_read_b128 v[24:27], v2 offset:208
    v_mfma_f32_16x16x32_bf16 v[68:71], v[32:35], a[164:167], v[68:71]
    v_mfma_f32_16x16x32_bf16 v[72:75], v[32:35], a[168:171], v[72:75]
    v_mfma_f32_16x16x32_bf16 v[76:79], v[32:35], a[172:175], v[76:79]
    s_waitcnt lgkmcnt(5)
    v_mfma_f32_16x16x32_bf16 v[80:83], v[36:39], a[160:163], v[80:83]
    ds_read_b128 v[28:31], v2 offset:8528
    v_mfma_f32_16x16x32_bf16 v[84:87], v[36:39], a[164:167], v[84:87]
    v_mfma_f32_16x16x32_bf16 v[88:91], v[36:39], a[168:171], v[88:91]
    v_mfma_f32_16x16x32_bf16 v[92:95], v[36:39], a[172:175], v[92:95]
    s_waitcnt lgkmcnt(5)
    v_mfma_f32_16x16x32_bf16 v[64:67], v[40:43], a[176:179], v[64:67]
    s_mov_b32 s29, s24
    ds_read_b128 v[32:35], v2 offset:224
    v_mfma_f32_16x16x32_bf16 v[68:71], v[40:43], a[180:183], v[68:71]
    v_mfma_f32_16x16x32_bf16 v[72:75], v[40:43], a[184:187], v[72:75]
    v_mfma_f32_16x16x32_bf16 v[76:79], v[40:43], a[188:191], v[76:79]
    s_waitcnt lgkmcnt(5)
    v_mfma_f32_16x16x32_bf16 v[80:83], v[44:47], a[176:179], v[80:83]
    s_add_u32 s24, s24, s32
    ds_read_b128 v[36:39], v2 offset:8544
    v_mfma_f32_16x16x32_bf16 v[84:87], v[44:47], a[180:183], v[84:87]
    v_mfma_f32_16x16x32_bf16 v[88:91], v[44:47], a[184:187], v[88:91]
    v_mfma_f32_16x16x32_bf16 v[92:95], v[44:47], a[188:191], v[92:95]
    s_waitcnt lgkmcnt(5)
    v_mfma_f32_16x16x32_bf16 v[64:67], v[16:19], a[192:195], v[64:67]
    s_sub_u32 s41, s33, 1
    ds_read_b128 v[40:43], v2 offset:240
    v_mfma_f32_16x16x32_bf16 v[68:71], v[16:19], a[196:199], v[68:71]
    s_cmp_lt_u32 s33, 10
    v_mfma_f32_16x16x32_bf16 v[72:75], v[16:19], a[200:203], v[72:75]
    s_cbranch_scc1 pj_es_200
s_pj_eb_201:
    v_mfma_f32_16x16x32_bf16 v[76:79], v[16:19], a[204:207], v[76:79]
    s_waitcnt lgkmcnt(5)
    v_mfma_f32_16x16x32_bf16 v[80:83], v[20:23], a[192:195], v[80:83]
    s_add_u32 s41, s41, s34
    ds_read_b128 v[44:47], v2 offset:8560
    v_mfma_f32_16x16x32_bf16 v[84:87], v[20:23], a[196:199], v[84:87]
    v_mov_b32 v4, s41
    v_mfma_f32_16x16x32_bf16 v[88:91], v[20:23], a[200:203], v[88:91]
    s_waitcnt vmcnt(12)
    s_barrier
    v_mfma_f32_16x16x32_bf16 v[92:95], v[20:23], a[204:207], v[92:95]
    s_waitcnt lgkmcnt(5)
    v_mfma_f32_16x16x32_bf16 v[64:67], v[24:27], a[208:211], v[64:67]
    ds_read_b128 v[16:19], v2 offset:33408
    v_mfma_f32_16x16x32_bf16 v[68:71], v[24:27], a[212:215], v[68:71]
    v_mfma_f32_16x16x32_bf16 v[72:75], v[24:27], a[216:219], v[72:75]
    buffer_store_dword v4, off, s[12:15], s27 sc1
    v_mfma_f32_16x16x32_bf16 v[76:79], v[24:27], a[220:223], v[76:79]
    s_waitcnt lgkmcnt(5)
    v_mfma_f32_16x16x32_bf16 v[80:83], v[28:31], a[208:211], v[80:83]
    ds_read_b128 v[20:23], v2 offset:41728
    v_mfma_f32_16x16x32_bf16 v[84:87], v[28:31], a[212:215], v[84:87]
    v_mfma_f32_16x16x32_bf16 v[88:91], v[28:31], a[216:219], v[88:91]
    v_mfma_f32_16x16x32_bf16 v[92:95], v[28:31], a[220:223], v[92:95]
    s_waitcnt lgkmcnt(5)
    v_mfma_f32_16x16x32_bf16 v[64:67], v[32:35], a[224:227], v[64:67]
    ds_read_b128 v[24:27], v2 offset:33424
    v_mfma_f32_16x16x32_bf16 v[68:71], v[32:35], a[228:231], v[68:71]
    v_mfma_f32_16x16x32_bf16 v[72:75], v[32:35], a[232:235], v[72:75]
    v_mfma_f32_16x16x32_bf16 v[76:79], v[32:35], a[236:239], v[76:79]
    s_waitcnt lgkmcnt(5)
    v_mfma_f32_16x16x32_bf16 v[80:83], v[36:39], a[224:227], v[80:83]
    ds_read_b128 v[28:31], v2 offset:41744
    v_mfma_f32_16x16x32_bf16 v[84:87], v[36:39], a[228:231], v[84:87]
    v_mfma_f32_16x16x32_bf16 v[88:91], v[36:39], a[232:235], v[88:91]
    v_mfma_f32_16x16x32_bf16 v[92:95], v[36:39], a[236:239], v[92:95]
    s_waitcnt lgkmcnt(5)
    v_mfma_f32_16x16x32_bf16 v[64:67], v[40:43], a[240:243], v[64:67]
    s_add_u32 s33, s33, 1
    ds_read_b128 v[32:35], v2 offset:33440
    v_mfma_f32_16x16x32_bf16 v[68:71], v[40:43], a[244:247], v[68:71]
    v_mfma_f32_16x16x32_bf16 v[72:75], v[40:43], a[248:251], v[72:75]
    v_mfma_f32_16x16x32_bf16 v[76:79], v[40:43], a[252:255], v[76:79]
    s_waitcnt lgkmcnt(5)
    v_mfma_f32_16x16x32_bf16 v[80:83], v[44:47], a[240:243], v[80:83]
    s_cmp_ge_u32 s33, s23
    ds_read_b128 v[36:39], v2 offset:41760
    v_mfma_f32_16x16x32_bf16 v[84:87], v[44:47], a[244:247], v[84:87]
    v_mfma_f32_16x16x32_bf16 v[88:91], v[44:47], a[248:251], v[88:91]
    v_mfma_f32_16x16x32_bf16 v[92:95], v[44:47], a[252:255], v[92:95]
    s_waitcnt lgkmcnt(5)
    s_cbranch_scc1 pj_fin0_198
    v_mfma_f32_16x16x32_bf16 v[96:99], v[16:19], a[0:3], 0
    ds_read_b128 v[40:43], v2 offset:33456
    v_mfma_f32_16x16x32_bf16 v[100:103], v[16:19], a[4:7], 0
    s_add_u32 m0, s30, 0
    v_mfma_f32_16x16x32_bf16 v[104:107], v[16:19], a[8:11], 0
    buffer_load_dwordx4 v1, s[16:19], s28 offen offset:0 lds
    v_mfma_f32_16x16x32_bf16 v[108:111], v[16:19], a[12:15], 0
    s_waitcnt lgkmcnt(5)
    v_mfma_f32_16x16x32_bf16 v[112:115], v[20:23], a[0:3], 0
    ds_read_b128 v[44:47], v2 offset:41776
    v_mfma_f32_16x16x32_bf16 v[116:119], v[20:23], a[4:7], 0
    s_add_u32 m0, s30, 16
    v_cvt_pk_bf16_f32 v128, v64, v65
    v_cvt_pk_bf16_f32 v129, v66, v67
    v_mfma_f32_16x16x32_bf16 v[120:123], v[20:23], a[8:11], 0
    buffer_load_dwordx4 v1, s[16:19], s28 offen offset:1024 lds
    v_mfma_f32_16x16x32_bf16 v[124:127], v[20:23], a[12:15], 0
    s_waitcnt lgkmcnt(5)
    v_cvt_pk_bf16_f32 v130, v80, v81
    v_cvt_pk_bf16_f32 v131, v82, v83
    v_mfma_f32_16x16x32_bf16 v[96:99], v[24:27], a[16:19], v[96:99]
    ds_read_b128 v[16:19], v2 offset:33472
    v_mfma_f32_16x16x32_bf16 v[100:103], v[24:27], a[20:23], v[100:103]
    s_add_u32 m0, s30, 32
    v_cvt_pk_bf16_f32 v132, v68, v69
    v_cvt_pk_bf16_f32 v133, v70, v71
    v_mfma_f32_16x16x32_bf16 v[104:107], v[24:27], a[24:27], v[104:107]
    buffer_load_dwordx4 v1, s[16:19], s28 offen offset:2048 lds
    v_mfma_f32_16x16x32_bf16 v[108:111], v[24:27], a[28:31], v[108:111]
    s_waitcnt lgkmcnt(5)
    v_cvt_pk_bf16_f32 v134, v84, v85
    v_cvt_pk_bf16_f32 v135, v86, v87
    v_mfma_f32_16x16x32_bf16 v[112:115], v[28:31], a[16:19], v[112:115]
    ds_read_b128 v[20:23], v2 offset:41792
    v_mfma_f32_16x16x32_bf16 v[116:119], v[28:31], a[20:23], v[116:119]
    s_add_u32 m0, s30, 48
    v_cvt_pk_bf16_f32 v136, v72, v73
    v_cvt_pk_bf16_f32 v137, v74, v75
    v_mfma_f32_16x16x32_bf16 v[120:123], v[28:31], a[24:27], v[120:123]
    buffer_load_dwordx4 v1, s[16:19], s28 offen offset:3072 lds
    v_mfma_f32_16x16x32_bf16 v[124:127], v[28:31], a[28:31], v[124:127]
    s_waitcnt lgkmcnt(5)
    v_cvt_pk_bf16_f32 v138, v88, v89
    v_cvt_pk_bf16_f32 v139, v90, v91
    v_mfma_f32_16x16x32_bf16 v[96:99], v[32:35], a[32:35], v[96:99]
    ds_read_b128 v[24:27], v2 offset:33488
    v_mfma_f32_16x16x32_bf16 v[100:103], v[32:35], a[36:39], v[100:103]
    s_add_u32 s37, s28, 4096
    v_cvt_pk_bf16_f32 v140, v76, v77
    v_cvt_pk_bf16_f32 v141, v78, v79
    v_mfma_f32_16x16x32_bf16 v[104:107], v[32:35], a[40:43], v[104:107]
    v_mfma_f32_16x16x32_bf16 v[108:111], v[32:35], a[44:47], v[108:111]
    s_waitcnt lgkmcnt(5)
    v_cvt_pk_bf16_f32 v142, v92, v93
    v_cvt_pk_bf16_f32 v143, v94, v95
    v_mfma_f32_16x16x32_bf16 v[112:115], v[36:39], a[32:35], v[112:115]
    ds_read_b128 v[28:31], v2 offset:41808
    v_mfma_f32_16x16x32_bf16 v[116:119], v[36:39], a[36:39], v[116:119]
    s_add_u32 m0, s30, 4160
    v_mfma_f32_16x16x32_bf16 v[120:123], v[36:39], a[40:43], v[120:123]
    buffer_load_dwordx4 v1, s[16:19], s37 offen offset:0 lds
    v_mfma_f32_16x16x32_bf16 v[124:127], v[36:39], a[44:47], v[124:127]
    s_waitcnt lgkmcnt(5)
    v_mfma_f32_16x16x32_bf16 v[96:99], v[40:43], a[48:51], v[96:99]
    ds_read_b128 v[32:35], v2 offset:33504
    v_mfma_f32_16x16x32_bf16 v[100:103], v[40:43], a[52:55], v[100:103]
    s_add_u32 m0, s30, 4176
    v_mfma_f32_16x16x32_bf16 v[104:107], v[40:43], a[56:59], v[104:107]
    buffer_load_dwordx4 v1, s[16:19], s37 offen offset:1024 lds
    v_mfma_f32_16x16x32_bf16 v[108:111], v[40:43], a[60:63], v[108:111]
    s_waitcnt lgkmcnt(5)
    v_mfma_f32_16x16x32_bf16 v[112:115], v[44:47], a[48:51], v[112:115]
    ds_read_b128 v[36:39], v2 offset:41824
    v_mfma_f32_16x16x32_bf16 v[116:119], v[44:47], a[52:55], v[116:119]
    s_add_u32 m0, s30, 4192
    v_mfma_f32_16x16x32_bf16 v[120:123], v[44:47], a[56:59], v[120:123]
    buffer_load_dwordx4 v1, s[16:19], s37 offen offset:2048 lds
    v_mfma_f32_16x16x32_bf16 v[124:127], v[44:47], a[60:63], v[124:127]
    s_waitcnt lgkmcnt(5)
    v_mfma_f32_16x16x32_bf16 v[96:99], v[16:19], a[64:67], v[96:99]
    ds_read_b128 v[40:43], v2 offset:33520
    v_mfma_f32_16x16x32_bf16 v[100:103], v[16:19], a[68:71], v[100:103]
    s_add_u32 m0, s30, 4208
    v_mfma_f32_16x16x32_bf16 v[104:107], v[16:19], a[72:75], v[104:107]
    buffer_load_dwordx4 v1, s[16:19], s37 offen offset:3072 lds
    v_mfma_f32_16x16x32_bf16 v[108:111], v[16:19], a[76:79], v[108:111]
    s_waitcnt lgkmcnt(5)
    v_mfma_f32_16x16x32_bf16 v[112:115], v[20:23], a[64:67], v[112:115]
    ds_read_b128 v[44:47], v2 offset:41840
    v_mfma_f32_16x16x32_bf16 v[116:119], v[20:23], a[68:71], v[116:119]
    s_add_u32 s28, s28, s31
    v_mfma_f32_16x16x32_bf16 v[120:123], v[20:23], a[72:75], v[120:123]
    v_mfma_f32_16x16x32_bf16 v[124:127], v[20:23], a[76:79], v[124:127]
    s_waitcnt lgkmcnt(5)
    v_mfma_f32_16x16x32_bf16 v[96:99], v[24:27], a[80:83], v[96:99]
    ds_read_b128 v[16:19], v2 offset:33536
    v_mfma_f32_16x16x32_bf16 v[100:103], v[24:27], a[84:87], v[100:103]
    s_add_u32 s30, s30, 33408
    v_mfma_f32_16x16x32_bf16 v[104:107], v[24:27], a[88:91], v[104:107]
    v_mfma_f32_16x16x32_bf16 v[108:111], v[24:27], a[92:95], v[108:111]
    s_waitcnt lgkmcnt(5)
    v_mfma_f32_16x16x32_bf16 v[112:115], v[28:31], a[80:83], v[112:115]
    s_cmp_ge_u32 s30, 133632
    ds_read_b128 v[20:23], v2 offset:41856
    v_mfma_f32_16x16x32_bf16 v[116:119], v[28:31], a[84:87], v[116:119]
    s_cselect_b32 s37, 133632, 0
    v_mfma_f32_16x16x32_bf16 v[120:123], v[28:31], a[88:91], v[120:123]
    s_sub_u32 s30, s30, s37
    v_mfma_f32_16x16x32_bf16 v[124:127], v[28:31], a[92:95], v[124:127]
    s_waitcnt lgkmcnt(5)
    v_mfma_f32_16x16x32_bf16 v[96:99], v[32:35], a[96:99], v[96:99]
    ds_read_b128 v[24:27], v2 offset:33552
    v_mfma_f32_16x16x32_bf16 v[100:103], v[32:35], a[100:103], v[100:103]
    v_mfma_f32_16x16x32_bf16 v[104:107], v[32:35], a[104:107], v[104:107]
    buffer_store_dwordx4 v[128:131], v3, s[12:15], s29 offen offset:0 sc1
    v_mfma_f32_16x16x32_bf16 v[108:111], v[32:35], a[108:111], v[108:111]
    s_waitcnt lgkmcnt(5)
    v_mfma_f32_16x16x32_bf16 v[112:115], v[36:39], a[96:99], v[112:115]
    ds_read_b128 v[28:31], v2 offset:41872
    v_mfma_f32_16x16x32_bf16 v[116:119], v[36:39], a[100:103], v[116:119]
    v_mfma_f32_16x16x32_bf16 v[120:123], v[36:39], a[104:107], v[120:123]
    buffer_store_dwordx4 v[132:135], v3, s[12:15], s29 offen offset:128 sc1
    v_mfma_f32_16x16x32_bf16 v[124:127], v[36:39], a[108:111], v[124:127]
    s_waitcnt lgkmcnt(5)
    v_mfma_f32_16x16x32_bf16 v[96:99], v[40:43], a[112:115], v[96:99]
    ds_read_b128 v[32:35], v2 offset:33568
    v_mfma_f32_16x16x32_bf16 v[100:103], v[40:43], a[116:119], v[100:103]
    v_mfma_f32_16x16x32_bf16 v[104:107], v[40:43], a[120:123], v[104:107]
    buffer_store_dwordx4 v[136:139], v3, s[12:15], s29 offen offset:2048 sc1
    v_mfma_f32_16x16x32_bf16 v[108:111], v[40:43], a[124:127], v[108:111]
    s_waitcnt lgkmcnt(5)
    v_mfma_f32_16x16x32_bf16 v[112:115], v[44:47], a[112:115], v[112:115]
    ds_read_b128 v[36:39], v2 offset:41888
    v_mfma_f32_16x16x32_bf16 v[116:119], v[44:47], a[116:119], v[116:119]
    v_mfma_f32_16x16x32_bf16 v[120:123], v[44:47], a[120:123], v[120:123]
    buffer_store_dwordx4 v[140:143], v3, s[12:15], s29 offen offset:2176 sc1
    v_mfma_f32_16x16x32_bf16 v[124:127], v[44:47], a[124:127], v[124:127]
    s_waitcnt lgkmcnt(5)
    v_mfma_f32_16x16x32_bf16 v[96:99], v[16:19], a[128:131], v[96:99]
    ds_read_b128 v[40:43], v2 offset:33584
    v_mfma_f32_16x16x32_bf16 v[100:103], v[16:19], a[132:135], v[100:103]
    v_mfma_f32_16x16x32_bf16 v[104:107], v[16:19], a[136:139], v[104:107]
    v_mfma_f32_16x16x32_bf16 v[108:111], v[16:19], a[140:143], v[108:111]
    s_waitcnt lgkmcnt(5)
    v_mfma_f32_16x16x32_bf16 v[112:115], v[20:23], a[128:131], v[112:115]
    ds_read_b128 v[44:47], v2 offset:41904
    v_mfma_f32_16x16x32_bf16 v[116:119], v[20:23], a[132:135], v[116:119]
    v_mfma_f32_16x16x32_bf16 v[120:123], v[20:23], a[136:139], v[120:123]
    v_mfma_f32_16x16x32_bf16 v[124:127], v[20:23], a[140:143], v[124:127]
    s_waitcnt lgkmcnt(5)
    v_mfma_f32_16x16x32_bf16 v[96:99], v[24:27], a[144:147], v[96:99]
    ds_read_b128 v[16:19], v2 offset:33600
    v_mfma_f32_16x16x32_bf16 v[100:103], v[24:27], a[148:151], v[100:103]
    v_mfma_f32_16x16x32_bf16 v[104:107], v[24:27], a[152:155], v[104:107]
    v_mfma_f32_16x16x32_bf16 v[108:111], v[24:27], a[156:159], v[108:111]
    s_waitcnt lgkmcnt(5)
    v_mfma_f32_16x16x32_bf16 v[112:115], v[28:31], a[144:147], v[112:115]
    ds_read_b128 v[20:23], v2 offset:41920
    v_mfma_f32_16x16x32_bf16 v[116:119], v[28:31], a[148:151], v[116:119]
    v_mfma_f32_16x16x32_bf16 v[120:123], v[28:31], a[152:155], v[120:123]
    v_mfma_f32_16x16x32_bf16 v[124:127], v[28:31], a[156:159], v[124:127]
    s_waitcnt lgkmcnt(5)
    v_mfma_f32_16x16x32_bf16 v[96:99], v[32:35], a[160:163], v[96:99]
    ds_read_b128 v[24:27], v2 offset:33616
    v_mfma_f32_16x16x32_bf16 v[100:103], v[32:35], a[164:167], v[100:103]
    v_mfma_f32_16x16x32_bf16 v[104:107], v[32:35], a[168:171], v[104:107]
    v_mfma_f32_16x16x32_bf16 v[108:111], v[32:35], a[172:175], v[108:111]
    s_waitcnt lgkmcnt(5)
    v_mfma_f32_16x16x32_bf16 v[112:115], v[36:39], a[160:163], v[112:115]
    ds_read_b128 v[28:31], v2 offset:41936
    v_mfma_f32_16x16x32_bf16 v[116:119], v[36:39], a[164:167], v[116:119]
    v_mfma_f32_16x16x32_bf16 v[120:123], v[36:39], a[168:171], v[120:123]
    v_mfma_f32_16x16x32_bf16 v[124:127], v[36:39], a[172:175], v[124:127]
    s_waitcnt lgkmcnt(5)
    v_mfma_f32_16x16x32_bf16 v[96:99], v[40:43], a[176:179], v[96:99]
    s_mov_b32 s29, s24
    ds_read_b128 v[32:35], v2 offset:33632
    v_mfma_f32_16x16x32_bf16 v[100:103], v[40:43], a[180:183], v[100:103]
    v_mfma_f32_16x16x32_bf16 v[104:107], v[40:43], a[184:187], v[104:107]
    v_mfma_f32_16x16x32_bf16 v[108:111], v[40:43], a[188:191], v[108:111]
    s_waitcnt lgkmcnt(5)
    v_mfma_f32_16x16x32_bf16 v[112:115], v[44:47], a[176:179], v[112:115]
    s_add_u32 s24, s24, s32
    ds_read_b128 v[36:39], v2 offset:41952
    v_mfma_f32_16x16x32_bf16 v[116:119], v[44:47], a[180:183], v[116:119]
    s_nop 0
    v_mfma_f32_16x16x32_bf16 v[120:123], v[44:47], a[184:187], v[120:123]
    s_nop 0
    v_mfma_f32_16x16x32_bf16 v[124:127], v[44:47], a[188:191], v[124:127]
    s_waitcnt lgkmcnt(5)
    v_mfma_f32_16x16x32_bf16 v[96:99], v[16:19], a[192:195], v[96:99]
    s_sub_u32 s41, s33, 1
    ds_read_b128 v[40:43], v2 offset:33648
    v_mfma_f32_16x16x32_bf16 v[100:103], v[16:19], a[196:199], v[100:103]
    s_cmp_lt_u32 s33, 10
    v_mfma_f32_16x16x32_bf16 v[104:107], v[16:19], a[200:203], v[104:107]
    s_cbranch_scc1 pj_es_202
s_pj_eb_203:
    v_mfma_f32_16x16x32_bf16 v[108:111], v[16:19], a[204:207], v[108:111]
    s_waitcnt lgkmcnt(5)
    v_mfma_f32_16x16x32_bf16 v[112:115], v[20:23], a[192:195], v[112:115]
    s_add_u32 s41, s41, s34
    ds_read_b128 v[44:47], v2 offset:41968
    v_mfma_f32_16x16x32_bf16 v[116:119], v[20:23], a[196:199], v[116:119]
    v_add_u32 v2, s40, v2
    v_mov_b32 v4, s41
    v_mfma_f32_16x16x32_bf16 v[120:123], v[20:23], a[200:203], v[120:123]
    s_waitcnt vmcnt(12)
    s_barrier
    v_mfma_f32_16x16x32_bf16 v[124:127], v[20:23], a[204:207], v[124:127]
    s_waitcnt lgkmcnt(5)
    v_mfma_f32_16x16x32_bf16 v[96:99], v[24:27], a[208:211], v[96:99]
    ds_read_b128 v[16:19], v2 offset:0
    v_mfma_f32_16x16x32_bf16 v[100:103], v[24:27], a[212:215], v[100:103]
    v_mfma_f32_16x16x32_bf16 v[104:107], v[24:27], a[216:219], v[104:107]
    buffer_store_dword v4, off, s[12:15], s27 sc1
    v_mfma_f32_16x16x32_bf16 v[108:111], v[24:27], a[220:223], v[108:111]
    s_waitcnt lgkmcnt(5)
    v_mfma_f32_16x16x32_bf16 v[112:115], v[28:31], a[208:211], v[112:115]
    ds_read_b128 v[20:23], v2 offset:8320
    v_mfma_f32_16x16x32_bf16 v[116:119], v[28:31], a[212:215], v[116:119]
    v_mfma_f32_16x16x32_bf16 v[120:123], v[28:31], a[216:219], v[120:123]
    v_mfma_f32_16x16x32_bf16 v[124:127], v[28:31], a[220:223], v[124:127]
    s_waitcnt lgkmcnt(5)
    v_mfma_f32_16x16x32_bf16 v[96:99], v[32:35], a[224:227], v[96:99]
    s_sub_u32 s40, 0, s40
    ds_read_b128 v[24:27], v2 offset:16
    v_mfma_f32_16x16x32_bf16 v[100:103], v[32:35], a[228:231], v[100:103]
    v_mfma_f32_16x16x32_bf16 v[104:107], v[32:35], a[232:235], v[104:107]
    v_mfma_f32_16x16x32_bf16 v[108:111], v[32:35], a[236:239], v[108:111]
    s_waitcnt lgkmcnt(5)
    v_mfma_f32_16x16x32_bf16 v[112:115], v[36:39], a[224:227], v[112:115]
    ds_read_b128 v[28:31], v2 offset:8336
    v_mfma_f32_16x16x32_bf16 v[116:119], v[36:39], a[228:231], v[116:119]
    v_mfma_f32_16x16x32_bf16 v[120:123], v[36:39], a[232:235], v[120:123]
    v_mfma_f32_16x16x32_bf16 v[124:127], v[36:39], a[236:239], v[124:127]
    s_waitcnt lgkmcnt(5)
    v_mfma_f32_16x16x32_bf16 v[96:99], v[40:43], a[240:243], v[96:99]
    s_add_u32 s33, s33, 1
    ds_read_b128 v[32:35], v2 offset:32
    v_mfma_f32_16x16x32_bf16 v[100:103], v[40:43], a[244:247], v[100:103]
    v_mfma_f32_16x16x32_bf16 v[104:107], v[40:43], a[248:251], v[104:107]
    v_mfma_f32_16x16x32_bf16 v[108:111], v[40:43], a[252:255], v[108:111]
    s_waitcnt lgkmcnt(5)
    v_mfma_f32_16x16x32_bf16 v[112:115], v[44:47], a[240:243], v[112:115]
    s_cmp_ge_u32 s33, s23
    ds_read_b128 v[36:39], v2 offset:8352
    v_mfma_f32_16x16x32_bf16 v[116:119], v[44:47], a[244:247], v[116:119]
    v_mfma_f32_16x16x32_bf16 v[120:123], v[44:47], a[248:251], v[120:123]
    v_mfma_f32_16x16x32_bf16 v[124:127], v[44:47], a[252:255], v[124:127]
    s_waitcnt lgkmcnt(5)
    s_cbranch_scc0 pj_loop_197
pj_fin1_199:
    v_cvt_pk_bf16_f32 v128, v96, v97
    v_cvt_pk_bf16_f32 v129, v98, v99
    v_cvt_pk_bf16_f32 v130, v112, v113
    v_cvt_pk_bf16_f32 v131, v114, v115
    buffer_store_dwordx4 v[128:131], v3, s[12:15], s29 offen offset:0 sc1
    v_cvt_pk_bf16_f32 v132, v100, v101
    v_cvt_pk_bf16_f32 v133, v102, v103
    v_cvt_pk_bf16_f32 v134, v116, v117
    v_cvt_pk_bf16_f32 v135, v118, v119
    buffer_store_dwordx4 v[132:135], v3, s[12:15], s29 offen offset:128 sc1
    v_cvt_pk_bf16_f32 v136, v104, v105
    v_cvt_pk_bf16_f32 v137, v106, v107
    v_cvt_pk_bf16_f32 v138, v120, v121
    v_cvt_pk_bf16_f32 v139, v122, v123
    buffer_store_dwordx4 v[136:139], v3, s[12:15], s29 offen offset:2048 sc1
    v_cvt_pk_bf16_f32 v140, v108, v109
    v_cvt_pk_bf16_f32 v141, v110, v111
    v_cvt_pk_bf16_f32 v142, v124, v125
    v_cvt_pk_bf16_f32 v143, v126, v127
    buffer_store_dwordx4 v[140:143], v3, s[12:15], s29 offen offset:2176 sc1
    s_branch pj_end_189
pj_es_200:
    s_waitcnt vmcnt(0)
    s_mov_b32 s41, s33
    s_branch s_pj_eb_201
pj_es_202:
    s_waitcnt vmcnt(0)
    s_mov_b32 s41, s33
    s_branch s_pj_eb_203
pj_fin0_198:
    v_cvt_pk_bf16_f32 v128, v64, v65
    v_cvt_pk_bf16_f32 v129, v66, v67
    v_cvt_pk_bf16_f32 v130, v80, v81
    v_cvt_pk_bf16_f32 v131, v82, v83
    buffer_store_dwordx4 v[128:131], v3, s[12:15], s29 offen offset:0 sc1
    v_cvt_pk_bf16_f32 v132, v68, v69
    v_cvt_pk_bf16_f32 v133, v70, v71
    v_cvt_pk_bf16_f32 v134, v84, v85
    v_cvt_pk_bf16_f32 v135, v86, v87
    buffer_store_dwordx4 v[132:135], v3, s[12:15], s29 offen offset:128 sc1
    v_cvt_pk_bf16_f32 v136, v72, v73
    v_cvt_pk_bf16_f32 v137, v74, v75
    v_cvt_pk_bf16_f32 v138, v88, v89
    v_cvt_pk_bf16_f32 v139, v90, v91
    buffer_store_dwordx4 v[136:139], v3, s[12:15], s29 offen offset:2048 sc1
    v_cvt_pk_bf16_f32 v140, v76, v77
    v_cvt_pk_bf16_f32 v141, v78, v79
    v_cvt_pk_bf16_f32 v142, v92, v93
    v_cvt_pk_bf16_f32 v143, v94, v95
    buffer_store_dwordx4 v[140:143], v3, s[12:15], s29 offen offset:2176 sc1
pj_end_189:
    s_waitcnt vmcnt(0) lgkmcnt(0)
    s_barrier
    s_add_u32 s41, s23, s34
    v_mov_b32 v4, s41
    buffer_store_dword v4, off, s[12:15], s27 sc1
    s_cmp_eq_u32 s6, 1
    s_cbranch_scc1 mn_aa
    s_lshr_b32 s60, s5, 4
    s_cmp_eq_u32 s60, 6
    s_cbranch_scc1 mn_x3
    s_cmp_eq_u32 s6, 2
    s_cselect_b32 s57, 256, 0
    s_add_u32 s57, s57, 146817024
    s_mov_b32 s59, s7
    s_cmp_eq_u32 s6, 2
    s_cbranch_scc1 mn_og
    s_cmp_lt_u32 s6, 4
    s_cbranch_scc1 mn_next
    s_bfe_u32 s60, s5, 0x10006
    s_mul_i32 s61, s60, 56
    s_add_u32 s61, s61, 40
    s_load_dwordx2 s[42:43], s[0:1], s61
    s_and_b32 s59, s5, 63
    s_lshl_b32 s59, s59, 2
    s_add_u32 s59, s59, s4
    s_waitcnt lgkmcnt(0)
    s_mov_b32 s8, s42
    s_mov_b32 s9, s43
    s_mov_b32 s10, 0x400000
    s_mov_b32 s11, 0x00020000
    s_lshl_b32 s58, s60, 22
    s_add_u32 s58, s58, 150994944
    v_lshlrev_b32 v1, 4, v0
    s_mul_i32 s38, s4, 17408
    s_lshl_b32 s40, s59, 14
    s_add_u32 s39, s40, 0
    s_add_u32 m0, s38, 0
    s_nop 0
    buffer_load_dwordx4 v1, s[8:11], s39 offen offset:0  lds
    s_add_u32 m0, s38, 64
    s_nop 0
    buffer_load_dwordx4 v1, s[8:11], s39 offen offset:1024  lds
    s_add_u32 m0, s38, 128
    s_nop 0
    buffer_load_dwordx4 v1, s[8:11], s39 offen offset:2048  lds
    s_add_u32 m0, s38, 192
    s_nop 0
    buffer_load_dwordx4 v1, s[8:11], s39 offen offset:3072  lds
    s_add_u32 s39, s40, 4096
    s_add_u32 m0, s38, 4352
    s_nop 0
    buffer_load_dwordx4 v1, s[8:11], s39 offen offset:0  lds
    s_add_u32 m0, s38, 4416
    s_nop 0
    buffer_load_dwordx4 v1, s[8:11], s39 offen offset:1024  lds
    s_add_u32 m0, s38, 4480
    s_nop 0
    buffer_load_dwordx4 v1, s[8:11], s39 offen offset:2048  lds
    s_add_u32 m0, s38, 4544
    s_nop 0
    buffer_load_dwordx4 v1, s[8:11], s39 offen offset:3072  lds
    s_add_u32 s39, s40, 8192
    s_add_u32 m0, s38, 8704
    s_nop 0
    buffer_load_dwordx4 v1, s[8:11], s39 offen offset:0  lds
    s_add_u32 m0, s38, 8768
    s_nop 0
    buffer_load_dwordx4 v1, s[8:11], s39 offen offset:1024  lds
    s_add_u32 m0, s38, 8832
    s_nop 0
    buffer_load_dwordx4 v1, s[8:11], s39 offen offset:2048  lds
    s_add_u32 m0, s38, 8896
    s_nop 0
    buffer_load_dwordx4 v1, s[8:11], s39 offen offset:3072  lds
    s_add_u32 s39, s40, 12288
    s_add_u32 m0, s38, 13056
    s_nop 0
    buffer_load_dwordx4 v1, s[8:11], s39 offen offset:0  lds
    s_add_u32 m0, s38, 13120
    s_nop 0
    buffer_load_dwordx4 v1, s[8:11], s39 offen offset:1024  lds
    s_add_u32 m0, s38, 13184
    s_nop 0
    buffer_load_dwordx4 v1, s[8:11], s39 offen offset:2048  lds
    s_add_u32 m0, s38, 13248
    s_nop 0
    buffer_load_dwordx4 v1, s[8:11], s39 offen offset:3072  lds
    v_lshrrev_b32 v5, 5, v0
    v_lshlrev_b32 v5, 2, v5
    v_bfe_u32 v6, v0, 2, 2
    v_add_u32 v5, v5, v6
    v_mul_u32_u24 v7, 1088, v5
    v_bfe_u32 v5, v0, 4, 1
    v_lshlrev_b32 v6, 5, v5
    v_bfe_u32 v5, v0, 0, 2
    v_lshl_add_u32 v6, v5, 3, v6
    v_add3_u32 v7, v7, v6, s38
    s_lshl_b32 s41, s59, 12
    s_add_u32 s41, s41, s58
    s_waitcnt vmcnt(0)
    ds_read_b64_tr_b16 v[128:129], v7 offset:0
    ds_read_b64_tr_b16 v[130:131], v7 offset:8704
    ds_read_b64_tr_b16 v[132:133], v7 offset:64
    ds_read_b64_tr_b16 v[134:135], v7 offset:8768
    ds_read_b64_tr_b16 v[136:137], v7 offset:128
    ds_read_b64_tr_b16 v[138:139], v7 offset:8832
    ds_read_b64_tr_b16 v[140:141], v7 offset:192
    ds_read_b64_tr_b16 v[142:143], v7 offset:8896
    ds_read_b64_tr_b16 v[144:145], v7 offset:256
    ds_read_b64_tr_b16 v[146:147], v7 offset:8960
    ds_read_b64_tr_b16 v[148:149], v7 offset:320
    ds_read_b64_tr_b16 v[150:151], v7 offset:9024
    ds_read_b64_tr_b16 v[152:153], v7 offset:384
    ds_read_b64_tr_b16 v[154:155], v7 offset:9088
    ds_read_b64_tr_b16 v[156:157], v7 offset:448
    ds_read_b64_tr_b16 v[158:159], v7 offset:9152
    ds_read_b64_tr_b16 v[160:161], v7 offset:512
    ds_read_b64_tr_b16 v[162:163], v7 offset:9216
    ds_read_b64_tr_b16 v[164:165], v7 offset:576
    ds_read_b64_tr_b16 v[166:167], v7 offset:9280
    ds_read_b64_tr_b16 v[168:169], v7 offset:640
    ds_read_b64_tr_b16 v[170:171], v7 offset:9344
    ds_read_b64_tr_b16 v[172:173], v7 offset:704
    ds_read_b64_tr_b16 v[174:175], v7 offset:9408
    ds_read_b64_tr_b16 v[176:177], v7 offset:768
    ds_read_b64_tr_b16 v[178:179], v7 offset:9472
    ds_read_b64_tr_b16 v[180:181], v7 offset:832
    ds_read_b64_tr_b16 v[182:183], v7 offset:9536
    ds_read_b64_tr_b16 v[184:185], v7 offset:896
    ds_read_b64_tr_b16 v[186:187], v7 offset:9600
    ds_read_b64_tr_b16 v[188:189], v7 offset:960
    ds_read_b64_tr_b16 v[190:191], v7 offset:9664
    s_waitcnt lgkmcnt(0)
    s_add_u32 s39, s41, 0
    buffer_store_dwordx4 v[128:131], v1, s[12:15], s39 offen offset:0 sc1
    buffer_store_dwordx4 v[132:135], v1, s[12:15], s39 offen offset:1024 sc1
    buffer_store_dwordx4 v[136:139], v1, s[12:15], s39 offen offset:2048 sc1
    buffer_store_dwordx4 v[140:143], v1, s[12:15], s39 offen offset:3072 sc1
    s_add_u32 s39, s41, 1048576
    buffer_store_dwordx4 v[144:147], v1, s[12:15], s39 offen offset:0 sc1
    buffer_store_dwordx4 v[148:151], v1, s[12:15], s39 offen offset:1024 sc1
    buffer_store_dwordx4 v[152:155], v1, s[12:15], s39 offen offset:2048 sc1
    buffer_store_dwordx4 v[156:159], v1, s[12:15], s39 offen offset:3072 sc1
    s_add_u32 s39, s41, 2097152
    buffer_store_dwordx4 v[160:163], v1, s[12:15], s39 offen offset:0 sc1
    buffer_store_dwordx4 v[164:167], v1, s[12:15], s39 offen offset:1024 sc1
    buffer_store_dwordx4 v[168:171], v1, s[12:15], s39 offen offset:2048 sc1
    buffer_store_dwordx4 v[172:175], v1, s[12:15], s39 offen offset:3072 sc1
    s_add_u32 s39, s41, 3145728
    buffer_store_dwordx4 v[176:179], v1, s[12:15], s39 offen offset:0 sc1
    buffer_store_dwordx4 v[180:183], v1, s[12:15], s39 offen offset:1024 sc1
    buffer_store_dwordx4 v[184:187], v1, s[12:15], s39 offen offset:2048 sc1
    buffer_store_dwordx4 v[188:191], v1, s[12:15], s39 offen offset:3072 sc1
    s_waitcnt vmcnt(0)
    s_barrier
    s_sub_u32 s60, s5, 128
    s_lshl_b32 s60, s60, 2
    s_add_u32 s60, s60, 146818048
    v_mov_b32 v4, 1
    buffer_store_dword v4, off, s[12:15], s60 sc1
    s_sub_u32 s60, s6, 4
    s_lshl_b32 s60, s60, 3
    s_and_b32 s61, s7, 7
    s_add_u32 s20, s60, s61
    s_lshr_b32 s61, s7, 3
    s_sub_u32 s21, 7, s61
    s_branch mn_att
mn_next:
    s_cmp_lg_u32 s4, 0
    s_cbranch_scc1 mn_tk1
    v_mov_b32 v4, 1
    v_mov_b32 v5, 0
    s_mov_b64 exec, 1
    buffer_atomic_add v4, off, s[12:15], s57 sc0
    s_waitcnt vmcnt(0)
    ds_write_b32 v5, v4
    s_mov_b64 exec, -1
    s_waitcnt lgkmcnt(0)
mn_tk1:
    s_barrier
    v_mov_b32_e64 v5, 0
    ds_read_b32 v4, v5
    s_sub_u32 s56, 7, s6
    s_min_u32 s56, s56, 4
    s_waitcnt lgkmcnt(0)
    v_readfirstlane_b32 s59, v4
    s_barrier
mn_have:
    s_cmp_lg_u32 s57, 146817024
    s_cbranch_scc1 mn_og
    s_cmp_lt_u32 s59, 128
    s_cbranch_scc1 mn_small
    s_cmp_eq_u32 s6, 3
    s_cbranch_scc1 mn_x3
    s_lshl_b32 s57, s6, 7
    s_add_u32 s57, s57, 146817024
    s_branch mn_next
mn_small:
    s_cmp_eq_u32 s6, 2
    s_cselect_b32 s60, 256, 0
    s_add_u32 s57, s57, s60
    s_and_b32 s20, s59, 31
    s_lshr_b32 s60, s59, 5
    s_sub_u32 s21, 3, s60
mn_att:
    s_lshl_b32 s60, s20, 4
    s_add_u32 s60, s60, 146810880
    s_lshr_b32 s61, s20, 1
    s_lshl_b32 s61, s61, 4
    s_add_u32 s61, s61, 146811392
    s_lshl_b32 s52, s21, 3
    s_sub_u32 s53, 66, s52
    s_mul_i32 s53, s53, 171
    s_lshr_b32 s53, s53, 9
    s_sub_u32 s54, 65, s52
    s_mul_i32 s54, s54, 171
    s_lshr_b32 s54, s54, 9
    s_sub_u32 s55, 64, s52
    s_mul_i32 s55, s55, 171
    s_lshr_b32 s55, s55, 9
    s_mov_b32 s63, 0
sp_204:
    buffer_load_dwordx4 v[4:7], off, s[12:15], s60 sc1
    buffer_load_dwordx4 v[8:11], off, s[12:15], s61 sc1
    s_waitcnt vmcnt(0)
    v_add3_u32 v4, v4, v5, v6
    v_add_u32 v4, v4, v7
    v_subrev_u32 v4, 64, v4
    v_subrev_u32 v8, s53, v8
    v_subrev_u32 v9, s54, v9
    v_subrev_u32 v10, s55, v10
    v_or3_b32 v4, v4, v8, v9
    v_or_b32 v4, v4, v10
    s_nop 0
    v_readfirstlane_b32 s62, v4
    s_nop 0
    s_cmp_ge_i32 s62, 0
    s_cbranch_scc1 spd_205
    s_add_u32 s63, s63, 1
    s_sleep 8
    s_cmp_lt_u32 s63, 32768
    s_cbranch_scc1 sp_204
spd_205:
    v_lshlrev_b32 v1, 4, v0
    v_and_b32 v3, 31, v0
    v_lshrrev_b32 v4, 5, v0
    v_lshlrev_b32_e64 v4, 2, v4
    v_sub_u32_e64 v3, v3, v4
    s_mov_b32 s27, 0x4b800000
    s_mov_b32 s28, 0xff800000
    s_mov_b32 s32, 0
at_top_206:
    v_mov_b32_e64 v2, v1
    s_lshl_b32 s23, s21, 2
    s_add_u32 s22, s23, s4
    s_add_u32 s22, s22, 1
    s_add_u32 s23, s23, 4
    s_lshl_b32 s36, s20, 19
    s_lshl_b32 s37, s4, 11
    s_add_u32 m0, s37, 106496
    s_add_u32 s38, s36, s37
    s_add_u32 s38, s38, 67108864
    buffer_load_dwordx4 v1, s[12:15], s38 offen sc1 lds
    buffer_load_dwordx4 v1, s[12:15], s38 offen offset:1024 sc1 lds
    s_lshl_b32 s37, s21, 16
    s_lshl_b32 s38, s4, 14
    s_add_u32 s37, s37, s38
    s_add_u32 s37, s37, s36
    s_add_u32 s37, s37, 50331648
    buffer_load_dwordx4 a[0:3], v1, s[12:15], s37 offen offset:0 sc1
    buffer_load_dwordx4 a[4:7], v1, s[12:15], s37 offen offset:1024 sc1
    buffer_load_dwordx4 a[8:11], v1, s[12:15], s37 offen offset:2048 sc1
    buffer_load_dwordx4 a[12:15], v1, s[12:15], s37 offen offset:3072 sc1
    s_add_u32 s37, s37, 4096
    buffer_load_dwordx4 a[16:19], v1, s[12:15], s37 offen offset:0 sc1
    buffer_load_dwordx4 a[20:23], v1, s[12:15], s37 offen offset:1024 sc1
    buffer_load_dwordx4 a[24:27], v1, s[12:15], s37 offen offset:2048 sc1
    buffer_load_dwordx4 a[28:31], v1, s[12:15], s37 offen offset:3072 sc1
    s_add_u32 s37, s37, 4096
    buffer_load_dwordx4 a[32:35], v1, s[12:15], s37 offen offset:0 sc1
    buffer_load_dwordx4 a[36:39], v1, s[12:15], s37 offen offset:1024 sc1
    buffer_load_dwordx4 a[40:43], v1, s[12:15], s37 offen offset:2048 sc1
    buffer_load_dwordx4 a[44:47], v1, s[12:15], s37 offen offset:3072 sc1
    s_add_u32 s37, s37, 4096
    buffer_load_dwordx4 a[48:51], v1, s[12:15], s37 offen offset:0 sc1
    buffer_load_dwordx4 a[52:55], v1, s[12:15], s37 offen offset:1024 sc1
    buffer_load_dwordx4 a[56:59], v1, s[12:15], s37 offen offset:2048 sc1
    buffer_load_dwordx4 a[60:63], v1, s[12:15], s37 offen offset:3072 sc1
    s_lshl_b32 s26, s4, 13
    s_add_u32 s25, s36, s26
    s_mov_b32 s37, 67117056
    s_cmp_ge_u32 s4, 2
    s_cselect_b32 s37, 83861504, s37
    s_add_u32 s25, s25, s37
    s_cmp_eq_u32 s4, 2
    s_cselect_b32 s39, 8192, 0
    s_add_u32 s25, s25, s39
    s_mov_b32 m0, s26
    s_nop 0
    buffer_load_dwordx4 v1, s[12:15], s25 offen offset:0 sc1 lds
    buffer_load_dwordx4 v1, s[12:15], s25 offen offset:1024 sc1 lds
    buffer_load_dwordx4 v1, s[12:15], s25 offen offset:2048 sc1 lds
    buffer_load_dwordx4 v1, s[12:15], s25 offen offset:3072 sc1 lds
    s_add_u32 m0, s26, 4096
    s_add_u32 s25, s25, 4096
    buffer_load_dwordx4 v1, s[12:15], s25 offen offset:0 sc1 lds
    buffer_load_dwordx4 v1, s[12:15], s25 offen offset:1024 sc1 lds
    buffer_load_dwordx4 v1, s[12:15], s25 offen offset:2048 sc1 lds
    buffer_load_dwordx4 v1, s[12:15], s25 offen offset:3072 sc1 lds
    s_add_u32 s25, s25, 12288
    s_add_u32 s26, s26, 32768
    s_and_b32 s26, s26, 131071
    s_sub_u32 s25, s25, s39
    s_mov_b32 m0, s26
    s_nop 0
    buffer_load_dwordx4 v1, s[12:15], s25 offen offset:0 sc1 lds
    buffer_load_dwordx4 v1, s[12:15], s25 offen offset:1024 sc1 lds
    buffer_load_dwordx4 v1, s[12:15], s25 offen offset:2048 sc1 lds
    buffer_load_dwordx4 v1, s[12:15], s25 offen offset:3072 sc1 lds
    s_add_u32 m0, s26, 4096
    s_add_u32 s25, s25, 4096
    buffer_load_dwordx4 v1, s[12:15], s25 offen offset:0 sc1 lds
    buffer_load_dwordx4 v1, s[12:15], s25 offen offset:1024 sc1 lds
    buffer_load_dwordx4 v1, s[12:15], s25 offen offset:2048 sc1 lds
    buffer_load_dwordx4 v1, s[12:15], s25 offen offset:3072 sc1 lds
    s_add_u32 s25, s25, 12288
    s_add_u32 s26, s26, 32768
    s_and_b32 s26, s26, 131071
    s_cmp_eq_u32 s32, 0
    s_cbranch_scc1 at_np_207
    v_add_f32 v12, v12, v13
    v_mov_b32 v13, v12
    s_nop 1
    v_permlane32_swap_b32 v12, v13
    v_add_f32 v12, v12, v13
    v_rcp_f32 v12, v12
    v_accvgpr_read_b32 v32, a64
    v_accvgpr_read_b32 v33, a65
    v_accvgpr_read_b32 v34, a66
    v_accvgpr_read_b32 v35, a67
    v_accvgpr_read_b32 v36, a68
    v_accvgpr_read_b32 v37, a69
    v_accvgpr_read_b32 v38, a70
    v_accvgpr_read_b32 v39, a71
    v_mul_f32 v32, v32, v12
    v_mul_f32 v33, v33, v12
    v_mul_f32 v34, v34, v12
    v_mul_f32 v35, v35, v12
    v_mul_f32 v36, v36, v12
    v_mul_f32 v37, v37, v12
    v_mul_f32 v38, v38, v12
    v_mul_f32 v39, v39, v12
    v_cvt_pk_bf16_f32 v160, v32, v33
    v_cvt_pk_bf16_f32 v161, v34, v35
    v_cvt_pk_bf16_f32 v162, v36, v37
    v_cvt_pk_bf16_f32 v163, v38, v39
    buffer_store_dwordx4 v[160:163], v1, s[12:15], s32 offen offset:0 sc1
    v_accvgpr_read_b32 v40, a72
    v_accvgpr_read_b32 v41, a73
    v_accvgpr_read_b32 v42, a74
    v_accvgpr_read_b32 v43, a75
    v_accvgpr_read_b32 v44, a76
    v_accvgpr_read_b32 v45, a77
    v_accvgpr_read_b32 v46, a78
    v_accvgpr_read_b32 v47, a79
    v_mul_f32 v40, v40, v12
    v_mul_f32 v41, v41, v12
    v_mul_f32 v42, v42, v12
    v_mul_f32 v43, v43, v12
    v_mul_f32 v44, v44, v12
    v_mul_f32 v45, v45, v12
    v_mul_f32 v46, v46, v12
    v_mul_f32 v47, v47, v12
    v_cvt_pk_bf16_f32 v164, v40, v41
    v_cvt_pk_bf16_f32 v165, v42, v43
    v_cvt_pk_bf16_f32 v166, v44, v45
    v_cvt_pk_bf16_f32 v167, v46, v47
    buffer_store_dwordx4 v[164:167], v1, s[12:15], s32 offen offset:1024 sc1
    v_accvgpr_read_b32 v48, a80
    v_accvgpr_read_b32 v49, a81
    v_accvgpr_read_b32 v50, a82
    v_accvgpr_read_b32 v51, a83
    v_accvgpr_read_b32 v52, a84
    v_accvgpr_read_b32 v53, a85
    v_accvgpr_read_b32 v54, a86
    v_accvgpr_read_b32 v55, a87
    v_mul_f32 v48, v48, v12
    v_mul_f32 v49, v49, v12
    v_mul_f32 v50, v50, v12
    v_mul_f32 v51, v51, v12
    v_mul_f32 v52, v52, v12
    v_mul_f32 v53, v53, v12
    v_mul_f32 v54, v54, v12
    v_mul_f32 v55, v55, v12
    v_cvt_pk_bf16_f32 v168, v48, v49
    v_cvt_pk_bf16_f32 v169, v50, v51
    v_cvt_pk_bf16_f32 v170, v52, v53
    v_cvt_pk_bf16_f32 v171, v54, v55
    buffer_store_dwordx4 v[168:171], v1, s[12:15], s32 offen offset:2048 sc1
    v_accvgpr_read_b32 v56, a88
    v_accvgpr_read_b32 v57, a89
    v_accvgpr_read_b32 v58, a90
    v_accvgpr_read_b32 v59, a91
    v_accvgpr_read_b32 v60, a92
    v_accvgpr_read_b32 v61, a93
    v_accvgpr_read_b32 v62, a94
    v_accvgpr_read_b32 v63, a95
    v_mul_f32 v56, v56, v12
    v_mul_f32 v57, v57, v12
    v_mul_f32 v58, v58, v12
    v_mul_f32 v59, v59, v12
    v_mul_f32 v60, v60, v12
    v_mul_f32 v61, v61, v12
    v_mul_f32 v62, v62, v12
    v_mul_f32 v63, v63, v12
    v_cvt_pk_bf16_f32 v172, v56, v57
    v_cvt_pk_bf16_f32 v173, v58, v59
    v_cvt_pk_bf16_f32 v174, v60, v61
    v_cvt_pk_bf16_f32 v175, v62, v63
    buffer_store_dwordx4 v[172:175], v1, s[12:15], s32 offen offset:3072 sc1
    v_accvgpr_read_b32 v32, a96
    v_accvgpr_read_b32 v33, a97
    v_accvgpr_read_b32 v34, a98
    v_accvgpr_read_b32 v35, a99
    v_accvgpr_read_b32 v36, a100
    v_accvgpr_read_b32 v37, a101
    v_accvgpr_read_b32 v38, a102
    v_accvgpr_read_b32 v39, a103
    v_mul_f32 v32, v32, v12
    v_mul_f32 v33, v33, v12
    v_mul_f32 v34, v34, v12
    v_mul_f32 v35, v35, v12
    v_mul_f32 v36, v36, v12
    v_mul_f32 v37, v37, v12
    v_mul_f32 v38, v38, v12
    v_mul_f32 v39, v39, v12
    v_cvt_pk_bf16_f32 v176, v32, v33
    v_cvt_pk_bf16_f32 v177, v34, v35
    v_cvt_pk_bf16_f32 v178, v36, v37
    v_cvt_pk_bf16_f32 v179, v38, v39
    s_add_u32 s32, s32, 4096
    buffer_store_dwordx4 v[176:179], v1, s[12:15], s32 offen offset:0 sc1
    v_accvgpr_read_b32 v40, a104
    v_accvgpr_read_b32 v41, a105
    v_accvgpr_read_b32 v42, a106
    v_accvgpr_read_b32 v43, a107
    v_accvgpr_read_b32 v44, a108
    v_accvgpr_read_b32 v45, a109
    v_accvgpr_read_b32 v46, a110
    v_accvgpr_read_b32 v47, a111
    v_mul_f32 v40, v40, v12
    v_mul_f32 v41, v41, v12
    v_mul_f32 v42, v42, v12
    v_mul_f32 v43, v43, v12
    v_mul_f32 v44, v44, v12
    v_mul_f32 v45, v45, v12
    v_mul_f32 v46, v46, v12
    v_mul_f32 v47, v47, v12
    v_cvt_pk_bf16_f32 v180, v40, v41
    v_cvt_pk_bf16_f32 v181, v42, v43
    v_cvt_pk_bf16_f32 v182, v44, v45
    v_cvt_pk_bf16_f32 v183, v46, v47
    buffer_store_dwordx4 v[180:183], v1, s[12:15], s32 offen offset:1024 sc1
    v_accvgpr_read_b32 v48, a112
    v_accvgpr_read_b32 v49, a113
    v_accvgpr_read_b32 v50, a114
    v_accvgpr_read_b32 v51, a115
    v_accvgpr_read_b32 v52, a116
    v_accvgpr_read_b32 v53, a117
    v_accvgpr_read_b32 v54, a118
    v_accvgpr_read_b32 v55, a119
    v_mul_f32 v48, v48, v12
    v_mul_f32 v49, v49, v12
    v_mul_f32 v50, v50, v12
    v_mul_f32 v51, v51, v12
    v_mul_f32 v52, v52, v12
    v_mul_f32 v53, v53, v12
    v_mul_f32 v54, v54, v12
    v_mul_f32 v55, v55, v12
    v_cvt_pk_bf16_f32 v184, v48, v49
    v_cvt_pk_bf16_f32 v185, v50, v51
    v_cvt_pk_bf16_f32 v186, v52, v53
    v_cvt_pk_bf16_f32 v187, v54, v55
    buffer_store_dwordx4 v[184:187], v1, s[12:15], s32 offen offset:2048 sc1
    v_accvgpr_read_b32 v56, a120
    v_accvgpr_read_b32 v57, a121
    v_accvgpr_read_b32 v58, a122
    v_accvgpr_read_b32 v59, a123
    v_accvgpr_read_b32 v60, a124
    v_accvgpr_read_b32 v61, a125
    v_accvgpr_read_b32 v62, a126
    v_accvgpr_read_b32 v63, a127
    v_mul_f32 v56, v56, v12
    v_mul_f32 v57, v57, v12
    v_mul_f32 v58, v58, v12
    v_mul_f32 v59, v59, v12
    v_mul_f32 v60, v60, v12
    v_mul_f32 v61, v61, v12
    v_mul_f32 v62, v62, v12
    v_mul_f32 v63, v63, v12
    v_cvt_pk_bf16_f32 v188, v56, v57
    v_cvt_pk_bf16_f32 v189, v58, v59
    v_cvt_pk_bf16_f32 v190, v60, v61
    v_cvt_pk_bf16_f32 v191, v62, v63
    buffer_store_dwordx4 v[188:191], v1, s[12:15], s32 offen offset:3072 sc1
    s_add_u32 s32, s32, 258048
    v_add_f32 v14, v14, v15
    v_mov_b32 v15, v14
    s_nop 1
    v_permlane32_swap_b32 v14, v15
    v_add_f32 v14, v14, v15
    v_rcp_f32 v14, v14
    v_accvgpr_read_b32 v32, a128
    v_accvgpr_read_b32 v33, a129
    v_accvgpr_read_b32 v34, a130
    v_accvgpr_read_b32 v35, a131
    v_accvgpr_read_b32 v36, a132
    v_accvgpr_read_b32 v37, a133
    v_accvgpr_read_b32 v38, a134
    v_accvgpr_read_b32 v39, a135
    v_mul_f32 v32, v32, v14
    v_mul_f32 v33, v33, v14
    v_mul_f32 v34, v34, v14
    v_mul_f32 v35, v35, v14
    v_mul_f32 v36, v36, v14
    v_mul_f32 v37, v37, v14
    v_mul_f32 v38, v38, v14
    v_mul_f32 v39, v39, v14
    v_cvt_pk_bf16_f32 v192, v32, v33
    v_cvt_pk_bf16_f32 v193, v34, v35
    v_cvt_pk_bf16_f32 v194, v36, v37
    v_cvt_pk_bf16_f32 v195, v38, v39
    buffer_store_dwordx4 v[192:195], v1, s[12:15], s32 offen offset:0 sc1
    v_accvgpr_read_b32 v40, a136
    v_accvgpr_read_b32 v41, a137
    v_accvgpr_read_b32 v42, a138
    v_accvgpr_read_b32 v43, a139
    v_accvgpr_read_b32 v44, a140
    v_accvgpr_read_b32 v45, a141
    v_accvgpr_read_b32 v46, a142
    v_accvgpr_read_b32 v47, a143
    v_mul_f32 v40, v40, v14
    v_mul_f32 v41, v41, v14
    v_mul_f32 v42, v42, v14
    v_mul_f32 v43, v43, v14
    v_mul_f32 v44, v44, v14
    v_mul_f32 v45, v45, v14
    v_mul_f32 v46, v46, v14
    v_mul_f32 v47, v47, v14
    v_cvt_pk_bf16_f32 v196, v40, v41
    v_cvt_pk_bf16_f32 v197, v42, v43
    v_cvt_pk_bf16_f32 v198, v44, v45
    v_cvt_pk_bf16_f32 v199, v46, v47
    buffer_store_dwordx4 v[196:199], v1, s[12:15], s32 offen offset:1024 sc1
    v_accvgpr_read_b32 v48, a144
    v_accvgpr_read_b32 v49, a145
    v_accvgpr_read_b32 v50, a146
    v_accvgpr_read_b32 v51, a147
    v_accvgpr_read_b32 v52, a148
    v_accvgpr_read_b32 v53, a149
    v_accvgpr_read_b32 v54, a150
    v_accvgpr_read_b32 v55, a151
    v_mul_f32 v48, v48, v14
    v_mul_f32 v49, v49, v14
    v_mul_f32 v50, v50, v14
    v_mul_f32 v51, v51, v14
    v_mul_f32 v52, v52, v14
    v_mul_f32 v53, v53, v14
    v_mul_f32 v54, v54, v14
    v_mul_f32 v55, v55, v14
    v_cvt_pk_bf16_f32 v200, v48, v49
    v_cvt_pk_bf16_f32 v201, v50, v51
    v_cvt_pk_bf16_f32 v202, v52, v53
    v_cvt_pk_bf16_f32 v203, v54, v55
    buffer_store_dwordx4 v[200:203], v1, s[12:15], s32 offen offset:2048 sc1
    v_accvgpr_read_b32 v56, a152
    v_accvgpr_read_b32 v57, a153
    v_accvgpr_read_b32 v58, a154
    v_accvgpr_read_b32 v59, a155
    v_accvgpr_read_b32 v60, a156
    v_accvgpr_read_b32 v61, a157
    v_accvgpr_read_b32 v62, a158
    v_accvgpr_read_b32 v63, a159
    v_mul_f32 v56, v56, v14
    v_mul_f32 v57, v57, v14
    v_mul_f32 v58, v58, v14
    v_mul_f32 v59, v59, v14
    v_mul_f32 v60, v60, v14
    v_mul_f32 v61, v61, v14
    v_mul_f32 v62, v62, v14
    v_mul_f32 v63, v63, v14
    v_cvt_pk_bf16_f32 v204, v56, v57
    v_cvt_pk_bf16_f32 v205, v58, v59
    v_cvt_pk_bf16_f32 v206, v60, v61
    v_cvt_pk_bf16_f32 v207, v62, v63
    buffer_store_dwordx4 v[204:207], v1, s[12:15], s32 offen offset:3072 sc1
    v_accvgpr_read_b32 v32, a160
    v_accvgpr_read_b32 v33, a161
    v_accvgpr_read_b32 v34, a162
    v_accvgpr_read_b32 v35, a163
    v_accvgpr_read_b32 v36, a164
    v_accvgpr_read_b32 v37, a165
    v_accvgpr_read_b32 v38, a166
    v_accvgpr_read_b32 v39, a167
    v_mul_f32 v32, v32, v14
    v_mul_f32 v33, v33, v14
    v_mul_f32 v34, v34, v14
    v_mul_f32 v35, v35, v14
    v_mul_f32 v36, v36, v14
    v_mul_f32 v37, v37, v14
    v_mul_f32 v38, v38, v14
    v_mul_f32 v39, v39, v14
    v_cvt_pk_bf16_f32 v208, v32, v33
    v_cvt_pk_bf16_f32 v209, v34, v35
    v_cvt_pk_bf16_f32 v210, v36, v37
    v_cvt_pk_bf16_f32 v211, v38, v39
    s_add_u32 s32, s32, 4096
    buffer_store_dwordx4 v[208:211], v1, s[12:15], s32 offen offset:0 sc1
    v_accvgpr_read_b32 v40, a168
    v_accvgpr_read_b32 v41, a169
    v_accvgpr_read_b32 v42, a170
    v_accvgpr_read_b32 v43, a171
    v_accvgpr_read_b32 v44, a172
    v_accvgpr_read_b32 v45, a173
    v_accvgpr_read_b32 v46, a174
    v_accvgpr_read_b32 v47, a175
    v_mul_f32 v40, v40, v14
    v_mul_f32 v41, v41, v14
    v_mul_f32 v42, v42, v14
    v_mul_f32 v43, v43, v14
    v_mul_f32 v44, v44, v14
    v_mul_f32 v45, v45, v14
    v_mul_f32 v46, v46, v14
    v_mul_f32 v47, v47, v14
    v_cvt_pk_bf16_f32 v212, v40, v41
    v_cvt_pk_bf16_f32 v213, v42, v43
    v_cvt_pk_bf16_f32 v214, v44, v45
    v_cvt_pk_bf16_f32 v215, v46, v47
    buffer_store_dwordx4 v[212:215], v1, s[12:15], s32 offen offset:1024 sc1
    v_accvgpr_read_b32 v48, a176
    v_accvgpr_read_b32 v49, a177
    v_accvgpr_read_b32 v50, a178
    v_accvgpr_read_b32 v51, a179
    v_accvgpr_read_b32 v52, a180
    v_accvgpr_read_b32 v53, a181
    v_accvgpr_read_b32 v54, a182
    v_accvgpr_read_b32 v55, a183
    v_mul_f32 v48, v48, v14
    v_mul_f32 v49, v49, v14
    v_mul_f32 v50, v50, v14
    v_mul_f32 v51, v51, v14
    v_mul_f32 v52, v52, v14
    v_mul_f32 v53, v53, v14
    v_mul_f32 v54, v54, v14
    v_mul_f32 v55, v55, v14
    v_cvt_pk_bf16_f32 v216, v48, v49
    v_cvt_pk_bf16_f32 v217, v50, v51
    v_cvt_pk_bf16_f32 v218, v52, v53
    v_cvt_pk_bf16_f32 v219, v54, v55
    buffer_store_dwordx4 v[216:219], v1, s[12:15], s32 offen offset:2048 sc1
    v_accvgpr_read_b32 v56, a184
    v_accvgpr_read_b32 v57, a185
    v_accvgpr_read_b32 v58, a186
    v_accvgpr_read_b32 v59, a187
    v_accvgpr_read_b32 v60, a188
    v_accvgpr_read_b32 v61, a189
    v_accvgpr_read_b32 v62, a190
    v_accvgpr_read_b32 v63, a191
    v_mul_f32 v56, v56, v14
    v_mul_f32 v57, v57, v14
    v_mul_f32 v58, v58, v14
    v_mul_f32 v59, v59, v14
    v_mul_f32 v60, v60, v14
    v_mul_f32 v61, v61, v14
    v_mul_f32 v62, v62, v14
    v_mul_f32 v63, v63, v14
    v_cvt_pk_bf16_f32 v220, v56, v57
    v_cvt_pk_bf16_f32 v221, v58, v59
    v_cvt_pk_bf16_f32 v222, v60, v61
    v_cvt_pk_bf16_f32 v223, v62, v63
    buffer_store_dwordx4 v[220:223], v1, s[12:15], s32 offen offset:3072 sc1
    s_add_u32 s32, s32, 258048
at_np_207:
    v_accvgpr_write_b32 a64, 0
    v_accvgpr_write_b32 a65, 0
    v_accvgpr_write_b32 a66, 0
    v_accvgpr_write_b32 a67, 0
    v_accvgpr_write_b32 a68, 0
    v_accvgpr_write_b32 a69, 0
    v_accvgpr_write_b32 a70, 0
    v_accvgpr_write_b32 a71, 0
    v_accvgpr_write_b32 a72, 0
    v_accvgpr_write_b32 a73, 0
    v_accvgpr_write_b32 a74, 0
    v_accvgpr_write_b32 a75, 0
    v_accvgpr_write_b32 a76, 0
    v_accvgpr_write_b32 a77, 0
    v_accvgpr_write_b32 a78, 0
    v_accvgpr_write_b32 a79, 0
    v_accvgpr_write_b32 a80, 0
    v_accvgpr_write_b32 a81, 0
    v_accvgpr_write_b32 a82, 0
    v_accvgpr_write_b32 a83, 0
    v_accvgpr_write_b32 a84, 0
    v_accvgpr_write_b32 a85, 0
    v_accvgpr_write_b32 a86, 0
    v_accvgpr_write_b32 a87, 0
    v_accvgpr_write_b32 a88, 0
    v_accvgpr_write_b32 a89, 0
    v_accvgpr_write_b32 a90, 0
    v_accvgpr_write_b32 a91, 0
    v_accvgpr_write_b32 a92, 0
    v_accvgpr_write_b32 a93, 0
    v_accvgpr_write_b32 a94, 0
    v_accvgpr_write_b32 a95, 0
    v_accvgpr_write_b32 a96, 0
    v_accvgpr_write_b32 a97, 0
    v_accvgpr_write_b32 a98, 0
    v_accvgpr_write_b32 a99, 0
    v_accvgpr_write_b32 a100, 0
    v_accvgpr_write_b32 a101, 0
    v_accvgpr_write_b32 a102, 0
    v_accvgpr_write_b32 a103, 0
    v_accvgpr_write_b32 a104, 0
    v_accvgpr_write_b32 a105, 0
    v_accvgpr_write_b32 a106, 0
    v_accvgpr_write_b32 a107, 0
    v_accvgpr_write_b32 a108, 0
    v_accvgpr_write_b32 a109, 0
    v_accvgpr_write_b32 a110, 0
    v_accvgpr_write_b32 a111, 0
    v_accvgpr_write_b32 a112, 0
    v_accvgpr_write_b32 a113, 0
    v_accvgpr_write_b32 a114, 0
    v_accvgpr_write_b32 a115, 0
    v_accvgpr_write_b32 a116, 0
    v_accvgpr_write_b32 a117, 0
    v_accvgpr_write_b32 a118, 0
    v_accvgpr_write_b32 a119, 0
    v_accvgpr_write_b32 a120, 0
    v_accvgpr_write_b32 a121, 0
    v_accvgpr_write_b32 a122, 0
    v_accvgpr_write_b32 a123, 0
    v_accvgpr_write_b32 a124, 0
    v_accvgpr_write_b32 a125, 0
    v_accvgpr_write_b32 a126, 0
    v_accvgpr_write_b32 a127, 0
    v_accvgpr_write_b32 a128, 0
    v_accvgpr_write_b32 a129, 0
    v_accvgpr_write_b32 a130, 0
    v_accvgpr_write_b32 a131, 0
    v_accvgpr_write_b32 a132, 0
    v_accvgpr_write_b32 a133, 0
    v_accvgpr_write_b32 a134, 0
    v_accvgpr_write_b32 a135, 0
    v_accvgpr_write_b32 a136, 0
    v_accvgpr_write_b32 a137, 0
    v_accvgpr_write_b32 a138, 0
    v_accvgpr_write_b32 a139, 0
    v_accvgpr_write_b32 a140, 0
    v_accvgpr_write_b32 a141, 0
    v_accvgpr_write_b32 a142, 0
    v_accvgpr_write_b32 a143, 0
    v_accvgpr_write_b32 a144, 0
    v_accvgpr_write_b32 a145, 0
    v_accvgpr_write_b32 a146, 0
    v_accvgpr_write_b32 a147, 0
    v_accvgpr_write_b32 a148, 0
    v_accvgpr_write_b32 a149, 0
    v_accvgpr_write_b32 a150, 0
    v_accvgpr_write_b32 a151, 0
    v_accvgpr_write_b32 a152, 0
    v_accvgpr_write_b32 a153, 0
    v_accvgpr_write_b32 a154, 0
    v_accvgpr_write_b32 a155, 0
    v_accvgpr_write_b32 a156, 0
    v_accvgpr_write_b32 a157, 0
    v_accvgpr_write_b32 a158, 0
    v_accvgpr_write_b32 a159, 0
    v_accvgpr_write_b32 a160, 0
    v_accvgpr_write_b32 a161, 0
    v_accvgpr_write_b32 a162, 0
    v_accvgpr_write_b32 a163, 0
    v_accvgpr_write_b32 a164, 0
    v_accvgpr_write_b32 a165, 0
    v_accvgpr_write_b32 a166, 0
    v_accvgpr_write_b32 a167, 0
    v_accvgpr_write_b32 a168, 0
    v_accvgpr_write_b32 a169, 0
    v_accvgpr_write_b32 a170, 0
    v_accvgpr_write_b32 a171, 0
    v_accvgpr_write_b32 a172, 0
    v_accvgpr_write_b32 a173, 0
    v_accvgpr_write_b32 a174, 0
    v_accvgpr_write_b32 a175, 0
    v_accvgpr_write_b32 a176, 0
    v_accvgpr_write_b32 a177, 0
    v_accvgpr_write_b32 a178, 0
    v_accvgpr_write_b32 a179, 0
    v_accvgpr_write_b32 a180, 0
    v_accvgpr_write_b32 a181, 0
    v_accvgpr_write_b32 a182, 0
    v_accvgpr_write_b32 a183, 0
    v_accvgpr_write_b32 a184, 0
    v_accvgpr_write_b32 a185, 0
    v_accvgpr_write_b32 a186, 0
    v_accvgpr_write_b32 a187, 0
    v_accvgpr_write_b32 a188, 0
    v_accvgpr_write_b32 a189, 0
    v_accvgpr_write_b32 a190, 0
    v_accvgpr_write_b32 a191, 0
    v_mov_b64 v[12:13], 0
    v_mov_b64 v[14:15], 0
    v_mov_b64 v[112:113], 0
    v_mov_b64 v[114:115], 0
    v_mov_b64 v[116:117], 0
    v_mov_b64 v[118:119], 0
    v_mov_b64 v[120:121], 0
    v_mov_b64 v[122:123], 0
    v_mov_b64 v[124:125], 0
    v_mov_b64 v[126:127], 0
    v_mov_b64 v[128:129], 0
    v_mov_b64 v[130:131], 0
    v_mov_b64 v[132:133], 0
    v_mov_b64 v[134:135], 0
    v_mov_b64 v[136:137], 0
    v_mov_b64 v[138:139], 0
    v_mov_b64 v[140:141], 0
    v_mov_b64 v[142:143], 0
    v_mov_b64 v[144:145], 0
    v_mov_b64 v[146:147], 0
    v_mov_b64 v[148:149], 0
    v_mov_b64 v[150:151], 0
    v_mov_b64 v[152:153], 0
    v_mov_b64 v[154:155], 0
    v_mov_b64 v[156:157], 0
    v_mov_b64 v[158:159], 0
    s_cmp_lg_u32 s22, 1
    s_cbranch_scc1 at_nm0_208
    v_mov_b32 v11, s28
    v_cmp_gt_i32 vcc, 0, v3
    s_nop 1
    v_cndmask_b32 v128, v128, v11, vcc
    v_cmp_gt_i32 vcc, 1, v3
    s_nop 1
    v_cndmask_b32 v129, v129, v11, vcc
    v_cmp_gt_i32 vcc, 2, v3
    s_nop 1
    v_cndmask_b32 v130, v130, v11, vcc
    v_cmp_gt_i32 vcc, 3, v3
    s_nop 1
    v_cndmask_b32 v131, v131, v11, vcc
    v_cmp_gt_i32 vcc, 8, v3
    s_nop 1
    v_cndmask_b32 v132, v132, v11, vcc
    v_cmp_gt_i32 vcc, 9, v3
    s_nop 1
    v_cndmask_b32 v133, v133, v11, vcc
    v_cmp_gt_i32 vcc, 10, v3
    s_nop 1
    v_cndmask_b32 v134, v134, v11, vcc
    v_cmp_gt_i32 vcc, 11, v3
    s_nop 1
    v_cndmask_b32 v135, v135, v11, vcc
    v_cmp_gt_i32 vcc, 16, v3
    s_nop 1
    v_cndmask_b32 v136, v136, v11, vcc
    v_cmp_gt_i32 vcc, 17, v3
    s_nop 1
    v_cndmask_b32 v137, v137, v11, vcc
    v_cmp_gt_i32 vcc, 18, v3
    s_nop 1
    v_cndmask_b32 v138, v138, v11, vcc
    v_cmp_gt_i32 vcc, 19, v3
    s_nop 1
    v_cndmask_b32 v139, v139, v11, vcc
    v_cmp_gt_i32 vcc, 24, v3
    s_nop 1
    v_cndmask_b32 v140, v140, v11, vcc
    v_cmp_gt_i32 vcc, 25, v3
    s_nop 1
    v_cndmask_b32 v141, v141, v11, vcc
    v_cmp_gt_i32 vcc, 26, v3
    s_nop 1
    v_cndmask_b32_e64 v142, v142, v11, vcc
    v_cmp_gt_i32_e64 vcc, 27, v3
    s_nop 1
    v_cndmask_b32_e64 v143, v143, v11, vcc
at_nm0_208:
    v_add_u32 v4, 65536, v1
    s_cmp_eq_u32 s32, 0
    s_cbranch_scc1 at_pk_209
    s_waitcnt vmcnt(32)
    s_branch at_pj_210
at_pk_209:
    s_waitcnt vmcnt(16)
at_pj_210:
    s_barrier
    ds_read_b128 a[192:195], v4 offset:40960
    ds_read_b128 a[196:199], v4 offset:41984
    ds_read_b128 a[200:203], v4 offset:43008
    ds_read_b128 a[204:207], v4 offset:44032
    ds_read_b128 a[208:211], v4 offset:45056
    ds_read_b128 a[212:215], v4 offset:46080
    ds_read_b128 a[216:219], v4 offset:47104
    ds_read_b128 a[220:223], v4 offset:48128
    s_waitcnt lgkmcnt(7)
    v_mfma_f32_32x32x16_bf16 v[32:47], a[192:195], a[0:3], v[128:143]
    v_mfma_f32_32x32x16_bf16 v[48:63], a[192:195], a[32:35], v[144:159]
    s_waitcnt lgkmcnt(6)
    v_mfma_f32_32x32x16_bf16 v[32:47], a[196:199], a[4:7], v[32:47]
    v_mfma_f32_32x32x16_bf16 v[48:63], a[196:199], a[36:39], v[48:63]
    s_waitcnt lgkmcnt(5)
    v_mfma_f32_32x32x16_bf16 v[32:47], a[200:203], a[8:11], v[32:47]
    v_mfma_f32_32x32x16_bf16 v[48:63], a[200:203], a[40:43], v[48:63]
    s_waitcnt lgkmcnt(4)
    v_mfma_f32_32x32x16_bf16 v[32:47], a[204:207], a[12:15], v[32:47]
    v_mfma_f32_32x32x16_bf16 v[48:63], a[204:207], a[44:47], v[48:63]
    s_waitcnt lgkmcnt(3)
    v_mfma_f32_32x32x16_bf16 v[32:47], a[208:211], a[16:19], v[32:47]
    v_mfma_f32_32x32x16_bf16 v[48:63], a[208:211], a[48:51], v[48:63]
    s_waitcnt lgkmcnt(2)
    v_mfma_f32_32x32x16_bf16 v[32:47], a[212:215], a[20:23], v[32:47]
    v_mfma_f32_32x32x16_bf16 v[48:63], a[212:215], a[52:55], v[48:63]
    s_waitcnt lgkmcnt(1)
    v_mfma_f32_32x32x16_bf16 v[32:47], a[216:219], a[24:27], v[32:47]
    s_nop 0
    v_mfma_f32_32x32x16_bf16 v[48:63], a[216:219], a[56:59], v[48:63]
    s_waitcnt lgkmcnt(0)
    v_mfma_f32_32x32x16_bf16 v[32:47], a[220:223], a[28:31], v[32:47]
    s_nop 0
    v_mfma_f32_32x32x16_bf16 v[48:63], a[220:223], a[60:63], v[48:63]
    s_cmp_eq_u32 s32, 0
    s_cbranch_scc1 at_pk_211
    s_waitcnt vmcnt(0)
    s_branch at_pj_212
at_pk_211:
    s_waitcnt vmcnt(8)
at_pj_212:
    s_barrier
    ds_read_b128 a[192:195], v2 offset:0
    ds_read_b128 a[196:199], v2 offset:1024
    ds_read_b128 a[200:203], v2 offset:2048
    ds_read_b128 a[204:207], v2 offset:3072
    ds_read_b128 a[208:211], v2 offset:4096
    s_cmp_eq_u32 s32, 0
    s_cbranch_scc1 at_ns_213
    s_cmp_lg_u32 s4, 1
    s_cselect_b32 s60, 0x80000000, s33
    v_mov_b32 v11, 1
    buffer_store_dword v11, off, s[12:15], s60 sc1
at_ns_213:
    v_max3_f32 v4, v32, v33, v34
    v_max3_f32 v4, v4, v35, v36
    v_max3_f32 v4, v4, v37, v38
    v_max3_f32 v4, v4, v39, v40
    v_max3_f32 v4, v4, v41, v42
    v_max3_f32 v4, v4, v43, v44
    v_max3_f32 v4, v4, v45, v46
    v_max_f32 v4, v4, v47
    v_mov_b32 v5, v4
    s_nop 1
    v_permlane32_swap_b32 v4, v5
    v_max_f32 v4, v4, v5
    v_sub_f32 v32, v32, v4
    v_sub_f32 v33, v33, v4
    v_sub_f32 v34, v34, v4
    v_sub_f32 v35, v35, v4
    v_sub_f32 v36, v36, v4
    v_sub_f32 v37, v37, v4
    v_sub_f32 v38, v38, v4
    v_sub_f32 v39, v39, v4
    v_sub_f32 v40, v40, v4
    v_sub_f32 v41, v41, v4
    v_sub_f32 v42, v42, v4
    v_sub_f32 v43, v43, v4
    v_sub_f32 v44, v44, v4
    v_sub_f32 v45, v45, v4
    v_sub_f32 v46, v46, v4
    v_sub_f32 v47, v47, v4
    v_sub_f32 v128, v128, v4
    v_sub_f32 v129, v129, v4
    v_sub_f32 v130, v130, v4
    v_sub_f32 v131, v131, v4
    v_sub_f32 v132, v132, v4
    v_sub_f32 v133, v133, v4
    v_sub_f32 v134, v134, v4
    v_sub_f32 v135, v135, v4
    v_sub_f32 v136, v136, v4
    v_sub_f32 v137, v137, v4
    v_sub_f32 v138, v138, v4
    v_sub_f32 v139, v139, v4
    v_sub_f32 v140, v140, v4
    v_sub_f32 v141, v141, v4
    v_sub_f32 v142, v142, v4
    v_sub_f32 v143, v143, v4
    v_max3_f32 v4, v48, v49, v50
    v_max3_f32 v4, v4, v51, v52
    v_max3_f32 v4, v4, v53, v54
    v_max3_f32 v4, v4, v55, v56
    v_max3_f32 v4, v4, v57, v58
    v_max3_f32 v4, v4, v59, v60
    v_max3_f32 v4, v4, v61, v62
    v_max_f32 v4, v4, v63
    v_mov_b32 v5, v4
    s_nop 1
    v_permlane32_swap_b32 v4, v5
    v_max_f32 v4, v4, v5
    v_sub_f32 v48, v48, v4
    v_sub_f32 v49, v49, v4
    v_sub_f32 v50, v50, v4
    v_sub_f32 v51, v51, v4
    v_sub_f32 v52, v52, v4
    v_sub_f32 v53, v53, v4
    v_sub_f32 v54, v54, v4
    v_sub_f32 v55, v55, v4
    v_sub_f32 v56, v56, v4
    v_sub_f32 v57, v57, v4
    v_sub_f32 v58, v58, v4
    v_sub_f32 v59, v59, v4
    v_sub_f32 v60, v60, v4
    v_sub_f32 v61, v61, v4
    v_sub_f32 v62, v62, v4
    v_sub_f32 v63, v63, v4
    v_sub_f32 v144, v144, v4
    v_sub_f32 v145, v145, v4
    v_sub_f32 v146, v146, v4
    v_sub_f32 v147, v147, v4
    v_sub_f32 v148, v148, v4
    v_sub_f32 v149, v149, v4
    v_sub_f32 v150, v150, v4
    v_sub_f32 v151, v151, v4
    v_sub_f32 v152, v152, v4
    v_sub_f32 v153, v153, v4
    v_sub_f32 v154, v154, v4
    v_sub_f32 v155, v155, v4
    v_sub_f32 v156, v156, v4
    v_sub_f32 v157, v157, v4
    v_sub_f32 v158, v158, v4
    v_sub_f32 v159, v159, v4
    s_mov_b32 s24, 0
    s_mov_b32 s29, 65536
    s_cmp_lg_u32 s22, 1
    s_cbranch_scc1 at_nh_217
    v_mov_b32 v11, s28
    v_cmp_gt_i32 vcc, 0, v3
    s_nop 1
    v_cndmask_b32 v144, v144, v11, vcc
    v_cmp_gt_i32 vcc, 1, v3
    s_nop 1
    v_cndmask_b32 v145, v145, v11, vcc
    v_cmp_gt_i32 vcc, 2, v3
    s_nop 1
    v_cndmask_b32 v146, v146, v11, vcc
    v_cmp_gt_i32 vcc, 3, v3
    s_nop 1
    v_cndmask_b32 v147, v147, v11, vcc
    v_cmp_gt_i32 vcc, 8, v3
    s_nop 1
    v_cndmask_b32 v148, v148, v11, vcc
    v_cmp_gt_i32 vcc, 9, v3
    s_nop 1
    v_cndmask_b32 v149, v149, v11, vcc
    v_cmp_gt_i32 vcc, 10, v3
    s_nop 1
    v_cndmask_b32 v150, v150, v11, vcc
    v_cmp_gt_i32 vcc, 11, v3
    s_nop 1
    v_cndmask_b32 v151, v151, v11, vcc
    v_cmp_gt_i32 vcc, 16, v3
    s_nop 1
    v_cndmask_b32 v152, v152, v11, vcc
    v_cmp_gt_i32 vcc, 17, v3
    s_nop 1
    v_cndmask_b32 v153, v153, v11, vcc
    v_cmp_gt_i32 vcc, 18, v3
    s_nop 1
    v_cndmask_b32 v154, v154, v11, vcc
    v_cmp_gt_i32 vcc, 19, v3
    s_nop 1
    v_cndmask_b32 v155, v155, v11, vcc
    v_cmp_gt_i32 vcc, 24, v3
    s_nop 1
    v_cndmask_b32 v156, v156, v11, vcc
    v_cmp_gt_i32 vcc, 25, v3
    s_nop 1
    v_cndmask_b32 v157, v157, v11, vcc
    v_cmp_gt_i32 vcc, 26, v3
    s_nop 1
    v_cndmask_b32 v158, v158, v11, vcc
    v_cmp_gt_i32 vcc, 27, v3
    s_nop 1
    v_cndmask_b32 v159, v159, v11, vcc
    v_mov_b32 v128, v11
    v_mov_b32 v129, v11
    v_mov_b32 v130, v11
    v_mov_b32 v131, v11
    v_mov_b32 v132, v11
    v_mov_b32 v133, v11
    v_mov_b32 v134, v11
    v_mov_b32 v135, v11
    v_mov_b32 v136, v11
    v_mov_b32 v137, v11
    v_mov_b32 v138, v11
    v_mov_b32 v139, v11
    v_mov_b32 v140, v11
    v_mov_b32 v141, v11
    v_mov_b32 v142, v11
    v_mov_b32 v143, v11
    s_nop 1
at_nh_217:
    s_waitcnt lgkmcnt(4)
.p2align 5
at_loop_214:
    v_mfma_f32_32x32x16_bf16 v[64:79], a[192:195], a[0:3], v[128:143]
    s_mov_b32 m0, s26
    ds_read_b128 a[212:215], v2 offset:5120
    v_mov_b64 v[20:21], v[12:13]
    v_mov_b64 v[22:23], v[14:15]
    v_exp_f32 v24, v32
    v_mfma_f32_32x32x16_bf16 v[80:95], a[192:195], a[32:35], v[144:159]
    s_waitcnt lgkmcnt(4)
    buffer_load_dwordx4 v1, s[12:15], s25 offen offset:0 sc1 lds
    v_exp_f32 v25, v33
    v_exp_f32 v26, v34
    v_mfma_f32_32x32x16_bf16 v[64:79], a[196:199], a[4:7], v[64:79]
    s_add_u32 s36, s24, 2
    ds_read_b128 a[216:219], v2 offset:6144
    v_exp_f32 v27, v35
    v_add_f32 v12, v12, v24
    v_add_f32 v13, v13, v25
    v_cvt_pk_bf16_f32 v96, v24, v25
    v_mfma_f32_32x32x16_bf16 v[80:95], a[196:199], a[36:39], v[80:95]
    s_waitcnt lgkmcnt(4)
    v_exp_f32 v28, v36
    v_exp_f32 v29, v37
    v_add_f32 v12, v12, v26
    v_mfma_f32_32x32x16_bf16 v[64:79], a[200:203], a[8:11], v[64:79]
    s_cmp_eq_u32 s36, s22
    ds_read_b128 a[220:223], v2 offset:7168
    v_add_f32 v13, v13, v27
    v_cvt_pk_bf16_f32 v97, v26, v27
    v_exp_f32 v30, v38
    v_mfma_f32_32x32x16_bf16 v[80:95], a[200:203], a[40:43], v[80:95]
    s_waitcnt lgkmcnt(4)
    buffer_load_dwordx4 v1, s[12:15], s25 offen offset:1024 sc1 lds
    v_exp_f32 v31, v39
    v_add_f32 v12, v12, v28
    v_add_f32 v13, v13, v29
    v_mfma_f32_32x32x16_bf16 v[64:79], a[204:207], a[12:15], v[64:79]
    s_cselect_b64 s[30:31], -1, 0
    ds_read_b128 a[192:195], v2 offset:16384
    v_cvt_pk_bf16_f32 v98, v28, v29
    v_exp_f32 v24, v40
    v_exp_f32 v25, v41
    v_mfma_f32_32x32x16_bf16 v[80:95], a[204:207], a[44:47], v[80:95]
    s_waitcnt lgkmcnt(4)
    v_add_f32 v12, v12, v30
    v_add_f32 v13, v13, v31
    v_cvt_pk_bf16_f32 v99, v30, v31
    v_mfma_f32_32x32x16_bf16 v[64:79], a[208:211], a[16:19], v[64:79]
    ds_read_b128 a[196:199], v2 offset:17408
    v_exp_f32 v26, v42
    v_exp_f32 v27, v43
    v_mfma_f32_32x32x16_bf16 v[80:95], a[208:211], a[48:51], v[80:95]
    s_waitcnt lgkmcnt(4)
    buffer_load_dwordx4 v1, s[12:15], s25 offen offset:2048 sc1 lds
    v_add_f32 v12, v12, v24
    v_add_f32 v13, v13, v25
    v_cvt_pk_bf16_f32 v100, v24, v25
    v_mfma_f32_32x32x16_bf16 v[64:79], a[212:215], a[20:23], v[64:79]
    ds_read_b128 a[200:203], v2 offset:18432
    v_exp_f32 v28, v44
    v_exp_f32 v29, v45
    v_mfma_f32_32x32x16_bf16 v[80:95], a[212:215], a[52:55], v[80:95]
    s_waitcnt lgkmcnt(4)
    v_add_f32 v12, v12, v26
    v_add_f32 v13, v13, v27
    v_cvt_pk_bf16_f32 v101, v26, v27
    v_exp_f32 v30, v46
    v_mfma_f32_32x32x16_bf16 v[64:79], a[216:219], a[24:27], v[64:79]
    ds_read_b128 a[204:207], v2 offset:19456
    v_exp_f32 v31, v47
    v_add_f32 v12, v12, v28
    v_mfma_f32_32x32x16_bf16 v[80:95], a[216:219], a[56:59], v[80:95]
    s_waitcnt lgkmcnt(4)
    buffer_load_dwordx4 v1, s[12:15], s25 offen offset:3072 sc1 lds
    v_add_f32 v13, v13, v29
    v_cvt_pk_bf16_f32 v102, v28, v29
    v_exp_f32 v24, v48
    v_mfma_f32_32x32x16_bf16 v[64:79], a[220:223], a[28:31], v[64:79]
    s_add_u32 m0, s26, 4096
    s_add_u32 s25, s25, 4096
    ds_read_b128 a[208:211], v2 offset:20480
    v_exp_f32 v25, v49
    v_add_f32 v12, v12, v30
    v_add_f32 v13, v13, v31
    v_mfma_f32_32x32x16_bf16 v[80:95], a[220:223], a[60:63], v[80:95]
    s_waitcnt lgkmcnt(4)
    v_cvt_pk_bf16_f32 v103, v30, v31
    v_exp_f32 v26, v50
    v_exp_f32 v27, v51
    v_mfma_f32_32x32x16_bf16 a[64:79], a[192:195], v[112:115], a[64:79]
    ds_read_b128 a[212:215], v2 offset:21504
    v_add_f32 v14, v14, v24
    v_add_f32 v15, v15, v25
    v_cvt_pk_bf16_f32 v104, v24, v25
    v_mfma_f32_32x32x16_bf16 a[128:143], a[192:195], v[120:123], a[128:143]
    s_waitcnt lgkmcnt(4)
    buffer_load_dwordx4 v1, s[12:15], s25 offen offset:0 sc1 lds
    v_exp_f32 v28, v52
    v_exp_f32 v29, v53
    v_mfma_f32_32x32x16_bf16 a[64:79], a[196:199], v[116:119], a[64:79]
    ds_read_b128 a[216:219], v2 offset:22528
    v_add_f32 v14, v14, v26
    v_add_f32 v15, v15, v27
    v_cvt_pk_bf16_f32 v105, v26, v27
    v_exp_f32 v30, v54
    v_mfma_f32_32x32x16_bf16 a[128:143], a[196:199], v[124:127], a[128:143]
    s_waitcnt lgkmcnt(4)
    v_exp_f32 v31, v55
    v_mfma_f32_32x32x16_bf16 a[80:95], a[200:203], v[112:115], a[80:95]
    ds_read_b128 a[220:223], v2 offset:23552
    v_add_f32 v14, v14, v28
    v_add_f32 v15, v15, v29
    v_cvt_pk_bf16_f32 v106, v28, v29
    v_exp_f32 v24, v56
    v_mfma_f32_32x32x16_bf16 a[144:159], a[200:203], v[120:123], a[144:159]
    s_waitcnt lgkmcnt(4)
    buffer_load_dwordx4 v1, s[12:15], s25 offen offset:1024 sc1 lds
    v_exp_f32 v25, v57
    v_add_f32 v14, v14, v30
    v_mfma_f32_32x32x16_bf16 a[80:95], a[204:207], v[116:119], a[80:95]
    ds_read_b128 a[192:195], v2 offset:8192
    v_add_f32 v15, v15, v31
    v_cvt_pk_bf16_f32 v107, v30, v31
    v_exp_f32 v26, v58
    v_mfma_f32_32x32x16_bf16 a[144:159], a[204:207], v[124:127], a[144:159]
    s_waitcnt lgkmcnt(4)
    v_exp_f32 v27, v59
    v_add_f32 v14, v14, v24
    v_add_f32 v15, v15, v25
    v_mfma_f32_32x32x16_bf16 a[96:111], a[208:211], v[112:115], a[96:111]
    ds_read_b128 a[196:199], v2 offset:9216
    v_cvt_pk_bf16_f32 v108, v24, v25
    v_exp_f32 v28, v60
    v_exp_f32 v29, v61
    v_mfma_f32_32x32x16_bf16 a[160:175], a[208:211], v[120:123], a[160:175]
    s_waitcnt lgkmcnt(4)
    buffer_load_dwordx4 v1, s[12:15], s25 offen offset:2048 sc1 lds
    v_add_f32 v14, v14, v26
    v_add_f32 v15, v15, v27
    v_cvt_pk_bf16_f32 v109, v26, v27
    v_mfma_f32_32x32x16_bf16 a[96:111], a[212:215], v[116:119], a[96:111]
    ds_read_b128 a[200:203], v2 offset:10240
    v_exp_f32 v30, v62
    v_exp_f32 v31, v63
    v_mfma_f32_32x32x16_bf16 a[160:175], a[212:215], v[124:127], a[160:175]
    s_waitcnt lgkmcnt(4)
    v_add_f32 v14, v14, v28
    v_add_f32 v15, v15, v29
    v_cvt_pk_bf16_f32 v110, v28, v29
    v_add_f32 v14, v14, v30
    v_mfma_f32_32x32x16_bf16 a[112:127], a[216:219], v[112:115], a[112:127]
    ds_read_b128 a[204:207], v2 offset:11264
    v_add_f32 v15, v15, v31
    v_cvt_pk_bf16_f32 v111, v30, v31
    v_max3_f32 v16, v12, v13, v14
    v_max_f32 v16, v16, v15
    v_mfma_f32_32x32x16_bf16 a[176:191], a[216:219], v[120:123], a[176:191]
    s_waitcnt lgkmcnt(4)
    buffer_load_dwordx4 v1, s[12:15], s25 offen offset:3072 sc1 lds
    v_cmp_nge_f32_e64 vcc, s27, v16
    v_mfma_f32_32x32x16_bf16 a[112:127], a[220:223], v[116:119], a[112:127]
    s_or_b64 s[36:37], vcc, s[30:31]
    ds_read_b128 a[208:211], v2 offset:12288
    v_mfma_f32_32x32x16_bf16 a[176:191], a[220:223], v[124:127], a[176:191]
    s_waitcnt lgkmcnt(4)
    s_cbranch_scc1 at_dp_218
s_at_rb_219:
    v_mfma_f32_32x32x16_bf16 v[32:47], a[192:195], a[0:3], v[128:143]
    s_add_u32 s25, s25, 12288
    ds_read_b128 a[212:215], v2 offset:13312
    v_mov_b64 v[20:21], v[12:13]
    v_mov_b64 v[22:23], v[14:15]
    v_exp_f32 v24, v64
    v_mfma_f32_32x32x16_bf16 v[48:63], a[192:195], a[32:35], v[144:159]
    s_waitcnt lgkmcnt(4)
    v_exp_f32 v25, v65
    v_exp_f32 v26, v66
    v_exp_f32 v27, v67
    v_mfma_f32_32x32x16_bf16 v[32:47], a[196:199], a[4:7], v[32:47]
    s_add_u32 s26, s26, 32768
    ds_read_b128 a[216:219], v2 offset:14336
    v_add_f32 v12, v12, v24
    v_add_f32 v13, v13, v25
    v_cvt_pk_bf16_f32 v112, v24, v25
    v_exp_f32 v28, v68
    v_mfma_f32_32x32x16_bf16 v[48:63], a[196:199], a[36:39], v[48:63]
    s_waitcnt lgkmcnt(4)
    v_exp_f32 v29, v69
    v_add_f32 v12, v12, v26
    v_mfma_f32_32x32x16_bf16 v[32:47], a[200:203], a[8:11], v[32:47]
    s_and_b32 s26, s26, 131071
    ds_read_b128 a[220:223], v2 offset:15360
    v_add_f32 v13, v13, v27
    v_cvt_pk_bf16_f32 v113, v26, v27
    v_exp_f32 v30, v70
    v_mfma_f32_32x32x16_bf16 v[48:63], a[200:203], a[40:43], v[48:63]
    s_waitcnt lgkmcnt(4)
    v_exp_f32 v31, v71
    v_add_f32 v12, v12, v28
    v_add_f32 v13, v13, v29
    v_mfma_f32_32x32x16_bf16 v[32:47], a[204:207], a[12:15], v[32:47]
    s_add_u32 s24, s24, 1
    ds_read_b128 a[192:195], v2 offset:24576
    v_cvt_pk_bf16_f32 v114, v28, v29
    v_exp_f32 v24, v72
    v_exp_f32 v25, v73
    v_mfma_f32_32x32x16_bf16 v[48:63], a[204:207], a[44:47], v[48:63]
    s_waitcnt lgkmcnt(4)
    v_add_f32 v12, v12, v30
    v_add_f32 v13, v13, v31
    v_cvt_pk_bf16_f32 v115, v30, v31
    v_mfma_f32_32x32x16_bf16 v[32:47], a[208:211], a[16:19], v[32:47]
    s_add_u32 s36, s24, 1
    ds_read_b128 a[196:199], v2 offset:25600
    v_exp_f32 v26, v74
    v_exp_f32 v27, v75
    v_mfma_f32_32x32x16_bf16 v[48:63], a[208:211], a[48:51], v[48:63]
    s_waitcnt lgkmcnt(4)
    v_add_f32 v12, v12, v24
    v_add_f32 v13, v13, v25
    v_cvt_pk_bf16_f32 v116, v24, v25
    v_mfma_f32_32x32x16_bf16 v[32:47], a[212:215], a[20:23], v[32:47]
    s_cmp_ge_u32 s36, s22
    ds_read_b128 a[200:203], v2 offset:26624
    v_exp_f32 v28, v76
    v_exp_f32 v29, v77
    v_mfma_f32_32x32x16_bf16 v[48:63], a[212:215], a[52:55], v[48:63]
    s_waitcnt lgkmcnt(4)
    v_add_f32 v12, v12, v26
    v_add_f32 v13, v13, v27
    v_cvt_pk_bf16_f32 v117, v26, v27
    v_exp_f32 v30, v78
    v_mfma_f32_32x32x16_bf16 v[32:47], a[216:219], a[24:27], v[32:47]
    s_cselect_b64 s[30:31], -1, 0
    ds_read_b128 a[204:207], v2 offset:27648
    v_exp_f32 v31, v79
    v_add_f32 v12, v12, v28
    v_mfma_f32_32x32x16_bf16 v[48:63], a[216:219], a[56:59], v[48:63]
    s_waitcnt lgkmcnt(4)
    v_add_f32 v13, v13, v29
    v_cvt_pk_bf16_f32 v118, v28, v29
    v_exp_f32 v24, v80
    v_mfma_f32_32x32x16_bf16 v[32:47], a[220:223], a[28:31], v[32:47]
    ds_read_b128 a[208:211], v2 offset:28672
    v_exp_f32 v25, v81
    v_add_f32 v12, v12, v30
    v_add_f32 v13, v13, v31
    v_mfma_f32_32x32x16_bf16 v[48:63], a[220:223], a[60:63], v[48:63]
    s_waitcnt lgkmcnt(4)
    v_cvt_pk_bf16_f32 v119, v30, v31
    v_exp_f32 v26, v82
    v_exp_f32 v27, v83
    v_mfma_f32_32x32x16_bf16 a[64:79], a[192:195], v[96:99], a[64:79]
    ds_read_b128 a[212:215], v2 offset:29696
    v_add_f32 v14, v14, v24
    v_add_f32 v15, v15, v25
    v_cvt_pk_bf16_f32 v120, v24, v25
    v_mfma_f32_32x32x16_bf16 a[128:143], a[192:195], v[104:107], a[128:143]
    s_waitcnt lgkmcnt(4)
    v_exp_f32 v28, v84
    v_exp_f32 v29, v85
    v_mfma_f32_32x32x16_bf16 a[64:79], a[196:199], v[100:103], a[64:79]
    ds_read_b128 a[216:219], v2 offset:30720
    v_add_f32 v14, v14, v26
    v_add_f32 v15, v15, v27
    v_cvt_pk_bf16_f32 v121, v26, v27
    v_exp_f32 v30, v86
    v_mfma_f32_32x32x16_bf16 a[128:143], a[196:199], v[108:111], a[128:143]
    s_waitcnt lgkmcnt(4)
    v_exp_f32 v31, v87
    v_mfma_f32_32x32x16_bf16 a[80:95], a[200:203], v[96:99], a[80:95]
    ds_read_b128 a[220:223], v2 offset:31744
    v_add_f32 v14, v14, v28
    v_add_f32 v15, v15, v29
    v_cvt_pk_bf16_f32 v122, v28, v29
    v_exp_f32 v24, v88
    v_mfma_f32_32x32x16_bf16 a[144:159], a[200:203], v[104:107], a[144:159]
    s_waitcnt lgkmcnt(4)
    s_waitcnt vmcnt(8)
    s_barrier
    v_mfma_f32_32x32x16_bf16 a[80:95], a[204:207], v[100:103], a[80:95]
    ds_read_b128 a[192:195], v2 offset:32768
    v_exp_f32 v25, v89
    v_add_f32 v14, v14, v30
    v_add_f32 v15, v15, v31
    v_cvt_pk_bf16_f32 v123, v30, v31
    v_mfma_f32_32x32x16_bf16 a[144:159], a[204:207], v[108:111], a[144:159]
    s_waitcnt lgkmcnt(4)
    v_exp_f32 v26, v90
    v_exp_f32 v27, v91
    v_add_f32 v14, v14, v24
    v_add_f32 v15, v15, v25
    v_mfma_f32_32x32x16_bf16 a[96:111], a[208:211], v[96:99], a[96:111]
    ds_read_b128 a[196:199], v2 offset:33792
    v_cvt_pk_bf16_f32 v124, v24, v25
    v_exp_f32 v28, v92
    v_exp_f32 v29, v93
    v_mfma_f32_32x32x16_bf16 a[160:175], a[208:211], v[104:107], a[160:175]
    s_waitcnt lgkmcnt(4)
    v_add_f32 v14, v14, v26
    v_add_f32 v15, v15, v27
    v_cvt_pk_bf16_f32 v125, v26, v27
    v_mfma_f32_32x32x16_bf16 a[96:111], a[212:215], v[100:103], a[96:111]
    ds_read_b128 a[200:203], v2 offset:34816
    v_exp_f32 v30, v94
    v_exp_f32 v31, v95
    v_mfma_f32_32x32x16_bf16 a[160:175], a[212:215], v[108:111], a[160:175]
    s_waitcnt lgkmcnt(4)
    v_add_f32 v14, v14, v28
    v_add_f32 v15, v15, v29
    v_cvt_pk_bf16_f32 v126, v28, v29
    v_add_f32_e64 v14, v14, v30
    v_mfma_f32_32x32x16_bf16 a[112:127], a[216:219], v[96:99], a[112:127]
    ds_read_b128 a[204:207], v2 offset:35840
    v_add_f32_e64 v15, v15, v31
    v_cvt_pk_bf16_f32 v127, v30, v31
    v_max3_f32 v16, v12, v13, v14
    v_max_f32_e64 v16, v16, v15
    v_mfma_f32_32x32x16_bf16 a[176:191], a[216:219], v[104:107], a[176:191]
    s_waitcnt lgkmcnt(4)
    v_cmp_nge_f32_e64 vcc, s27, v16
    v_mfma_f32_32x32x16_bf16 a[112:127], a[220:223], v[100:103], a[112:127]
    s_or_b64 s[36:37], vcc, s[30:31]
    ds_read_b128 a[208:211], v2 offset:36864
    v_mfma_f32_32x32x16_bf16 a[176:191], a[220:223], v[108:111], a[176:191]
    s_waitcnt lgkmcnt(4)
    s_cbranch_scc1 at_dp_221
s_at_rb_222:
    v_mfma_f32_32x32x16_bf16 v[64:79], a[192:195], a[0:3], v[128:143]
    s_mov_b32 m0, s26
    ds_read_b128 a[212:215], v2 offset:37888
    v_mov_b64 v[20:21], v[12:13]
    v_mov_b64 v[22:23], v[14:15]
    v_exp_f32 v24, v32
    v_mfma_f32_32x32x16_bf16 v[80:95], a[192:195], a[32:35], v[144:159]
    s_waitcnt lgkmcnt(4)
    buffer_load_dwordx4 v1, s[12:15], s25 offen offset:0 sc1 lds
    v_exp_f32 v25, v33
    v_exp_f32 v26, v34
    v_mfma_f32_32x32x16_bf16 v[64:79], a[196:199], a[4:7], v[64:79]
    s_add_u32 s36, s24, 2
    ds_read_b128 a[216:219], v2 offset:38912
    v_exp_f32 v27, v35
    v_add_f32 v12, v12, v24
    v_add_f32 v13, v13, v25
    v_cvt_pk_bf16_f32 v96, v24, v25
    v_mfma_f32_32x32x16_bf16 v[80:95], a[196:199], a[36:39], v[80:95]
    s_waitcnt lgkmcnt(4)
    v_exp_f32 v28, v36
    v_exp_f32 v29, v37
    v_add_f32 v12, v12, v26
    v_mfma_f32_32x32x16_bf16 v[64:79], a[200:203], a[8:11], v[64:79]
    s_cmp_eq_u32 s36, s22
    ds_read_b128 a[220:223], v2 offset:39936
    v_add_f32 v13, v13, v27
    v_cvt_pk_bf16_f32 v97, v26, v27
    v_exp_f32 v30, v38
    v_mfma_f32_32x32x16_bf16 v[80:95], a[200:203], a[40:43], v[80:95]
    s_waitcnt lgkmcnt(4)
    buffer_load_dwordx4 v1, s[12:15], s25 offen offset:1024 sc1 lds
    v_exp_f32 v31, v39
    v_add_f32 v12, v12, v28
    v_add_f32 v13, v13, v29
    v_mfma_f32_32x32x16_bf16 v[64:79], a[204:207], a[12:15], v[64:79]
    s_cselect_b64 s[30:31], -1, 0
    ds_read_b128 a[192:195], v2 offset:49152
    v_cvt_pk_bf16_f32 v98, v28, v29
    v_exp_f32 v24, v40
    v_exp_f32 v25, v41
    v_mfma_f32_32x32x16_bf16 v[80:95], a[204:207], a[44:47], v[80:95]
    s_waitcnt lgkmcnt(4)
    v_add_f32 v12, v12, v30
    v_add_f32 v13, v13, v31
    v_cvt_pk_bf16_f32 v99, v30, v31
    v_mfma_f32_32x32x16_bf16 v[64:79], a[208:211], a[16:19], v[64:79]
    ds_read_b128 a[196:199], v2 offset:50176
    v_exp_f32 v26, v42
    v_exp_f32 v27, v43
    v_mfma_f32_32x32x16_bf16 v[80:95], a[208:211], a[48:51], v[80:95]
    s_waitcnt lgkmcnt(4)
    buffer_load_dwordx4 v1, s[12:15], s25 offen offset:2048 sc1 lds
    v_add_f32 v12, v12, v24
    v_add_f32 v13, v13, v25
    v_cvt_pk_bf16_f32 v100, v24, v25
    v_mfma_f32_32x32x16_bf16 v[64:79], a[212:215], a[20:23], v[64:79]
    ds_read_b128 a[200:203], v2 offset:51200
    v_exp_f32 v28, v44
    v_exp_f32 v29, v45
    v_mfma_f32_32x32x16_bf16 v[80:95], a[212:215], a[52:55], v[80:95]
    s_waitcnt lgkmcnt(4)
    v_add_f32 v12, v12, v26
    v_add_f32 v13, v13, v27
    v_cvt_pk_bf16_f32 v101, v26, v27
    v_exp_f32 v30, v46
    v_mfma_f32_32x32x16_bf16 v[64:79], a[216:219], a[24:27], v[64:79]
    ds_read_b128 a[204:207], v2 offset:52224
    v_exp_f32 v31, v47
    v_add_f32 v12, v12, v28
    v_mfma_f32_32x32x16_bf16 v[80:95], a[216:219], a[56:59], v[80:95]
    s_waitcnt lgkmcnt(4)
    buffer_load_dwordx4 v1, s[12:15], s25 offen offset:3072 sc1 lds
    v_add_f32 v13, v13, v29
    v_cvt_pk_bf16_f32 v102, v28, v29
    v_exp_f32 v24, v48
    v_mfma_f32_32x32x16_bf16 v[64:79], a[220:223], a[28:31], v[64:79]
    s_add_u32 m0, s26, 4096
    s_add_u32 s25, s25, 4096
    ds_read_b128 a[208:211], v2 offset:53248
    v_exp_f32 v25, v49
    v_add_f32 v12, v12, v30
    v_add_f32 v13, v13, v31
    v_mfma_f32_32x32x16_bf16 v[80:95], a[220:223], a[60:63], v[80:95]
    s_waitcnt lgkmcnt(4)
    v_cvt_pk_bf16_f32 v103, v30, v31
    v_exp_f32 v26, v50
    v_exp_f32 v27, v51
    v_mfma_f32_32x32x16_bf16 a[64:79], a[192:195], v[112:115], a[64:79]
    ds_read_b128 a[212:215], v2 offset:54272
    v_add_f32 v14, v14, v24
    v_add_f32 v15, v15, v25
    v_cvt_pk_bf16_f32 v104, v24, v25
    v_mfma_f32_32x32x16_bf16 a[128:143], a[192:195], v[120:123], a[128:143]
    s_waitcnt lgkmcnt(4)
    buffer_load_dwordx4 v1, s[12:15], s25 offen offset:0 sc1 lds
    v_exp_f32 v28, v52
    v_exp_f32 v29, v53
    v_mfma_f32_32x32x16_bf16 a[64:79], a[196:199], v[116:119], a[64:79]
    ds_read_b128 a[216:219], v2 offset:55296
    v_add_f32 v14, v14, v26
    v_add_f32 v15, v15, v27
    v_cvt_pk_bf16_f32 v105, v26, v27
    v_exp_f32 v30, v54
    v_mfma_f32_32x32x16_bf16 a[128:143], a[196:199], v[124:127], a[128:143]
    s_waitcnt lgkmcnt(4)
    v_exp_f32 v31, v55
    v_mfma_f32_32x32x16_bf16 a[80:95], a[200:203], v[112:115], a[80:95]
    ds_read_b128 a[220:223], v2 offset:56320
    v_add_f32 v14, v14, v28
    v_add_f32 v15, v15, v29
    v_cvt_pk_bf16_f32 v106, v28, v29
    v_exp_f32 v24, v56
    v_mfma_f32_32x32x16_bf16 a[144:159], a[200:203], v[120:123], a[144:159]
    s_waitcnt lgkmcnt(4)
    buffer_load_dwordx4 v1, s[12:15], s25 offen offset:1024 sc1 lds
    v_exp_f32 v25, v57
    v_add_f32 v14, v14, v30
    v_mfma_f32_32x32x16_bf16 a[80:95], a[204:207], v[116:119], a[80:95]
    ds_read_b128 a[192:195], v2 offset:40960
    v_add_f32 v15, v15, v31
    v_cvt_pk_bf16_f32 v107, v30, v31
    v_exp_f32 v26, v58
    v_mfma_f32_32x32x16_bf16 a[144:159], a[204:207], v[124:127], a[144:159]
    s_waitcnt lgkmcnt(4)
    v_exp_f32 v27, v59
    v_add_f32 v14, v14, v24
    v_add_f32 v15, v15, v25
    v_mfma_f32_32x32x16_bf16 a[96:111], a[208:211], v[112:115], a[96:111]
    ds_read_b128 a[196:199], v2 offset:41984
    v_cvt_pk_bf16_f32 v108, v24, v25
    v_exp_f32 v28, v60
    v_exp_f32 v29, v61
    v_mfma_f32_32x32x16_bf16 a[160:175], a[208:211], v[120:123], a[160:175]
    s_waitcnt lgkmcnt(4)
    buffer_load_dwordx4 v1, s[12:15], s25 offen offset:2048 sc1 lds
    v_add_f32 v14, v14, v26
    v_add_f32 v15, v15, v27
    v_cvt_pk_bf16_f32 v109, v26, v27
    v_mfma_f32_32x32x16_bf16 a[96:111], a[212:215], v[116:119], a[96:111]
    ds_read_b128 a[200:203], v2 offset:43008
    v_exp_f32 v30, v62
    v_exp_f32 v31, v63
    v_mfma_f32_32x32x16_bf16 a[160:175], a[212:215], v[124:127], a[160:175]
    s_waitcnt lgkmcnt(4)
    v_add_f32 v14, v14, v28
    v_add_f32 v15, v15, v29
    v_cvt_pk_bf16_f32 v110, v28, v29
    v_add_f32 v14, v14, v30
    v_mfma_f32_32x32x16_bf16 a[112:127], a[216:219], v[112:115], a[112:127]
    ds_read_b128 a[204:207], v2 offset:44032
    v_add_f32 v15, v15, v31
    v_cvt_pk_bf16_f32 v111, v30, v31
    v_max3_f32 v16, v12, v13, v14
    v_max_f32 v16, v16, v15
    v_mfma_f32_32x32x16_bf16 a[176:191], a[216:219], v[120:123], a[176:191]
    s_waitcnt lgkmcnt(4)
    buffer_load_dwordx4 v1, s[12:15], s25 offen offset:3072 sc1 lds
    v_cmp_nge_f32 vcc, s27, v16
    v_mfma_f32_32x32x16_bf16 a[112:127], a[220:223], v[116:119], a[112:127]
    s_or_b64 s[36:37], vcc, s[30:31]
    ds_read_b128 a[208:211], v2 offset:45056
    v_mfma_f32_32x32x16_bf16 a[176:191], a[220:223], v[124:127], a[176:191]
    s_waitcnt lgkmcnt(4)
    s_cbranch_scc1 at_dp_224
s_at_rb_225:
    v_mfma_f32_32x32x16_bf16 v[32:47], a[192:195], a[0:3], v[128:143]
    s_add_u32 s25, s25, 12288
    ds_read_b128 a[212:215], v2 offset:46080
    v_mov_b64 v[20:21], v[12:13]
    v_mov_b64 v[22:23], v[14:15]
    v_exp_f32 v24, v64
    v_mfma_f32_32x32x16_bf16 v[48:63], a[192:195], a[32:35], v[144:159]
    s_waitcnt lgkmcnt(4)
    v_exp_f32 v25, v65
    v_exp_f32 v26, v66
    v_exp_f32 v27, v67
    v_mfma_f32_32x32x16_bf16 v[32:47], a[196:199], a[4:7], v[32:47]
    s_add_u32 s26, s26, 32768
    ds_read_b128 a[216:219], v2 offset:47104
    v_add_f32 v12, v12, v24
    v_add_f32 v13, v13, v25
    v_cvt_pk_bf16_f32 v112, v24, v25
    v_exp_f32 v28, v68
    v_mfma_f32_32x32x16_bf16 v[48:63], a[196:199], a[36:39], v[48:63]
    s_waitcnt lgkmcnt(4)
    v_exp_f32 v29, v69
    v_add_f32 v12, v12, v26
    v_mfma_f32_32x32x16_bf16 v[32:47], a[200:203], a[8:11], v[32:47]
    s_and_b32 s26, s26, 131071
    ds_read_b128 a[220:223], v2 offset:48128
    v_add_f32 v13, v13, v27
    v_cvt_pk_bf16_f32 v113, v26, v27
    v_exp_f32 v30, v70
    v_mfma_f32_32x32x16_bf16 v[48:63], a[200:203], a[40:43], v[48:63]
    s_waitcnt lgkmcnt(4)
    v_exp_f32 v31, v71
    v_add_f32 v12, v12, v28
    v_add_f32 v13, v13, v29
    v_mfma_f32_32x32x16_bf16 v[32:47], a[204:207], a[12:15], v[32:47]
    s_add_u32 s24, s24, 1
    ds_read_b128 a[192:195], v2 offset:57344
    v_cvt_pk_bf16_f32 v114, v28, v29
    v_exp_f32 v24, v72
    v_exp_f32 v25, v73
    v_mfma_f32_32x32x16_bf16 v[48:63], a[204:207], a[44:47], v[48:63]
    s_waitcnt lgkmcnt(4)
    v_add_f32 v12, v12, v30
    v_add_f32 v13, v13, v31
    v_cvt_pk_bf16_f32 v115, v30, v31
    v_mfma_f32_32x32x16_bf16 v[32:47], a[208:211], a[16:19], v[32:47]
    s_add_u32 s36, s24, 1
    ds_read_b128 a[196:199], v2 offset:58368
    v_exp_f32 v26, v74
    v_exp_f32 v27, v75
    v_mfma_f32_32x32x16_bf16 v[48:63], a[208:211], a[48:51], v[48:63]
    s_waitcnt lgkmcnt(4)
    v_add_f32 v12, v12, v24
    v_add_f32 v13, v13, v25
    v_cvt_pk_bf16_f32 v116, v24, v25
    v_mfma_f32_32x32x16_bf16 v[32:47], a[212:215], a[20:23], v[32:47]
    s_cmp_ge_u32 s36, s22
    ds_read_b128 a[200:203], v2 offset:59392
    v_exp_f32 v28, v76
    v_exp_f32 v29, v77
    v_mfma_f32_32x32x16_bf16 v[48:63], a[212:215], a[52:55], v[48:63]
    s_waitcnt lgkmcnt(4)
    v_add_f32 v12, v12, v26
    v_add_f32 v13, v13, v27
    v_cvt_pk_bf16_f32 v117, v26, v27
    v_exp_f32 v30, v78
    v_mfma_f32_32x32x16_bf16 v[32:47], a[216:219], a[24:27], v[32:47]
    s_cselect_b64 s[30:31], -1, 0
    ds_read_b128 a[204:207], v2 offset:60416
    v_exp_f32 v31, v79
    v_add_f32 v12, v12, v28
    v_mfma_f32_32x32x16_bf16 v[48:63], a[216:219], a[56:59], v[48:63]
    s_waitcnt lgkmcnt(4)
    v_add_f32 v13, v13, v29
    v_cvt_pk_bf16_f32 v118, v28, v29
    v_exp_f32 v24, v80
    v_mfma_f32_32x32x16_bf16 v[32:47], a[220:223], a[28:31], v[32:47]
    ds_read_b128 a[208:211], v2 offset:61440
    v_exp_f32 v25, v81
    v_add_f32 v12, v12, v30
    v_add_f32 v13, v13, v31
    v_mfma_f32_32x32x16_bf16 v[48:63], a[220:223], a[60:63], v[48:63]
    s_waitcnt lgkmcnt(4)
    v_cvt_pk_bf16_f32 v119, v30, v31
    v_exp_f32 v26, v82
    v_exp_f32 v27, v83
    v_mfma_f32_32x32x16_bf16 a[64:79], a[192:195], v[96:99], a[64:79]
    ds_read_b128 a[212:215], v2 offset:62464
    v_add_f32 v14, v14, v24
    v_add_f32 v15, v15, v25
    v_cvt_pk_bf16_f32 v120, v24, v25
    v_mfma_f32_32x32x16_bf16 a[128:143], a[192:195], v[104:107], a[128:143]
    s_waitcnt lgkmcnt(4)
    v_exp_f32 v28, v84
    v_exp_f32 v29, v85
    v_mfma_f32_32x32x16_bf16 a[64:79], a[196:199], v[100:103], a[64:79]
    ds_read_b128 a[216:219], v2 offset:63488
    v_add_f32 v14, v14, v26
    v_add_f32 v15, v15, v27
    v_cvt_pk_bf16_f32 v121, v26, v27
    v_exp_f32 v30, v86
    v_mfma_f32_32x32x16_bf16 a[128:143], a[196:199], v[108:111], a[128:143]
    s_waitcnt lgkmcnt(4)
    v_exp_f32 v31, v87
    v_mfma_f32_32x32x16_bf16 a[80:95], a[200:203], v[96:99], a[80:95]
    ds_read_b128 a[220:223], v2 offset:64512
    v_add_f32 v14, v14, v28
    v_add_f32 v15, v15, v29
    v_cvt_pk_bf16_f32 v122, v28, v29
    v_exp_f32 v24, v88
    v_mfma_f32_32x32x16_bf16 a[144:159], a[200:203], v[104:107], a[144:159]
    s_waitcnt lgkmcnt(4)
    s_waitcnt vmcnt(8)
    s_barrier
    v_xor_b32 v2, s29, v2
    v_mfma_f32_32x32x16_bf16 a[80:95], a[204:207], v[100:103], a[80:95]
    ds_read_b128 a[192:195], v2 offset:0
    v_exp_f32 v25, v89
    v_add_f32 v14, v14, v30
    v_add_f32 v15, v15, v31
    v_cvt_pk_bf16_f32 v123, v30, v31
    v_mfma_f32_32x32x16_bf16 a[144:159], a[204:207], v[108:111], a[144:159]
    s_waitcnt lgkmcnt(4)
    v_exp_f32 v26, v90
    v_exp_f32 v27, v91
    v_add_f32 v14, v14, v24
    v_add_f32 v15, v15, v25
    v_mfma_f32_32x32x16_bf16 a[96:111], a[208:211], v[96:99], a[96:111]
    ds_read_b128 a[196:199], v2 offset:1024
    v_cvt_pk_bf16_f32 v124, v24, v25
    v_exp_f32 v28, v92
    v_exp_f32 v29, v93
    v_mfma_f32_32x32x16_bf16 a[160:175], a[208:211], v[104:107], a[160:175]
    s_waitcnt lgkmcnt(4)
    v_add_f32 v14, v14, v26
    v_add_f32 v15, v15, v27
    v_cvt_pk_bf16_f32 v125, v26, v27
    v_mfma_f32_32x32x16_bf16 a[96:111], a[212:215], v[100:103], a[96:111]
    ds_read_b128 a[200:203], v2 offset:2048
    v_exp_f32 v30, v94
    v_exp_f32 v31, v95
    v_mfma_f32_32x32x16_bf16 a[160:175], a[212:215], v[108:111], a[160:175]
    s_waitcnt lgkmcnt(4)
    v_add_f32 v14, v14, v28
    v_add_f32 v15, v15, v29
    v_cvt_pk_bf16_f32 v126, v28, v29
    v_add_f32 v14, v14, v30
    v_mfma_f32_32x32x16_bf16 a[112:127], a[216:219], v[96:99], a[112:127]
    ds_read_b128 a[204:207], v2 offset:3072
    v_add_f32_e64 v15, v15, v31
    v_cvt_pk_bf16_f32 v127, v30, v31
    v_max3_f32 v16, v12, v13, v14
    v_max_f32_e64 v16, v16, v15
    v_mfma_f32_32x32x16_bf16 a[176:191], a[216:219], v[104:107], a[176:191]
    s_waitcnt lgkmcnt(4)
    v_cmp_nge_f32_e64 vcc, s27, v16
    v_mfma_f32_32x32x16_bf16 a[112:127], a[220:223], v[100:103], a[112:127]
    s_or_b64 s[36:37], vcc, s[30:31]
    ds_read_b128 a[208:211], v2 offset:4096
    v_mfma_f32_32x32x16_bf16 a[176:191], a[220:223], v[108:111], a[176:191]
    s_waitcnt lgkmcnt(4)
    s_cbranch_scc1 at_dp_227
s_at_rb_228:
    s_branch at_loop_214
at_dp_218:
    s_cbranch_vccz at_nr_220
    v_max3_f32 v4, v32, v33, v34
    v_max3_f32 v4, v4, v35, v36
    v_max3_f32 v4, v4, v37, v38
    v_max3_f32 v4, v4, v39, v40
    v_max3_f32 v4, v4, v41, v42
    v_max3_f32 v4, v4, v43, v44
    v_max3_f32 v4, v4, v45, v46
    v_max_f32 v4, v4, v47
    v_mov_b32 v5, v4
    s_nop 1
    v_permlane32_swap_b32 v4, v5
    v_max_f32 v4, v4, v5
    v_add_f32 v6, v20, v21
    v_mov_b32 v5, v6
    s_nop 1
    v_permlane32_swap_b32 v6, v5
    v_add_f32 v6, v6, v5
    v_log_f32 v6, v6
    s_nop 0
    v_add_f32 v6, -4.0, v6
    v_add_f32 v6, -4.0, v6
    v_add_f32 v6, -4.0, v6
    v_max3_f32 v4, v4, 0, v6
    v_sub_f32 v32, v32, v4
    v_sub_f32 v33, v33, v4
    v_sub_f32 v34, v34, v4
    v_sub_f32 v35, v35, v4
    v_sub_f32 v36, v36, v4
    v_sub_f32 v37, v37, v4
    v_sub_f32 v38, v38, v4
    v_sub_f32 v39, v39, v4
    v_sub_f32 v40, v40, v4
    v_sub_f32 v41, v41, v4
    v_sub_f32 v42, v42, v4
    v_sub_f32 v43, v43, v4
    v_sub_f32 v44, v44, v4
    v_sub_f32 v45, v45, v4
    v_sub_f32 v46, v46, v4
    v_sub_f32 v47, v47, v4
    v_sub_f32 v128, v128, v4
    v_sub_f32 v129, v129, v4
    v_sub_f32 v130, v130, v4
    v_sub_f32 v131, v131, v4
    v_sub_f32 v132, v132, v4
    v_sub_f32 v133, v133, v4
    v_sub_f32 v134, v134, v4
    v_sub_f32 v135, v135, v4
    v_sub_f32 v136, v136, v4
    v_sub_f32 v137, v137, v4
    v_sub_f32 v138, v138, v4
    v_sub_f32 v139, v139, v4
    v_sub_f32 v140, v140, v4
    v_sub_f32 v141, v141, v4
    v_sub_f32 v142, v142, v4
    v_sub_f32 v143, v143, v4
    v_sub_f32 v64, v64, v4
    v_sub_f32 v65, v65, v4
    v_sub_f32 v66, v66, v4
    v_sub_f32 v67, v67, v4
    v_sub_f32 v68, v68, v4
    v_sub_f32 v69, v69, v4
    v_sub_f32 v70, v70, v4
    v_sub_f32 v71, v71, v4
    v_sub_f32 v72, v72, v4
    v_sub_f32 v73, v73, v4
    v_sub_f32 v74, v74, v4
    v_sub_f32 v75, v75, v4
    v_sub_f32 v76, v76, v4
    v_sub_f32 v77, v77, v4
    v_sub_f32 v78, v78, v4
    v_sub_f32 v79, v79, v4
    v_sub_f32 v6, 0, v4
    v_exp_f32 v6, v6
    s_nop 0
    v_mul_f32 v12, v20, v6
    v_mul_f32 v13, v21, v6
    v_exp_f32 v24, v32
    v_exp_f32 v25, v33
    v_add_f32 v12, v12, v24
    v_add_f32 v13, v13, v25
    v_cvt_pk_bf16_f32 v96, v24, v25
    v_exp_f32 v24, v34
    v_exp_f32 v25, v35
    v_add_f32 v12, v12, v24
    v_add_f32 v13, v13, v25
    v_cvt_pk_bf16_f32 v97, v24, v25
    v_exp_f32 v24, v36
    v_exp_f32 v25, v37
    v_add_f32 v12, v12, v24
    v_add_f32 v13, v13, v25
    v_cvt_pk_bf16_f32 v98, v24, v25
    v_exp_f32 v24, v38
    v_exp_f32 v25, v39
    v_add_f32 v12, v12, v24
    v_add_f32 v13, v13, v25
    v_cvt_pk_bf16_f32 v99, v24, v25
    v_exp_f32 v24, v40
    v_exp_f32 v25, v41
    v_add_f32 v12, v12, v24
    v_add_f32 v13, v13, v25
    v_cvt_pk_bf16_f32 v100, v24, v25
    v_exp_f32 v24, v42
    v_exp_f32 v25, v43
    v_add_f32 v12, v12, v24
    v_add_f32 v13, v13, v25
    v_cvt_pk_bf16_f32 v101, v24, v25
    v_exp_f32 v24, v44
    v_exp_f32 v25, v45
    v_add_f32 v12, v12, v24
    v_add_f32 v13, v13, v25
    v_cvt_pk_bf16_f32 v102, v24, v25
    v_exp_f32 v24, v46
    v_exp_f32 v25, v47
    v_add_f32 v12, v12, v24
    v_add_f32 v13, v13, v25
    v_cvt_pk_bf16_f32 v103, v24, v25
    v_accvgpr_read_b32 v7, a64
    v_accvgpr_read_b32 v8, a65
    v_accvgpr_read_b32 v9, a66
    v_accvgpr_read_b32 v10, a67
    v_mul_f32 v7, v7, v6
    v_mul_f32 v8, v8, v6
    v_mul_f32 v9, v9, v6
    v_mul_f32 v10, v10, v6
    v_accvgpr_write_b32 a64, v7
    v_accvgpr_write_b32 a65, v8
    v_accvgpr_write_b32 a66, v9
    v_accvgpr_write_b32 a67, v10
    v_accvgpr_read_b32 v7, a68
    v_accvgpr_read_b32 v8, a69
    v_accvgpr_read_b32 v9, a70
    v_accvgpr_read_b32 v10, a71
    v_mul_f32 v7, v7, v6
    v_mul_f32 v8, v8, v6
    v_mul_f32 v9, v9, v6
    v_mul_f32 v10, v10, v6
    v_accvgpr_write_b32 a68, v7
    v_accvgpr_write_b32 a69, v8
    v_accvgpr_write_b32 a70, v9
    v_accvgpr_write_b32 a71, v10
    v_accvgpr_read_b32 v7, a72
    v_accvgpr_read_b32 v8, a73
    v_accvgpr_read_b32 v9, a74
    v_accvgpr_read_b32 v10, a75
    v_mul_f32 v7, v7, v6
    v_mul_f32 v8, v8, v6
    v_mul_f32 v9, v9, v6
    v_mul_f32 v10, v10, v6
    v_accvgpr_write_b32 a72, v7
    v_accvgpr_write_b32 a73, v8
    v_accvgpr_write_b32 a74, v9
    v_accvgpr_write_b32 a75, v10
    v_accvgpr_read_b32 v7, a76
    v_accvgpr_read_b32 v8, a77
    v_accvgpr_read_b32 v9, a78
    v_accvgpr_read_b32 v10, a79
    v_mul_f32 v7, v7, v6
    v_mul_f32 v8, v8, v6
    v_mul_f32 v9, v9, v6
    v_mul_f32 v10, v10, v6
    v_accvgpr_write_b32 a76, v7
    v_accvgpr_write_b32 a77, v8
    v_accvgpr_write_b32 a78, v9
    v_accvgpr_write_b32 a79, v10
    v_accvgpr_read_b32 v7, a80
    v_accvgpr_read_b32 v8, a81
    v_accvgpr_read_b32 v9, a82
    v_accvgpr_read_b32 v10, a83
    v_mul_f32 v7, v7, v6
    v_mul_f32 v8, v8, v6
    v_mul_f32 v9, v9, v6
    v_mul_f32 v10, v10, v6
    v_accvgpr_write_b32 a80, v7
    v_accvgpr_write_b32 a81, v8
    v_accvgpr_write_b32 a82, v9
    v_accvgpr_write_b32 a83, v10
    v_accvgpr_read_b32 v7, a84
    v_accvgpr_read_b32 v8, a85
    v_accvgpr_read_b32 v9, a86
    v_accvgpr_read_b32 v10, a87
    v_mul_f32 v7, v7, v6
    v_mul_f32 v8, v8, v6
    v_mul_f32 v9, v9, v6
    v_mul_f32 v10, v10, v6
    v_accvgpr_write_b32 a84, v7
    v_accvgpr_write_b32 a85, v8
    v_accvgpr_write_b32 a86, v9
    v_accvgpr_write_b32 a87, v10
    v_accvgpr_read_b32 v7, a88
    v_accvgpr_read_b32 v8, a89
    v_accvgpr_read_b32 v9, a90
    v_accvgpr_read_b32 v10, a91
    v_mul_f32 v7, v7, v6
    v_mul_f32 v8, v8, v6
    v_mul_f32 v9, v9, v6
    v_mul_f32 v10, v10, v6
    v_accvgpr_write_b32 a88, v7
    v_accvgpr_write_b32 a89, v8
    v_accvgpr_write_b32 a90, v9
    v_accvgpr_write_b32 a91, v10
    v_accvgpr_read_b32 v7, a92
    v_accvgpr_read_b32 v8, a93
    v_accvgpr_read_b32 v9, a94
    v_accvgpr_read_b32 v10, a95
    v_mul_f32 v7, v7, v6
    v_mul_f32 v8, v8, v6
    v_mul_f32 v9, v9, v6
    v_mul_f32 v10, v10, v6
    v_accvgpr_write_b32 a92, v7
    v_accvgpr_write_b32 a93, v8
    v_accvgpr_write_b32 a94, v9
    v_accvgpr_write_b32 a95, v10
    v_accvgpr_read_b32 v7, a96
    v_accvgpr_read_b32 v8, a97
    v_accvgpr_read_b32 v9, a98
    v_accvgpr_read_b32 v10, a99
    v_mul_f32 v7, v7, v6
    v_mul_f32 v8, v8, v6
    v_mul_f32 v9, v9, v6
    v_mul_f32 v10, v10, v6
    v_accvgpr_write_b32 a96, v7
    v_accvgpr_write_b32 a97, v8
    v_accvgpr_write_b32 a98, v9
    v_accvgpr_write_b32 a99, v10
    v_accvgpr_read_b32 v7, a100
    v_accvgpr_read_b32 v8, a101
    v_accvgpr_read_b32 v9, a102
    v_accvgpr_read_b32 v10, a103
    v_mul_f32 v7, v7, v6
    v_mul_f32 v8, v8, v6
    v_mul_f32 v9, v9, v6
    v_mul_f32 v10, v10, v6
    v_accvgpr_write_b32 a100, v7
    v_accvgpr_write_b32 a101, v8
    v_accvgpr_write_b32 a102, v9
    v_accvgpr_write_b32 a103, v10
    v_accvgpr_read_b32 v7, a104
    v_accvgpr_read_b32 v8, a105
    v_accvgpr_read_b32 v9, a106
    v_accvgpr_read_b32 v10, a107
    v_mul_f32 v7, v7, v6
    v_mul_f32 v8, v8, v6
    v_mul_f32 v9, v9, v6
    v_mul_f32 v10, v10, v6
    v_accvgpr_write_b32 a104, v7
    v_accvgpr_write_b32 a105, v8
    v_accvgpr_write_b32 a106, v9
    v_accvgpr_write_b32 a107, v10
    v_accvgpr_read_b32 v7, a108
    v_accvgpr_read_b32 v8, a109
    v_accvgpr_read_b32 v9, a110
    v_accvgpr_read_b32 v10, a111
    v_mul_f32 v7, v7, v6
    v_mul_f32 v8, v8, v6
    v_mul_f32 v9, v9, v6
    v_mul_f32 v10, v10, v6
    v_accvgpr_write_b32 a108, v7
    v_accvgpr_write_b32 a109, v8
    v_accvgpr_write_b32 a110, v9
    v_accvgpr_write_b32 a111, v10
    v_accvgpr_read_b32 v7, a112
    v_accvgpr_read_b32 v8, a113
    v_accvgpr_read_b32 v9, a114
    v_accvgpr_read_b32 v10, a115
    v_mul_f32 v7, v7, v6
    v_mul_f32 v8, v8, v6
    v_mul_f32 v9, v9, v6
    v_mul_f32 v10, v10, v6
    v_accvgpr_write_b32 a112, v7
    v_accvgpr_write_b32 a113, v8
    v_accvgpr_write_b32 a114, v9
    v_accvgpr_write_b32 a115, v10
    v_accvgpr_read_b32 v7, a116
    v_accvgpr_read_b32 v8, a117
    v_accvgpr_read_b32 v9, a118
    v_accvgpr_read_b32 v10, a119
    v_mul_f32 v7, v7, v6
    v_mul_f32 v8, v8, v6
    v_mul_f32 v9, v9, v6
    v_mul_f32 v10, v10, v6
    v_accvgpr_write_b32 a116, v7
    v_accvgpr_write_b32 a117, v8
    v_accvgpr_write_b32 a118, v9
    v_accvgpr_write_b32 a119, v10
    v_accvgpr_read_b32 v7, a120
    v_accvgpr_read_b32 v8, a121
    v_accvgpr_read_b32 v9, a122
    v_accvgpr_read_b32 v10, a123
    v_mul_f32 v7, v7, v6
    v_mul_f32 v8, v8, v6
    v_mul_f32 v9, v9, v6
    v_mul_f32 v10, v10, v6
    v_accvgpr_write_b32 a120, v7
    v_accvgpr_write_b32 a121, v8
    v_accvgpr_write_b32 a122, v9
    v_accvgpr_write_b32 a123, v10
    v_accvgpr_read_b32 v7, a124
    v_accvgpr_read_b32 v8, a125
    v_accvgpr_read_b32 v9, a126
    v_accvgpr_read_b32 v10, a127
    v_mul_f32 v7, v7, v6
    v_mul_f32 v8, v8, v6
    v_mul_f32 v9, v9, v6
    v_mul_f32 v10, v10, v6
    v_accvgpr_write_b32 a124, v7
    v_accvgpr_write_b32 a125, v8
    v_accvgpr_write_b32 a126, v9
    v_accvgpr_write_b32 a127, v10
    v_max3_f32 v4, v48, v49, v50
    v_max3_f32 v4, v4, v51, v52
    v_max3_f32 v4, v4, v53, v54
    v_max3_f32 v4, v4, v55, v56
    v_max3_f32 v4, v4, v57, v58
    v_max3_f32 v4, v4, v59, v60
    v_max3_f32 v4, v4, v61, v62
    v_max_f32 v4, v4, v63
    v_mov_b32 v5, v4
    s_nop 1
    v_permlane32_swap_b32 v4, v5
    v_max_f32 v4, v4, v5
    v_add_f32 v6, v22, v23
    v_mov_b32 v5, v6
    s_nop 1
    v_permlane32_swap_b32 v6, v5
    v_add_f32 v6, v6, v5
    v_log_f32 v6, v6
    s_nop 0
    v_add_f32 v6, -4.0, v6
    v_add_f32 v6, -4.0, v6
    v_add_f32 v6, -4.0, v6
    v_max3_f32 v4, v4, 0, v6
    v_sub_f32 v48, v48, v4
    v_sub_f32 v49, v49, v4
    v_sub_f32 v50, v50, v4
    v_sub_f32 v51, v51, v4
    v_sub_f32 v52, v52, v4
    v_sub_f32 v53, v53, v4
    v_sub_f32 v54, v54, v4
    v_sub_f32 v55, v55, v4
    v_sub_f32 v56, v56, v4
    v_sub_f32 v57, v57, v4
    v_sub_f32 v58, v58, v4
    v_sub_f32 v59, v59, v4
    v_sub_f32 v60, v60, v4
    v_sub_f32 v61, v61, v4
    v_sub_f32 v62, v62, v4
    v_sub_f32 v63, v63, v4
    v_sub_f32 v144, v144, v4
    v_sub_f32 v145, v145, v4
    v_sub_f32 v146, v146, v4
    v_sub_f32 v147, v147, v4
    v_sub_f32 v148, v148, v4
    v_sub_f32 v149, v149, v4
    v_sub_f32 v150, v150, v4
    v_sub_f32 v151, v151, v4
    v_sub_f32 v152, v152, v4
    v_sub_f32 v153, v153, v4
    v_sub_f32 v154, v154, v4
    v_sub_f32 v155, v155, v4
    v_sub_f32 v156, v156, v4
    v_sub_f32 v157, v157, v4
    v_sub_f32 v158, v158, v4
    v_sub_f32 v159, v159, v4
    v_sub_f32 v80, v80, v4
    v_sub_f32 v81, v81, v4
    v_sub_f32 v82, v82, v4
    v_sub_f32 v83, v83, v4
    v_sub_f32 v84, v84, v4
    v_sub_f32 v85, v85, v4
    v_sub_f32 v86, v86, v4
    v_sub_f32 v87, v87, v4
    v_sub_f32 v88, v88, v4
    v_sub_f32 v89, v89, v4
    v_sub_f32 v90, v90, v4
    v_sub_f32 v91, v91, v4
    v_sub_f32 v92, v92, v4
    v_sub_f32 v93, v93, v4
    v_sub_f32 v94, v94, v4
    v_sub_f32 v95, v95, v4
    v_sub_f32 v6, 0, v4
    v_exp_f32 v6, v6
    s_nop 0
    v_mul_f32 v14, v22, v6
    v_mul_f32 v15, v23, v6
    v_exp_f32 v24, v48
    v_exp_f32 v25, v49
    v_add_f32 v14, v14, v24
    v_add_f32 v15, v15, v25
    v_cvt_pk_bf16_f32 v104, v24, v25
    v_exp_f32 v24, v50
    v_exp_f32 v25, v51
    v_add_f32 v14, v14, v24
    v_add_f32 v15, v15, v25
    v_cvt_pk_bf16_f32 v105, v24, v25
    v_exp_f32 v24, v52
    v_exp_f32 v25, v53
    v_add_f32 v14, v14, v24
    v_add_f32 v15, v15, v25
    v_cvt_pk_bf16_f32 v106, v24, v25
    v_exp_f32 v24, v54
    v_exp_f32 v25, v55
    v_add_f32 v14, v14, v24
    v_add_f32 v15, v15, v25
    v_cvt_pk_bf16_f32 v107, v24, v25
    v_exp_f32 v24, v56
    v_exp_f32 v25, v57
    v_add_f32 v14, v14, v24
    v_add_f32 v15, v15, v25
    v_cvt_pk_bf16_f32 v108, v24, v25
    v_exp_f32 v24, v58
    v_exp_f32 v25, v59
    v_add_f32 v14, v14, v24
    v_add_f32 v15, v15, v25
    v_cvt_pk_bf16_f32 v109, v24, v25
    v_exp_f32 v24, v60
    v_exp_f32 v25, v61
    v_add_f32 v14, v14, v24
    v_add_f32 v15, v15, v25
    v_cvt_pk_bf16_f32 v110, v24, v25
    v_exp_f32 v24, v62
    v_exp_f32 v25, v63
    v_add_f32 v14, v14, v24
    v_add_f32 v15, v15, v25
    v_cvt_pk_bf16_f32 v111, v24, v25
    v_accvgpr_read_b32 v7, a128
    v_accvgpr_read_b32 v8, a129
    v_accvgpr_read_b32 v9, a130
    v_accvgpr_read_b32 v10, a131
    v_mul_f32 v7, v7, v6
    v_mul_f32 v8, v8, v6
    v_mul_f32 v9, v9, v6
    v_mul_f32 v10, v10, v6
    v_accvgpr_write_b32 a128, v7
    v_accvgpr_write_b32 a129, v8
    v_accvgpr_write_b32 a130, v9
    v_accvgpr_write_b32 a131, v10
    v_accvgpr_read_b32 v7, a132
    v_accvgpr_read_b32 v8, a133
    v_accvgpr_read_b32 v9, a134
    v_accvgpr_read_b32 v10, a135
    v_mul_f32 v7, v7, v6
    v_mul_f32 v8, v8, v6
    v_mul_f32 v9, v9, v6
    v_mul_f32 v10, v10, v6
    v_accvgpr_write_b32 a132, v7
    v_accvgpr_write_b32 a133, v8
    v_accvgpr_write_b32 a134, v9
    v_accvgpr_write_b32 a135, v10
    v_accvgpr_read_b32 v7, a136
    v_accvgpr_read_b32 v8, a137
    v_accvgpr_read_b32 v9, a138
    v_accvgpr_read_b32 v10, a139
    v_mul_f32 v7, v7, v6
    v_mul_f32 v8, v8, v6
    v_mul_f32 v9, v9, v6
    v_mul_f32 v10, v10, v6
    v_accvgpr_write_b32 a136, v7
    v_accvgpr_write_b32 a137, v8
    v_accvgpr_write_b32 a138, v9
    v_accvgpr_write_b32 a139, v10
    v_accvgpr_read_b32 v7, a140
    v_accvgpr_read_b32 v8, a141
    v_accvgpr_read_b32 v9, a142
    v_accvgpr_read_b32 v10, a143
    v_mul_f32 v7, v7, v6
    v_mul_f32 v8, v8, v6
    v_mul_f32 v9, v9, v6
    v_mul_f32 v10, v10, v6
    v_accvgpr_write_b32 a140, v7
    v_accvgpr_write_b32 a141, v8
    v_accvgpr_write_b32 a142, v9
    v_accvgpr_write_b32 a143, v10
    v_accvgpr_read_b32 v7, a144
    v_accvgpr_read_b32 v8, a145
    v_accvgpr_read_b32 v9, a146
    v_accvgpr_read_b32 v10, a147
    v_mul_f32 v7, v7, v6
    v_mul_f32 v8, v8, v6
    v_mul_f32 v9, v9, v6
    v_mul_f32 v10, v10, v6
    v_accvgpr_write_b32 a144, v7
    v_accvgpr_write_b32 a145, v8
    v_accvgpr_write_b32 a146, v9
    v_accvgpr_write_b32 a147, v10
    v_accvgpr_read_b32 v7, a148
    v_accvgpr_read_b32 v8, a149
    v_accvgpr_read_b32 v9, a150
    v_accvgpr_read_b32 v10, a151
    v_mul_f32 v7, v7, v6
    v_mul_f32 v8, v8, v6
    v_mul_f32 v9, v9, v6
    v_mul_f32 v10, v10, v6
    v_accvgpr_write_b32 a148, v7
    v_accvgpr_write_b32 a149, v8
    v_accvgpr_write_b32 a150, v9
    v_accvgpr_write_b32 a151, v10
    v_accvgpr_read_b32 v7, a152
    v_accvgpr_read_b32 v8, a153
    v_accvgpr_read_b32 v9, a154
    v_accvgpr_read_b32 v10, a155
    v_mul_f32 v7, v7, v6
    v_mul_f32 v8, v8, v6
    v_mul_f32 v9, v9, v6
    v_mul_f32 v10, v10, v6
    v_accvgpr_write_b32 a152, v7
    v_accvgpr_write_b32 a153, v8
    v_accvgpr_write_b32 a154, v9
    v_accvgpr_write_b32 a155, v10
    v_accvgpr_read_b32 v7, a156
    v_accvgpr_read_b32 v8, a157
    v_accvgpr_read_b32 v9, a158
    v_accvgpr_read_b32 v10, a159
    v_mul_f32 v7, v7, v6
    v_mul_f32 v8, v8, v6
    v_mul_f32 v9, v9, v6
    v_mul_f32 v10, v10, v6
    v_accvgpr_write_b32 a156, v7
    v_accvgpr_write_b32 a157, v8
    v_accvgpr_write_b32 a158, v9
    v_accvgpr_write_b32 a159, v10
    v_accvgpr_read_b32 v7, a160
    v_accvgpr_read_b32 v8, a161
    v_accvgpr_read_b32 v9, a162
    v_accvgpr_read_b32 v10, a163
    v_mul_f32 v7, v7, v6
    v_mul_f32 v8, v8, v6
    v_mul_f32 v9, v9, v6
    v_mul_f32 v10, v10, v6
    v_accvgpr_write_b32 a160, v7
    v_accvgpr_write_b32 a161, v8
    v_accvgpr_write_b32 a162, v9
    v_accvgpr_write_b32 a163, v10
    v_accvgpr_read_b32 v7, a164
    v_accvgpr_read_b32 v8, a165
    v_accvgpr_read_b32 v9, a166
    v_accvgpr_read_b32 v10, a167
    v_mul_f32 v7, v7, v6
    v_mul_f32 v8, v8, v6
    v_mul_f32 v9, v9, v6
    v_mul_f32 v10, v10, v6
    v_accvgpr_write_b32 a164, v7
    v_accvgpr_write_b32 a165, v8
    v_accvgpr_write_b32 a166, v9
    v_accvgpr_write_b32 a167, v10
    v_accvgpr_read_b32 v7, a168
    v_accvgpr_read_b32 v8, a169
    v_accvgpr_read_b32 v9, a170
    v_accvgpr_read_b32 v10, a171
    v_mul_f32 v7, v7, v6
    v_mul_f32 v8, v8, v6
    v_mul_f32 v9, v9, v6
    v_mul_f32 v10, v10, v6
    v_accvgpr_write_b32 a168, v7
    v_accvgpr_write_b32 a169, v8
    v_accvgpr_write_b32 a170, v9
    v_accvgpr_write_b32 a171, v10
    v_accvgpr_read_b32 v7, a172
    v_accvgpr_read_b32 v8, a173
    v_accvgpr_read_b32 v9, a174
    v_accvgpr_read_b32 v10, a175
    v_mul_f32 v7, v7, v6
    v_mul_f32 v8, v8, v6
    v_mul_f32 v9, v9, v6
    v_mul_f32 v10, v10, v6
    v_accvgpr_write_b32 a172, v7
    v_accvgpr_write_b32 a173, v8
    v_accvgpr_write_b32 a174, v9
    v_accvgpr_write_b32 a175, v10
    v_accvgpr_read_b32 v7, a176
    v_accvgpr_read_b32 v8, a177
    v_accvgpr_read_b32 v9, a178
    v_accvgpr_read_b32 v10, a179
    v_mul_f32 v7, v7, v6
    v_mul_f32 v8, v8, v6
    v_mul_f32 v9, v9, v6
    v_mul_f32 v10, v10, v6
    v_accvgpr_write_b32 a176, v7
    v_accvgpr_write_b32 a177, v8
    v_accvgpr_write_b32 a178, v9
    v_accvgpr_write_b32 a179, v10
    v_accvgpr_read_b32 v7, a180
    v_accvgpr_read_b32 v8, a181
    v_accvgpr_read_b32 v9, a182
    v_accvgpr_read_b32 v10, a183
    v_mul_f32 v7, v7, v6
    v_mul_f32 v8, v8, v6
    v_mul_f32 v9, v9, v6
    v_mul_f32 v10, v10, v6
    v_accvgpr_write_b32 a180, v7
    v_accvgpr_write_b32 a181, v8
    v_accvgpr_write_b32 a182, v9
    v_accvgpr_write_b32 a183, v10
    v_accvgpr_read_b32 v7, a184
    v_accvgpr_read_b32 v8, a185
    v_accvgpr_read_b32 v9, a186
    v_accvgpr_read_b32 v10, a187
    v_mul_f32 v7, v7, v6
    v_mul_f32 v8, v8, v6
    v_mul_f32 v9, v9, v6
    v_mul_f32 v10, v10, v6
    v_accvgpr_write_b32 a184, v7
    v_accvgpr_write_b32 a185, v8
    v_accvgpr_write_b32 a186, v9
    v_accvgpr_write_b32 a187, v10
    v_accvgpr_read_b32 v7, a188
    v_accvgpr_read_b32 v8, a189
    v_accvgpr_read_b32 v9, a190
    v_accvgpr_read_b32 v10, a191
    v_mul_f32_e64 v7, v7, v6
    v_mul_f32_e64 v8, v8, v6
    v_mul_f32_e64 v9, v9, v6
    v_mul_f32_e64 v10, v10, v6
    v_accvgpr_write_b32 a188, v7
    v_accvgpr_write_b32 a189, v8
    v_accvgpr_write_b32 a190, v9
    v_accvgpr_write_b32 a191, v10
at_nr_220:
    s_cmp_eq_u64 s[30:31], 0
    s_cbranch_scc1 s_at_rb_219
    v_mov_b32 v11, s28
    v_cmp_gt_i32 vcc, 0, v3
    s_nop 1
    v_cndmask_b32 v128, v128, v11, vcc
    v_cmp_gt_i32 vcc, 1, v3
    s_nop 1
    v_cndmask_b32 v129, v129, v11, vcc
    v_cmp_gt_i32 vcc, 2, v3
    s_nop 1
    v_cndmask_b32 v130, v130, v11, vcc
    v_cmp_gt_i32 vcc, 3, v3
    s_nop 1
    v_cndmask_b32 v131, v131, v11, vcc
    v_cmp_gt_i32 vcc, 8, v3
    s_nop 1
    v_cndmask_b32 v132, v132, v11, vcc
    v_cmp_gt_i32 vcc, 9, v3
    s_nop 1
    v_cndmask_b32 v133, v133, v11, vcc
    v_cmp_gt_i32 vcc, 10, v3
    s_nop 1
    v_cndmask_b32 v134, v134, v11, vcc
    v_cmp_gt_i32 vcc, 11, v3
    s_nop 1
    v_cndmask_b32 v135, v135, v11, vcc
    v_cmp_gt_i32 vcc, 16, v3
    s_nop 1
    v_cndmask_b32 v136, v136, v11, vcc
    v_cmp_gt_i32 vcc, 17, v3
    s_nop 1
    v_cndmask_b32 v137, v137, v11, vcc
    v_cmp_gt_i32 vcc, 18, v3
    s_nop 1
    v_cndmask_b32 v138, v138, v11, vcc
    v_cmp_gt_i32 vcc, 19, v3
    s_nop 1
    v_cndmask_b32 v139, v139, v11, vcc
    v_cmp_gt_i32 vcc, 24, v3
    s_nop 1
    v_cndmask_b32 v140, v140, v11, vcc
    v_cmp_gt_i32 vcc, 25, v3
    s_nop 1
    v_cndmask_b32 v141, v141, v11, vcc
    v_cmp_gt_i32_e64 vcc, 26, v3
    s_nop 1
    v_cndmask_b32_e64 v142, v142, v11, vcc
    v_cmp_gt_i32_e64 vcc, 27, v3
    s_nop 1
    v_cndmask_b32_e64 v143, v143, v11, vcc
    s_nop 1
    s_branch s_at_rb_219
at_dp_221:
    s_cbranch_vccz at_nr_223
    v_max3_f32 v4, v64, v65, v66
    v_max3_f32 v4, v4, v67, v68
    v_max3_f32 v4, v4, v69, v70
    v_max3_f32 v4, v4, v71, v72
    v_max3_f32 v4, v4, v73, v74
    v_max3_f32 v4, v4, v75, v76
    v_max3_f32 v4, v4, v77, v78
    v_max_f32 v4, v4, v79
    v_mov_b32 v5, v4
    s_nop 1
    v_permlane32_swap_b32 v4, v5
    v_max_f32 v4, v4, v5
    v_add_f32 v6, v20, v21
    v_mov_b32 v5, v6
    s_nop 1
    v_permlane32_swap_b32 v6, v5
    v_add_f32 v6, v6, v5
    v_log_f32 v6, v6
    s_nop 0
    v_add_f32 v6, -4.0, v6
    v_add_f32 v6, -4.0, v6
    v_add_f32 v6, -4.0, v6
    v_max3_f32 v4, v4, 0, v6
    v_sub_f32 v64, v64, v4
    v_sub_f32 v65, v65, v4
    v_sub_f32 v66, v66, v4
    v_sub_f32 v67, v67, v4
    v_sub_f32 v68, v68, v4
    v_sub_f32 v69, v69, v4
    v_sub_f32 v70, v70, v4
    v_sub_f32 v71, v71, v4
    v_sub_f32 v72, v72, v4
    v_sub_f32 v73, v73, v4
    v_sub_f32 v74, v74, v4
    v_sub_f32 v75, v75, v4
    v_sub_f32 v76, v76, v4
    v_sub_f32 v77, v77, v4
    v_sub_f32 v78, v78, v4
    v_sub_f32 v79, v79, v4
    v_sub_f32 v128, v128, v4
    v_sub_f32 v129, v129, v4
    v_sub_f32 v130, v130, v4
    v_sub_f32 v131, v131, v4
    v_sub_f32 v132, v132, v4
    v_sub_f32 v133, v133, v4
    v_sub_f32 v134, v134, v4
    v_sub_f32 v135, v135, v4
    v_sub_f32 v136, v136, v4
    v_sub_f32 v137, v137, v4
    v_sub_f32 v138, v138, v4
    v_sub_f32 v139, v139, v4
    v_sub_f32 v140, v140, v4
    v_sub_f32 v141, v141, v4
    v_sub_f32 v142, v142, v4
    v_sub_f32 v143, v143, v4
    v_sub_f32 v32, v32, v4
    v_sub_f32 v33, v33, v4
    v_sub_f32 v34, v34, v4
    v_sub_f32 v35, v35, v4
    v_sub_f32 v36, v36, v4
    v_sub_f32 v37, v37, v4
    v_sub_f32 v38, v38, v4
    v_sub_f32 v39, v39, v4
    v_sub_f32 v40, v40, v4
    v_sub_f32 v41, v41, v4
    v_sub_f32 v42, v42, v4
    v_sub_f32 v43, v43, v4
    v_sub_f32 v44, v44, v4
    v_sub_f32 v45, v45, v4
    v_sub_f32 v46, v46, v4
    v_sub_f32 v47, v47, v4
    v_sub_f32 v6, 0, v4
    v_exp_f32 v6, v6
    s_nop 0
    v_mul_f32 v12, v20, v6
    v_mul_f32 v13, v21, v6
    v_exp_f32 v24, v64
    v_exp_f32 v25, v65
    v_add_f32 v12, v12, v24
    v_add_f32 v13, v13, v25
    v_cvt_pk_bf16_f32 v112, v24, v25
    v_exp_f32 v24, v66
    v_exp_f32 v25, v67
    v_add_f32 v12, v12, v24
    v_add_f32 v13, v13, v25
    v_cvt_pk_bf16_f32 v113, v24, v25
    v_exp_f32 v24, v68
    v_exp_f32 v25, v69
    v_add_f32 v12, v12, v24
    v_add_f32 v13, v13, v25
    v_cvt_pk_bf16_f32 v114, v24, v25
    v_exp_f32 v24, v70
    v_exp_f32 v25, v71
    v_add_f32 v12, v12, v24
    v_add_f32 v13, v13, v25
    v_cvt_pk_bf16_f32 v115, v24, v25
    v_exp_f32 v24, v72
    v_exp_f32 v25, v73
    v_add_f32 v12, v12, v24
    v_add_f32 v13, v13, v25
    v_cvt_pk_bf16_f32 v116, v24, v25
    v_exp_f32 v24, v74
    v_exp_f32 v25, v75
    v_add_f32 v12, v12, v24
    v_add_f32 v13, v13, v25
    v_cvt_pk_bf16_f32 v117, v24, v25
    v_exp_f32 v24, v76
    v_exp_f32 v25, v77
    v_add_f32 v12, v12, v24
    v_add_f32 v13, v13, v25
    v_cvt_pk_bf16_f32 v118, v24, v25
    v_exp_f32 v24, v78
    v_exp_f32 v25, v79
    v_add_f32 v12, v12, v24
    v_add_f32 v13, v13, v25
    v_cvt_pk_bf16_f32 v119, v24, v25
    v_accvgpr_read_b32 v7, a64
    v_accvgpr_read_b32 v8, a65
    v_accvgpr_read_b32 v9, a66
    v_accvgpr_read_b32 v10, a67
    v_mul_f32 v7, v7, v6
    v_mul_f32 v8, v8, v6
    v_mul_f32 v9, v9, v6
    v_mul_f32 v10, v10, v6
    v_accvgpr_write_b32 a64, v7
    v_accvgpr_write_b32 a65, v8
    v_accvgpr_write_b32 a66, v9
    v_accvgpr_write_b32 a67, v10
    v_accvgpr_read_b32 v7, a68
    v_accvgpr_read_b32 v8, a69
    v_accvgpr_read_b32 v9, a70
    v_accvgpr_read_b32 v10, a71
    v_mul_f32 v7, v7, v6
    v_mul_f32 v8, v8, v6
    v_mul_f32 v9, v9, v6
    v_mul_f32 v10, v10, v6
    v_accvgpr_write_b32 a68, v7
    v_accvgpr_write_b32 a69, v8
    v_accvgpr_write_b32 a70, v9
    v_accvgpr_write_b32 a71, v10
    v_accvgpr_read_b32 v7, a72
    v_accvgpr_read_b32 v8, a73
    v_accvgpr_read_b32 v9, a74
    v_accvgpr_read_b32 v10, a75
    v_mul_f32 v7, v7, v6
    v_mul_f32 v8, v8, v6
    v_mul_f32 v9, v9, v6
    v_mul_f32 v10, v10, v6
    v_accvgpr_write_b32 a72, v7
    v_accvgpr_write_b32 a73, v8
    v_accvgpr_write_b32 a74, v9
    v_accvgpr_write_b32 a75, v10
    v_accvgpr_read_b32 v7, a76
    v_accvgpr_read_b32 v8, a77
    v_accvgpr_read_b32 v9, a78
    v_accvgpr_read_b32 v10, a79
    v_mul_f32 v7, v7, v6
    v_mul_f32 v8, v8, v6
    v_mul_f32 v9, v9, v6
    v_mul_f32 v10, v10, v6
    v_accvgpr_write_b32 a76, v7
    v_accvgpr_write_b32 a77, v8
    v_accvgpr_write_b32 a78, v9
    v_accvgpr_write_b32 a79, v10
    v_accvgpr_read_b32 v7, a80
    v_accvgpr_read_b32 v8, a81
    v_accvgpr_read_b32 v9, a82
    v_accvgpr_read_b32 v10, a83
    v_mul_f32 v7, v7, v6
    v_mul_f32 v8, v8, v6
    v_mul_f32 v9, v9, v6
    v_mul_f32 v10, v10, v6
    v_accvgpr_write_b32 a80, v7
    v_accvgpr_write_b32 a81, v8
    v_accvgpr_write_b32 a82, v9
    v_accvgpr_write_b32 a83, v10
    v_accvgpr_read_b32 v7, a84
    v_accvgpr_read_b32 v8, a85
    v_accvgpr_read_b32 v9, a86
    v_accvgpr_read_b32 v10, a87
    v_mul_f32 v7, v7, v6
    v_mul_f32 v8, v8, v6
    v_mul_f32 v9, v9, v6
    v_mul_f32 v10, v10, v6
    v_accvgpr_write_b32 a84, v7
    v_accvgpr_write_b32 a85, v8
    v_accvgpr_write_b32 a86, v9
    v_accvgpr_write_b32 a87, v10
    v_accvgpr_read_b32 v7, a88
    v_accvgpr_read_b32 v8, a89
    v_accvgpr_read_b32 v9, a90
    v_accvgpr_read_b32 v10, a91
    v_mul_f32 v7, v7, v6
    v_mul_f32 v8, v8, v6
    v_mul_f32 v9, v9, v6
    v_mul_f32 v10, v10, v6
    v_accvgpr_write_b32 a88, v7
    v_accvgpr_write_b32 a89, v8
    v_accvgpr_write_b32 a90, v9
    v_accvgpr_write_b32 a91, v10
    v_accvgpr_read_b32 v7, a92
    v_accvgpr_read_b32 v8, a93
    v_accvgpr_read_b32 v9, a94
    v_accvgpr_read_b32 v10, a95
    v_mul_f32 v7, v7, v6
    v_mul_f32 v8, v8, v6
    v_mul_f32 v9, v9, v6
    v_mul_f32 v10, v10, v6
    v_accvgpr_write_b32 a92, v7
    v_accvgpr_write_b32 a93, v8
    v_accvgpr_write_b32 a94, v9
    v_accvgpr_write_b32 a95, v10
    v_accvgpr_read_b32 v7, a96
    v_accvgpr_read_b32 v8, a97
    v_accvgpr_read_b32 v9, a98
    v_accvgpr_read_b32 v10, a99
    v_mul_f32 v7, v7, v6
    v_mul_f32 v8, v8, v6
    v_mul_f32 v9, v9, v6
    v_mul_f32 v10, v10, v6
    v_accvgpr_write_b32 a96, v7
    v_accvgpr_write_b32 a97, v8
    v_accvgpr_write_b32 a98, v9
    v_accvgpr_write_b32 a99, v10
    v_accvgpr_read_b32 v7, a100
    v_accvgpr_read_b32 v8, a101
    v_accvgpr_read_b32 v9, a102
    v_accvgpr_read_b32 v10, a103
    v_mul_f32 v7, v7, v6
    v_mul_f32 v8, v8, v6
    v_mul_f32 v9, v9, v6
    v_mul_f32 v10, v10, v6
    v_accvgpr_write_b32 a100, v7
    v_accvgpr_write_b32 a101, v8
    v_accvgpr_write_b32 a102, v9
    v_accvgpr_write_b32 a103, v10
    v_accvgpr_read_b32 v7, a104
    v_accvgpr_read_b32 v8, a105
    v_accvgpr_read_b32 v9, a106
    v_accvgpr_read_b32 v10, a107
    v_mul_f32 v7, v7, v6
    v_mul_f32 v8, v8, v6
    v_mul_f32 v9, v9, v6
    v_mul_f32 v10, v10, v6
    v_accvgpr_write_b32 a104, v7
    v_accvgpr_write_b32 a105, v8
    v_accvgpr_write_b32 a106, v9
    v_accvgpr_write_b32 a107, v10
    v_accvgpr_read_b32 v7, a108
    v_accvgpr_read_b32 v8, a109
    v_accvgpr_read_b32 v9, a110
    v_accvgpr_read_b32 v10, a111
    v_mul_f32 v7, v7, v6
    v_mul_f32 v8, v8, v6
    v_mul_f32 v9, v9, v6
    v_mul_f32 v10, v10, v6
    v_accvgpr_write_b32 a108, v7
    v_accvgpr_write_b32 a109, v8
    v_accvgpr_write_b32 a110, v9
    v_accvgpr_write_b32 a111, v10
    v_accvgpr_read_b32 v7, a112
    v_accvgpr_read_b32 v8, a113
    v_accvgpr_read_b32 v9, a114
    v_accvgpr_read_b32 v10, a115
    v_mul_f32 v7, v7, v6
    v_mul_f32 v8, v8, v6
    v_mul_f32 v9, v9, v6
    v_mul_f32 v10, v10, v6
    v_accvgpr_write_b32 a112, v7
    v_accvgpr_write_b32 a113, v8
    v_accvgpr_write_b32 a114, v9
    v_accvgpr_write_b32 a115, v10
    v_accvgpr_read_b32 v7, a116
    v_accvgpr_read_b32 v8, a117
    v_accvgpr_read_b32 v9, a118
    v_accvgpr_read_b32 v10, a119
    v_mul_f32 v7, v7, v6
    v_mul_f32 v8, v8, v6
    v_mul_f32 v9, v9, v6
    v_mul_f32 v10, v10, v6
    v_accvgpr_write_b32 a116, v7
    v_accvgpr_write_b32 a117, v8
    v_accvgpr_write_b32 a118, v9
    v_accvgpr_write_b32 a119, v10
    v_accvgpr_read_b32 v7, a120
    v_accvgpr_read_b32 v8, a121
    v_accvgpr_read_b32 v9, a122
    v_accvgpr_read_b32 v10, a123
    v_mul_f32 v7, v7, v6
    v_mul_f32 v8, v8, v6
    v_mul_f32 v9, v9, v6
    v_mul_f32 v10, v10, v6
    v_accvgpr_write_b32 a120, v7
    v_accvgpr_write_b32 a121, v8
    v_accvgpr_write_b32 a122, v9
    v_accvgpr_write_b32 a123, v10
    v_accvgpr_read_b32 v7, a124
    v_accvgpr_read_b32 v8, a125
    v_accvgpr_read_b32 v9, a126
    v_accvgpr_read_b32 v10, a127
    v_mul_f32 v7, v7, v6
    v_mul_f32 v8, v8, v6
    v_mul_f32 v9, v9, v6
    v_mul_f32 v10, v10, v6
    v_accvgpr_write_b32 a124, v7
    v_accvgpr_write_b32 a125, v8
    v_accvgpr_write_b32 a126, v9
    v_accvgpr_write_b32 a127, v10
    v_max3_f32 v4, v80, v81, v82
    v_max3_f32 v4, v4, v83, v84
    v_max3_f32 v4, v4, v85, v86
    v_max3_f32 v4, v4, v87, v88
    v_max3_f32 v4, v4, v89, v90
    v_max3_f32 v4, v4, v91, v92
    v_max3_f32 v4, v4, v93, v94
    v_max_f32 v4, v4, v95
    v_mov_b32 v5, v4
    s_nop 1
    v_permlane32_swap_b32 v4, v5
    v_max_f32 v4, v4, v5
    v_add_f32 v6, v22, v23
    v_mov_b32 v5, v6
    s_nop 1
    v_permlane32_swap_b32 v6, v5
    v_add_f32 v6, v6, v5
    v_log_f32 v6, v6
    s_nop 0
    v_add_f32 v6, -4.0, v6
    v_add_f32 v6, -4.0, v6
    v_add_f32 v6, -4.0, v6
    v_max3_f32 v4, v4, 0, v6
    v_sub_f32 v80, v80, v4
    v_sub_f32 v81, v81, v4
    v_sub_f32 v82, v82, v4
    v_sub_f32 v83, v83, v4
    v_sub_f32 v84, v84, v4
    v_sub_f32 v85, v85, v4
    v_sub_f32 v86, v86, v4
    v_sub_f32 v87, v87, v4
    v_sub_f32 v88, v88, v4
    v_sub_f32 v89, v89, v4
    v_sub_f32 v90, v90, v4
    v_sub_f32 v91, v91, v4
    v_sub_f32 v92, v92, v4
    v_sub_f32 v93, v93, v4
    v_sub_f32 v94, v94, v4
    v_sub_f32 v95, v95, v4
    v_sub_f32 v144, v144, v4
    v_sub_f32 v145, v145, v4
    v_sub_f32 v146, v146, v4
    v_sub_f32 v147, v147, v4
    v_sub_f32 v148, v148, v4
    v_sub_f32 v149, v149, v4
    v_sub_f32 v150, v150, v4
    v_sub_f32 v151, v151, v4
    v_sub_f32 v152, v152, v4
    v_sub_f32 v153, v153, v4
    v_sub_f32 v154, v154, v4
    v_sub_f32 v155, v155, v4
    v_sub_f32 v156, v156, v4
    v_sub_f32 v157, v157, v4
    v_sub_f32 v158, v158, v4
    v_sub_f32 v159, v159, v4
    v_sub_f32 v48, v48, v4
    v_sub_f32 v49, v49, v4
    v_sub_f32 v50, v50, v4
    v_sub_f32 v51, v51, v4
    v_sub_f32 v52, v52, v4
    v_sub_f32 v53, v53, v4
    v_sub_f32 v54, v54, v4
    v_sub_f32 v55, v55, v4
    v_sub_f32 v56, v56, v4
    v_sub_f32 v57, v57, v4
    v_sub_f32 v58, v58, v4
    v_sub_f32 v59, v59, v4
    v_sub_f32 v60, v60, v4
    v_sub_f32 v61, v61, v4
    v_sub_f32 v62, v62, v4
    v_sub_f32 v63, v63, v4
    v_sub_f32 v6, 0, v4
    v_exp_f32 v6, v6
    s_nop 0
    v_mul_f32 v14, v22, v6
    v_mul_f32 v15, v23, v6
    v_exp_f32 v24, v80
    v_exp_f32 v25, v81
    v_add_f32 v14, v14, v24
    v_add_f32 v15, v15, v25
    v_cvt_pk_bf16_f32 v120, v24, v25
    v_exp_f32 v24, v82
    v_exp_f32 v25, v83
    v_add_f32 v14, v14, v24
    v_add_f32 v15, v15, v25
    v_cvt_pk_bf16_f32 v121, v24, v25
    v_exp_f32 v24, v84
    v_exp_f32 v25, v85
    v_add_f32 v14, v14, v24
    v_add_f32 v15, v15, v25
    v_cvt_pk_bf16_f32 v122, v24, v25
    v_exp_f32 v24, v86
    v_exp_f32 v25, v87
    v_add_f32 v14, v14, v24
    v_add_f32 v15, v15, v25
    v_cvt_pk_bf16_f32 v123, v24, v25
    v_exp_f32 v24, v88
    v_exp_f32 v25, v89
    v_add_f32 v14, v14, v24
    v_add_f32 v15, v15, v25
    v_cvt_pk_bf16_f32 v124, v24, v25
    v_exp_f32 v24, v90
    v_exp_f32 v25, v91
    v_add_f32 v14, v14, v24
    v_add_f32 v15, v15, v25
    v_cvt_pk_bf16_f32 v125, v24, v25
    v_exp_f32 v24, v92
    v_exp_f32 v25, v93
    v_add_f32 v14, v14, v24
    v_add_f32 v15, v15, v25
    v_cvt_pk_bf16_f32 v126, v24, v25
    v_exp_f32 v24, v94
    v_exp_f32 v25, v95
    v_add_f32 v14, v14, v24
    v_add_f32 v15, v15, v25
    v_cvt_pk_bf16_f32 v127, v24, v25
    v_accvgpr_read_b32 v7, a128
    v_accvgpr_read_b32 v8, a129
    v_accvgpr_read_b32 v9, a130
    v_accvgpr_read_b32 v10, a131
    v_mul_f32 v7, v7, v6
    v_mul_f32 v8, v8, v6
    v_mul_f32 v9, v9, v6
    v_mul_f32 v10, v10, v6
    v_accvgpr_write_b32 a128, v7
    v_accvgpr_write_b32 a129, v8
    v_accvgpr_write_b32 a130, v9
    v_accvgpr_write_b32 a131, v10
    v_accvgpr_read_b32 v7, a132
    v_accvgpr_read_b32 v8, a133
    v_accvgpr_read_b32 v9, a134
    v_accvgpr_read_b32 v10, a135
    v_mul_f32 v7, v7, v6
    v_mul_f32 v8, v8, v6
    v_mul_f32 v9, v9, v6
    v_mul_f32 v10, v10, v6
    v_accvgpr_write_b32 a132, v7
    v_accvgpr_write_b32 a133, v8
    v_accvgpr_write_b32 a134, v9
    v_accvgpr_write_b32 a135, v10
    v_accvgpr_read_b32 v7, a136
    v_accvgpr_read_b32 v8, a137
    v_accvgpr_read_b32 v9, a138
    v_accvgpr_read_b32 v10, a139
    v_mul_f32 v7, v7, v6
    v_mul_f32 v8, v8, v6
    v_mul_f32 v9, v9, v6
    v_mul_f32 v10, v10, v6
    v_accvgpr_write_b32 a136, v7
    v_accvgpr_write_b32 a137, v8
    v_accvgpr_write_b32 a138, v9
    v_accvgpr_write_b32 a139, v10
    v_accvgpr_read_b32 v7, a140
    v_accvgpr_read_b32 v8, a141
    v_accvgpr_read_b32 v9, a142
    v_accvgpr_read_b32 v10, a143
    v_mul_f32 v7, v7, v6
    v_mul_f32 v8, v8, v6
    v_mul_f32 v9, v9, v6
    v_mul_f32 v10, v10, v6
    v_accvgpr_write_b32 a140, v7
    v_accvgpr_write_b32 a141, v8
    v_accvgpr_write_b32 a142, v9
    v_accvgpr_write_b32 a143, v10
    v_accvgpr_read_b32 v7, a144
    v_accvgpr_read_b32 v8, a145
    v_accvgpr_read_b32 v9, a146
    v_accvgpr_read_b32 v10, a147
    v_mul_f32 v7, v7, v6
    v_mul_f32 v8, v8, v6
    v_mul_f32 v9, v9, v6
    v_mul_f32 v10, v10, v6
    v_accvgpr_write_b32 a144, v7
    v_accvgpr_write_b32 a145, v8
    v_accvgpr_write_b32 a146, v9
    v_accvgpr_write_b32 a147, v10
    v_accvgpr_read_b32 v7, a148
    v_accvgpr_read_b32 v8, a149
    v_accvgpr_read_b32 v9, a150
    v_accvgpr_read_b32 v10, a151
    v_mul_f32 v7, v7, v6
    v_mul_f32 v8, v8, v6
    v_mul_f32 v9, v9, v6
    v_mul_f32 v10, v10, v6
    v_accvgpr_write_b32 a148, v7
    v_accvgpr_write_b32 a149, v8
    v_accvgpr_write_b32 a150, v9
    v_accvgpr_write_b32 a151, v10
    v_accvgpr_read_b32 v7, a152
    v_accvgpr_read_b32 v8, a153
    v_accvgpr_read_b32 v9, a154
    v_accvgpr_read_b32 v10, a155
    v_mul_f32 v7, v7, v6
    v_mul_f32 v8, v8, v6
    v_mul_f32 v9, v9, v6
    v_mul_f32 v10, v10, v6
    v_accvgpr_write_b32 a152, v7
    v_accvgpr_write_b32 a153, v8
    v_accvgpr_write_b32 a154, v9
    v_accvgpr_write_b32 a155, v10
    v_accvgpr_read_b32 v7, a156
    v_accvgpr_read_b32 v8, a157
    v_accvgpr_read_b32 v9, a158
    v_accvgpr_read_b32 v10, a159
    v_mul_f32 v7, v7, v6
    v_mul_f32 v8, v8, v6
    v_mul_f32 v9, v9, v6
    v_mul_f32 v10, v10, v6
    v_accvgpr_write_b32 a156, v7
    v_accvgpr_write_b32 a157, v8
    v_accvgpr_write_b32 a158, v9
    v_accvgpr_write_b32 a159, v10
    v_accvgpr_read_b32 v7, a160
    v_accvgpr_read_b32 v8, a161
    v_accvgpr_read_b32 v9, a162
    v_accvgpr_read_b32 v10, a163
    v_mul_f32 v7, v7, v6
    v_mul_f32 v8, v8, v6
    v_mul_f32 v9, v9, v6
    v_mul_f32 v10, v10, v6
    v_accvgpr_write_b32 a160, v7
    v_accvgpr_write_b32 a161, v8
    v_accvgpr_write_b32 a162, v9
    v_accvgpr_write_b32 a163, v10
    v_accvgpr_read_b32 v7, a164
    v_accvgpr_read_b32 v8, a165
    v_accvgpr_read_b32 v9, a166
    v_accvgpr_read_b32 v10, a167
    v_mul_f32 v7, v7, v6
    v_mul_f32 v8, v8, v6
    v_mul_f32 v9, v9, v6
    v_mul_f32 v10, v10, v6
    v_accvgpr_write_b32 a164, v7
    v_accvgpr_write_b32 a165, v8
    v_accvgpr_write_b32 a166, v9
    v_accvgpr_write_b32 a167, v10
    v_accvgpr_read_b32 v7, a168
    v_accvgpr_read_b32 v8, a169
    v_accvgpr_read_b32 v9, a170
    v_accvgpr_read_b32 v10, a171
    v_mul_f32 v7, v7, v6
    v_mul_f32 v8, v8, v6
    v_mul_f32 v9, v9, v6
    v_mul_f32 v10, v10, v6
    v_accvgpr_write_b32 a168, v7
    v_accvgpr_write_b32 a169, v8
    v_accvgpr_write_b32 a170, v9
    v_accvgpr_write_b32 a171, v10
    v_accvgpr_read_b32 v7, a172
    v_accvgpr_read_b32 v8, a173
    v_accvgpr_read_b32 v9, a174
    v_accvgpr_read_b32 v10, a175
    v_mul_f32 v7, v7, v6
    v_mul_f32 v8, v8, v6
    v_mul_f32 v9, v9, v6
    v_mul_f32 v10, v10, v6
    v_accvgpr_write_b32 a172, v7
    v_accvgpr_write_b32 a173, v8
    v_accvgpr_write_b32 a174, v9
    v_accvgpr_write_b32 a175, v10
    v_accvgpr_read_b32 v7, a176
    v_accvgpr_read_b32 v8, a177
    v_accvgpr_read_b32 v9, a178
    v_accvgpr_read_b32 v10, a179
    v_mul_f32 v7, v7, v6
    v_mul_f32 v8, v8, v6
    v_mul_f32 v9, v9, v6
    v_mul_f32 v10, v10, v6
    v_accvgpr_write_b32 a176, v7
    v_accvgpr_write_b32 a177, v8
    v_accvgpr_write_b32 a178, v9
    v_accvgpr_write_b32 a179, v10
    v_accvgpr_read_b32 v7, a180
    v_accvgpr_read_b32 v8, a181
    v_accvgpr_read_b32 v9, a182
    v_accvgpr_read_b32 v10, a183
    v_mul_f32 v7, v7, v6
    v_mul_f32 v8, v8, v6
    v_mul_f32 v9, v9, v6
    v_mul_f32 v10, v10, v6
    v_accvgpr_write_b32 a180, v7
    v_accvgpr_write_b32 a181, v8
    v_accvgpr_write_b32 a182, v9
    v_accvgpr_write_b32 a183, v10
    v_accvgpr_read_b32 v7, a184
    v_accvgpr_read_b32 v8, a185
    v_accvgpr_read_b32 v9, a186
    v_accvgpr_read_b32 v10, a187
    v_mul_f32 v7, v7, v6
    v_mul_f32 v8, v8, v6
    v_mul_f32 v9, v9, v6
    v_mul_f32 v10, v10, v6
    v_accvgpr_write_b32 a184, v7
    v_accvgpr_write_b32 a185, v8
    v_accvgpr_write_b32 a186, v9
    v_accvgpr_write_b32 a187, v10
    v_accvgpr_read_b32 v7, a188
    v_accvgpr_read_b32 v8, a189
    v_accvgpr_read_b32 v9, a190
    v_accvgpr_read_b32 v10, a191
    v_mul_f32 v7, v7, v6
    v_mul_f32 v8, v8, v6
    v_mul_f32 v9, v9, v6
    v_mul_f32 v10, v10, v6
    v_accvgpr_write_b32 a188, v7
    v_accvgpr_write_b32 a189, v8
    v_accvgpr_write_b32 a190, v9
    v_accvgpr_write_b32 a191, v10
at_nr_223:
    s_cmp_eq_u64 s[30:31], 0
    s_cbranch_scc1 s_at_rb_222
    s_cmp_eq_u32 s24, s22
    s_cbranch_scc1 at_tail1_216
    v_mov_b32 v11, s28
    v_cmp_gt_i32 vcc, 0, v3
    s_nop 1
    v_cndmask_b32 v144, v144, v11, vcc
    v_cmp_gt_i32 vcc, 1, v3
    s_nop 1
    v_cndmask_b32 v145, v145, v11, vcc
    v_cmp_gt_i32 vcc, 2, v3
    s_nop 1
    v_cndmask_b32 v146, v146, v11, vcc
    v_cmp_gt_i32 vcc, 3, v3
    s_nop 1
    v_cndmask_b32 v147, v147, v11, vcc
    v_cmp_gt_i32 vcc, 8, v3
    s_nop 1
    v_cndmask_b32 v148, v148, v11, vcc
    v_cmp_gt_i32 vcc, 9, v3
    s_nop 1
    v_cndmask_b32 v149, v149, v11, vcc
    v_cmp_gt_i32 vcc, 10, v3
    s_nop 1
    v_cndmask_b32 v150, v150, v11, vcc
    v_cmp_gt_i32 vcc, 11, v3
    s_nop 1
    v_cndmask_b32 v151, v151, v11, vcc
    v_cmp_gt_i32 vcc, 16, v3
    s_nop 1
    v_cndmask_b32 v152, v152, v11, vcc
    v_cmp_gt_i32 vcc, 17, v3
    s_nop 1
    v_cndmask_b32 v153, v153, v11, vcc
    v_cmp_gt_i32 vcc, 18, v3
    s_nop 1
    v_cndmask_b32 v154, v154, v11, vcc
    v_cmp_gt_i32 vcc, 19, v3
    s_nop 1
    v_cndmask_b32 v155, v155, v11, vcc
    v_cmp_gt_i32 vcc, 24, v3
    s_nop 1
    v_cndmask_b32 v156, v156, v11, vcc
    v_cmp_gt_i32 vcc, 25, v3
    s_nop 1
    v_cndmask_b32 v157, v157, v11, vcc
    v_cmp_gt_i32 vcc, 26, v3
    s_nop 1
    v_cndmask_b32 v158, v158, v11, vcc
    v_cmp_gt_i32 vcc, 27, v3
    s_nop 1
    v_cndmask_b32 v159, v159, v11, vcc
    v_mov_b32 v128, v11
    v_mov_b32 v129, v11
    v_mov_b32 v130, v11
    v_mov_b32 v131, v11
    v_mov_b32 v132, v11
    v_mov_b32 v133, v11
    v_mov_b32 v134, v11
    v_mov_b32 v135, v11
    v_mov_b32 v136, v11
    v_mov_b32 v137, v11
    v_mov_b32 v138, v11
    v_mov_b32 v139, v11
    v_mov_b32 v140, v11
    v_mov_b32 v141, v11
    v_mov_b32 v142, v11
    v_mov_b32 v143, v11
    s_nop 1
    s_branch s_at_rb_222
at_dp_224:
    s_cbranch_vccz at_nr_226
    v_max3_f32 v4, v32, v33, v34
    v_max3_f32 v4, v4, v35, v36
    v_max3_f32 v4, v4, v37, v38
    v_max3_f32 v4, v4, v39, v40
    v_max3_f32 v4, v4, v41, v42
    v_max3_f32 v4, v4, v43, v44
    v_max3_f32 v4, v4, v45, v46
    v_max_f32 v4, v4, v47
    v_mov_b32 v5, v4
    s_nop 1
    v_permlane32_swap_b32 v4, v5
    v_max_f32 v4, v4, v5
    v_add_f32 v6, v20, v21
    v_mov_b32 v5, v6
    s_nop 1
    v_permlane32_swap_b32 v6, v5
    v_add_f32 v6, v6, v5
    v_log_f32 v6, v6
    s_nop 0
    v_add_f32 v6, -4.0, v6
    v_add_f32 v6, -4.0, v6
    v_add_f32 v6, -4.0, v6
    v_max3_f32 v4, v4, 0, v6
    v_sub_f32 v32, v32, v4
    v_sub_f32 v33, v33, v4
    v_sub_f32 v34, v34, v4
    v_sub_f32 v35, v35, v4
    v_sub_f32 v36, v36, v4
    v_sub_f32 v37, v37, v4
    v_sub_f32 v38, v38, v4
    v_sub_f32 v39, v39, v4
    v_sub_f32 v40, v40, v4
    v_sub_f32 v41, v41, v4
    v_sub_f32 v42, v42, v4
    v_sub_f32 v43, v43, v4
    v_sub_f32 v44, v44, v4
    v_sub_f32 v45, v45, v4
    v_sub_f32 v46, v46, v4
    v_sub_f32 v47, v47, v4
    v_sub_f32 v128, v128, v4
    v_sub_f32 v129, v129, v4
    v_sub_f32 v130, v130, v4
    v_sub_f32 v131, v131, v4
    v_sub_f32 v132, v132, v4
    v_sub_f32 v133, v133, v4
    v_sub_f32 v134, v134, v4
    v_sub_f32 v135, v135, v4
    v_sub_f32 v136, v136, v4
    v_sub_f32 v137, v137, v4
    v_sub_f32 v138, v138, v4
    v_sub_f32 v139, v139, v4
    v_sub_f32 v140, v140, v4
    v_sub_f32 v141, v141, v4
    v_sub_f32 v142, v142, v4
    v_sub_f32 v143, v143, v4
    v_sub_f32 v64, v64, v4
    v_sub_f32 v65, v65, v4
    v_sub_f32 v66, v66, v4
    v_sub_f32 v67, v67, v4
    v_sub_f32 v68, v68, v4
    v_sub_f32 v69, v69, v4
    v_sub_f32 v70, v70, v4
    v_sub_f32 v71, v71, v4
    v_sub_f32 v72, v72, v4
    v_sub_f32 v73, v73, v4
    v_sub_f32 v74, v74, v4
    v_sub_f32 v75, v75, v4
    v_sub_f32 v76, v76, v4
    v_sub_f32 v77, v77, v4
    v_sub_f32 v78, v78, v4
    v_sub_f32 v79, v79, v4
    v_sub_f32 v6, 0, v4
    v_exp_f32 v6, v6
    s_nop 0
    v_mul_f32 v12, v20, v6
    v_mul_f32 v13, v21, v6
    v_exp_f32 v24, v32
    v_exp_f32 v25, v33
    v_add_f32 v12, v12, v24
    v_add_f32 v13, v13, v25
    v_cvt_pk_bf16_f32 v96, v24, v25
    v_exp_f32 v24, v34
    v_exp_f32 v25, v35
    v_add_f32 v12, v12, v24
    v_add_f32 v13, v13, v25
    v_cvt_pk_bf16_f32 v97, v24, v25
    v_exp_f32 v24, v36
    v_exp_f32 v25, v37
    v_add_f32 v12, v12, v24
    v_add_f32 v13, v13, v25
    v_cvt_pk_bf16_f32 v98, v24, v25
    v_exp_f32 v24, v38
    v_exp_f32 v25, v39
    v_add_f32 v12, v12, v24
    v_add_f32 v13, v13, v25
    v_cvt_pk_bf16_f32 v99, v24, v25
    v_exp_f32 v24, v40
    v_exp_f32 v25, v41
    v_add_f32 v12, v12, v24
    v_add_f32 v13, v13, v25
    v_cvt_pk_bf16_f32 v100, v24, v25
    v_exp_f32 v24, v42
    v_exp_f32 v25, v43
    v_add_f32 v12, v12, v24
    v_add_f32 v13, v13, v25
    v_cvt_pk_bf16_f32 v101, v24, v25
    v_exp_f32 v24, v44
    v_exp_f32 v25, v45
    v_add_f32 v12, v12, v24
    v_add_f32 v13, v13, v25
    v_cvt_pk_bf16_f32 v102, v24, v25
    v_exp_f32 v24, v46
    v_exp_f32 v25, v47
    v_add_f32 v12, v12, v24
    v_add_f32 v13, v13, v25
    v_cvt_pk_bf16_f32 v103, v24, v25
    v_accvgpr_read_b32 v7, a64
    v_accvgpr_read_b32 v8, a65
    v_accvgpr_read_b32 v9, a66
    v_accvgpr_read_b32 v10, a67
    v_mul_f32 v7, v7, v6
    v_mul_f32 v8, v8, v6
    v_mul_f32 v9, v9, v6
    v_mul_f32 v10, v10, v6
    v_accvgpr_write_b32 a64, v7
    v_accvgpr_write_b32 a65, v8
    v_accvgpr_write_b32 a66, v9
    v_accvgpr_write_b32 a67, v10
    v_accvgpr_read_b32 v7, a68
    v_accvgpr_read_b32 v8, a69
    v_accvgpr_read_b32 v9, a70
    v_accvgpr_read_b32 v10, a71
    v_mul_f32 v7, v7, v6
    v_mul_f32 v8, v8, v6
    v_mul_f32 v9, v9, v6
    v_mul_f32 v10, v10, v6
    v_accvgpr_write_b32 a68, v7
    v_accvgpr_write_b32 a69, v8
    v_accvgpr_write_b32 a70, v9
    v_accvgpr_write_b32 a71, v10
    v_accvgpr_read_b32 v7, a72
    v_accvgpr_read_b32 v8, a73
    v_accvgpr_read_b32 v9, a74
    v_accvgpr_read_b32 v10, a75
    v_mul_f32 v7, v7, v6
    v_mul_f32 v8, v8, v6
    v_mul_f32 v9, v9, v6
    v_mul_f32 v10, v10, v6
    v_accvgpr_write_b32 a72, v7
    v_accvgpr_write_b32 a73, v8
    v_accvgpr_write_b32 a74, v9
    v_accvgpr_write_b32 a75, v10
    v_accvgpr_read_b32 v7, a76
    v_accvgpr_read_b32 v8, a77
    v_accvgpr_read_b32 v9, a78
    v_accvgpr_read_b32 v10, a79
    v_mul_f32 v7, v7, v6
    v_mul_f32 v8, v8, v6
    v_mul_f32 v9, v9, v6
    v_mul_f32 v10, v10, v6
    v_accvgpr_write_b32 a76, v7
    v_accvgpr_write_b32 a77, v8
    v_accvgpr_write_b32 a78, v9
    v_accvgpr_write_b32 a79, v10
    v_accvgpr_read_b32 v7, a80
    v_accvgpr_read_b32 v8, a81
    v_accvgpr_read_b32 v9, a82
    v_accvgpr_read_b32 v10, a83
    v_mul_f32 v7, v7, v6
    v_mul_f32 v8, v8, v6
    v_mul_f32 v9, v9, v6
    v_mul_f32 v10, v10, v6
    v_accvgpr_write_b32 a80, v7
    v_accvgpr_write_b32 a81, v8
    v_accvgpr_write_b32 a82, v9
    v_accvgpr_write_b32 a83, v10
    v_accvgpr_read_b32 v7, a84
    v_accvgpr_read_b32 v8, a85
    v_accvgpr_read_b32 v9, a86
    v_accvgpr_read_b32 v10, a87
    v_mul_f32 v7, v7, v6
    v_mul_f32 v8, v8, v6
    v_mul_f32 v9, v9, v6
    v_mul_f32 v10, v10, v6
    v_accvgpr_write_b32 a84, v7
    v_accvgpr_write_b32 a85, v8
    v_accvgpr_write_b32 a86, v9
    v_accvgpr_write_b32 a87, v10
    v_accvgpr_read_b32 v7, a88
    v_accvgpr_read_b32 v8, a89
    v_accvgpr_read_b32 v9, a90
    v_accvgpr_read_b32 v10, a91
    v_mul_f32 v7, v7, v6
    v_mul_f32 v8, v8, v6
    v_mul_f32 v9, v9, v6
    v_mul_f32 v10, v10, v6
    v_accvgpr_write_b32 a88, v7
    v_accvgpr_write_b32 a89, v8
    v_accvgpr_write_b32 a90, v9
    v_accvgpr_write_b32 a91, v10
    v_accvgpr_read_b32 v7, a92
    v_accvgpr_read_b32 v8, a93
    v_accvgpr_read_b32 v9, a94
    v_accvgpr_read_b32 v10, a95
    v_mul_f32 v7, v7, v6
    v_mul_f32 v8, v8, v6
    v_mul_f32 v9, v9, v6
    v_mul_f32 v10, v10, v6
    v_accvgpr_write_b32 a92, v7
    v_accvgpr_write_b32 a93, v8
    v_accvgpr_write_b32 a94, v9
    v_accvgpr_write_b32 a95, v10
    v_accvgpr_read_b32 v7, a96
    v_accvgpr_read_b32 v8, a97
    v_accvgpr_read_b32 v9, a98
    v_accvgpr_read_b32 v10, a99
    v_mul_f32 v7, v7, v6
    v_mul_f32 v8, v8, v6
    v_mul_f32 v9, v9, v6
    v_mul_f32 v10, v10, v6
    v_accvgpr_write_b32 a96, v7
    v_accvgpr_write_b32 a97, v8
    v_accvgpr_write_b32 a98, v9
    v_accvgpr_write_b32 a99, v10
    v_accvgpr_read_b32 v7, a100
    v_accvgpr_read_b32 v8, a101
    v_accvgpr_read_b32 v9, a102
    v_accvgpr_read_b32 v10, a103
    v_mul_f32 v7, v7, v6
    v_mul_f32 v8, v8, v6
    v_mul_f32 v9, v9, v6
    v_mul_f32 v10, v10, v6
    v_accvgpr_write_b32 a100, v7
    v_accvgpr_write_b32 a101, v8
    v_accvgpr_write_b32 a102, v9
    v_accvgpr_write_b32 a103, v10
    v_accvgpr_read_b32 v7, a104
    v_accvgpr_read_b32 v8, a105
    v_accvgpr_read_b32 v9, a106
    v_accvgpr_read_b32 v10, a107
    v_mul_f32 v7, v7, v6
    v_mul_f32 v8, v8, v6
    v_mul_f32 v9, v9, v6
    v_mul_f32 v10, v10, v6
    v_accvgpr_write_b32 a104, v7
    v_accvgpr_write_b32 a105, v8
    v_accvgpr_write_b32 a106, v9
    v_accvgpr_write_b32 a107, v10
    v_accvgpr_read_b32 v7, a108
    v_accvgpr_read_b32 v8, a109
    v_accvgpr_read_b32 v9, a110
    v_accvgpr_read_b32 v10, a111
    v_mul_f32 v7, v7, v6
    v_mul_f32 v8, v8, v6
    v_mul_f32 v9, v9, v6
    v_mul_f32 v10, v10, v6
    v_accvgpr_write_b32 a108, v7
    v_accvgpr_write_b32 a109, v8
    v_accvgpr_write_b32 a110, v9
    v_accvgpr_write_b32 a111, v10
    v_accvgpr_read_b32 v7, a112
    v_accvgpr_read_b32 v8, a113
    v_accvgpr_read_b32 v9, a114
    v_accvgpr_read_b32 v10, a115
    v_mul_f32 v7, v7, v6
    v_mul_f32 v8, v8, v6
    v_mul_f32 v9, v9, v6
    v_mul_f32 v10, v10, v6
    v_accvgpr_write_b32 a112, v7
    v_accvgpr_write_b32 a113, v8
    v_accvgpr_write_b32 a114, v9
    v_accvgpr_write_b32 a115, v10
    v_accvgpr_read_b32 v7, a116
    v_accvgpr_read_b32 v8, a117
    v_accvgpr_read_b32 v9, a118
    v_accvgpr_read_b32 v10, a119
    v_mul_f32 v7, v7, v6
    v_mul_f32 v8, v8, v6
    v_mul_f32 v9, v9, v6
    v_mul_f32 v10, v10, v6
    v_accvgpr_write_b32 a116, v7
    v_accvgpr_write_b32 a117, v8
    v_accvgpr_write_b32 a118, v9
    v_accvgpr_write_b32 a119, v10
    v_accvgpr_read_b32 v7, a120
    v_accvgpr_read_b32 v8, a121
    v_accvgpr_read_b32 v9, a122
    v_accvgpr_read_b32 v10, a123
    v_mul_f32 v7, v7, v6
    v_mul_f32 v8, v8, v6
    v_mul_f32 v9, v9, v6
    v_mul_f32 v10, v10, v6
    v_accvgpr_write_b32 a120, v7
    v_accvgpr_write_b32 a121, v8
    v_accvgpr_write_b32 a122, v9
    v_accvgpr_write_b32 a123, v10
    v_accvgpr_read_b32 v7, a124
    v_accvgpr_read_b32 v8, a125
    v_accvgpr_read_b32 v9, a126
    v_accvgpr_read_b32 v10, a127
    v_mul_f32 v7, v7, v6
    v_mul_f32 v8, v8, v6
    v_mul_f32 v9, v9, v6
    v_mul_f32 v10, v10, v6
    v_accvgpr_write_b32 a124, v7
    v_accvgpr_write_b32 a125, v8
    v_accvgpr_write_b32 a126, v9
    v_accvgpr_write_b32 a127, v10
    v_max3_f32 v4, v48, v49, v50
    v_max3_f32 v4, v4, v51, v52
    v_max3_f32 v4, v4, v53, v54
    v_max3_f32 v4, v4, v55, v56
    v_max3_f32 v4, v4, v57, v58
    v_max3_f32 v4, v4, v59, v60
    v_max3_f32 v4, v4, v61, v62
    v_max_f32 v4, v4, v63
    v_mov_b32 v5, v4
    s_nop 1
    v_permlane32_swap_b32 v4, v5
    v_max_f32 v4, v4, v5
    v_add_f32 v6, v22, v23
    v_mov_b32 v5, v6
    s_nop 1
    v_permlane32_swap_b32 v6, v5
    v_add_f32 v6, v6, v5
    v_log_f32 v6, v6
    s_nop 0
    v_add_f32 v6, -4.0, v6
    v_add_f32 v6, -4.0, v6
    v_add_f32 v6, -4.0, v6
    v_max3_f32 v4, v4, 0, v6
    v_sub_f32 v48, v48, v4
    v_sub_f32 v49, v49, v4
    v_sub_f32 v50, v50, v4
    v_sub_f32 v51, v51, v4
    v_sub_f32 v52, v52, v4
    v_sub_f32 v53, v53, v4
    v_sub_f32 v54, v54, v4
    v_sub_f32 v55, v55, v4
    v_sub_f32 v56, v56, v4
    v_sub_f32 v57, v57, v4
    v_sub_f32 v58, v58, v4
    v_sub_f32 v59, v59, v4
    v_sub_f32 v60, v60, v4
    v_sub_f32 v61, v61, v4
    v_sub_f32 v62, v62, v4
    v_sub_f32 v63, v63, v4
    v_sub_f32 v144, v144, v4
    v_sub_f32 v145, v145, v4
    v_sub_f32 v146, v146, v4
    v_sub_f32 v147, v147, v4
    v_sub_f32 v148, v148, v4
    v_sub_f32 v149, v149, v4
    v_sub_f32 v150, v150, v4
    v_sub_f32 v151, v151, v4
    v_sub_f32 v152, v152, v4
    v_sub_f32 v153, v153, v4
    v_sub_f32 v154, v154, v4
    v_sub_f32 v155, v155, v4
    v_sub_f32 v156, v156, v4
    v_sub_f32 v157, v157, v4
    v_sub_f32 v158, v158, v4
    v_sub_f32 v159, v159, v4
    v_sub_f32 v80, v80, v4
    v_sub_f32 v81, v81, v4
    v_sub_f32 v82, v82, v4
    v_sub_f32 v83, v83, v4
    v_sub_f32 v84, v84, v4
    v_sub_f32 v85, v85, v4
    v_sub_f32 v86, v86, v4
    v_sub_f32 v87, v87, v4
    v_sub_f32 v88, v88, v4
    v_sub_f32 v89, v89, v4
    v_sub_f32 v90, v90, v4
    v_sub_f32 v91, v91, v4
    v_sub_f32 v92, v92, v4
    v_sub_f32 v93, v93, v4
    v_sub_f32 v94, v94, v4
    v_sub_f32 v95, v95, v4
    v_sub_f32 v6, 0, v4
    v_exp_f32 v6, v6
    s_nop 0
    v_mul_f32 v14, v22, v6
    v_mul_f32 v15, v23, v6
    v_exp_f32 v24, v48
    v_exp_f32 v25, v49
    v_add_f32 v14, v14, v24
    v_add_f32 v15, v15, v25
    v_cvt_pk_bf16_f32 v104, v24, v25
    v_exp_f32 v24, v50
    v_exp_f32 v25, v51
    v_add_f32 v14, v14, v24
    v_add_f32 v15, v15, v25
    v_cvt_pk_bf16_f32 v105, v24, v25
    v_exp_f32 v24, v52
    v_exp_f32 v25, v53
    v_add_f32 v14, v14, v24
    v_add_f32 v15, v15, v25
    v_cvt_pk_bf16_f32 v106, v24, v25
    v_exp_f32 v24, v54
    v_exp_f32 v25, v55
    v_add_f32 v14, v14, v24
    v_add_f32 v15, v15, v25
    v_cvt_pk_bf16_f32 v107, v24, v25
    v_exp_f32 v24, v56
    v_exp_f32 v25, v57
    v_add_f32 v14, v14, v24
    v_add_f32 v15, v15, v25
    v_cvt_pk_bf16_f32 v108, v24, v25
    v_exp_f32 v24, v58
    v_exp_f32 v25, v59
    v_add_f32 v14, v14, v24
    v_add_f32 v15, v15, v25
    v_cvt_pk_bf16_f32 v109, v24, v25
    v_exp_f32 v24, v60
    v_exp_f32 v25, v61
    v_add_f32 v14, v14, v24
    v_add_f32 v15, v15, v25
    v_cvt_pk_bf16_f32 v110, v24, v25
    v_exp_f32 v24, v62
    v_exp_f32 v25, v63
    v_add_f32 v14, v14, v24
    v_add_f32 v15, v15, v25
    v_cvt_pk_bf16_f32 v111, v24, v25
    v_accvgpr_read_b32 v7, a128
    v_accvgpr_read_b32 v8, a129
    v_accvgpr_read_b32 v9, a130
    v_accvgpr_read_b32 v10, a131
    v_mul_f32 v7, v7, v6
    v_mul_f32 v8, v8, v6
    v_mul_f32 v9, v9, v6
    v_mul_f32 v10, v10, v6
    v_accvgpr_write_b32 a128, v7
    v_accvgpr_write_b32 a129, v8
    v_accvgpr_write_b32 a130, v9
    v_accvgpr_write_b32 a131, v10
    v_accvgpr_read_b32 v7, a132
    v_accvgpr_read_b32 v8, a133
    v_accvgpr_read_b32 v9, a134
    v_accvgpr_read_b32 v10, a135
    v_mul_f32 v7, v7, v6
    v_mul_f32 v8, v8, v6
    v_mul_f32 v9, v9, v6
    v_mul_f32 v10, v10, v6
    v_accvgpr_write_b32 a132, v7
    v_accvgpr_write_b32 a133, v8
    v_accvgpr_write_b32 a134, v9
    v_accvgpr_write_b32 a135, v10
    v_accvgpr_read_b32 v7, a136
    v_accvgpr_read_b32 v8, a137
    v_accvgpr_read_b32 v9, a138
    v_accvgpr_read_b32 v10, a139
    v_mul_f32 v7, v7, v6
    v_mul_f32 v8, v8, v6
    v_mul_f32 v9, v9, v6
    v_mul_f32 v10, v10, v6
    v_accvgpr_write_b32 a136, v7
    v_accvgpr_write_b32 a137, v8
    v_accvgpr_write_b32 a138, v9
    v_accvgpr_write_b32 a139, v10
    v_accvgpr_read_b32 v7, a140
    v_accvgpr_read_b32 v8, a141
    v_accvgpr_read_b32 v9, a142
    v_accvgpr_read_b32 v10, a143
    v_mul_f32 v7, v7, v6
    v_mul_f32 v8, v8, v6
    v_mul_f32 v9, v9, v6
    v_mul_f32 v10, v10, v6
    v_accvgpr_write_b32 a140, v7
    v_accvgpr_write_b32 a141, v8
    v_accvgpr_write_b32 a142, v9
    v_accvgpr_write_b32 a143, v10
    v_accvgpr_read_b32 v7, a144
    v_accvgpr_read_b32 v8, a145
    v_accvgpr_read_b32 v9, a146
    v_accvgpr_read_b32 v10, a147
    v_mul_f32 v7, v7, v6
    v_mul_f32 v8, v8, v6
    v_mul_f32 v9, v9, v6
    v_mul_f32 v10, v10, v6
    v_accvgpr_write_b32 a144, v7
    v_accvgpr_write_b32 a145, v8
    v_accvgpr_write_b32 a146, v9
    v_accvgpr_write_b32 a147, v10
    v_accvgpr_read_b32 v7, a148
    v_accvgpr_read_b32 v8, a149
    v_accvgpr_read_b32 v9, a150
    v_accvgpr_read_b32 v10, a151
    v_mul_f32 v7, v7, v6
    v_mul_f32 v8, v8, v6
    v_mul_f32 v9, v9, v6
    v_mul_f32 v10, v10, v6
    v_accvgpr_write_b32 a148, v7
    v_accvgpr_write_b32 a149, v8
    v_accvgpr_write_b32 a150, v9
    v_accvgpr_write_b32 a151, v10
    v_accvgpr_read_b32 v7, a152
    v_accvgpr_read_b32 v8, a153
    v_accvgpr_read_b32 v9, a154
    v_accvgpr_read_b32 v10, a155
    v_mul_f32 v7, v7, v6
    v_mul_f32 v8, v8, v6
    v_mul_f32 v9, v9, v6
    v_mul_f32 v10, v10, v6
    v_accvgpr_write_b32 a152, v7
    v_accvgpr_write_b32 a153, v8
    v_accvgpr_write_b32 a154, v9
    v_accvgpr_write_b32 a155, v10
    v_accvgpr_read_b32 v7, a156
    v_accvgpr_read_b32 v8, a157
    v_accvgpr_read_b32 v9, a158
    v_accvgpr_read_b32 v10, a159
    v_mul_f32 v7, v7, v6
    v_mul_f32 v8, v8, v6
    v_mul_f32 v9, v9, v6
    v_mul_f32 v10, v10, v6
    v_accvgpr_write_b32 a156, v7
    v_accvgpr_write_b32 a157, v8
    v_accvgpr_write_b32 a158, v9
    v_accvgpr_write_b32 a159, v10
    v_accvgpr_read_b32 v7, a160
    v_accvgpr_read_b32 v8, a161
    v_accvgpr_read_b32 v9, a162
    v_accvgpr_read_b32 v10, a163
    v_mul_f32 v7, v7, v6
    v_mul_f32 v8, v8, v6
    v_mul_f32 v9, v9, v6
    v_mul_f32 v10, v10, v6
    v_accvgpr_write_b32 a160, v7
    v_accvgpr_write_b32 a161, v8
    v_accvgpr_write_b32 a162, v9
    v_accvgpr_write_b32 a163, v10
    v_accvgpr_read_b32 v7, a164
    v_accvgpr_read_b32 v8, a165
    v_accvgpr_read_b32 v9, a166
    v_accvgpr_read_b32 v10, a167
    v_mul_f32 v7, v7, v6
    v_mul_f32 v8, v8, v6
    v_mul_f32 v9, v9, v6
    v_mul_f32 v10, v10, v6
    v_accvgpr_write_b32 a164, v7
    v_accvgpr_write_b32 a165, v8
    v_accvgpr_write_b32 a166, v9
    v_accvgpr_write_b32 a167, v10
    v_accvgpr_read_b32 v7, a168
    v_accvgpr_read_b32 v8, a169
    v_accvgpr_read_b32 v9, a170
    v_accvgpr_read_b32 v10, a171
    v_mul_f32 v7, v7, v6
    v_mul_f32 v8, v8, v6
    v_mul_f32 v9, v9, v6
    v_mul_f32 v10, v10, v6
    v_accvgpr_write_b32 a168, v7
    v_accvgpr_write_b32 a169, v8
    v_accvgpr_write_b32 a170, v9
    v_accvgpr_write_b32 a171, v10
    v_accvgpr_read_b32 v7, a172
    v_accvgpr_read_b32 v8, a173
    v_accvgpr_read_b32 v9, a174
    v_accvgpr_read_b32 v10, a175
    v_mul_f32 v7, v7, v6
    v_mul_f32 v8, v8, v6
    v_mul_f32 v9, v9, v6
    v_mul_f32 v10, v10, v6
    v_accvgpr_write_b32 a172, v7
    v_accvgpr_write_b32 a173, v8
    v_accvgpr_write_b32 a174, v9
    v_accvgpr_write_b32 a175, v10
    v_accvgpr_read_b32 v7, a176
    v_accvgpr_read_b32 v8, a177
    v_accvgpr_read_b32 v9, a178
    v_accvgpr_read_b32 v10, a179
    v_mul_f32 v7, v7, v6
    v_mul_f32 v8, v8, v6
    v_mul_f32 v9, v9, v6
    v_mul_f32 v10, v10, v6
    v_accvgpr_write_b32 a176, v7
    v_accvgpr_write_b32 a177, v8
    v_accvgpr_write_b32 a178, v9
    v_accvgpr_write_b32 a179, v10
    v_accvgpr_read_b32 v7, a180
    v_accvgpr_read_b32 v8, a181
    v_accvgpr_read_b32 v9, a182
    v_accvgpr_read_b32 v10, a183
    v_mul_f32 v7, v7, v6
    v_mul_f32 v8, v8, v6
    v_mul_f32 v9, v9, v6
    v_mul_f32 v10, v10, v6
    v_accvgpr_write_b32 a180, v7
    v_accvgpr_write_b32 a181, v8
    v_accvgpr_write_b32 a182, v9
    v_accvgpr_write_b32 a183, v10
    v_accvgpr_read_b32 v7, a184
    v_accvgpr_read_b32 v8, a185
    v_accvgpr_read_b32 v9, a186
    v_accvgpr_read_b32 v10, a187
    v_mul_f32 v7, v7, v6
    v_mul_f32 v8, v8, v6
    v_mul_f32 v9, v9, v6
    v_mul_f32 v10, v10, v6
    v_accvgpr_write_b32 a184, v7
    v_accvgpr_write_b32 a185, v8
    v_accvgpr_write_b32 a186, v9
    v_accvgpr_write_b32 a187, v10
    v_accvgpr_read_b32 v7, a188
    v_accvgpr_read_b32 v8, a189
    v_accvgpr_read_b32 v9, a190
    v_accvgpr_read_b32 v10, a191
    v_mul_f32 v7, v7, v6
    v_mul_f32 v8, v8, v6
    v_mul_f32 v9, v9, v6
    v_mul_f32 v10, v10, v6
    v_accvgpr_write_b32 a188, v7
    v_accvgpr_write_b32 a189, v8
    v_accvgpr_write_b32 a190, v9
    v_accvgpr_write_b32 a191, v10
at_nr_226:
    s_cmp_eq_u64 s[30:31], 0
    s_cbranch_scc1 s_at_rb_225
    v_mov_b32 v11, s28
    v_cmp_gt_i32 vcc, 0, v3
    s_nop 1
    v_cndmask_b32 v128, v128, v11, vcc
    v_cmp_gt_i32 vcc, 1, v3
    s_nop 1
    v_cndmask_b32 v129, v129, v11, vcc
    v_cmp_gt_i32 vcc, 2, v3
    s_nop 1
    v_cndmask_b32 v130, v130, v11, vcc
    v_cmp_gt_i32 vcc, 3, v3
    s_nop 1
    v_cndmask_b32 v131, v131, v11, vcc
    v_cmp_gt_i32 vcc, 8, v3
    s_nop 1
    v_cndmask_b32 v132, v132, v11, vcc
    v_cmp_gt_i32 vcc, 9, v3
    s_nop 1
    v_cndmask_b32 v133, v133, v11, vcc
    v_cmp_gt_i32 vcc, 10, v3
    s_nop 1
    v_cndmask_b32 v134, v134, v11, vcc
    v_cmp_gt_i32 vcc, 11, v3
    s_nop 1
    v_cndmask_b32 v135, v135, v11, vcc
    v_cmp_gt_i32 vcc, 16, v3
    s_nop 1
    v_cndmask_b32 v136, v136, v11, vcc
    v_cmp_gt_i32 vcc, 17, v3
    s_nop 1
    v_cndmask_b32 v137, v137, v11, vcc
    v_cmp_gt_i32 vcc, 18, v3
    s_nop 1
    v_cndmask_b32 v138, v138, v11, vcc
    v_cmp_gt_i32 vcc, 19, v3
    s_nop 1
    v_cndmask_b32 v139, v139, v11, vcc
    v_cmp_gt_i32 vcc, 24, v3
    s_nop 1
    v_cndmask_b32 v140, v140, v11, vcc
    v_cmp_gt_i32 vcc, 25, v3
    s_nop 1
    v_cndmask_b32 v141, v141, v11, vcc
    v_cmp_gt_i32 vcc, 26, v3
    s_nop 1
    v_cndmask_b32 v142, v142, v11, vcc
    v_cmp_gt_i32_e64 vcc, 27, v3
    s_nop 1
    v_cndmask_b32_e64 v143, v143, v11, vcc
    s_nop 1
    s_branch s_at_rb_225
at_dp_227:
    s_cbranch_vccz at_nr_229
    v_max3_f32 v4, v64, v65, v66
    v_max3_f32 v4, v4, v67, v68
    v_max3_f32 v4, v4, v69, v70
    v_max3_f32 v4, v4, v71, v72
    v_max3_f32 v4, v4, v73, v74
    v_max3_f32 v4, v4, v75, v76
    v_max3_f32 v4, v4, v77, v78
    v_max_f32 v4, v4, v79
    v_mov_b32 v5, v4
    s_nop 1
    v_permlane32_swap_b32 v4, v5
    v_max_f32 v4, v4, v5
    v_add_f32 v6, v20, v21
    v_mov_b32 v5, v6
    s_nop 1
    v_permlane32_swap_b32 v6, v5
    v_add_f32 v6, v6, v5
    v_log_f32 v6, v6
    s_nop 0
    v_add_f32 v6, -4.0, v6
    v_add_f32 v6, -4.0, v6
    v_add_f32 v6, -4.0, v6
    v_max3_f32 v4, v4, 0, v6
    v_sub_f32 v64, v64, v4
    v_sub_f32 v65, v65, v4
    v_sub_f32 v66, v66, v4
    v_sub_f32 v67, v67, v4
    v_sub_f32 v68, v68, v4
    v_sub_f32 v69, v69, v4
    v_sub_f32 v70, v70, v4
    v_sub_f32 v71, v71, v4
    v_sub_f32 v72, v72, v4
    v_sub_f32 v73, v73, v4
    v_sub_f32 v74, v74, v4
    v_sub_f32 v75, v75, v4
    v_sub_f32 v76, v76, v4
    v_sub_f32 v77, v77, v4
    v_sub_f32 v78, v78, v4
    v_sub_f32 v79, v79, v4
    v_sub_f32 v128, v128, v4
    v_sub_f32 v129, v129, v4
    v_sub_f32 v130, v130, v4
    v_sub_f32 v131, v131, v4
    v_sub_f32 v132, v132, v4
    v_sub_f32 v133, v133, v4
    v_sub_f32 v134, v134, v4
    v_sub_f32 v135, v135, v4
    v_sub_f32 v136, v136, v4
    v_sub_f32 v137, v137, v4
    v_sub_f32 v138, v138, v4
    v_sub_f32 v139, v139, v4
    v_sub_f32 v140, v140, v4
    v_sub_f32 v141, v141, v4
    v_sub_f32 v142, v142, v4
    v_sub_f32 v143, v143, v4
    v_sub_f32 v32, v32, v4
    v_sub_f32 v33, v33, v4
    v_sub_f32 v34, v34, v4
    v_sub_f32 v35, v35, v4
    v_sub_f32 v36, v36, v4
    v_sub_f32 v37, v37, v4
    v_sub_f32 v38, v38, v4
    v_sub_f32 v39, v39, v4
    v_sub_f32 v40, v40, v4
    v_sub_f32 v41, v41, v4
    v_sub_f32 v42, v42, v4
    v_sub_f32 v43, v43, v4
    v_sub_f32 v44, v44, v4
    v_sub_f32 v45, v45, v4
    v_sub_f32 v46, v46, v4
    v_sub_f32 v47, v47, v4
    v_sub_f32 v6, 0, v4
    v_exp_f32 v6, v6
    s_nop 0
    v_mul_f32 v12, v20, v6
    v_mul_f32 v13, v21, v6
    v_exp_f32 v24, v64
    v_exp_f32 v25, v65
    v_add_f32 v12, v12, v24
    v_add_f32 v13, v13, v25
    v_cvt_pk_bf16_f32 v112, v24, v25
    v_exp_f32 v24, v66
    v_exp_f32 v25, v67
    v_add_f32 v12, v12, v24
    v_add_f32 v13, v13, v25
    v_cvt_pk_bf16_f32 v113, v24, v25
    v_exp_f32 v24, v68
    v_exp_f32 v25, v69
    v_add_f32 v12, v12, v24
    v_add_f32 v13, v13, v25
    v_cvt_pk_bf16_f32 v114, v24, v25
    v_exp_f32 v24, v70
    v_exp_f32 v25, v71
    v_add_f32 v12, v12, v24
    v_add_f32 v13, v13, v25
    v_cvt_pk_bf16_f32 v115, v24, v25
    v_exp_f32 v24, v72
    v_exp_f32 v25, v73
    v_add_f32 v12, v12, v24
    v_add_f32 v13, v13, v25
    v_cvt_pk_bf16_f32 v116, v24, v25
    v_exp_f32 v24, v74
    v_exp_f32 v25, v75
    v_add_f32 v12, v12, v24
    v_add_f32 v13, v13, v25
    v_cvt_pk_bf16_f32 v117, v24, v25
    v_exp_f32 v24, v76
    v_exp_f32 v25, v77
    v_add_f32 v12, v12, v24
    v_add_f32 v13, v13, v25
    v_cvt_pk_bf16_f32 v118, v24, v25
    v_exp_f32 v24, v78
    v_exp_f32 v25, v79
    v_add_f32 v12, v12, v24
    v_add_f32 v13, v13, v25
    v_cvt_pk_bf16_f32 v119, v24, v25
    v_accvgpr_read_b32 v7, a64
    v_accvgpr_read_b32 v8, a65
    v_accvgpr_read_b32 v9, a66
    v_accvgpr_read_b32 v10, a67
    v_mul_f32 v7, v7, v6
    v_mul_f32 v8, v8, v6
    v_mul_f32 v9, v9, v6
    v_mul_f32 v10, v10, v6
    v_accvgpr_write_b32 a64, v7
    v_accvgpr_write_b32 a65, v8
    v_accvgpr_write_b32 a66, v9
    v_accvgpr_write_b32 a67, v10
    v_accvgpr_read_b32 v7, a68
    v_accvgpr_read_b32 v8, a69
    v_accvgpr_read_b32 v9, a70
    v_accvgpr_read_b32 v10, a71
    v_mul_f32 v7, v7, v6
    v_mul_f32 v8, v8, v6
    v_mul_f32 v9, v9, v6
    v_mul_f32 v10, v10, v6
    v_accvgpr_write_b32 a68, v7
    v_accvgpr_write_b32 a69, v8
    v_accvgpr_write_b32 a70, v9
    v_accvgpr_write_b32 a71, v10
    v_accvgpr_read_b32 v7, a72
    v_accvgpr_read_b32 v8, a73
    v_accvgpr_read_b32 v9, a74
    v_accvgpr_read_b32 v10, a75
    v_mul_f32 v7, v7, v6
    v_mul_f32 v8, v8, v6
    v_mul_f32 v9, v9, v6
    v_mul_f32 v10, v10, v6
    v_accvgpr_write_b32 a72, v7
    v_accvgpr_write_b32 a73, v8
    v_accvgpr_write_b32 a74, v9
    v_accvgpr_write_b32 a75, v10
    v_accvgpr_read_b32 v7, a76
    v_accvgpr_read_b32 v8, a77
    v_accvgpr_read_b32 v9, a78
    v_accvgpr_read_b32 v10, a79
    v_mul_f32 v7, v7, v6
    v_mul_f32 v8, v8, v6
    v_mul_f32 v9, v9, v6
    v_mul_f32 v10, v10, v6
    v_accvgpr_write_b32 a76, v7
    v_accvgpr_write_b32 a77, v8
    v_accvgpr_write_b32 a78, v9
    v_accvgpr_write_b32 a79, v10
    v_accvgpr_read_b32 v7, a80
    v_accvgpr_read_b32 v8, a81
    v_accvgpr_read_b32 v9, a82
    v_accvgpr_read_b32 v10, a83
    v_mul_f32 v7, v7, v6
    v_mul_f32 v8, v8, v6
    v_mul_f32 v9, v9, v6
    v_mul_f32 v10, v10, v6
    v_accvgpr_write_b32 a80, v7
    v_accvgpr_write_b32 a81, v8
    v_accvgpr_write_b32 a82, v9
    v_accvgpr_write_b32 a83, v10
    v_accvgpr_read_b32 v7, a84
    v_accvgpr_read_b32 v8, a85
    v_accvgpr_read_b32 v9, a86
    v_accvgpr_read_b32 v10, a87
    v_mul_f32 v7, v7, v6
    v_mul_f32 v8, v8, v6
    v_mul_f32 v9, v9, v6
    v_mul_f32 v10, v10, v6
    v_accvgpr_write_b32 a84, v7
    v_accvgpr_write_b32 a85, v8
    v_accvgpr_write_b32 a86, v9
    v_accvgpr_write_b32 a87, v10
    v_accvgpr_read_b32 v7, a88
    v_accvgpr_read_b32 v8, a89
    v_accvgpr_read_b32 v9, a90
    v_accvgpr_read_b32 v10, a91
    v_mul_f32 v7, v7, v6
    v_mul_f32 v8, v8, v6
    v_mul_f32 v9, v9, v6
    v_mul_f32 v10, v10, v6
    v_accvgpr_write_b32 a88, v7
    v_accvgpr_write_b32 a89, v8
    v_accvgpr_write_b32 a90, v9
    v_accvgpr_write_b32 a91, v10
    v_accvgpr_read_b32 v7, a92
    v_accvgpr_read_b32 v8, a93
    v_accvgpr_read_b32 v9, a94
    v_accvgpr_read_b32 v10, a95
    v_mul_f32 v7, v7, v6
    v_mul_f32 v8, v8, v6
    v_mul_f32 v9, v9, v6
    v_mul_f32 v10, v10, v6
    v_accvgpr_write_b32 a92, v7
    v_accvgpr_write_b32 a93, v8
    v_accvgpr_write_b32 a94, v9
    v_accvgpr_write_b32 a95, v10
    v_accvgpr_read_b32 v7, a96
    v_accvgpr_read_b32 v8, a97
    v_accvgpr_read_b32 v9, a98
    v_accvgpr_read_b32 v10, a99
    v_mul_f32 v7, v7, v6
    v_mul_f32 v8, v8, v6
    v_mul_f32 v9, v9, v6
    v_mul_f32 v10, v10, v6
    v_accvgpr_write_b32 a96, v7
    v_accvgpr_write_b32 a97, v8
    v_accvgpr_write_b32 a98, v9
    v_accvgpr_write_b32 a99, v10
    v_accvgpr_read_b32 v7, a100
    v_accvgpr_read_b32 v8, a101
    v_accvgpr_read_b32 v9, a102
    v_accvgpr_read_b32 v10, a103
    v_mul_f32 v7, v7, v6
    v_mul_f32 v8, v8, v6
    v_mul_f32 v9, v9, v6
    v_mul_f32 v10, v10, v6
    v_accvgpr_write_b32 a100, v7
    v_accvgpr_write_b32 a101, v8
    v_accvgpr_write_b32 a102, v9
    v_accvgpr_write_b32 a103, v10
    v_accvgpr_read_b32 v7, a104
    v_accvgpr_read_b32 v8, a105
    v_accvgpr_read_b32 v9, a106
    v_accvgpr_read_b32 v10, a107
    v_mul_f32 v7, v7, v6
    v_mul_f32 v8, v8, v6
    v_mul_f32 v9, v9, v6
    v_mul_f32 v10, v10, v6
    v_accvgpr_write_b32 a104, v7
    v_accvgpr_write_b32 a105, v8
    v_accvgpr_write_b32 a106, v9
    v_accvgpr_write_b32 a107, v10
    v_accvgpr_read_b32 v7, a108
    v_accvgpr_read_b32 v8, a109
    v_accvgpr_read_b32 v9, a110
    v_accvgpr_read_b32 v10, a111
    v_mul_f32 v7, v7, v6
    v_mul_f32 v8, v8, v6
    v_mul_f32 v9, v9, v6
    v_mul_f32 v10, v10, v6
    v_accvgpr_write_b32 a108, v7
    v_accvgpr_write_b32 a109, v8
    v_accvgpr_write_b32 a110, v9
    v_accvgpr_write_b32 a111, v10
    v_accvgpr_read_b32 v7, a112
    v_accvgpr_read_b32 v8, a113
    v_accvgpr_read_b32 v9, a114
    v_accvgpr_read_b32 v10, a115
    v_mul_f32 v7, v7, v6
    v_mul_f32 v8, v8, v6
    v_mul_f32 v9, v9, v6
    v_mul_f32 v10, v10, v6
    v_accvgpr_write_b32 a112, v7
    v_accvgpr_write_b32 a113, v8
    v_accvgpr_write_b32 a114, v9
    v_accvgpr_write_b32 a115, v10
    v_accvgpr_read_b32 v7, a116
    v_accvgpr_read_b32 v8, a117
    v_accvgpr_read_b32 v9, a118
    v_accvgpr_read_b32 v10, a119
    v_mul_f32 v7, v7, v6
    v_mul_f32 v8, v8, v6
    v_mul_f32 v9, v9, v6
    v_mul_f32 v10, v10, v6
    v_accvgpr_write_b32 a116, v7
    v_accvgpr_write_b32 a117, v8
    v_accvgpr_write_b32 a118, v9
    v_accvgpr_write_b32 a119, v10
    v_accvgpr_read_b32 v7, a120
    v_accvgpr_read_b32 v8, a121
    v_accvgpr_read_b32 v9, a122
    v_accvgpr_read_b32 v10, a123
    v_mul_f32 v7, v7, v6
    v_mul_f32 v8, v8, v6
    v_mul_f32 v9, v9, v6
    v_mul_f32 v10, v10, v6
    v_accvgpr_write_b32 a120, v7
    v_accvgpr_write_b32 a121, v8
    v_accvgpr_write_b32 a122, v9
    v_accvgpr_write_b32 a123, v10
    v_accvgpr_read_b32 v7, a124
    v_accvgpr_read_b32 v8, a125
    v_accvgpr_read_b32 v9, a126
    v_accvgpr_read_b32 v10, a127
    v_mul_f32 v7, v7, v6
    v_mul_f32 v8, v8, v6
    v_mul_f32 v9, v9, v6
    v_mul_f32 v10, v10, v6
    v_accvgpr_write_b32 a124, v7
    v_accvgpr_write_b32 a125, v8
    v_accvgpr_write_b32 a126, v9
    v_accvgpr_write_b32 a127, v10
    v_max3_f32 v4, v80, v81, v82
    v_max3_f32 v4, v4, v83, v84
    v_max3_f32 v4, v4, v85, v86
    v_max3_f32 v4, v4, v87, v88
    v_max3_f32 v4, v4, v89, v90
    v_max3_f32 v4, v4, v91, v92
    v_max3_f32 v4, v4, v93, v94
    v_max_f32 v4, v4, v95
    v_mov_b32 v5, v4
    s_nop 1
    v_permlane32_swap_b32 v4, v5
    v_max_f32 v4, v4, v5
    v_add_f32 v6, v22, v23
    v_mov_b32 v5, v6
    s_nop 1
    v_permlane32_swap_b32 v6, v5
    v_add_f32 v6, v6, v5
    v_log_f32 v6, v6
    s_nop 0
    v_add_f32 v6, -4.0, v6
    v_add_f32 v6, -4.0, v6
    v_add_f32 v6, -4.0, v6
    v_max3_f32 v4, v4, 0, v6
    v_sub_f32 v80, v80, v4
    v_sub_f32 v81, v81, v4
    v_sub_f32 v82, v82, v4
    v_sub_f32 v83, v83, v4
    v_sub_f32 v84, v84, v4
    v_sub_f32 v85, v85, v4
    v_sub_f32 v86, v86, v4
    v_sub_f32 v87, v87, v4
    v_sub_f32 v88, v88, v4
    v_sub_f32 v89, v89, v4
    v_sub_f32 v90, v90, v4
    v_sub_f32 v91, v91, v4
    v_sub_f32 v92, v92, v4
    v_sub_f32 v93, v93, v4
    v_sub_f32 v94, v94, v4
    v_sub_f32 v95, v95, v4
    v_sub_f32 v144, v144, v4
    v_sub_f32 v145, v145, v4
    v_sub_f32 v146, v146, v4
    v_sub_f32 v147, v147, v4
    v_sub_f32 v148, v148, v4
    v_sub_f32 v149, v149, v4
    v_sub_f32 v150, v150, v4
    v_sub_f32 v151, v151, v4
    v_sub_f32 v152, v152, v4
    v_sub_f32 v153, v153, v4
    v_sub_f32 v154, v154, v4
    v_sub_f32 v155, v155, v4
    v_sub_f32 v156, v156, v4
    v_sub_f32 v157, v157, v4
    v_sub_f32 v158, v158, v4
    v_sub_f32 v159, v159, v4
    v_sub_f32 v48, v48, v4
    v_sub_f32 v49, v49, v4
    v_sub_f32 v50, v50, v4
    v_sub_f32 v51, v51, v4
    v_sub_f32 v52, v52, v4
    v_sub_f32 v53, v53, v4
    v_sub_f32 v54, v54, v4
    v_sub_f32 v55, v55, v4
    v_sub_f32 v56, v56, v4
    v_sub_f32 v57, v57, v4
    v_sub_f32 v58, v58, v4
    v_sub_f32 v59, v59, v4
    v_sub_f32 v60, v60, v4
    v_sub_f32 v61, v61, v4
    v_sub_f32 v62, v62, v4
    v_sub_f32 v63, v63, v4
    v_sub_f32 v6, 0, v4
    v_exp_f32 v6, v6
    s_nop 0
    v_mul_f32 v14, v22, v6
    v_mul_f32 v15, v23, v6
    v_exp_f32 v24, v80
    v_exp_f32 v25, v81
    v_add_f32 v14, v14, v24
    v_add_f32 v15, v15, v25
    v_cvt_pk_bf16_f32 v120, v24, v25
    v_exp_f32 v24, v82
    v_exp_f32 v25, v83
    v_add_f32 v14, v14, v24
    v_add_f32 v15, v15, v25
    v_cvt_pk_bf16_f32 v121, v24, v25
    v_exp_f32 v24, v84
    v_exp_f32 v25, v85
    v_add_f32 v14, v14, v24
    v_add_f32 v15, v15, v25
    v_cvt_pk_bf16_f32 v122, v24, v25
    v_exp_f32 v24, v86
    v_exp_f32 v25, v87
    v_add_f32 v14, v14, v24
    v_add_f32 v15, v15, v25
    v_cvt_pk_bf16_f32 v123, v24, v25
    v_exp_f32 v24, v88
    v_exp_f32 v25, v89
    v_add_f32 v14, v14, v24
    v_add_f32 v15, v15, v25
    v_cvt_pk_bf16_f32 v124, v24, v25
    v_exp_f32 v24, v90
    v_exp_f32 v25, v91
    v_add_f32 v14, v14, v24
    v_add_f32 v15, v15, v25
    v_cvt_pk_bf16_f32 v125, v24, v25
    v_exp_f32 v24, v92
    v_exp_f32 v25, v93
    v_add_f32 v14, v14, v24
    v_add_f32 v15, v15, v25
    v_cvt_pk_bf16_f32 v126, v24, v25
    v_exp_f32 v24, v94
    v_exp_f32 v25, v95
    v_add_f32 v14, v14, v24
    v_add_f32 v15, v15, v25
    v_cvt_pk_bf16_f32 v127, v24, v25
    v_accvgpr_read_b32 v7, a128
    v_accvgpr_read_b32 v8, a129
    v_accvgpr_read_b32 v9, a130
    v_accvgpr_read_b32 v10, a131
    v_mul_f32 v7, v7, v6
    v_mul_f32 v8, v8, v6
    v_mul_f32 v9, v9, v6
    v_mul_f32 v10, v10, v6
    v_accvgpr_write_b32 a128, v7
    v_accvgpr_write_b32 a129, v8
    v_accvgpr_write_b32 a130, v9
    v_accvgpr_write_b32 a131, v10
    v_accvgpr_read_b32 v7, a132
    v_accvgpr_read_b32 v8, a133
    v_accvgpr_read_b32 v9, a134
    v_accvgpr_read_b32 v10, a135
    v_mul_f32 v7, v7, v6
    v_mul_f32 v8, v8, v6
    v_mul_f32 v9, v9, v6
    v_mul_f32 v10, v10, v6
    v_accvgpr_write_b32 a132, v7
    v_accvgpr_write_b32 a133, v8
    v_accvgpr_write_b32 a134, v9
    v_accvgpr_write_b32 a135, v10
    v_accvgpr_read_b32 v7, a136
    v_accvgpr_read_b32 v8, a137
    v_accvgpr_read_b32 v9, a138
    v_accvgpr_read_b32 v10, a139
    v_mul_f32 v7, v7, v6
    v_mul_f32 v8, v8, v6
    v_mul_f32 v9, v9, v6
    v_mul_f32 v10, v10, v6
    v_accvgpr_write_b32 a136, v7
    v_accvgpr_write_b32 a137, v8
    v_accvgpr_write_b32 a138, v9
    v_accvgpr_write_b32 a139, v10
    v_accvgpr_read_b32 v7, a140
    v_accvgpr_read_b32 v8, a141
    v_accvgpr_read_b32 v9, a142
    v_accvgpr_read_b32 v10, a143
    v_mul_f32 v7, v7, v6
    v_mul_f32 v8, v8, v6
    v_mul_f32 v9, v9, v6
    v_mul_f32 v10, v10, v6
    v_accvgpr_write_b32 a140, v7
    v_accvgpr_write_b32 a141, v8
    v_accvgpr_write_b32 a142, v9
    v_accvgpr_write_b32 a143, v10
    v_accvgpr_read_b32 v7, a144
    v_accvgpr_read_b32 v8, a145
    v_accvgpr_read_b32 v9, a146
    v_accvgpr_read_b32 v10, a147
    v_mul_f32 v7, v7, v6
    v_mul_f32 v8, v8, v6
    v_mul_f32 v9, v9, v6
    v_mul_f32 v10, v10, v6
    v_accvgpr_write_b32 a144, v7
    v_accvgpr_write_b32 a145, v8
    v_accvgpr_write_b32 a146, v9
    v_accvgpr_write_b32 a147, v10
    v_accvgpr_read_b32 v7, a148
    v_accvgpr_read_b32 v8, a149
    v_accvgpr_read_b32 v9, a150
    v_accvgpr_read_b32 v10, a151
    v_mul_f32 v7, v7, v6
    v_mul_f32 v8, v8, v6
    v_mul_f32 v9, v9, v6
    v_mul_f32 v10, v10, v6
    v_accvgpr_write_b32 a148, v7
    v_accvgpr_write_b32 a149, v8
    v_accvgpr_write_b32 a150, v9
    v_accvgpr_write_b32 a151, v10
    v_accvgpr_read_b32 v7, a152
    v_accvgpr_read_b32 v8, a153
    v_accvgpr_read_b32 v9, a154
    v_accvgpr_read_b32 v10, a155
    v_mul_f32 v7, v7, v6
    v_mul_f32 v8, v8, v6
    v_mul_f32 v9, v9, v6
    v_mul_f32 v10, v10, v6
    v_accvgpr_write_b32 a152, v7
    v_accvgpr_write_b32 a153, v8
    v_accvgpr_write_b32 a154, v9
    v_accvgpr_write_b32 a155, v10
    v_accvgpr_read_b32 v7, a156
    v_accvgpr_read_b32 v8, a157
    v_accvgpr_read_b32 v9, a158
    v_accvgpr_read_b32 v10, a159
    v_mul_f32 v7, v7, v6
    v_mul_f32 v8, v8, v6
    v_mul_f32 v9, v9, v6
    v_mul_f32 v10, v10, v6
    v_accvgpr_write_b32 a156, v7
    v_accvgpr_write_b32 a157, v8
    v_accvgpr_write_b32 a158, v9
    v_accvgpr_write_b32 a159, v10
    v_accvgpr_read_b32 v7, a160
    v_accvgpr_read_b32 v8, a161
    v_accvgpr_read_b32 v9, a162
    v_accvgpr_read_b32 v10, a163
    v_mul_f32 v7, v7, v6
    v_mul_f32 v8, v8, v6
    v_mul_f32 v9, v9, v6
    v_mul_f32 v10, v10, v6
    v_accvgpr_write_b32 a160, v7
    v_accvgpr_write_b32 a161, v8
    v_accvgpr_write_b32 a162, v9
    v_accvgpr_write_b32 a163, v10
    v_accvgpr_read_b32 v7, a164
    v_accvgpr_read_b32 v8, a165
    v_accvgpr_read_b32 v9, a166
    v_accvgpr_read_b32 v10, a167
    v_mul_f32 v7, v7, v6
    v_mul_f32 v8, v8, v6
    v_mul_f32 v9, v9, v6
    v_mul_f32 v10, v10, v6
    v_accvgpr_write_b32 a164, v7
    v_accvgpr_write_b32 a165, v8
    v_accvgpr_write_b32 a166, v9
    v_accvgpr_write_b32 a167, v10
    v_accvgpr_read_b32 v7, a168
    v_accvgpr_read_b32 v8, a169
    v_accvgpr_read_b32 v9, a170
    v_accvgpr_read_b32 v10, a171
    v_mul_f32 v7, v7, v6
    v_mul_f32 v8, v8, v6
    v_mul_f32 v9, v9, v6
    v_mul_f32 v10, v10, v6
    v_accvgpr_write_b32 a168, v7
    v_accvgpr_write_b32 a169, v8
    v_accvgpr_write_b32 a170, v9
    v_accvgpr_write_b32 a171, v10
    v_accvgpr_read_b32 v7, a172
    v_accvgpr_read_b32 v8, a173
    v_accvgpr_read_b32 v9, a174
    v_accvgpr_read_b32 v10, a175
    v_mul_f32 v7, v7, v6
    v_mul_f32 v8, v8, v6
    v_mul_f32 v9, v9, v6
    v_mul_f32 v10, v10, v6
    v_accvgpr_write_b32 a172, v7
    v_accvgpr_write_b32 a173, v8
    v_accvgpr_write_b32 a174, v9
    v_accvgpr_write_b32 a175, v10
    v_accvgpr_read_b32 v7, a176
    v_accvgpr_read_b32 v8, a177
    v_accvgpr_read_b32 v9, a178
    v_accvgpr_read_b32 v10, a179
    v_mul_f32 v7, v7, v6
    v_mul_f32 v8, v8, v6
    v_mul_f32 v9, v9, v6
    v_mul_f32 v10, v10, v6
    v_accvgpr_write_b32 a176, v7
    v_accvgpr_write_b32 a177, v8
    v_accvgpr_write_b32 a178, v9
    v_accvgpr_write_b32 a179, v10
    v_accvgpr_read_b32 v7, a180
    v_accvgpr_read_b32 v8, a181
    v_accvgpr_read_b32 v9, a182
    v_accvgpr_read_b32 v10, a183
    v_mul_f32 v7, v7, v6
    v_mul_f32 v8, v8, v6
    v_mul_f32 v9, v9, v6
    v_mul_f32 v10, v10, v6
    v_accvgpr_write_b32 a180, v7
    v_accvgpr_write_b32 a181, v8
    v_accvgpr_write_b32 a182, v9
    v_accvgpr_write_b32 a183, v10
    v_accvgpr_read_b32 v7, a184
    v_accvgpr_read_b32 v8, a185
    v_accvgpr_read_b32 v9, a186
    v_accvgpr_read_b32 v10, a187
    v_mul_f32 v7, v7, v6
    v_mul_f32 v8, v8, v6
    v_mul_f32 v9, v9, v6
    v_mul_f32 v10, v10, v6
    v_accvgpr_write_b32 a184, v7
    v_accvgpr_write_b32 a185, v8
    v_accvgpr_write_b32 a186, v9
    v_accvgpr_write_b32 a187, v10
    v_accvgpr_read_b32 v7, a188
    v_accvgpr_read_b32 v8, a189
    v_accvgpr_read_b32 v9, a190
    v_accvgpr_read_b32 v10, a191
    v_mul_f32 v7, v7, v6
    v_mul_f32 v8, v8, v6
    v_mul_f32 v9, v9, v6
    v_mul_f32 v10, v10, v6
    v_accvgpr_write_b32 a188, v7
    v_accvgpr_write_b32 a189, v8
    v_accvgpr_write_b32 a190, v9
    v_accvgpr_write_b32 a191, v10
at_nr_229:
    s_cmp_eq_u64 s[30:31], 0
    s_cbranch_scc1 s_at_rb_228
    s_cmp_eq_u32 s24, s22
    s_cbranch_scc1 at_tail0_215
    v_mov_b32 v11, s28
    v_cmp_gt_i32 vcc, 0, v3
    s_nop 1
    v_cndmask_b32 v144, v144, v11, vcc
    v_cmp_gt_i32 vcc, 1, v3
    s_nop 1
    v_cndmask_b32 v145, v145, v11, vcc
    v_cmp_gt_i32 vcc, 2, v3
    s_nop 1
    v_cndmask_b32 v146, v146, v11, vcc
    v_cmp_gt_i32 vcc, 3, v3
    s_nop 1
    v_cndmask_b32 v147, v147, v11, vcc
    v_cmp_gt_i32 vcc, 8, v3
    s_nop 1
    v_cndmask_b32 v148, v148, v11, vcc
    v_cmp_gt_i32 vcc, 9, v3
    s_nop 1
    v_cndmask_b32 v149, v149, v11, vcc
    v_cmp_gt_i32 vcc, 10, v3
    s_nop 1
    v_cndmask_b32 v150, v150, v11, vcc
    v_cmp_gt_i32 vcc, 11, v3
    s_nop 1
    v_cndmask_b32 v151, v151, v11, vcc
    v_cmp_gt_i32 vcc, 16, v3
    s_nop 1
    v_cndmask_b32 v152, v152, v11, vcc
    v_cmp_gt_i32 vcc, 17, v3
    s_nop 1
    v_cndmask_b32 v153, v153, v11, vcc
    v_cmp_gt_i32 vcc, 18, v3
    s_nop 1
    v_cndmask_b32 v154, v154, v11, vcc
    v_cmp_gt_i32 vcc, 19, v3
    s_nop 1
    v_cndmask_b32 v155, v155, v11, vcc
    v_cmp_gt_i32 vcc, 24, v3
    s_nop 1
    v_cndmask_b32 v156, v156, v11, vcc
    v_cmp_gt_i32 vcc, 25, v3
    s_nop 1
    v_cndmask_b32 v157, v157, v11, vcc
    v_cmp_gt_i32 vcc, 26, v3
    s_nop 1
    v_cndmask_b32 v158, v158, v11, vcc
    v_cmp_gt_i32 vcc, 27, v3
    s_nop 1
    v_cndmask_b32 v159, v159, v11, vcc
    v_mov_b32 v128, v11
    v_mov_b32 v129, v11
    v_mov_b32 v130, v11
    v_mov_b32 v131, v11
    v_mov_b32 v132, v11
    v_mov_b32 v133, v11
    v_mov_b32 v134, v11
    v_mov_b32 v135, v11
    v_mov_b32 v136, v11
    v_mov_b32 v137, v11
    v_mov_b32 v138, v11
    v_mov_b32 v139, v11
    v_mov_b32_e64 v140, v11
    v_mov_b32_e64 v141, v11
    v_mov_b32_e64 v142, v11
    v_mov_b32_e64 v143, v11
    s_nop 1
    s_branch s_at_rb_228
at_tail0_215:
    s_waitcnt lgkmcnt(0)
    ds_read_b128 a[192:195], v2 offset:16384
    ds_read_b128 a[196:199], v2 offset:17408
    ds_read_b128 a[200:203], v2 offset:18432
    ds_read_b128 a[204:207], v2 offset:19456
    ds_read_b128 a[208:211], v2 offset:20480
    ds_read_b128 a[212:215], v2 offset:21504
    ds_read_b128 a[216:219], v2 offset:22528
    ds_read_b128 a[220:223], v2 offset:23552
    s_branch at_fin_230
at_tail1_216:
    s_waitcnt lgkmcnt(0)
    ds_read_b128 a[192:195], v2 offset:49152
    ds_read_b128 a[196:199], v2 offset:50176
    ds_read_b128 a[200:203], v2 offset:51200
    ds_read_b128 a[204:207], v2 offset:52224
    ds_read_b128 a[208:211], v2 offset:53248
    ds_read_b128 a[212:215], v2 offset:54272
    ds_read_b128 a[216:219], v2 offset:55296
    ds_read_b128 a[220:223], v2 offset:56320
at_fin_230:
    s_cmp_lg_u32 s4, 0
    s_cbranch_scc1 at_nt_233
    v_mov_b32 v4, 1
    v_min_u32_e64 v5, 47, v0
    v_lshlrev_b32_e64 v5, 4, v5
    s_mov_b32 s60, 146810880
    buffer_load_dwordx4 v[8:11], v5, s[12:15], s60 offen sc1
    s_mov_b64 exec, 1
    buffer_atomic_add v4, off, s[12:15], s57 sc0
    s_mov_b64 exec, -1
at_nt_233:
    s_add_u32 s36, s24, 2
    s_cmp_gt_u32 s36, s23
    s_cbranch_scc1 at_sk_234
    s_mov_b32 m0, s26
    s_nop 0
    buffer_load_dwordx4 v1, s[12:15], s25 offen offset:0 sc1 lds
    buffer_load_dwordx4 v1, s[12:15], s25 offen offset:1024 sc1 lds
    buffer_load_dwordx4 v1, s[12:15], s25 offen offset:2048 sc1 lds
    buffer_load_dwordx4 v1, s[12:15], s25 offen offset:3072 sc1 lds
    s_add_u32 m0, s26, 4096
    s_add_u32 s25, s25, 4096
    buffer_load_dwordx4 v1, s[12:15], s25 offen offset:0 sc1 lds
    buffer_load_dwordx4 v1, s[12:15], s25 offen offset:1024 sc1 lds
    buffer_load_dwordx4 v1, s[12:15], s25 offen offset:2048 sc1 lds
    buffer_load_dwordx4 v1, s[12:15], s25 offen offset:3072 sc1 lds
    s_add_u32 s25, s25, 12288
    s_add_u32 s26, s26, 32768
    s_and_b32 s26, s26, 131071
at_sk_234:
    s_waitcnt lgkmcnt(7)
    v_mfma_f32_32x32x16_bf16 a[64:79], a[192:195], v[112:115], a[64:79]
    v_mfma_f32_32x32x16_bf16 a[128:143], a[192:195], v[120:123], a[128:143]
    s_waitcnt lgkmcnt(6)
    v_mfma_f32_32x32x16_bf16 a[64:79], a[196:199], v[116:119], a[64:79]
    v_mfma_f32_32x32x16_bf16 a[128:143], a[196:199], v[124:127], a[128:143]
    s_waitcnt lgkmcnt(5)
    v_mfma_f32_32x32x16_bf16 a[80:95], a[200:203], v[112:115], a[80:95]
    v_mfma_f32_32x32x16_bf16 a[144:159], a[200:203], v[120:123], a[144:159]
    s_waitcnt lgkmcnt(4)
    v_mfma_f32_32x32x16_bf16 a[80:95], a[204:207], v[116:119], a[80:95]
    v_mfma_f32_32x32x16_bf16 a[144:159], a[204:207], v[124:127], a[144:159]
    s_waitcnt lgkmcnt(3)
    v_mfma_f32_32x32x16_bf16 a[96:111], a[208:211], v[112:115], a[96:111]
    v_mfma_f32_32x32x16_bf16 a[160:175], a[208:211], v[120:123], a[160:175]
    s_waitcnt lgkmcnt(2)
    v_mfma_f32_32x32x16_bf16 a[96:111], a[212:215], v[116:119], a[96:111]
    v_mfma_f32_32x32x16_bf16 a[160:175], a[212:215], v[124:127], a[160:175]
    s_waitcnt lgkmcnt(1)
    v_mfma_f32_32x32x16_bf16 a[112:127], a[216:219], v[112:115], a[112:127]
    s_nop 0
    v_mfma_f32_32x32x16_bf16 a[176:191], a[216:219], v[120:123], a[176:191]
    s_waitcnt lgkmcnt(0)
    v_mfma_f32_32x32x16_bf16 a[112:127], a[220:223], v[116:119], a[112:127]
    s_nop 0
    v_mfma_f32_32x32x16_bf16 a[176:191], a[220:223], v[124:127], a[176:191]
    s_cmp_lg_u32 s4, 0
    s_cbranch_scc1 at_idle_231
    s_waitcnt vmcnt(8)
    v_add3_u32 v8, v8, v9, v10
    v_add_u32_e64 v8, v8, v11
    v_cmp_gt_u32_e64 vcc, 64, v8
    v_readfirstlane_b32 s58, v4
    s_cmp_eq_u64 vcc, 0
    s_cselect_b32 s62, 0, 0x80000000
    s_cmp_eq_u32 s6, 2
    s_cselect_b32 s62, 0x80000000, s62
    s_or_b32 s58, s58, s62
    v_mov_b32_e64 v4, s58
    v_mov_b32 v5, 131072
    ds_write_b32 v5, v4
    s_waitcnt lgkmcnt(0)
at_idle_231:
    s_cmp_ge_u32 s24, s23
    s_cbranch_scc1 at_epi_232
    s_add_u32 s24, s24, 1
    s_cmp_ge_u32 s24, s23
    s_cbranch_scc1 at_w0_235
    s_waitcnt vmcnt(8)
    s_branch at_w1_236
at_w0_235:
    s_waitcnt vmcnt(0)
at_w1_236:
    s_barrier
    s_add_u32 s36, s24, 2
    s_cmp_gt_u32 s36, s23
    s_cbranch_scc1 at_sk_237
    s_mov_b32 m0, s26
    s_nop 0
    buffer_load_dwordx4 v1, s[12:15], s25 offen offset:0 sc1 lds
    buffer_load_dwordx4 v1, s[12:15], s25 offen offset:1024 sc1 lds
    buffer_load_dwordx4 v1, s[12:15], s25 offen offset:2048 sc1 lds
    buffer_load_dwordx4 v1, s[12:15], s25 offen offset:3072 sc1 lds
    s_add_u32 m0, s26, 4096
    s_add_u32 s25, s25, 4096
    buffer_load_dwordx4 v1, s[12:15], s25 offen offset:0 sc1 lds
    buffer_load_dwordx4 v1, s[12:15], s25 offen offset:1024 sc1 lds
    buffer_load_dwordx4 v1, s[12:15], s25 offen offset:2048 sc1 lds
    buffer_load_dwordx4 v1, s[12:15], s25 offen offset:3072 sc1 lds
    s_add_u32 s25, s25, 12288
    s_add_u32 s26, s26, 32768
    s_and_b32 s26, s26, 131071
at_sk_237:
    s_branch at_idle_231
at_epi_232:
    s_lshl_b32 s36, s21, 3
    s_lshl_b32 s37, s4, 1
    s_add_u32 s36, s36, s37
    s_lshl_b32 s36, s36, 5
    s_add_u32 s36, s36, s20
    s_lshl_b32 s36, s36, 13
    s_add_u32 s32, s36, 117440512
    v_mov_b32 v5, 131072
    ds_read_b32 v4, v5
    s_lshl_b32 s33, s21, 5
    s_add_u32 s33, s33, s20
    s_lshl_b32 s33, s33, 2
    s_add_u32 s33, s33, 146811904
    s_waitcnt lgkmcnt(0)
    v_readfirstlane_b32 s59, v4
    s_barrier
    s_cmp_ge_u32 s59, 128
    s_cbranch_scc1 mn_nc_238
    s_and_b32 s20, s59, 31
    s_lshr_b32 s60, s59, 5
    s_sub_u32 s21, 3, s60
    s_branch at_top_206
mn_nc_238:
    v_add_f32 v12, v12, v13
    v_mov_b32 v13, v12
    s_nop 1
    v_permlane32_swap_b32 v12, v13
    v_add_f32 v12, v12, v13
    v_rcp_f32 v12, v12
    v_accvgpr_read_b32 v32, a64
    v_accvgpr_read_b32 v33, a65
    v_accvgpr_read_b32 v34, a66
    v_accvgpr_read_b32 v35, a67
    v_accvgpr_read_b32 v36, a68
    v_accvgpr_read_b32 v37, a69
    v_accvgpr_read_b32 v38, a70
    v_accvgpr_read_b32 v39, a71
    v_mul_f32 v32, v32, v12
    v_mul_f32 v33, v33, v12
    v_mul_f32 v34, v34, v12
    v_mul_f32 v35, v35, v12
    v_mul_f32 v36, v36, v12
    v_mul_f32 v37, v37, v12
    v_mul_f32 v38, v38, v12
    v_mul_f32 v39, v39, v12
    v_cvt_pk_bf16_f32 v160, v32, v33
    v_cvt_pk_bf16_f32 v161, v34, v35
    v_cvt_pk_bf16_f32 v162, v36, v37
    v_cvt_pk_bf16_f32 v163, v38, v39
    buffer_store_dwordx4 v[160:163], v1, s[12:15], s32 offen offset:0 sc1
    v_accvgpr_read_b32 v40, a72
    v_accvgpr_read_b32 v41, a73
    v_accvgpr_read_b32 v42, a74
    v_accvgpr_read_b32 v43, a75
    v_accvgpr_read_b32 v44, a76
    v_accvgpr_read_b32 v45, a77
    v_accvgpr_read_b32 v46, a78
    v_accvgpr_read_b32 v47, a79
    v_mul_f32 v40, v40, v12
    v_mul_f32 v41, v41, v12
    v_mul_f32 v42, v42, v12
    v_mul_f32 v43, v43, v12
    v_mul_f32 v44, v44, v12
    v_mul_f32 v45, v45, v12
    v_mul_f32 v46, v46, v12
    v_mul_f32 v47, v47, v12
    v_cvt_pk_bf16_f32 v164, v40, v41
    v_cvt_pk_bf16_f32 v165, v42, v43
    v_cvt_pk_bf16_f32 v166, v44, v45
    v_cvt_pk_bf16_f32 v167, v46, v47
    buffer_store_dwordx4 v[164:167], v1, s[12:15], s32 offen offset:1024 sc1
    v_accvgpr_read_b32 v48, a80
    v_accvgpr_read_b32 v49, a81
    v_accvgpr_read_b32 v50, a82
    v_accvgpr_read_b32 v51, a83
    v_accvgpr_read_b32 v52, a84
    v_accvgpr_read_b32 v53, a85
    v_accvgpr_read_b32 v54, a86
    v_accvgpr_read_b32 v55, a87
    v_mul_f32 v48, v48, v12
    v_mul_f32 v49, v49, v12
    v_mul_f32 v50, v50, v12
    v_mul_f32 v51, v51, v12
    v_mul_f32 v52, v52, v12
    v_mul_f32 v53, v53, v12
    v_mul_f32 v54, v54, v12
    v_mul_f32 v55, v55, v12
    v_cvt_pk_bf16_f32 v168, v48, v49
    v_cvt_pk_bf16_f32 v169, v50, v51
    v_cvt_pk_bf16_f32 v170, v52, v53
    v_cvt_pk_bf16_f32 v171, v54, v55
    buffer_store_dwordx4 v[168:171], v1, s[12:15], s32 offen offset:2048 sc1
    v_accvgpr_read_b32 v56, a88
    v_accvgpr_read_b32 v57, a89
    v_accvgpr_read_b32 v58, a90
    v_accvgpr_read_b32 v59, a91
    v_accvgpr_read_b32 v60, a92
    v_accvgpr_read_b32 v61, a93
    v_accvgpr_read_b32 v62, a94
    v_accvgpr_read_b32 v63, a95
    v_mul_f32 v56, v56, v12
    v_mul_f32 v57, v57, v12
    v_mul_f32 v58, v58, v12
    v_mul_f32 v59, v59, v12
    v_mul_f32 v60, v60, v12
    v_mul_f32 v61, v61, v12
    v_mul_f32 v62, v62, v12
    v_mul_f32 v63, v63, v12
    v_cvt_pk_bf16_f32 v172, v56, v57
    v_cvt_pk_bf16_f32 v173, v58, v59
    v_cvt_pk_bf16_f32 v174, v60, v61
    v_cvt_pk_bf16_f32 v175, v62, v63
    buffer_store_dwordx4 v[172:175], v1, s[12:15], s32 offen offset:3072 sc1
    v_accvgpr_read_b32 v32, a96
    v_accvgpr_read_b32 v33, a97
    v_accvgpr_read_b32 v34, a98
    v_accvgpr_read_b32 v35, a99
    v_accvgpr_read_b32 v36, a100
    v_accvgpr_read_b32 v37, a101
    v_accvgpr_read_b32 v38, a102
    v_accvgpr_read_b32 v39, a103
    v_mul_f32 v32, v32, v12
    v_mul_f32 v33, v33, v12
    v_mul_f32 v34, v34, v12
    v_mul_f32 v35, v35, v12
    v_mul_f32 v36, v36, v12
    v_mul_f32 v37, v37, v12
    v_mul_f32 v38, v38, v12
    v_mul_f32 v39, v39, v12
    v_cvt_pk_bf16_f32 v176, v32, v33
    v_cvt_pk_bf16_f32 v177, v34, v35
    v_cvt_pk_bf16_f32 v178, v36, v37
    v_cvt_pk_bf16_f32 v179, v38, v39
    s_add_u32 s32, s32, 4096
    buffer_store_dwordx4 v[176:179], v1, s[12:15], s32 offen offset:0 sc1
    v_accvgpr_read_b32 v40, a104
    v_accvgpr_read_b32 v41, a105
    v_accvgpr_read_b32 v42, a106
    v_accvgpr_read_b32 v43, a107
    v_accvgpr_read_b32 v44, a108
    v_accvgpr_read_b32 v45, a109
    v_accvgpr_read_b32 v46, a110
    v_accvgpr_read_b32 v47, a111
    v_mul_f32 v40, v40, v12
    v_mul_f32 v41, v41, v12
    v_mul_f32 v42, v42, v12
    v_mul_f32 v43, v43, v12
    v_mul_f32 v44, v44, v12
    v_mul_f32 v45, v45, v12
    v_mul_f32 v46, v46, v12
    v_mul_f32 v47, v47, v12
    v_cvt_pk_bf16_f32 v180, v40, v41
    v_cvt_pk_bf16_f32 v181, v42, v43
    v_cvt_pk_bf16_f32 v182, v44, v45
    v_cvt_pk_bf16_f32 v183, v46, v47
    buffer_store_dwordx4 v[180:183], v1, s[12:15], s32 offen offset:1024 sc1
    v_accvgpr_read_b32 v48, a112
    v_accvgpr_read_b32 v49, a113
    v_accvgpr_read_b32 v50, a114
    v_accvgpr_read_b32 v51, a115
    v_accvgpr_read_b32 v52, a116
    v_accvgpr_read_b32 v53, a117
    v_accvgpr_read_b32 v54, a118
    v_accvgpr_read_b32 v55, a119
    v_mul_f32 v48, v48, v12
    v_mul_f32 v49, v49, v12
    v_mul_f32 v50, v50, v12
    v_mul_f32 v51, v51, v12
    v_mul_f32 v52, v52, v12
    v_mul_f32 v53, v53, v12
    v_mul_f32 v54, v54, v12
    v_mul_f32 v55, v55, v12
    v_cvt_pk_bf16_f32 v184, v48, v49
    v_cvt_pk_bf16_f32 v185, v50, v51
    v_cvt_pk_bf16_f32 v186, v52, v53
    v_cvt_pk_bf16_f32 v187, v54, v55
    buffer_store_dwordx4 v[184:187], v1, s[12:15], s32 offen offset:2048 sc1
    v_accvgpr_read_b32 v56, a120
    v_accvgpr_read_b32 v57, a121
    v_accvgpr_read_b32 v58, a122
    v_accvgpr_read_b32 v59, a123
    v_accvgpr_read_b32 v60, a124
    v_accvgpr_read_b32 v61, a125
    v_accvgpr_read_b32 v62, a126
    v_accvgpr_read_b32 v63, a127
    v_mul_f32 v56, v56, v12
    v_mul_f32 v57, v57, v12
    v_mul_f32 v58, v58, v12
    v_mul_f32 v59, v59, v12
    v_mul_f32 v60, v60, v12
    v_mul_f32 v61, v61, v12
    v_mul_f32 v62, v62, v12
    v_mul_f32 v63, v63, v12
    v_cvt_pk_bf16_f32 v188, v56, v57
    v_cvt_pk_bf16_f32 v189, v58, v59
    v_cvt_pk_bf16_f32 v190, v60, v61
    v_cvt_pk_bf16_f32 v191, v62, v63
    buffer_store_dwordx4 v[188:191], v1, s[12:15], s32 offen offset:3072 sc1
    s_add_u32 s32, s32, 258048
    v_add_f32 v14, v14, v15
    v_mov_b32 v15, v14
    s_nop 1
    v_permlane32_swap_b32 v14, v15
    v_add_f32 v14, v14, v15
    v_rcp_f32 v14, v14
    v_accvgpr_read_b32 v32, a128
    v_accvgpr_read_b32 v33, a129
    v_accvgpr_read_b32 v34, a130
    v_accvgpr_read_b32 v35, a131
    v_accvgpr_read_b32 v36, a132
    v_accvgpr_read_b32 v37, a133
    v_accvgpr_read_b32 v38, a134
    v_accvgpr_read_b32 v39, a135
    v_mul_f32 v32, v32, v14
    v_mul_f32 v33, v33, v14
    v_mul_f32 v34, v34, v14
    v_mul_f32 v35, v35, v14
    v_mul_f32 v36, v36, v14
    v_mul_f32 v37, v37, v14
    v_mul_f32 v38, v38, v14
    v_mul_f32 v39, v39, v14
    v_cvt_pk_bf16_f32 v192, v32, v33
    v_cvt_pk_bf16_f32 v193, v34, v35
    v_cvt_pk_bf16_f32 v194, v36, v37
    v_cvt_pk_bf16_f32 v195, v38, v39
    buffer_store_dwordx4 v[192:195], v1, s[12:15], s32 offen offset:0 sc1
    v_accvgpr_read_b32 v40, a136
    v_accvgpr_read_b32 v41, a137
    v_accvgpr_read_b32 v42, a138
    v_accvgpr_read_b32 v43, a139
    v_accvgpr_read_b32 v44, a140
    v_accvgpr_read_b32 v45, a141
    v_accvgpr_read_b32 v46, a142
    v_accvgpr_read_b32 v47, a143
    v_mul_f32 v40, v40, v14
    v_mul_f32 v41, v41, v14
    v_mul_f32 v42, v42, v14
    v_mul_f32 v43, v43, v14
    v_mul_f32 v44, v44, v14
    v_mul_f32 v45, v45, v14
    v_mul_f32 v46, v46, v14
    v_mul_f32 v47, v47, v14
    v_cvt_pk_bf16_f32 v196, v40, v41
    v_cvt_pk_bf16_f32 v197, v42, v43
    v_cvt_pk_bf16_f32 v198, v44, v45
    v_cvt_pk_bf16_f32 v199, v46, v47
    buffer_store_dwordx4 v[196:199], v1, s[12:15], s32 offen offset:1024 sc1
    v_accvgpr_read_b32 v48, a144
    v_accvgpr_read_b32 v49, a145
    v_accvgpr_read_b32 v50, a146
    v_accvgpr_read_b32 v51, a147
    v_accvgpr_read_b32 v52, a148
    v_accvgpr_read_b32 v53, a149
    v_accvgpr_read_b32 v54, a150
    v_accvgpr_read_b32 v55, a151
    v_mul_f32 v48, v48, v14
    v_mul_f32 v49, v49, v14
    v_mul_f32 v50, v50, v14
    v_mul_f32 v51, v51, v14
    v_mul_f32 v52, v52, v14
    v_mul_f32 v53, v53, v14
    v_mul_f32 v54, v54, v14
    v_mul_f32 v55, v55, v14
    v_cvt_pk_bf16_f32 v200, v48, v49
    v_cvt_pk_bf16_f32 v201, v50, v51
    v_cvt_pk_bf16_f32 v202, v52, v53
    v_cvt_pk_bf16_f32 v203, v54, v55
    buffer_store_dwordx4 v[200:203], v1, s[12:15], s32 offen offset:2048 sc1
    v_accvgpr_read_b32 v56, a152
    v_accvgpr_read_b32 v57, a153
    v_accvgpr_read_b32 v58, a154
    v_accvgpr_read_b32 v59, a155
    v_accvgpr_read_b32 v60, a156
    v_accvgpr_read_b32 v61, a157
    v_accvgpr_read_b32 v62, a158
    v_accvgpr_read_b32 v63, a159
    v_mul_f32 v56, v56, v14
    v_mul_f32 v57, v57, v14
    v_mul_f32 v58, v58, v14
    v_mul_f32 v59, v59, v14
    v_mul_f32 v60, v60, v14
    v_mul_f32 v61, v61, v14
    v_mul_f32 v62, v62, v14
    v_mul_f32 v63, v63, v14
    v_cvt_pk_bf16_f32 v204, v56, v57
    v_cvt_pk_bf16_f32 v205, v58, v59
    v_cvt_pk_bf16_f32 v206, v60, v61
    v_cvt_pk_bf16_f32 v207, v62, v63
    buffer_store_dwordx4 v[204:207], v1, s[12:15], s32 offen offset:3072 sc1
    v_accvgpr_read_b32 v32, a160
    v_accvgpr_read_b32 v33, a161
    v_accvgpr_read_b32 v34, a162
    v_accvgpr_read_b32 v35, a163
    v_accvgpr_read_b32 v36, a164
    v_accvgpr_read_b32 v37, a165
    v_accvgpr_read_b32 v38, a166
    v_accvgpr_read_b32 v39, a167
    v_mul_f32 v32, v32, v14
    v_mul_f32 v33, v33, v14
    v_mul_f32 v34, v34, v14
    v_mul_f32 v35, v35, v14
    v_mul_f32 v36, v36, v14
    v_mul_f32 v37, v37, v14
    v_mul_f32 v38, v38, v14
    v_mul_f32 v39, v39, v14
    v_cvt_pk_bf16_f32 v208, v32, v33
    v_cvt_pk_bf16_f32 v209, v34, v35
    v_cvt_pk_bf16_f32 v210, v36, v37
    v_cvt_pk_bf16_f32 v211, v38, v39
    s_add_u32 s32, s32, 4096
    buffer_store_dwordx4 v[208:211], v1, s[12:15], s32 offen offset:0 sc1
    v_accvgpr_read_b32 v40, a168
    v_accvgpr_read_b32 v41, a169
    v_accvgpr_read_b32 v42, a170
    v_accvgpr_read_b32 v43, a171
    v_accvgpr_read_b32 v44, a172
    v_accvgpr_read_b32 v45, a173
    v_accvgpr_read_b32 v46, a174
    v_accvgpr_read_b32 v47, a175
    v_mul_f32 v40, v40, v14
    v_mul_f32 v41, v41, v14
    v_mul_f32 v42, v42, v14
    v_mul_f32 v43, v43, v14
    v_mul_f32 v44, v44, v14
    v_mul_f32 v45, v45, v14
    v_mul_f32 v46, v46, v14
    v_mul_f32 v47, v47, v14
    v_cvt_pk_bf16_f32 v212, v40, v41
    v_cvt_pk_bf16_f32 v213, v42, v43
    v_cvt_pk_bf16_f32 v214, v44, v45
    v_cvt_pk_bf16_f32 v215, v46, v47
    buffer_store_dwordx4 v[212:215], v1, s[12:15], s32 offen offset:1024 sc1
    v_accvgpr_read_b32 v48, a176
    v_accvgpr_read_b32 v49, a177
    v_accvgpr_read_b32 v50, a178
    v_accvgpr_read_b32 v51, a179
    v_accvgpr_read_b32 v52, a180
    v_accvgpr_read_b32 v53, a181
    v_accvgpr_read_b32 v54, a182
    v_accvgpr_read_b32 v55, a183
    v_mul_f32 v48, v48, v14
    v_mul_f32 v49, v49, v14
    v_mul_f32 v50, v50, v14
    v_mul_f32 v51, v51, v14
    v_mul_f32 v52, v52, v14
    v_mul_f32 v53, v53, v14
    v_mul_f32 v54, v54, v14
    v_mul_f32 v55, v55, v14
    v_cvt_pk_bf16_f32 v216, v48, v49
    v_cvt_pk_bf16_f32 v217, v50, v51
    v_cvt_pk_bf16_f32 v218, v52, v53
    v_cvt_pk_bf16_f32 v219, v54, v55
    buffer_store_dwordx4 v[216:219], v1, s[12:15], s32 offen offset:2048 sc1
    v_accvgpr_read_b32 v56, a184
    v_accvgpr_read_b32 v57, a185
    v_accvgpr_read_b32 v58, a186
    v_accvgpr_read_b32 v59, a187
    v_accvgpr_read_b32 v60, a188
    v_accvgpr_read_b32 v61, a189
    v_accvgpr_read_b32 v62, a190
    v_accvgpr_read_b32 v63, a191
    v_mul_f32 v56, v56, v14
    v_mul_f32 v57, v57, v14
    v_mul_f32 v58, v58, v14
    v_mul_f32 v59, v59, v14
    v_mul_f32 v60, v60, v14
    v_mul_f32 v61, v61, v14
    v_mul_f32 v62, v62, v14
    v_mul_f32 v63, v63, v14
    v_cvt_pk_bf16_f32 v220, v56, v57
    v_cvt_pk_bf16_f32 v221, v58, v59
    v_cvt_pk_bf16_f32 v222, v60, v61
    v_cvt_pk_bf16_f32 v223, v62, v63
    buffer_store_dwordx4 v[220:223], v1, s[12:15], s32 offen offset:3072 sc1
    s_add_u32 s32, s32, 258048
    s_waitcnt vmcnt(0)
    s_barrier
    s_cmp_lg_u32 s4, 1
    s_cselect_b32 s60, 0x80000000, s33
    v_mov_b32 v11, 1
    buffer_store_dword v11, off, s[12:15], s60 sc1
    s_bitset0_b32 s59, 31
    s_branch mn_have
mn_og:
    s_mov_b32 s58, s59
    s_and_b32 s21, s59, 3
    s_mov_b32 s33, 159383552
    s_mov_b32 s34, 146829312
    s_cmp_eq_u32 s6, 2
    s_cbranch_scc0 mn_ogb
    s_cmp_ge_u32 s59, 64
    s_cbranch_scc1 mn_fin
    s_lshr_b32 s20, s59, 2
    s_mov_b32 s30, 0
    s_mov_b32 s60, 0
    s_cmp_lt_u32 s59, 32
    s_cbranch_scc1 mn_ogo
    s_and_b32 s30, s20, 1
    s_add_u32 s30, s30, 1
    s_lshr_b32 s20, s59, 3
    s_add_u32 s20, s20, 4
    s_mov_b32 s33, 163577856
    s_mov_b32 s34, 146804736
    s_branch mn_ogo
mn_ogb:
    s_lshr_b32 s59, s59, 2
    mn_ogs:
    s_and_b32 s30, s6, 1
    s_add_u32 s30, s30, 1
    s_mov_b32 s60, 0x13e57ca8
    s_cmp_ge_u32 s6, 6
    s_cselect_b32 s60, 0x2f46db9, s60
    s_lshl_b32 s59, s59, 2
    s_lshr_b32 s60, s60, s59
    s_and_b32 s20, s60, 15
    s_mov_b32 s60, 1
mn_ogo:
    s_lshl_b32 s29, s60, 22
    s_add_u32 s29, s29, 150994944
    s_load_dwordx2 s[44:45], s[0:1], 104
    s_lshl_b32 s22, s60, 24
    s_add_u32 s22, s22, 100663296
    s_lshl_b32 s23, s60, 10
    s_lshr_b32 s61, s20, 1
    s_lshl_b32 s61, s61, 7
    s_add_u32 s61, s61, 146811904
    s_lshl_b32 s62, s20, 2
    s_add_u32 s62, s62, s4
    s_lshl_b32 s62, s62, 7
    s_add_u32 s62, s62, 146821120
    s_cmp_lg_u32 s60, 0
    s_cselect_b32 s60, s61, s62
    s_waitcnt lgkmcnt(0)
    s_mov_b32 s16, s44
    s_mov_b32 s17, s45
    s_mov_b32 s18, 0x400000
    s_mov_b32 s19, 0x00020000
    s_mov_b32 s61, 146818048
    v_lshlrev_b32 v6, 3, v0
    s_mov_b32 s62, 0
sp_239:
    buffer_load_dwordx2 v[4:5], v6, s[12:15], s61 offen sc1
    s_waitcnt vmcnt(0)
    v_min_u32 v4, v4, v5
    v_cmp_eq_u32 vcc, 0, v4
    s_nop 0
    s_cmp_eq_u64 vcc, 0
    s_cbranch_scc1 spd_240
    s_add_u32 s62, s62, 1
    s_sleep 16
    s_cmp_lt_u32 s62, 32768
    s_cbranch_scc1 sp_239
spd_240:
    v_lshlrev_b32 v1, 4, v0
    v_mov_b32 v12, v1
    v_bfe_u32 v4, v0, 0, 5
    v_lshlrev_b32 v3, 11, v4
    v_bfe_u32 v4, v0, 5, 1
    v_lshl_add_u32 v3, v4, 4, v3
    s_lshl_b32 s24, s20, 2
    s_add_u32 s24, s24, s4
    s_lshl_b32 s36, s24, 16
    s_lshl_b32 s24, s24, 18
    s_add_u32 s24, s24, s22
    s_lshl_b32 s25, s21, 8
    s_add_u32 s36, s36, s25
    s_add_u32 s23, s23, s36
    s_lshl_b32 s26, s4, 13
    s_lshl_b32 s25, s21, 20
    s_add_u32 s25, s25, s26
    s_add_u32 s25, s25, s29
    s_mov_b32 s28, 0
    s_cmp_eq_u32 s30, 0
    s_cselect_b32 s27, 0, 16
    s_lshr_b32 s36, s30, 1
    s_lshl_b32 s37, s36, 17
    s_add_u32 s24, s24, s37
    s_lshl_b32 s37, s36, 19
    s_add_u32 s25, s25, s37
    s_add_u32 m0, s26, 0
    s_nop 0
    buffer_load_dwordx4 v1, s[12:15], s25 offen offset:0 sc1 lds
    buffer_load_dwordx4 v1, s[12:15], s25 offen offset:1024 sc1 lds
    buffer_load_dwordx4 v1, s[12:15], s25 offen offset:2048 sc1 lds
    buffer_load_dwordx4 v1, s[12:15], s25 offen offset:3072 sc1 lds
    s_add_u32 s25, s25, 4096
    s_add_u32 m0, s26, 4096
    s_nop 0
    buffer_load_dwordx4 v1, s[12:15], s25 offen offset:0 sc1 lds
    buffer_load_dwordx4 v1, s[12:15], s25 offen offset:1024 sc1 lds
    buffer_load_dwordx4 v1, s[12:15], s25 offen offset:2048 sc1 lds
    buffer_load_dwordx4 v1, s[12:15], s25 offen offset:3072 sc1 lds
    s_add_u32 s25, s25, 28672
    s_add_u32 s26, s26, 32768
    s_cmp_ge_u32 s26, 163840
    s_cselect_b32 s37, 163840, 0
    s_sub_u32 s26, s26, s37
    s_add_u32 m0, s26, 0
    s_nop 0
    buffer_load_dwordx4 v1, s[12:15], s25 offen offset:0 sc1 lds
    buffer_load_dwordx4 v1, s[12:15], s25 offen offset:1024 sc1 lds
    buffer_load_dwordx4 v1, s[12:15], s25 offen offset:2048 sc1 lds
    buffer_load_dwordx4 v1, s[12:15], s25 offen offset:3072 sc1 lds
    s_add_u32 s25, s25, 4096
    s_add_u32 m0, s26, 4096
    s_nop 0
    buffer_load_dwordx4 v1, s[12:15], s25 offen offset:0 sc1 lds
    buffer_load_dwordx4 v1, s[12:15], s25 offen offset:1024 sc1 lds
    buffer_load_dwordx4 v1, s[12:15], s25 offen offset:2048 sc1 lds
    buffer_load_dwordx4 v1, s[12:15], s25 offen offset:3072 sc1 lds
    s_add_u32 s25, s25, 28672
    s_add_u32 s26, s26, 32768
    s_cmp_ge_u32 s26, 163840
    s_cselect_b32 s37, 163840, 0
    s_sub_u32 s26, s26, s37
    s_add_u32 m0, s26, 0
    s_nop 0
    buffer_load_dwordx4 v1, s[12:15], s25 offen offset:0 sc1 lds
    buffer_load_dwordx4 v1, s[12:15], s25 offen offset:1024 sc1 lds
    buffer_load_dwordx4 v1, s[12:15], s25 offen offset:2048 sc1 lds
    buffer_load_dwordx4 v1, s[12:15], s25 offen offset:3072 sc1 lds
    s_add_u32 s25, s25, 4096
    s_add_u32 m0, s26, 4096
    s_nop 0
    buffer_load_dwordx4 v1, s[12:15], s25 offen offset:0 sc1 lds
    buffer_load_dwordx4 v1, s[12:15], s25 offen offset:1024 sc1 lds
    buffer_load_dwordx4 v1, s[12:15], s25 offen offset:2048 sc1 lds
    buffer_load_dwordx4 v1, s[12:15], s25 offen offset:3072 sc1 lds
    s_add_u32 s25, s25, 28672
    s_add_u32 s26, s26, 32768
    s_cmp_ge_u32 s26, 163840
    s_cselect_b32 s37, 163840, 0
    s_sub_u32 s26, s26, s37
    v_and_b32 v7, 31, v0
    v_lshlrev_b32 v7, 2, v7
    s_mov_b32 s62, 0
sp_241:
    buffer_load_dword v6, v7, s[12:15], s60 offen sc1
    s_waitcnt vmcnt(0)
    v_cmp_eq_u32_e64 vcc, 0, v6
    s_nop 0
    s_cmp_eq_u64 vcc, 0
    s_cbranch_scc1 spd_242
    s_add_u32 s62, s62, 1
    s_sleep 8
    s_cmp_lt_u32 s62, 32768
    s_cbranch_scc1 sp_241
spd_242:
    buffer_load_dwordx4 v[128:131], v1, s[12:15], s24 offen offset:0 sc1
    buffer_load_dwordx4 v[132:135], v1, s[12:15], s24 offen offset:1024 sc1
    buffer_load_dwordx4 v[136:139], v1, s[12:15], s24 offen offset:2048 sc1
    buffer_load_dwordx4 v[140:143], v1, s[12:15], s24 offen offset:3072 sc1
    s_add_u32 s24, s24, 4096
    buffer_load_dwordx4 v[144:147], v1, s[12:15], s24 offen offset:0 sc1
    buffer_load_dwordx4 v[148:151], v1, s[12:15], s24 offen offset:1024 sc1
    buffer_load_dwordx4 v[152:155], v1, s[12:15], s24 offen offset:2048 sc1
    buffer_load_dwordx4 v[156:159], v1, s[12:15], s24 offen offset:3072 sc1
    s_add_u32 s24, s24, 4096
    buffer_load_dwordx4 v[160:163], v1, s[12:15], s24 offen offset:0 sc1
    buffer_load_dwordx4 v[164:167], v1, s[12:15], s24 offen offset:1024 sc1
    buffer_load_dwordx4 v[168:171], v1, s[12:15], s24 offen offset:2048 sc1
    buffer_load_dwordx4 v[172:175], v1, s[12:15], s24 offen offset:3072 sc1
    s_add_u32 s24, s24, 4096
    buffer_load_dwordx4 v[176:179], v1, s[12:15], s24 offen offset:0 sc1
    buffer_load_dwordx4 v[180:183], v1, s[12:15], s24 offen offset:1024 sc1
    buffer_load_dwordx4 v[184:187], v1, s[12:15], s24 offen offset:2048 sc1
    buffer_load_dwordx4 v[188:191], v1, s[12:15], s24 offen offset:3072 sc1
    s_add_u32 s24, s24, 4096
    s_waitcnt vmcnt(16)
    s_barrier
    ds_read_b128 v[80:83], v12 offset:0
    ds_read_b128 v[84:87], v12 offset:1024
    ds_read_b128 v[88:91], v12 offset:2048
    ds_read_b128 v[92:95], v12 offset:3072
    ds_read_b128 v[96:99], v12 offset:4096
    ds_read_b128 v[100:103], v12 offset:5120
    v_mov_b64 v[16:17], 0
    v_mov_b64 v[18:19], 0
    v_mov_b64 v[20:21], 0
    v_mov_b64 v[22:23], 0
    v_mov_b64 v[24:25], 0
    v_mov_b64 v[26:27], 0
    v_mov_b64 v[28:29], 0
    v_mov_b64 v[30:31], 0
    v_mov_b64 v[32:33], 0
    v_mov_b64 v[34:35], 0
    v_mov_b64 v[36:37], 0
    v_mov_b64 v[38:39], 0
    v_mov_b64 v[40:41], 0
    v_mov_b64 v[42:43], 0
    v_mov_b64 v[44:45], 0
    v_mov_b64 v[46:47], 0
    v_mov_b64 v[48:49], 0
    v_mov_b64 v[50:51], 0
    v_mov_b64 v[52:53], 0
    v_mov_b64 v[54:55], 0
    v_mov_b64 v[56:57], 0
    v_mov_b64 v[58:59], 0
    v_mov_b64 v[60:61], 0
    v_mov_b64 v[62:63], 0
    v_mov_b64 v[64:65], 0
    v_mov_b64 v[66:67], 0
    v_mov_b64 v[68:69], 0
    v_mov_b64 v[70:71], 0
    v_mov_b64 v[72:73], 0
    v_mov_b64 v[74:75], 0
    v_mov_b64 v[76:77], 0
    v_mov_b64 v[78:79], 0
    s_waitcnt vmcnt(0) lgkmcnt(5)
.p2align 5
og_loop_243:
    v_mfma_f32_32x32x16_bf16 v[16:31], v[80:83], v[128:131], v[16:31]
    s_waitcnt lgkmcnt(4)
    s_add_u32 m0, s26, 0
    ds_read_b128 v[104:107], v12 offset:6144
    buffer_load_dwordx4 v[192:195], v1, s[12:15], s24 offen offset:0 sc1
    v_mfma_f32_32x32x16_bf16 v[32:47], v[84:87], v[128:131], v[32:47]
    s_waitcnt lgkmcnt(4)
    ds_read_b128 v[108:111], v12 offset:7168
    buffer_load_dwordx4 v1, s[12:15], s25 offen offset:0 sc1 lds
    v_mfma_f32_32x32x16_bf16 v[48:63], v[88:91], v[128:131], v[48:63]
    s_waitcnt lgkmcnt(4)
    ds_read_b128 v[80:83], v12 offset:8192
    v_mfma_f32_32x32x16_bf16 v[64:79], v[92:95], v[128:131], v[64:79]
    s_waitcnt vmcnt(31) lgkmcnt(4)
    s_cmp_eq_u32 s27, 28
    s_cselect_b32 s31, 0x40000000, 0
    ds_read_b128 v[84:87], v12 offset:9216
    v_mfma_f32_32x32x16_bf16 v[16:31], v[96:99], v[132:135], v[16:31]
    s_waitcnt lgkmcnt(4)
    ds_read_b128 v[88:91], v12 offset:10240
    buffer_load_dwordx4 v[196:199], v1, s[12:15], s24 offen offset:1024 sc1
    v_mfma_f32_32x32x16_bf16 v[32:47], v[100:103], v[132:135], v[32:47]
    s_waitcnt lgkmcnt(4)
    ds_read_b128 v[92:95], v12 offset:11264
    buffer_load_dwordx4 v1, s[12:15], s25 offen offset:1024 sc1 lds
    v_mfma_f32_32x32x16_bf16 v[48:63], v[104:107], v[132:135], v[48:63]
    s_waitcnt lgkmcnt(4)
    ds_read_b128 v[96:99], v12 offset:12288
    v_mfma_f32_32x32x16_bf16 v[64:79], v[108:111], v[132:135], v[64:79]
    s_waitcnt vmcnt(31) lgkmcnt(4)
    s_cmp_eq_u32 s27, 29
    s_cselect_b32 s32, 0x40000000, 0
    ds_read_b128 v[100:103], v12 offset:13312
    v_mfma_f32_32x32x16_bf16 v[16:31], v[80:83], v[136:139], v[16:31]
    s_waitcnt lgkmcnt(4)
    ds_read_b128 v[104:107], v12 offset:14336
    buffer_load_dwordx4 v[200:203], v1, s[12:15], s24 offen offset:2048 sc1
    v_mfma_f32_32x32x16_bf16 v[32:47], v[84:87], v[136:139], v[32:47]
    s_waitcnt lgkmcnt(4)
    ds_read_b128 v[108:111], v12 offset:15360
    buffer_load_dwordx4 v1, s[12:15], s25 offen offset:2048 sc1 lds
    v_mfma_f32_32x32x16_bf16 v[48:63], v[88:91], v[136:139], v[48:63]
    s_waitcnt lgkmcnt(4)
    ds_read_b128 v[80:83], v12 offset:16384
    v_mfma_f32_32x32x16_bf16 v[64:79], v[92:95], v[136:139], v[64:79]
    s_waitcnt vmcnt(31) lgkmcnt(4)
    s_add_u32 s28, s28, 32768
    s_cmp_ge_u32 s28, 163840
    s_cselect_b32 s37, 163840, 0
    s_sub_u32 s28, s28, s37
    ds_read_b128 v[84:87], v12 offset:17408
    v_mfma_f32_32x32x16_bf16 v[16:31], v[96:99], v[140:143], v[16:31]
    s_waitcnt lgkmcnt(4)
    ds_read_b128 v[88:91], v12 offset:18432
    buffer_load_dwordx4 v[204:207], v1, s[12:15], s24 offen offset:3072 sc1
    v_mfma_f32_32x32x16_bf16 v[32:47], v[100:103], v[140:143], v[32:47]
    s_waitcnt lgkmcnt(4)
    s_add_u32 s24, s24, 4096
    ds_read_b128 v[92:95], v12 offset:19456
    buffer_load_dwordx4 v1, s[12:15], s25 offen offset:3072 sc1 lds
    v_mfma_f32_32x32x16_bf16 v[48:63], v[104:107], v[140:143], v[48:63]
    s_waitcnt lgkmcnt(4)
    s_add_u32 s25, s25, 4096
    ds_read_b128 v[96:99], v12 offset:20480
    v_mfma_f32_32x32x16_bf16 v[64:79], v[108:111], v[140:143], v[64:79]
    s_waitcnt vmcnt(31) lgkmcnt(4)
    ds_read_b128 v[100:103], v12 offset:21504
    v_mfma_f32_32x32x16_bf16 v[16:31], v[80:83], v[144:147], v[16:31]
    s_waitcnt lgkmcnt(4)
    s_add_u32 m0, s26, 4096
    ds_read_b128 v[104:107], v12 offset:22528
    buffer_load_dwordx4 v[208:211], v1, s[12:15], s24 offen offset:0 sc1
    v_mfma_f32_32x32x16_bf16 v[32:47], v[84:87], v[144:147], v[32:47]
    s_waitcnt lgkmcnt(4)
    ds_read_b128 v[108:111], v12 offset:23552
    buffer_load_dwordx4 v1, s[12:15], s25 offen offset:0 sc1 lds
    v_mfma_f32_32x32x16_bf16 v[48:63], v[88:91], v[144:147], v[48:63]
    s_waitcnt lgkmcnt(4)
    ds_read_b128 v[80:83], v12 offset:24576
    v_mfma_f32_32x32x16_bf16 v[64:79], v[92:95], v[144:147], v[64:79]
    s_waitcnt vmcnt(31) lgkmcnt(4)
    ds_read_b128 v[84:87], v12 offset:25600
    v_mfma_f32_32x32x16_bf16 v[16:31], v[96:99], v[148:151], v[16:31]
    s_waitcnt lgkmcnt(4)
    ds_read_b128 v[88:91], v12 offset:26624
    buffer_load_dwordx4 v[212:215], v1, s[12:15], s24 offen offset:1024 sc1
    v_mfma_f32_32x32x16_bf16 v[32:47], v[100:103], v[148:151], v[32:47]
    s_waitcnt lgkmcnt(4)
    ds_read_b128 v[92:95], v12 offset:27648
    buffer_load_dwordx4 v1, s[12:15], s25 offen offset:1024 sc1 lds
    v_mfma_f32_32x32x16_bf16 v[48:63], v[104:107], v[148:151], v[48:63]
    s_waitcnt lgkmcnt(4)
    ds_read_b128 v[96:99], v12 offset:28672
    v_mfma_f32_32x32x16_bf16 v[64:79], v[108:111], v[148:151], v[64:79]
    s_waitcnt vmcnt(31) lgkmcnt(4)
    ds_read_b128 v[100:103], v12 offset:29696
    v_mfma_f32_32x32x16_bf16 v[16:31], v[80:83], v[152:155], v[16:31]
    s_waitcnt lgkmcnt(4)
    ds_read_b128 v[104:107], v12 offset:30720
    buffer_load_dwordx4 v[216:219], v1, s[12:15], s24 offen offset:2048 sc1
    v_mfma_f32_32x32x16_bf16 v[32:47], v[84:87], v[152:155], v[32:47]
    s_waitcnt lgkmcnt(4)
    ds_read_b128 v[108:111], v12 offset:31744
    buffer_load_dwordx4 v1, s[12:15], s25 offen offset:2048 sc1 lds
    v_add_u32 v12, s28, v1
    v_mfma_f32_32x32x16_bf16 v[48:63], v[88:91], v[152:155], v[48:63]
    s_waitcnt vmcnt(29) lgkmcnt(4)
    s_barrier
    ds_read_b128 v[80:83], v12 offset:0
    v_mfma_f32_32x32x16_bf16 v[64:79], v[92:95], v[152:155], v[64:79]
    s_waitcnt vmcnt(31) lgkmcnt(4)
    ds_read_b128 v[84:87], v12 offset:1024
    v_mfma_f32_32x32x16_bf16 v[16:31], v[96:99], v[156:159], v[16:31]
    s_waitcnt lgkmcnt(4)
    ds_read_b128 v[88:91], v12 offset:2048
    buffer_load_dwordx4 v[220:223], v1, s[12:15], s24 offen offset:3072 sc1
    v_mfma_f32_32x32x16_bf16 v[32:47], v[100:103], v[156:159], v[32:47]
    s_waitcnt lgkmcnt(4)
    s_add_u32 s24, s24, 4096
    ds_read_b128 v[92:95], v12 offset:3072
    buffer_load_dwordx4 v1, s[12:15], s25 offen offset:3072 sc1 lds
    v_mfma_f32_32x32x16_bf16 v[48:63], v[104:107], v[156:159], v[48:63]
    s_waitcnt lgkmcnt(4)
    s_add_u32 s25, s25, 28672
    s_add_u32 s26, s26, 32768
    s_cmp_ge_u32 s26, 163840
    s_cselect_b32 s37, 163840, 0
    s_sub_u32 s26, s26, s37
    ds_read_b128 v[96:99], v12 offset:4096
    v_mfma_f32_32x32x16_bf16 v[64:79], v[108:111], v[156:159], v[64:79]
    s_waitcnt vmcnt(31) lgkmcnt(4)
    s_add_u32 s25, s25, s31
    s_add_u32 s24, s24, s32
    s_add_u32 s27, s27, 1
    s_cmp_ge_u32 s27, 32
    ds_read_b128 v[100:103], v12 offset:5120
    s_cbranch_scc1 og_done_244
    v_mfma_f32_32x32x16_bf16 v[16:31], v[80:83], v[160:163], v[16:31]
    s_waitcnt lgkmcnt(4)
    s_add_u32 m0, s26, 0
    ds_read_b128 v[104:107], v12 offset:6144
    buffer_load_dwordx4 v[128:131], v1, s[12:15], s24 offen offset:0 sc1
    v_mfma_f32_32x32x16_bf16 v[32:47], v[84:87], v[160:163], v[32:47]
    s_waitcnt lgkmcnt(4)
    ds_read_b128 v[108:111], v12 offset:7168
    buffer_load_dwordx4 v1, s[12:15], s25 offen offset:0 sc1 lds
    v_mfma_f32_32x32x16_bf16 v[48:63], v[88:91], v[160:163], v[48:63]
    s_waitcnt lgkmcnt(4)
    ds_read_b128 v[80:83], v12 offset:8192
    v_mfma_f32_32x32x16_bf16 v[64:79], v[92:95], v[160:163], v[64:79]
    s_waitcnt vmcnt(31) lgkmcnt(4)
    s_cmp_eq_u32 s27, 28
    s_cselect_b32 s31, 0x40000000, 0
    ds_read_b128 v[84:87], v12 offset:9216
    v_mfma_f32_32x32x16_bf16 v[16:31], v[96:99], v[164:167], v[16:31]
    s_waitcnt lgkmcnt(4)
    ds_read_b128 v[88:91], v12 offset:10240
    buffer_load_dwordx4 v[132:135], v1, s[12:15], s24 offen offset:1024 sc1
    v_mfma_f32_32x32x16_bf16 v[32:47], v[100:103], v[164:167], v[32:47]
    s_waitcnt lgkmcnt(4)
    ds_read_b128 v[92:95], v12 offset:11264
    buffer_load_dwordx4 v1, s[12:15], s25 offen offset:1024 sc1 lds
    v_mfma_f32_32x32x16_bf16 v[48:63], v[104:107], v[164:167], v[48:63]
    s_waitcnt lgkmcnt(4)
    ds_read_b128 v[96:99], v12 offset:12288
    v_mfma_f32_32x32x16_bf16 v[64:79], v[108:111], v[164:167], v[64:79]
    s_waitcnt vmcnt(31) lgkmcnt(4)
    s_cmp_eq_u32 s27, 29
    s_cselect_b32 s32, 0x40000000, 0
    ds_read_b128 v[100:103], v12 offset:13312
    v_mfma_f32_32x32x16_bf16 v[16:31], v[80:83], v[168:171], v[16:31]
    s_waitcnt lgkmcnt(4)
    ds_read_b128 v[104:107], v12 offset:14336
    buffer_load_dwordx4 v[136:139], v1, s[12:15], s24 offen offset:2048 sc1
    v_mfma_f32_32x32x16_bf16 v[32:47], v[84:87], v[168:171], v[32:47]
    s_waitcnt lgkmcnt(4)
    ds_read_b128 v[108:111], v12 offset:15360
    buffer_load_dwordx4 v1, s[12:15], s25 offen offset:2048 sc1 lds
    v_mfma_f32_32x32x16_bf16 v[48:63], v[88:91], v[168:171], v[48:63]
    s_waitcnt lgkmcnt(4)
    ds_read_b128 v[80:83], v12 offset:16384
    v_mfma_f32_32x32x16_bf16 v[64:79], v[92:95], v[168:171], v[64:79]
    s_waitcnt vmcnt(31) lgkmcnt(4)
    s_add_u32 s28, s28, 32768
    s_cmp_ge_u32 s28, 163840
    s_cselect_b32 s37, 163840, 0
    s_sub_u32 s28, s28, s37
    ds_read_b128 v[84:87], v12 offset:17408
    v_mfma_f32_32x32x16_bf16 v[16:31], v[96:99], v[172:175], v[16:31]
    s_waitcnt lgkmcnt(4)
    ds_read_b128 v[88:91], v12 offset:18432
    buffer_load_dwordx4 v[140:143], v1, s[12:15], s24 offen offset:3072 sc1
    v_mfma_f32_32x32x16_bf16 v[32:47], v[100:103], v[172:175], v[32:47]
    s_waitcnt lgkmcnt(4)
    s_add_u32 s24, s24, 4096
    ds_read_b128 v[92:95], v12 offset:19456
    buffer_load_dwordx4 v1, s[12:15], s25 offen offset:3072 sc1 lds
    v_mfma_f32_32x32x16_bf16 v[48:63], v[104:107], v[172:175], v[48:63]
    s_waitcnt lgkmcnt(4)
    s_add_u32 s25, s25, 4096
    ds_read_b128 v[96:99], v12 offset:20480
    v_mfma_f32_32x32x16_bf16 v[64:79], v[108:111], v[172:175], v[64:79]
    s_waitcnt vmcnt(31) lgkmcnt(4)
    ds_read_b128 v[100:103], v12 offset:21504
    v_mfma_f32_32x32x16_bf16 v[16:31], v[80:83], v[176:179], v[16:31]
    s_waitcnt lgkmcnt(4)
    s_add_u32 m0, s26, 4096
    ds_read_b128 v[104:107], v12 offset:22528
    buffer_load_dwordx4 v[144:147], v1, s[12:15], s24 offen offset:0 sc1
    v_mfma_f32_32x32x16_bf16 v[32:47], v[84:87], v[176:179], v[32:47]
    s_waitcnt lgkmcnt(4)
    ds_read_b128 v[108:111], v12 offset:23552
    buffer_load_dwordx4 v1, s[12:15], s25 offen offset:0 sc1 lds
    v_mfma_f32_32x32x16_bf16 v[48:63], v[88:91], v[176:179], v[48:63]
    s_waitcnt lgkmcnt(4)
    ds_read_b128 v[80:83], v12 offset:24576
    v_mfma_f32_32x32x16_bf16 v[64:79], v[92:95], v[176:179], v[64:79]
    s_waitcnt vmcnt(31) lgkmcnt(4)
    ds_read_b128 v[84:87], v12 offset:25600
    v_mfma_f32_32x32x16_bf16 v[16:31], v[96:99], v[180:183], v[16:31]
    s_waitcnt lgkmcnt(4)
    ds_read_b128 v[88:91], v12 offset:26624
    buffer_load_dwordx4 v[148:151], v1, s[12:15], s24 offen offset:1024 sc1
    v_mfma_f32_32x32x16_bf16 v[32:47], v[100:103], v[180:183], v[32:47]
    s_waitcnt lgkmcnt(4)
    ds_read_b128 v[92:95], v12 offset:27648
    buffer_load_dwordx4 v1, s[12:15], s25 offen offset:1024 sc1 lds
    v_mfma_f32_32x32x16_bf16 v[48:63], v[104:107], v[180:183], v[48:63]
    s_waitcnt lgkmcnt(4)
    ds_read_b128 v[96:99], v12 offset:28672
    v_mfma_f32_32x32x16_bf16 v[64:79], v[108:111], v[180:183], v[64:79]
    s_waitcnt vmcnt(31) lgkmcnt(4)
    ds_read_b128 v[100:103], v12 offset:29696
    v_mfma_f32_32x32x16_bf16 v[16:31], v[80:83], v[184:187], v[16:31]
    s_waitcnt lgkmcnt(4)
    ds_read_b128 v[104:107], v12 offset:30720
    buffer_load_dwordx4 v[152:155], v1, s[12:15], s24 offen offset:2048 sc1
    v_mfma_f32_32x32x16_bf16 v[32:47], v[84:87], v[184:187], v[32:47]
    s_waitcnt lgkmcnt(4)
    ds_read_b128 v[108:111], v12 offset:31744
    buffer_load_dwordx4 v1, s[12:15], s25 offen offset:2048 sc1 lds
    v_add_u32_e64 v12, s28, v1
    v_mfma_f32_32x32x16_bf16 v[48:63], v[88:91], v[184:187], v[48:63]
    s_waitcnt vmcnt(29) lgkmcnt(4)
    s_barrier
    ds_read_b128 v[80:83], v12 offset:0
    v_mfma_f32_32x32x16_bf16 v[64:79], v[92:95], v[184:187], v[64:79]
    s_waitcnt vmcnt(31) lgkmcnt(4)
    ds_read_b128 v[84:87], v12 offset:1024
    v_mfma_f32_32x32x16_bf16 v[16:31], v[96:99], v[188:191], v[16:31]
    s_waitcnt lgkmcnt(4)
    ds_read_b128 v[88:91], v12 offset:2048
    buffer_load_dwordx4 v[156:159], v1, s[12:15], s24 offen offset:3072 sc1
    v_mfma_f32_32x32x16_bf16 v[32:47], v[100:103], v[188:191], v[32:47]
    s_waitcnt lgkmcnt(4)
    s_add_u32 s24, s24, 4096
    ds_read_b128 v[92:95], v12 offset:3072
    buffer_load_dwordx4 v1, s[12:15], s25 offen offset:3072 sc1 lds
    v_mfma_f32_32x32x16_bf16 v[48:63], v[104:107], v[188:191], v[48:63]
    s_waitcnt lgkmcnt(4)
    s_add_u32 s25, s25, 28672
    s_add_u32 s26, s26, 32768
    s_cmp_ge_u32 s26, 163840
    s_cselect_b32 s37, 163840, 0
    s_sub_u32 s26, s26, s37
    ds_read_b128 v[96:99], v12 offset:4096
    v_mfma_f32_32x32x16_bf16 v[64:79], v[108:111], v[188:191], v[64:79]
    s_waitcnt vmcnt(31) lgkmcnt(4)
    s_add_u32 s25, s25, s31
    s_add_u32 s24, s24, s32
    s_add_u32 s27, s27, 1
    s_cmp_ge_u32 s27, 32
    ds_read_b128 v[100:103], v12 offset:5120
    s_cbranch_scc1 og_done_244
    v_mfma_f32_32x32x16_bf16 v[16:31], v[80:83], v[192:195], v[16:31]
    s_waitcnt lgkmcnt(4)
    s_add_u32 m0, s26, 0
    ds_read_b128 v[104:107], v12 offset:6144
    buffer_load_dwordx4 v[160:163], v1, s[12:15], s24 offen offset:0 sc1
    v_mfma_f32_32x32x16_bf16 v[32:47], v[84:87], v[192:195], v[32:47]
    s_waitcnt lgkmcnt(4)
    ds_read_b128 v[108:111], v12 offset:7168
    buffer_load_dwordx4 v1, s[12:15], s25 offen offset:0 sc1 lds
    v_mfma_f32_32x32x16_bf16 v[48:63], v[88:91], v[192:195], v[48:63]
    s_waitcnt lgkmcnt(4)
    ds_read_b128 v[80:83], v12 offset:8192
    v_mfma_f32_32x32x16_bf16 v[64:79], v[92:95], v[192:195], v[64:79]
    s_waitcnt vmcnt(31) lgkmcnt(4)
    s_cmp_eq_u32 s27, 28
    s_cselect_b32 s31, 0x40000000, 0
    ds_read_b128 v[84:87], v12 offset:9216
    v_mfma_f32_32x32x16_bf16 v[16:31], v[96:99], v[196:199], v[16:31]
    s_waitcnt lgkmcnt(4)
    ds_read_b128 v[88:91], v12 offset:10240
    buffer_load_dwordx4 v[164:167], v1, s[12:15], s24 offen offset:1024 sc1
    v_mfma_f32_32x32x16_bf16 v[32:47], v[100:103], v[196:199], v[32:47]
    s_waitcnt lgkmcnt(4)
    ds_read_b128 v[92:95], v12 offset:11264
    buffer_load_dwordx4 v1, s[12:15], s25 offen offset:1024 sc1 lds
    v_mfma_f32_32x32x16_bf16 v[48:63], v[104:107], v[196:199], v[48:63]
    s_waitcnt lgkmcnt(4)
    ds_read_b128 v[96:99], v12 offset:12288
    v_mfma_f32_32x32x16_bf16 v[64:79], v[108:111], v[196:199], v[64:79]
    s_waitcnt vmcnt(31) lgkmcnt(4)
    s_cmp_eq_u32 s27, 29
    s_cselect_b32 s32, 0x40000000, 0
    ds_read_b128 v[100:103], v12 offset:13312
    v_mfma_f32_32x32x16_bf16 v[16:31], v[80:83], v[200:203], v[16:31]
    s_waitcnt lgkmcnt(4)
    ds_read_b128 v[104:107], v12 offset:14336
    buffer_load_dwordx4 v[168:171], v1, s[12:15], s24 offen offset:2048 sc1
    v_mfma_f32_32x32x16_bf16 v[32:47], v[84:87], v[200:203], v[32:47]
    s_waitcnt lgkmcnt(4)
    ds_read_b128 v[108:111], v12 offset:15360
    buffer_load_dwordx4 v1, s[12:15], s25 offen offset:2048 sc1 lds
    v_mfma_f32_32x32x16_bf16 v[48:63], v[88:91], v[200:203], v[48:63]
    s_waitcnt lgkmcnt(4)
    ds_read_b128 v[80:83], v12 offset:16384
    v_mfma_f32_32x32x16_bf16 v[64:79], v[92:95], v[200:203], v[64:79]
    s_waitcnt vmcnt(31) lgkmcnt(4)
    s_add_u32 s28, s28, 32768
    s_cmp_ge_u32 s28, 163840
    s_cselect_b32 s37, 163840, 0
    s_sub_u32 s28, s28, s37
    ds_read_b128 v[84:87], v12 offset:17408
    v_mfma_f32_32x32x16_bf16 v[16:31], v[96:99], v[204:207], v[16:31]
    s_waitcnt lgkmcnt(4)
    ds_read_b128 v[88:91], v12 offset:18432
    buffer_load_dwordx4 v[172:175], v1, s[12:15], s24 offen offset:3072 sc1
    v_mfma_f32_32x32x16_bf16 v[32:47], v[100:103], v[204:207], v[32:47]
    s_waitcnt lgkmcnt(4)
    s_add_u32 s24, s24, 4096
    ds_read_b128 v[92:95], v12 offset:19456
    buffer_load_dwordx4 v1, s[12:15], s25 offen offset:3072 sc1 lds
    v_mfma_f32_32x32x16_bf16 v[48:63], v[104:107], v[204:207], v[48:63]
    s_waitcnt lgkmcnt(4)
    s_add_u32 s25, s25, 4096
    ds_read_b128 v[96:99], v12 offset:20480
    v_mfma_f32_32x32x16_bf16 v[64:79], v[108:111], v[204:207], v[64:79]
    s_waitcnt vmcnt(31) lgkmcnt(4)
    ds_read_b128 v[100:103], v12 offset:21504
    v_mfma_f32_32x32x16_bf16 v[16:31], v[80:83], v[208:211], v[16:31]
    s_waitcnt lgkmcnt(4)
    s_add_u32 m0, s26, 4096
    ds_read_b128 v[104:107], v12 offset:22528
    buffer_load_dwordx4 v[176:179], v1, s[12:15], s24 offen offset:0 sc1
    v_mfma_f32_32x32x16_bf16 v[32:47], v[84:87], v[208:211], v[32:47]
    s_waitcnt lgkmcnt(4)
    ds_read_b128 v[108:111], v12 offset:23552
    buffer_load_dwordx4 v1, s[12:15], s25 offen offset:0 sc1 lds
    v_mfma_f32_32x32x16_bf16 v[48:63], v[88:91], v[208:211], v[48:63]
    s_waitcnt lgkmcnt(4)
    ds_read_b128 v[80:83], v12 offset:24576
    v_mfma_f32_32x32x16_bf16 v[64:79], v[92:95], v[208:211], v[64:79]
    s_waitcnt vmcnt(31) lgkmcnt(4)
    ds_read_b128 v[84:87], v12 offset:25600
    v_mfma_f32_32x32x16_bf16 v[16:31], v[96:99], v[212:215], v[16:31]
    s_waitcnt lgkmcnt(4)
    ds_read_b128 v[88:91], v12 offset:26624
    buffer_load_dwordx4 v[180:183], v1, s[12:15], s24 offen offset:1024 sc1
    v_mfma_f32_32x32x16_bf16 v[32:47], v[100:103], v[212:215], v[32:47]
    s_waitcnt lgkmcnt(4)
    ds_read_b128 v[92:95], v12 offset:27648
    buffer_load_dwordx4 v1, s[12:15], s25 offen offset:1024 sc1 lds
    v_mfma_f32_32x32x16_bf16 v[48:63], v[104:107], v[212:215], v[48:63]
    s_waitcnt lgkmcnt(4)
    ds_read_b128 v[96:99], v12 offset:28672
    v_mfma_f32_32x32x16_bf16 v[64:79], v[108:111], v[212:215], v[64:79]
    s_waitcnt vmcnt(31) lgkmcnt(4)
    ds_read_b128 v[100:103], v12 offset:29696
    v_mfma_f32_32x32x16_bf16 v[16:31], v[80:83], v[216:219], v[16:31]
    s_waitcnt lgkmcnt(4)
    ds_read_b128 v[104:107], v12 offset:30720
    buffer_load_dwordx4 v[184:187], v1, s[12:15], s24 offen offset:2048 sc1
    v_mfma_f32_32x32x16_bf16 v[32:47], v[84:87], v[216:219], v[32:47]
    s_waitcnt lgkmcnt(4)
    ds_read_b128 v[108:111], v12 offset:31744
    buffer_load_dwordx4 v1, s[12:15], s25 offen offset:2048 sc1 lds
    v_add_u32 v12, s28, v1
    v_mfma_f32_32x32x16_bf16 v[48:63], v[88:91], v[216:219], v[48:63]
    s_waitcnt vmcnt(29) lgkmcnt(4)
    s_barrier
    ds_read_b128 v[80:83], v12 offset:0
    v_mfma_f32_32x32x16_bf16 v[64:79], v[92:95], v[216:219], v[64:79]
    s_waitcnt vmcnt(31) lgkmcnt(4)
    ds_read_b128 v[84:87], v12 offset:1024
    v_mfma_f32_32x32x16_bf16 v[16:31], v[96:99], v[220:223], v[16:31]
    s_waitcnt lgkmcnt(4)
    ds_read_b128 v[88:91], v12 offset:2048
    buffer_load_dwordx4 v[188:191], v1, s[12:15], s24 offen offset:3072 sc1
    v_mfma_f32_32x32x16_bf16 v[32:47], v[100:103], v[220:223], v[32:47]
    s_waitcnt lgkmcnt(4)
    s_add_u32 s24, s24, 4096
    ds_read_b128 v[92:95], v12 offset:3072
    buffer_load_dwordx4 v1, s[12:15], s25 offen offset:3072 sc1 lds
    v_mfma_f32_32x32x16_bf16 v[48:63], v[104:107], v[220:223], v[48:63]
    s_waitcnt lgkmcnt(4)
    s_add_u32 s25, s25, 28672
    s_add_u32 s26, s26, 32768
    s_cmp_ge_u32 s26, 163840
    s_cselect_b32 s37, 163840, 0
    s_sub_u32 s26, s26, s37
    ds_read_b128 v[96:99], v12 offset:4096
    v_mfma_f32_32x32x16_bf16 v[64:79], v[108:111], v[220:223], v[64:79]
    s_waitcnt vmcnt(31) lgkmcnt(4)
    s_add_u32 s25, s25, s31
    s_add_u32 s24, s24, s32
    s_add_u32 s27, s27, 1
    s_cmp_ge_u32 s27, 32
    ds_read_b128 v[100:103], v12 offset:5120
    s_branch og_loop_243
og_done_244:
    s_cmp_lg_u32 s30, 0
    s_cbranch_scc1 og_sp_245
    s_waitcnt vmcnt(0)
    v_cvt_pk_bf16_f32 v224, v16, v17
    v_cvt_pk_bf16_f32 v225, v18, v19
    v_cvt_pk_bf16_f32 v226, v20, v21
    v_cvt_pk_bf16_f32 v227, v22, v23
    v_cvt_pk_bf16_f32 v228, v24, v25
    v_cvt_pk_bf16_f32 v229, v26, v27
    v_cvt_pk_bf16_f32 v230, v28, v29
    v_cvt_pk_bf16_f32 v231, v30, v31
    v_permlane32_swap_b32 v224, v226
    v_permlane32_swap_b32 v225, v227
    buffer_store_dwordx4 v[224:227], v3, s[16:19], s23 offen offset:0
    v_permlane32_swap_b32 v228, v230
    v_permlane32_swap_b32 v229, v231
    buffer_store_dwordx4 v[228:231], v3, s[16:19], s23 offen offset:32
    v_cvt_pk_bf16_f32 v232, v32, v33
    v_cvt_pk_bf16_f32 v233, v34, v35
    v_cvt_pk_bf16_f32 v234, v36, v37
    v_cvt_pk_bf16_f32 v235, v38, v39
    v_cvt_pk_bf16_f32 v236, v40, v41
    v_cvt_pk_bf16_f32 v237, v42, v43
    v_cvt_pk_bf16_f32 v238, v44, v45
    v_cvt_pk_bf16_f32 v239, v46, v47
    v_permlane32_swap_b32 v232, v234
    v_permlane32_swap_b32 v233, v235
    buffer_store_dwordx4 v[232:235], v3, s[16:19], s23 offen offset:64
    v_permlane32_swap_b32 v236, v238
    v_permlane32_swap_b32 v237, v239
    buffer_store_dwordx4 v[236:239], v3, s[16:19], s23 offen offset:96
    v_cvt_pk_bf16_f32 v240, v48, v49
    v_cvt_pk_bf16_f32 v241, v50, v51
    v_cvt_pk_bf16_f32 v242, v52, v53
    v_cvt_pk_bf16_f32 v243, v54, v55
    v_cvt_pk_bf16_f32 v244, v56, v57
    v_cvt_pk_bf16_f32 v245, v58, v59
    v_cvt_pk_bf16_f32 v246, v60, v61
    v_cvt_pk_bf16_f32 v247, v62, v63
    v_permlane32_swap_b32 v240, v242
    v_permlane32_swap_b32 v241, v243
    buffer_store_dwordx4 v[240:243], v3, s[16:19], s23 offen offset:128
    v_permlane32_swap_b32 v244, v246
    v_permlane32_swap_b32 v245, v247
    buffer_store_dwordx4 v[244:247], v3, s[16:19], s23 offen offset:160
    v_cvt_pk_bf16_f32 v248, v64, v65
    v_cvt_pk_bf16_f32 v249, v66, v67
    v_cvt_pk_bf16_f32 v250, v68, v69
    v_cvt_pk_bf16_f32 v251, v70, v71
    v_cvt_pk_bf16_f32 v252, v72, v73
    v_cvt_pk_bf16_f32 v253, v74, v75
    v_cvt_pk_bf16_f32 v254, v76, v77
    v_cvt_pk_bf16_f32 v255, v78, v79
    v_permlane32_swap_b32 v248, v250
    v_permlane32_swap_b32 v249, v251
    buffer_store_dwordx4 v[248:251], v3, s[16:19], s23 offen offset:192
    v_permlane32_swap_b32 v252, v254
    v_permlane32_swap_b32 v253, v255
    buffer_store_dwordx4 v[252:255], v3, s[16:19], s23 offen offset:224
    s_branch og_end_247
og_sp_245:
    s_lshl_b32 s36, s20, 2
    s_add_u32 s36, s36, s21
    s_lshl_b32 s36, s36, 1
    s_add_u32 s36, s36, s30
    s_sub_u32 s36, s36, 1
    s_lshl_b32 s36, s36, 2
    s_add_u32 s36, s36, s4
    s_xor_b32 s37, s36, 4
    s_lshl_b32 s24, s36, 13
    s_add_u32 s24, s24, s33
    s_lshl_b32 s25, s37, 13
    s_add_u32 s25, s25, s33
    s_lshl_b32 s26, s36, 5
    s_add_u32 s26, s26, s34
    s_lshl_b32 s28, s37, 5
    s_add_u32 s28, s28, s34
    v_mov_b32 v4, 1
    s_cmp_eq_u32 s30, 2
    s_cbranch_scc1 og_h2_246
    buffer_store_dwordx4 v[48:51], v1, s[12:15], s24 offen offset:0 sc1
    buffer_store_dwordx4 v[52:55], v1, s[12:15], s24 offen offset:1024 sc1
    buffer_store_dwordx4 v[56:59], v1, s[12:15], s24 offen offset:2048 sc1
    buffer_store_dwordx4 v[60:63], v1, s[12:15], s24 offen offset:3072 sc1
    s_add_u32 s24, s24, 4096
    buffer_store_dwordx4 v[64:67], v1, s[12:15], s24 offen offset:0 sc1
    buffer_store_dwordx4 v[68:71], v1, s[12:15], s24 offen offset:1024 sc1
    buffer_store_dwordx4 v[72:75], v1, s[12:15], s24 offen offset:2048 sc1
    buffer_store_dwordx4 v[76:79], v1, s[12:15], s24 offen offset:3072 sc1
    s_waitcnt vmcnt(0)
    buffer_store_dword v4, off, s[12:15], s26 sc1
    s_mov_b32 s39, 0
sp_248:
    buffer_load_dword v5, off, s[12:15], s28 offset:0 sc1
    s_waitcnt vmcnt(0)
    v_readfirstlane_b32 s38, v5
    s_nop 0
    s_cmp_ge_u32 s38, 1
    s_cbranch_scc1 spd_249
    s_add_u32 s39, s39, 1
    s_sleep 2
    s_cmp_lt_u32 s39, 32768
    s_cbranch_scc1 sp_248
spd_249:
    buffer_load_dwordx4 v[128:131], v1, s[12:15], s25 offen offset:0 sc1
    buffer_load_dwordx4 v[132:135], v1, s[12:15], s25 offen offset:1024 sc1
    buffer_load_dwordx4 v[136:139], v1, s[12:15], s25 offen offset:2048 sc1
    buffer_load_dwordx4 v[140:143], v1, s[12:15], s25 offen offset:3072 sc1
    s_add_u32 s25, s25, 4096
    buffer_load_dwordx4 v[144:147], v1, s[12:15], s25 offen offset:0 sc1
    buffer_load_dwordx4 v[148:151], v1, s[12:15], s25 offen offset:1024 sc1
    buffer_load_dwordx4 v[152:155], v1, s[12:15], s25 offen offset:2048 sc1
    buffer_load_dwordx4 v[156:159], v1, s[12:15], s25 offen offset:3072 sc1
    s_waitcnt vmcnt(0)
    v_add_f32 v16, v16, v128
    v_add_f32 v17, v17, v129
    v_add_f32 v18, v18, v130
    v_add_f32 v19, v19, v131
    v_add_f32 v20, v20, v132
    v_add_f32 v21, v21, v133
    v_add_f32 v22, v22, v134
    v_add_f32 v23, v23, v135
    v_add_f32 v24, v24, v136
    v_add_f32 v25, v25, v137
    v_add_f32 v26, v26, v138
    v_add_f32 v27, v27, v139
    v_add_f32 v28, v28, v140
    v_add_f32 v29, v29, v141
    v_add_f32 v30, v30, v142
    v_add_f32 v31, v31, v143
    v_add_f32 v32, v32, v144
    v_add_f32 v33, v33, v145
    v_add_f32 v34, v34, v146
    v_add_f32 v35, v35, v147
    v_add_f32 v36, v36, v148
    v_add_f32 v37, v37, v149
    v_add_f32 v38, v38, v150
    v_add_f32 v39, v39, v151
    v_add_f32 v40, v40, v152
    v_add_f32 v41, v41, v153
    v_add_f32 v42, v42, v154
    v_add_f32 v43, v43, v155
    v_add_f32 v44, v44, v156
    v_add_f32 v45, v45, v157
    v_add_f32_e64 v46, v46, v158
    v_add_f32_e64 v47, v47, v159
    v_cvt_pk_bf16_f32 v224, v16, v17
    v_cvt_pk_bf16_f32 v225, v18, v19
    v_cvt_pk_bf16_f32 v226, v20, v21
    v_cvt_pk_bf16_f32 v227, v22, v23
    v_cvt_pk_bf16_f32 v228, v24, v25
    v_cvt_pk_bf16_f32 v229, v26, v27
    v_cvt_pk_bf16_f32 v230, v28, v29
    v_cvt_pk_bf16_f32 v231, v30, v31
    v_permlane32_swap_b32 v224, v226
    v_permlane32_swap_b32 v225, v227
    buffer_store_dwordx4 v[224:227], v3, s[16:19], s23 offen offset:0
    v_permlane32_swap_b32 v228, v230
    v_permlane32_swap_b32 v229, v231
    buffer_store_dwordx4 v[228:231], v3, s[16:19], s23 offen offset:32
    v_cvt_pk_bf16_f32 v232, v32, v33
    v_cvt_pk_bf16_f32 v233, v34, v35
    v_cvt_pk_bf16_f32 v234, v36, v37
    v_cvt_pk_bf16_f32 v235, v38, v39
    v_cvt_pk_bf16_f32 v236, v40, v41
    v_cvt_pk_bf16_f32 v237, v42, v43
    v_cvt_pk_bf16_f32 v238, v44, v45
    v_cvt_pk_bf16_f32 v239, v46, v47
    v_permlane32_swap_b32 v232, v234
    v_permlane32_swap_b32 v233, v235
    buffer_store_dwordx4 v[232:235], v3, s[16:19], s23 offen offset:64
    v_permlane32_swap_b32 v236, v238
    v_permlane32_swap_b32 v237, v239
    buffer_store_dwordx4 v[236:239], v3, s[16:19], s23 offen offset:96
    s_branch og_end_247
og_h2_246:
    buffer_store_dwordx4 v[16:19], v1, s[12:15], s24 offen offset:0 sc1
    buffer_store_dwordx4 v[20:23], v1, s[12:15], s24 offen offset:1024 sc1
    buffer_store_dwordx4 v[24:27], v1, s[12:15], s24 offen offset:2048 sc1
    buffer_store_dwordx4 v[28:31], v1, s[12:15], s24 offen offset:3072 sc1
    s_add_u32 s24, s24, 4096
    buffer_store_dwordx4 v[32:35], v1, s[12:15], s24 offen offset:0 sc1
    buffer_store_dwordx4 v[36:39], v1, s[12:15], s24 offen offset:1024 sc1
    buffer_store_dwordx4 v[40:43], v1, s[12:15], s24 offen offset:2048 sc1
    buffer_store_dwordx4 v[44:47], v1, s[12:15], s24 offen offset:3072 sc1
    s_waitcnt vmcnt(0)
    buffer_store_dword v4, off, s[12:15], s26 sc1
    s_mov_b32 s39, 0
sp_250:
    buffer_load_dword v5, off, s[12:15], s28 offset:0 sc1
    s_waitcnt vmcnt(0)
    v_readfirstlane_b32 s38, v5
    s_nop 0
    s_cmp_ge_u32 s38, 1
    s_cbranch_scc1 spd_251
    s_add_u32 s39, s39, 1
    s_sleep 2
    s_cmp_lt_u32 s39, 32768
    s_cbranch_scc1 sp_250
spd_251:
    buffer_load_dwordx4 v[128:131], v1, s[12:15], s25 offen offset:0 sc1
    buffer_load_dwordx4 v[132:135], v1, s[12:15], s25 offen offset:1024 sc1
    buffer_load_dwordx4 v[136:139], v1, s[12:15], s25 offen offset:2048 sc1
    buffer_load_dwordx4 v[140:143], v1, s[12:15], s25 offen offset:3072 sc1
    s_add_u32 s25, s25, 4096
    buffer_load_dwordx4 v[144:147], v1, s[12:15], s25 offen offset:0 sc1
    buffer_load_dwordx4 v[148:151], v1, s[12:15], s25 offen offset:1024 sc1
    buffer_load_dwordx4 v[152:155], v1, s[12:15], s25 offen offset:2048 sc1
    buffer_load_dwordx4 v[156:159], v1, s[12:15], s25 offen offset:3072 sc1
    s_waitcnt vmcnt(0)
    v_add_f32 v48, v48, v128
    v_add_f32 v49, v49, v129
    v_add_f32 v50, v50, v130
    v_add_f32 v51, v51, v131
    v_add_f32 v52, v52, v132
    v_add_f32 v53, v53, v133
    v_add_f32 v54, v54, v134
    v_add_f32 v55, v55, v135
    v_add_f32 v56, v56, v136
    v_add_f32 v57, v57, v137
    v_add_f32 v58, v58, v138
    v_add_f32 v59, v59, v139
    v_add_f32 v60, v60, v140
    v_add_f32 v61, v61, v141
    v_add_f32 v62, v62, v142
    v_add_f32 v63, v63, v143
    v_add_f32 v64, v64, v144
    v_add_f32 v65, v65, v145
    v_add_f32 v66, v66, v146
    v_add_f32 v67, v67, v147
    v_add_f32 v68, v68, v148
    v_add_f32 v69, v69, v149
    v_add_f32 v70, v70, v150
    v_add_f32 v71, v71, v151
    v_add_f32 v72, v72, v152
    v_add_f32 v73, v73, v153
    v_add_f32 v74, v74, v154
    v_add_f32 v75, v75, v155
    v_add_f32 v76, v76, v156
    v_add_f32_e64 v77, v77, v157
    v_add_f32_e64 v78, v78, v158
    v_add_f32_e64 v79, v79, v159
    v_cvt_pk_bf16_f32 v240, v48, v49
    v_cvt_pk_bf16_f32 v241, v50, v51
    v_cvt_pk_bf16_f32 v242, v52, v53
    v_cvt_pk_bf16_f32 v243, v54, v55
    v_cvt_pk_bf16_f32 v244, v56, v57
    v_cvt_pk_bf16_f32 v245, v58, v59
    v_cvt_pk_bf16_f32 v246, v60, v61
    v_cvt_pk_bf16_f32 v247, v62, v63
    v_permlane32_swap_b32 v240, v242
    v_permlane32_swap_b32 v241, v243
    buffer_store_dwordx4 v[240:243], v3, s[16:19], s23 offen offset:128
    v_permlane32_swap_b32 v244, v246
    v_permlane32_swap_b32 v245, v247
    buffer_store_dwordx4 v[244:247], v3, s[16:19], s23 offen offset:160
    v_cvt_pk_bf16_f32 v248, v64, v65
    v_cvt_pk_bf16_f32 v249, v66, v67
    v_cvt_pk_bf16_f32 v250, v68, v69
    v_cvt_pk_bf16_f32 v251, v70, v71
    v_cvt_pk_bf16_f32 v252, v72, v73
    v_cvt_pk_bf16_f32 v253, v74, v75
    v_cvt_pk_bf16_f32 v254, v76, v77
    v_cvt_pk_bf16_f32 v255, v78, v79
    v_permlane32_swap_b32 v248, v250
    v_permlane32_swap_b32 v249, v251
    buffer_store_dwordx4 v[248:251], v3, s[16:19], s23 offen offset:192
    v_permlane32_swap_b32 v252, v254
    v_permlane32_swap_b32 v253, v255
    buffer_store_dwordx4 v[252:255], v3, s[16:19], s23 offen offset:224
og_end_247:
    s_waitcnt lgkmcnt(0)
    s_barrier
    s_add_u32 s59, s58, 32
    s_cmp_eq_u32 s6, 2
    s_cbranch_scc1 mn_og
    mn_spare:
    s_and_b32 s20, s59, 15
    s_cmp_ge_u32 s59, 48
    s_cselect_b32 s60, 12, 0
    s_cselect_b32 s25, 1, 3
    s_add_u32 s60, s60, s6
    s_add_u32 s23, s60, 108
    s_mov_b32 s24, 4
    s_branch mn_otb2
mn_x3:
    s_lshr_b32 s60, s7, 4
    s_add_u32 s23, s60, 96
    s_mov_b32 s25, 8
    s_mov_b32 s24, 2
    s_and_b32 s20, s7, 15
mn_otb:
    s_load_dwordx2 s[44:45], s[0:1], 104
    s_waitcnt lgkmcnt(0)
    s_mov_b32 s16, s44
    s_mov_b32 s17, s45
    s_mov_b32 s18, 0x400000
    s_mov_b32 s19, 0x00020000
    s_mov_b32 s61, 146818048
    v_lshlrev_b32 v6, 3, v0
    s_mov_b32 s62, 0
sp_252:
    buffer_load_dwordx2 v[4:5], v6, s[12:15], s61 offen sc1
    s_waitcnt vmcnt(0)
    v_min_u32 v4, v4, v5
    v_cmp_eq_u32 vcc, 0, v4
    s_nop 0
    s_cmp_eq_u64 vcc, 0
    s_cbranch_scc1 spd_253
    s_add_u32 s62, s62, 1
    s_sleep 16
    s_cmp_lt_u32 s62, 32768
    s_cbranch_scc1 sp_252
spd_253:
mn_otb2:
    v_bfe_u32 v5, v0, 5, 1
    v_lshlrev_b32 v6, 12, v5
    v_bfe_u32 v5, v0, 4, 1
    v_lshl_add_u32 v6, v5, 9, v6
    v_bfe_u32 v5, v0, 0, 4
    v_lshl_add_u32 v6, v5, 4, v6
    s_lshr_b32 s36, s20, 2
    s_lshl_b32 s36, s36, 20
    s_and_b32 s37, s20, 3
    s_lshl_b32 s37, s37, 10
    s_add_u32 s36, s36, s37
    s_lshl_b32 s37, s4, 18
    s_add_u32 s36, s36, s37
    s_add_u32 s36, s36, 150994944
    buffer_load_dwordx4 a[0:3], v6, s[12:15], s36 offen offset:0 sc1
    buffer_load_dwordx4 a[4:7], v6, s[12:15], s36 offen offset:256 sc1
    s_add_u32 s36, s36, 8192
    buffer_load_dwordx4 a[8:11], v6, s[12:15], s36 offen offset:0 sc1
    buffer_load_dwordx4 a[12:15], v6, s[12:15], s36 offen offset:256 sc1
    s_add_u32 s36, s36, 8192
    buffer_load_dwordx4 a[16:19], v6, s[12:15], s36 offen offset:0 sc1
    buffer_load_dwordx4 a[20:23], v6, s[12:15], s36 offen offset:256 sc1
    s_add_u32 s36, s36, 8192
    buffer_load_dwordx4 a[24:27], v6, s[12:15], s36 offen offset:0 sc1
    buffer_load_dwordx4 a[28:31], v6, s[12:15], s36 offen offset:256 sc1
    s_add_u32 s36, s36, 8192
    buffer_load_dwordx4 a[32:35], v6, s[12:15], s36 offen offset:0 sc1
    buffer_load_dwordx4 a[36:39], v6, s[12:15], s36 offen offset:256 sc1
    s_add_u32 s36, s36, 8192
    buffer_load_dwordx4 a[40:43], v6, s[12:15], s36 offen offset:0 sc1
    buffer_load_dwordx4 a[44:47], v6, s[12:15], s36 offen offset:256 sc1
    s_add_u32 s36, s36, 8192
    buffer_load_dwordx4 a[48:51], v6, s[12:15], s36 offen offset:0 sc1
    buffer_load_dwordx4 a[52:55], v6, s[12:15], s36 offen offset:256 sc1
    s_add_u32 s36, s36, 8192
    buffer_load_dwordx4 a[56:59], v6, s[12:15], s36 offen offset:0 sc1
    buffer_load_dwordx4 a[60:63], v6, s[12:15], s36 offen offset:256 sc1
    s_add_u32 s36, s36, 8192
    buffer_load_dwordx4 a[64:67], v6, s[12:15], s36 offen offset:0 sc1
    buffer_load_dwordx4 a[68:71], v6, s[12:15], s36 offen offset:256 sc1
    s_add_u32 s36, s36, 8192
    buffer_load_dwordx4 a[72:75], v6, s[12:15], s36 offen offset:0 sc1
    buffer_load_dwordx4 a[76:79], v6, s[12:15], s36 offen offset:256 sc1
    s_add_u32 s36, s36, 8192
    buffer_load_dwordx4 a[80:83], v6, s[12:15], s36 offen offset:0 sc1
    buffer_load_dwordx4 a[84:87], v6, s[12:15], s36 offen offset:256 sc1
    s_add_u32 s36, s36, 8192
    buffer_load_dwordx4 a[88:91], v6, s[12:15], s36 offen offset:0 sc1
    buffer_load_dwordx4 a[92:95], v6, s[12:15], s36 offen offset:256 sc1
    s_add_u32 s36, s36, 8192
    buffer_load_dwordx4 a[96:99], v6, s[12:15], s36 offen offset:0 sc1
    buffer_load_dwordx4 a[100:103], v6, s[12:15], s36 offen offset:256 sc1
    s_add_u32 s36, s36, 8192
    buffer_load_dwordx4 a[104:107], v6, s[12:15], s36 offen offset:0 sc1
    buffer_load_dwordx4 a[108:111], v6, s[12:15], s36 offen offset:256 sc1
    s_add_u32 s36, s36, 8192
    buffer_load_dwordx4 a[112:115], v6, s[12:15], s36 offen offset:0 sc1
    buffer_load_dwordx4 a[116:119], v6, s[12:15], s36 offen offset:256 sc1
    s_add_u32 s36, s36, 8192
    buffer_load_dwordx4 a[120:123], v6, s[12:15], s36 offen offset:0 sc1
    buffer_load_dwordx4 a[124:127], v6, s[12:15], s36 offen offset:256 sc1
    s_add_u32 s36, s36, 8192
    buffer_load_dwordx4 a[128:131], v6, s[12:15], s36 offen offset:0 sc1
    buffer_load_dwordx4 a[132:135], v6, s[12:15], s36 offen offset:256 sc1
    s_add_u32 s36, s36, 8192
    buffer_load_dwordx4 a[136:139], v6, s[12:15], s36 offen offset:0 sc1
    buffer_load_dwordx4 a[140:143], v6, s[12:15], s36 offen offset:256 sc1
    s_add_u32 s36, s36, 8192
    buffer_load_dwordx4 a[144:147], v6, s[12:15], s36 offen offset:0 sc1
    buffer_load_dwordx4 a[148:151], v6, s[12:15], s36 offen offset:256 sc1
    s_add_u32 s36, s36, 8192
    buffer_load_dwordx4 a[152:155], v6, s[12:15], s36 offen offset:0 sc1
    buffer_load_dwordx4 a[156:159], v6, s[12:15], s36 offen offset:256 sc1
    s_add_u32 s36, s36, 8192
    buffer_load_dwordx4 a[160:163], v6, s[12:15], s36 offen offset:0 sc1
    buffer_load_dwordx4 a[164:167], v6, s[12:15], s36 offen offset:256 sc1
    s_add_u32 s36, s36, 8192
    buffer_load_dwordx4 a[168:171], v6, s[12:15], s36 offen offset:0 sc1
    buffer_load_dwordx4 a[172:175], v6, s[12:15], s36 offen offset:256 sc1
    s_add_u32 s36, s36, 8192
    buffer_load_dwordx4 a[176:179], v6, s[12:15], s36 offen offset:0 sc1
    buffer_load_dwordx4 a[180:183], v6, s[12:15], s36 offen offset:256 sc1
    s_add_u32 s36, s36, 8192
    buffer_load_dwordx4 a[184:187], v6, s[12:15], s36 offen offset:0 sc1
    buffer_load_dwordx4 a[188:191], v6, s[12:15], s36 offen offset:256 sc1
    s_add_u32 s36, s36, 8192
    s_waitcnt vmcnt(32)
    buffer_load_dwordx4 a[192:195], v6, s[12:15], s36 offen offset:0 sc1
    buffer_load_dwordx4 a[196:199], v6, s[12:15], s36 offen offset:256 sc1
    s_add_u32 s36, s36, 8192
    buffer_load_dwordx4 a[200:203], v6, s[12:15], s36 offen offset:0 sc1
    buffer_load_dwordx4 a[204:207], v6, s[12:15], s36 offen offset:256 sc1
    s_add_u32 s36, s36, 8192
    buffer_load_dwordx4 a[208:211], v6, s[12:15], s36 offen offset:0 sc1
    buffer_load_dwordx4 a[212:215], v6, s[12:15], s36 offen offset:256 sc1
    s_add_u32 s36, s36, 8192
    buffer_load_dwordx4 a[216:219], v6, s[12:15], s36 offen offset:0 sc1
    buffer_load_dwordx4 a[220:223], v6, s[12:15], s36 offen offset:256 sc1
    s_add_u32 s36, s36, 8192
    buffer_load_dwordx4 a[224:227], v6, s[12:15], s36 offen offset:0 sc1
    buffer_load_dwordx4 a[228:231], v6, s[12:15], s36 offen offset:256 sc1
    s_add_u32 s36, s36, 8192
    buffer_load_dwordx4 a[232:235], v6, s[12:15], s36 offen offset:0 sc1
    buffer_load_dwordx4 a[236:239], v6, s[12:15], s36 offen offset:256 sc1
    s_add_u32 s36, s36, 8192
    buffer_load_dwordx4 a[240:243], v6, s[12:15], s36 offen offset:0 sc1
    buffer_load_dwordx4 a[244:247], v6, s[12:15], s36 offen offset:256 sc1
    s_add_u32 s36, s36, 8192
    buffer_load_dwordx4 a[248:251], v6, s[12:15], s36 offen offset:0 sc1
    buffer_load_dwordx4 a[252:255], v6, s[12:15], s36 offen offset:256 sc1
    s_add_u32 s36, s36, 8192
    v_bfe_u32 v5, v0, 4, 2
    v_lshlrev_b32 v1, 9, v5
    v_bfe_u32 v5, v0, 0, 4
    v_lshl_add_u32 v1, v5, 4, v1
    v_bfe_u32 v5, v0, 0, 4
    v_lshlrev_b32 v4, 11, v5
    v_bfe_u32 v5, v0, 4, 2
    v_lshl_add_u32 v4, v5, 3, v4
    v_lshlrev_b32 v5, 4, v0
    s_lshl_b32 s36, s4, 11
    v_add_u32 v2, s36, v5
    s_and_b32 s36, s4, 1
    s_lshl_b32 s37, s36, 10
    v_add_u32 v3, s37, v5
    s_lshl_b32 s36, s36, 5
    s_lshl_b32 s37, s20, 6
    s_add_u32 s36, s36, s37
    s_cmp_ge_u32 s4, 2
    s_cselect_b32 s36, 0x40000000, s36
    v_add_u32_e64 v4, s36, v4
    s_lshl_b32 s31, s4, 16
    s_add_u32 s31, s31, 100663296
    v_and_b32_e64 v11, 7, v0
    s_lshl_b32 s36, s4, 5
    v_lshl_add_u32 v11, v11, 2, s36
    s_waitcnt vmcnt(0)
    s_mov_b32 s29, 0
    s_lshr_b32 s36, s23, 1
    s_lshl_b32 s36, s36, 7
    s_add_u32 s36, s36, 146821120
    s_mov_b32 s37, 0
sp_257:
    buffer_load_dword v10, v11, s[12:15], s36 offen sc1
    s_waitcnt vmcnt(0)
    v_cmp_eq_u32_e64 vcc, 0, v10
    s_nop 0
    s_cmp_eq_u64 vcc, 0
    s_cbranch_scc1 spd_258
    s_add_u32 s37, s37, 1
    s_sleep 2
    s_cmp_lt_u32 s37, 32768
    s_cbranch_scc1 sp_257
spd_258:
    s_lshr_b32 s28, s23, 1
    s_lshl_b32 s28, s28, 18
    s_and_b32 s36, s23, 1
    s_lshl_b32 s36, s36, 8
    s_add_u32 s28, s28, s36
    s_add_u32 s28, s28, s31
    buffer_load_dwordx4 v[64:67], v1, s[12:15], s28 offen offset:0 sc1
    buffer_load_dwordx4 v[68:71], v1, s[12:15], s28 offen offset:2048 sc1
    s_add_u32 s28, s28, 4096
    buffer_load_dwordx4 v[72:75], v1, s[12:15], s28 offen offset:0 sc1
    buffer_load_dwordx4 v[76:79], v1, s[12:15], s28 offen offset:2048 sc1
    s_add_u32 s28, s28, 4096
    buffer_load_dwordx4 v[80:83], v1, s[12:15], s28 offen offset:0 sc1
    buffer_load_dwordx4 v[84:87], v1, s[12:15], s28 offen offset:2048 sc1
    s_add_u32 s28, s28, 4096
    buffer_load_dwordx4 v[88:91], v1, s[12:15], s28 offen offset:0 sc1
    buffer_load_dwordx4 v[92:95], v1, s[12:15], s28 offen offset:2048 sc1
    s_add_u32 s28, s28, 4096
    buffer_load_dwordx4 v[96:99], v1, s[12:15], s28 offen offset:0 sc1
    buffer_load_dwordx4 v[100:103], v1, s[12:15], s28 offen offset:2048 sc1
    s_add_u32 s28, s28, 4096
    buffer_load_dwordx4 v[104:107], v1, s[12:15], s28 offen offset:0 sc1
    buffer_load_dwordx4 v[108:111], v1, s[12:15], s28 offen offset:2048 sc1
    s_add_u32 s28, s28, 4096
    buffer_load_dwordx4 v[112:115], v1, s[12:15], s28 offen offset:0 sc1
    buffer_load_dwordx4 v[116:119], v1, s[12:15], s28 offen offset:2048 sc1
    s_add_u32 s28, s28, 4096
    buffer_load_dwordx4 v[120:123], v1, s[12:15], s28 offen offset:0 sc1
    buffer_load_dwordx4 v[124:127], v1, s[12:15], s28 offen offset:2048 sc1
    s_add_u32 s28, s28, 4096
    buffer_load_dwordx4 v[128:131], v1, s[12:15], s28 offen offset:0 sc1
    buffer_load_dwordx4 v[132:135], v1, s[12:15], s28 offen offset:2048 sc1
    s_add_u32 s28, s28, 4096
    buffer_load_dwordx4 v[136:139], v1, s[12:15], s28 offen offset:0 sc1
    buffer_load_dwordx4 v[140:143], v1, s[12:15], s28 offen offset:2048 sc1
    s_add_u32 s28, s28, 4096
    buffer_load_dwordx4 v[144:147], v1, s[12:15], s28 offen offset:0 sc1
    buffer_load_dwordx4 v[148:151], v1, s[12:15], s28 offen offset:2048 sc1
    s_add_u32 s28, s28, 4096
    buffer_load_dwordx4 v[152:155], v1, s[12:15], s28 offen offset:0 sc1
    buffer_load_dwordx4 v[156:159], v1, s[12:15], s28 offen offset:2048 sc1
    s_add_u32 s28, s28, 4096
    buffer_load_dwordx4 v[160:163], v1, s[12:15], s28 offen offset:0 sc1
    buffer_load_dwordx4 v[164:167], v1, s[12:15], s28 offen offset:2048 sc1
    s_add_u32 s28, s28, 4096
    buffer_load_dwordx4 v[168:171], v1, s[12:15], s28 offen offset:0 sc1
    buffer_load_dwordx4 v[172:175], v1, s[12:15], s28 offen offset:2048 sc1
    s_add_u32 s28, s28, 4096
    buffer_load_dwordx4 v[176:179], v1, s[12:15], s28 offen offset:0 sc1
    buffer_load_dwordx4 v[180:183], v1, s[12:15], s28 offen offset:2048 sc1
    s_add_u32 s28, s28, 4096
    buffer_load_dwordx4 v[184:187], v1, s[12:15], s28 offen offset:0 sc1
    buffer_load_dwordx4 v[188:191], v1, s[12:15], s28 offen offset:2048 sc1
    s_add_u32 s28, s28, 4096
o6_loop_254:
    s_waitcnt vmcnt(31)
    v_mfma_f32_16x16x32_bf16 v[16:19], a[0:3], v[64:67], 0
    v_mfma_f32_16x16x32_bf16 v[20:23], a[4:7], v[64:67], 0
    s_waitcnt vmcnt(30)
    v_mfma_f32_16x16x32_bf16 v[16:19], a[8:11], v[68:71], v[16:19]
    v_mfma_f32_16x16x32_bf16 v[20:23], a[12:15], v[68:71], v[20:23]
    s_waitcnt vmcnt(29)
    v_mfma_f32_16x16x32_bf16 v[16:19], a[16:19], v[72:75], v[16:19]
    v_mfma_f32_16x16x32_bf16 v[20:23], a[20:23], v[72:75], v[20:23]
    s_waitcnt vmcnt(28)
    v_mfma_f32_16x16x32_bf16 v[16:19], a[24:27], v[76:79], v[16:19]
    v_mfma_f32_16x16x32_bf16 v[20:23], a[28:31], v[76:79], v[20:23]
    s_waitcnt vmcnt(27)
    v_mfma_f32_16x16x32_bf16 v[16:19], a[32:35], v[80:83], v[16:19]
    v_mfma_f32_16x16x32_bf16 v[20:23], a[36:39], v[80:83], v[20:23]
    s_waitcnt vmcnt(26)
    v_mfma_f32_16x16x32_bf16 v[16:19], a[40:43], v[84:87], v[16:19]
    v_mfma_f32_16x16x32_bf16 v[20:23], a[44:47], v[84:87], v[20:23]
    s_waitcnt vmcnt(25)
    v_mfma_f32_16x16x32_bf16 v[16:19], a[48:51], v[88:91], v[16:19]
    v_mfma_f32_16x16x32_bf16 v[20:23], a[52:55], v[88:91], v[20:23]
    s_waitcnt vmcnt(24)
    v_mfma_f32_16x16x32_bf16 v[16:19], a[56:59], v[92:95], v[16:19]
    v_mfma_f32_16x16x32_bf16 v[20:23], a[60:63], v[92:95], v[20:23]
    s_waitcnt vmcnt(23)
    v_mfma_f32_16x16x32_bf16 v[16:19], a[64:67], v[96:99], v[16:19]
    v_mfma_f32_16x16x32_bf16 v[20:23], a[68:71], v[96:99], v[20:23]
    s_waitcnt vmcnt(22)
    v_mfma_f32_16x16x32_bf16 v[16:19], a[72:75], v[100:103], v[16:19]
    v_mfma_f32_16x16x32_bf16 v[20:23], a[76:79], v[100:103], v[20:23]
    s_waitcnt vmcnt(21)
    v_mfma_f32_16x16x32_bf16 v[16:19], a[80:83], v[104:107], v[16:19]
    v_mfma_f32_16x16x32_bf16 v[20:23], a[84:87], v[104:107], v[20:23]
    s_waitcnt vmcnt(20)
    v_mfma_f32_16x16x32_bf16 v[16:19], a[88:91], v[108:111], v[16:19]
    v_mfma_f32_16x16x32_bf16 v[20:23], a[92:95], v[108:111], v[20:23]
    s_add_u32 s38, s23, s24
    s_lshr_b32 s36, s38, 1
    s_lshl_b32 s36, s36, 7
    s_add_u32 s36, s36, 146821120
    buffer_load_dword v10, v11, s[12:15], s36 offen sc1
    s_waitcnt vmcnt(19)
    v_mfma_f32_16x16x32_bf16 v[16:19], a[96:99], v[112:115], v[16:19]
    v_mfma_f32_16x16x32_bf16 v[20:23], a[100:103], v[112:115], v[20:23]
    s_waitcnt vmcnt(18)
    v_mfma_f32_16x16x32_bf16 v[16:19], a[104:107], v[116:119], v[16:19]
    v_mfma_f32_16x16x32_bf16 v[20:23], a[108:111], v[116:119], v[20:23]
    s_waitcnt vmcnt(17)
    v_mfma_f32_16x16x32_bf16 v[16:19], a[112:115], v[120:123], v[16:19]
    v_mfma_f32_16x16x32_bf16 v[20:23], a[116:119], v[120:123], v[20:23]
    s_waitcnt vmcnt(16)
    v_mfma_f32_16x16x32_bf16 v[16:19], a[120:123], v[124:127], v[16:19]
    v_mfma_f32_16x16x32_bf16 v[20:23], a[124:127], v[124:127], v[20:23]
    s_waitcnt vmcnt(15)
    v_mfma_f32_16x16x32_bf16 v[16:19], a[128:131], v[128:131], v[16:19]
    v_mfma_f32_16x16x32_bf16 v[20:23], a[132:135], v[128:131], v[20:23]
    s_waitcnt vmcnt(14)
    v_mfma_f32_16x16x32_bf16 v[16:19], a[136:139], v[132:135], v[16:19]
    v_mfma_f32_16x16x32_bf16 v[20:23], a[140:143], v[132:135], v[20:23]
    s_waitcnt vmcnt(13)
    v_mfma_f32_16x16x32_bf16 v[16:19], a[144:147], v[136:139], v[16:19]
    v_mfma_f32_16x16x32_bf16 v[20:23], a[148:151], v[136:139], v[20:23]
    s_waitcnt vmcnt(12)
    v_mfma_f32_16x16x32_bf16 v[16:19], a[152:155], v[140:143], v[16:19]
    v_mfma_f32_16x16x32_bf16 v[20:23], a[156:159], v[140:143], v[20:23]
    s_waitcnt vmcnt(11)
    v_mfma_f32_16x16x32_bf16 v[16:19], a[160:163], v[144:147], v[16:19]
    v_mfma_f32_16x16x32_bf16 v[20:23], a[164:167], v[144:147], v[20:23]
    s_waitcnt vmcnt(10)
    v_mfma_f32_16x16x32_bf16 v[16:19], a[168:171], v[148:151], v[16:19]
    v_mfma_f32_16x16x32_bf16 v[20:23], a[172:175], v[148:151], v[20:23]
    s_waitcnt vmcnt(9)
    v_mfma_f32_16x16x32_bf16 v[16:19], a[176:179], v[152:155], v[16:19]
    v_mfma_f32_16x16x32_bf16 v[20:23], a[180:183], v[152:155], v[20:23]
    s_waitcnt vmcnt(8)
    v_mfma_f32_16x16x32_bf16 v[16:19], a[184:187], v[156:159], v[16:19]
    v_mfma_f32_16x16x32_bf16 v[20:23], a[188:191], v[156:159], v[20:23]
    s_waitcnt vmcnt(7)
    v_mfma_f32_16x16x32_bf16 v[16:19], a[192:195], v[160:163], v[16:19]
    v_mfma_f32_16x16x32_bf16 v[20:23], a[196:199], v[160:163], v[20:23]
    s_waitcnt vmcnt(6)
    v_mfma_f32_16x16x32_bf16 v[16:19], a[200:203], v[164:167], v[16:19]
    v_mfma_f32_16x16x32_bf16 v[20:23], a[204:207], v[164:167], v[20:23]
    s_waitcnt vmcnt(5)
    v_mfma_f32_16x16x32_bf16 v[16:19], a[208:211], v[168:171], v[16:19]
    v_mfma_f32_16x16x32_bf16 v[20:23], a[212:215], v[168:171], v[20:23]
    s_waitcnt vmcnt(4)
    v_mfma_f32_16x16x32_bf16 v[16:19], a[216:219], v[172:175], v[16:19]
    v_mfma_f32_16x16x32_bf16 v[20:23], a[220:223], v[172:175], v[20:23]
    s_waitcnt vmcnt(3)
    v_mfma_f32_16x16x32_bf16 v[16:19], a[224:227], v[176:179], v[16:19]
    v_mfma_f32_16x16x32_bf16 v[20:23], a[228:231], v[176:179], v[20:23]
    s_waitcnt vmcnt(2)
    v_mfma_f32_16x16x32_bf16 v[16:19], a[232:235], v[180:183], v[16:19]
    s_nop 0
    v_mfma_f32_16x16x32_bf16 v[20:23], a[236:239], v[180:183], v[20:23]
    s_waitcnt vmcnt(1)
    v_mfma_f32_16x16x32_bf16 v[16:19], a[240:243], v[184:187], v[16:19]
    s_nop 0
    v_mfma_f32_16x16x32_bf16 v[20:23], a[244:247], v[184:187], v[20:23]
    s_waitcnt vmcnt(0)
    v_mfma_f32_16x16x32_bf16 v[16:19], a[248:251], v[188:191], v[16:19]
    s_nop 0
    v_mfma_f32_16x16x32_bf16 v[20:23], a[252:255], v[188:191], v[20:23]
    s_lshl_b32 s30, s23, 15
    s_add_u32 s23, s23, s24
    s_add_u32 s29, s29, 1
    s_nop 1
    ds_write_b128 v2, v[16:19] offset:0
    s_nop 1
    ds_write_b128 v2, v[20:23] offset:1024
    s_cmp_ge_u32 s29, s25
    s_cbranch_scc1 o6_last_255
    v_cmp_eq_u32 vcc, 0, v10
    s_cbranch_vccnz o6_late_256
    s_lshr_b32 s28, s23, 1
    s_lshl_b32 s28, s28, 18
    s_and_b32 s36, s23, 1
    s_lshl_b32 s36, s36, 8
    s_add_u32 s28, s28, s36
    s_add_u32 s28, s28, s31
    buffer_load_dwordx4 v[64:67], v1, s[12:15], s28 offen offset:0 sc1
    buffer_load_dwordx4 v[68:71], v1, s[12:15], s28 offen offset:2048 sc1
    s_add_u32 s28, s28, 4096
    buffer_load_dwordx4 v[72:75], v1, s[12:15], s28 offen offset:0 sc1
    buffer_load_dwordx4 v[76:79], v1, s[12:15], s28 offen offset:2048 sc1
    s_add_u32 s28, s28, 4096
    buffer_load_dwordx4 v[80:83], v1, s[12:15], s28 offen offset:0 sc1
    buffer_load_dwordx4 v[84:87], v1, s[12:15], s28 offen offset:2048 sc1
    s_add_u32 s28, s28, 4096
    buffer_load_dwordx4 v[88:91], v1, s[12:15], s28 offen offset:0 sc1
    buffer_load_dwordx4 v[92:95], v1, s[12:15], s28 offen offset:2048 sc1
    s_add_u32 s28, s28, 4096
    buffer_load_dwordx4 v[96:99], v1, s[12:15], s28 offen offset:0 sc1
    buffer_load_dwordx4 v[100:103], v1, s[12:15], s28 offen offset:2048 sc1
    s_add_u32 s28, s28, 4096
    buffer_load_dwordx4 v[104:107], v1, s[12:15], s28 offen offset:0 sc1
    buffer_load_dwordx4 v[108:111], v1, s[12:15], s28 offen offset:2048 sc1
    s_add_u32 s28, s28, 4096
    buffer_load_dwordx4 v[112:115], v1, s[12:15], s28 offen offset:0 sc1
    buffer_load_dwordx4 v[116:119], v1, s[12:15], s28 offen offset:2048 sc1
    s_add_u32 s28, s28, 4096
    buffer_load_dwordx4 v[120:123], v1, s[12:15], s28 offen offset:0 sc1
    buffer_load_dwordx4 v[124:127], v1, s[12:15], s28 offen offset:2048 sc1
    s_add_u32 s28, s28, 4096
    buffer_load_dwordx4 v[128:131], v1, s[12:15], s28 offen offset:0 sc1
    buffer_load_dwordx4 v[132:135], v1, s[12:15], s28 offen offset:2048 sc1
    s_add_u32 s28, s28, 4096
    buffer_load_dwordx4 v[136:139], v1, s[12:15], s28 offen offset:0 sc1
    buffer_load_dwordx4 v[140:143], v1, s[12:15], s28 offen offset:2048 sc1
    s_add_u32 s28, s28, 4096
    buffer_load_dwordx4 v[144:147], v1, s[12:15], s28 offen offset:0 sc1
    buffer_load_dwordx4 v[148:151], v1, s[12:15], s28 offen offset:2048 sc1
    s_add_u32 s28, s28, 4096
    buffer_load_dwordx4 v[152:155], v1, s[12:15], s28 offen offset:0 sc1
    buffer_load_dwordx4 v[156:159], v1, s[12:15], s28 offen offset:2048 sc1
    s_add_u32 s28, s28, 4096
    buffer_load_dwordx4 v[160:163], v1, s[12:15], s28 offen offset:0 sc1
    buffer_load_dwordx4 v[164:167], v1, s[12:15], s28 offen offset:2048 sc1
    s_add_u32 s28, s28, 4096
    buffer_load_dwordx4 v[168:171], v1, s[12:15], s28 offen offset:0 sc1
    buffer_load_dwordx4 v[172:175], v1, s[12:15], s28 offen offset:2048 sc1
    s_add_u32 s28, s28, 4096
    buffer_load_dwordx4 v[176:179], v1, s[12:15], s28 offen offset:0 sc1
    buffer_load_dwordx4 v[180:183], v1, s[12:15], s28 offen offset:2048 sc1
    s_add_u32 s28, s28, 4096
    buffer_load_dwordx4 v[184:187], v1, s[12:15], s28 offen offset:0 sc1
    buffer_load_dwordx4 v[188:191], v1, s[12:15], s28 offen offset:2048 sc1
    s_add_u32 s28, s28, 4096
    s_waitcnt lgkmcnt(0)
    s_barrier
    ds_read_b128 v[32:35], v3 offset:0
    ds_read_b128 v[36:39], v3 offset:2048
    ds_read_b128 v[40:43], v3 offset:4096
    ds_read_b128 v[44:47], v3 offset:6144
    v_xor_b32 v2, 8192, v2
    v_xor_b32 v3, 8192, v3
    s_waitcnt lgkmcnt(0)
    v_add_f32 v32, v32, v36
    v_add_f32 v40, v40, v44
    v_add_f32 v33, v33, v37
    v_add_f32 v41, v41, v45
    v_add_f32 v34, v34, v38
    v_add_f32 v42, v42, v46
    v_add_f32 v35, v35, v39
    v_add_f32 v43, v43, v47
    v_add_f32 v32, v32, v40
    v_add_f32 v33, v33, v41
    v_add_f32 v34, v34, v42
    v_add_f32 v35, v35, v43
    v_cvt_pk_bf16_f32 v32, v32, v33
    v_cvt_pk_bf16_f32 v33, v34, v35
    buffer_store_dwordx2 v[32:33], v4, s[16:19], s30 offen
    s_branch o6_loop_254
o6_late_256:
    s_waitcnt lgkmcnt(0)
    s_barrier
    ds_read_b128 v[32:35], v3 offset:0
    ds_read_b128 v[36:39], v3 offset:2048
    ds_read_b128 v[40:43], v3 offset:4096
    ds_read_b128 v[44:47], v3 offset:6144
    v_xor_b32 v2, 8192, v2
    v_xor_b32 v3, 8192, v3
    s_waitcnt lgkmcnt(0)
    v_add_f32 v32, v32, v36
    v_add_f32 v40, v40, v44
    v_add_f32 v33, v33, v37
    v_add_f32 v41, v41, v45
    v_add_f32 v34, v34, v38
    v_add_f32 v42, v42, v46
    v_add_f32 v35, v35, v39
    v_add_f32 v43, v43, v47
    v_add_f32 v32, v32, v40
    v_add_f32 v33, v33, v41
    v_add_f32 v34, v34, v42
    v_add_f32 v35, v35, v43
    v_cvt_pk_bf16_f32 v32, v32, v33
    v_cvt_pk_bf16_f32 v33, v34, v35
    buffer_store_dwordx2 v[32:33], v4, s[16:19], s30 offen
    s_lshr_b32 s36, s23, 1
    s_lshl_b32 s36, s36, 7
    s_add_u32 s36, s36, 146821120
    s_mov_b32 s37, 0
sp_259:
    buffer_load_dword v10, v11, s[12:15], s36 offen sc1
    s_waitcnt vmcnt(0)
    v_cmp_eq_u32_e64 vcc, 0, v10
    s_nop 0
    s_cmp_eq_u64 vcc, 0
    s_cbranch_scc1 spd_260
    s_add_u32 s37, s37, 1
    s_sleep 2
    s_cmp_lt_u32 s37, 32768
    s_cbranch_scc1 sp_259
spd_260:
    s_lshr_b32 s28, s23, 1
    s_lshl_b32 s28, s28, 18
    s_and_b32 s36, s23, 1
    s_lshl_b32 s36, s36, 8
    s_add_u32 s28, s28, s36
    s_add_u32 s28, s28, s31
    buffer_load_dwordx4 v[64:67], v1, s[12:15], s28 offen offset:0 sc1
    buffer_load_dwordx4 v[68:71], v1, s[12:15], s28 offen offset:2048 sc1
    s_add_u32 s28, s28, 4096
    buffer_load_dwordx4 v[72:75], v1, s[12:15], s28 offen offset:0 sc1
    buffer_load_dwordx4 v[76:79], v1, s[12:15], s28 offen offset:2048 sc1
    s_add_u32 s28, s28, 4096
    buffer_load_dwordx4 v[80:83], v1, s[12:15], s28 offen offset:0 sc1
    buffer_load_dwordx4 v[84:87], v1, s[12:15], s28 offen offset:2048 sc1
    s_add_u32 s28, s28, 4096
    buffer_load_dwordx4 v[88:91], v1, s[12:15], s28 offen offset:0 sc1
    buffer_load_dwordx4 v[92:95], v1, s[12:15], s28 offen offset:2048 sc1
    s_add_u32 s28, s28, 4096
    buffer_load_dwordx4 v[96:99], v1, s[12:15], s28 offen offset:0 sc1
    buffer_load_dwordx4 v[100:103], v1, s[12:15], s28 offen offset:2048 sc1
    s_add_u32 s28, s28, 4096
    buffer_load_dwordx4 v[104:107], v1, s[12:15], s28 offen offset:0 sc1
    buffer_load_dwordx4 v[108:111], v1, s[12:15], s28 offen offset:2048 sc1
    s_add_u32 s28, s28, 4096
    buffer_load_dwordx4 v[112:115], v1, s[12:15], s28 offen offset:0 sc1
    buffer_load_dwordx4 v[116:119], v1, s[12:15], s28 offen offset:2048 sc1
    s_add_u32 s28, s28, 4096
    buffer_load_dwordx4 v[120:123], v1, s[12:15], s28 offen offset:0 sc1
    buffer_load_dwordx4 v[124:127], v1, s[12:15], s28 offen offset:2048 sc1
    s_add_u32 s28, s28, 4096
    buffer_load_dwordx4 v[128:131], v1, s[12:15], s28 offen offset:0 sc1
    buffer_load_dwordx4 v[132:135], v1, s[12:15], s28 offen offset:2048 sc1
    s_add_u32 s28, s28, 4096
    buffer_load_dwordx4 v[136:139], v1, s[12:15], s28 offen offset:0 sc1
    buffer_load_dwordx4 v[140:143], v1, s[12:15], s28 offen offset:2048 sc1
    s_add_u32 s28, s28, 4096
    buffer_load_dwordx4 v[144:147], v1, s[12:15], s28 offen offset:0 sc1
    buffer_load_dwordx4 v[148:151], v1, s[12:15], s28 offen offset:2048 sc1
    s_add_u32 s28, s28, 4096
    buffer_load_dwordx4 v[152:155], v1, s[12:15], s28 offen offset:0 sc1
    buffer_load_dwordx4 v[156:159], v1, s[12:15], s28 offen offset:2048 sc1
    s_add_u32 s28, s28, 4096
    buffer_load_dwordx4 v[160:163], v1, s[12:15], s28 offen offset:0 sc1
    buffer_load_dwordx4 v[164:167], v1, s[12:15], s28 offen offset:2048 sc1
    s_add_u32 s28, s28, 4096
    buffer_load_dwordx4 v[168:171], v1, s[12:15], s28 offen offset:0 sc1
    buffer_load_dwordx4 v[172:175], v1, s[12:15], s28 offen offset:2048 sc1
    s_add_u32 s28, s28, 4096
    buffer_load_dwordx4 v[176:179], v1, s[12:15], s28 offen offset:0 sc1
    buffer_load_dwordx4 v[180:183], v1, s[12:15], s28 offen offset:2048 sc1
    s_add_u32 s28, s28, 4096
    buffer_load_dwordx4 v[184:187], v1, s[12:15], s28 offen offset:0 sc1
    buffer_load_dwordx4 v[188:191], v1, s[12:15], s28 offen offset:2048 sc1
    s_add_u32 s28, s28, 4096
    s_branch o6_loop_254
o6_last_255:
    s_waitcnt lgkmcnt(0)
    s_barrier
    ds_read_b128 v[32:35], v3 offset:0
    ds_read_b128 v[36:39], v3 offset:2048
    ds_read_b128 v[40:43], v3 offset:4096
    ds_read_b128 v[44:47], v3 offset:6144
    v_xor_b32 v2, 8192, v2
    v_xor_b32 v3, 8192, v3
    s_waitcnt lgkmcnt(0)
    v_add_f32 v32, v32, v36
    v_add_f32 v40, v40, v44
    v_add_f32 v33, v33, v37
    v_add_f32 v41, v41, v45
    v_add_f32 v34, v34, v38
    v_add_f32 v42, v42, v46
    v_add_f32 v35, v35, v39
    v_add_f32 v43, v43, v47
    v_add_f32 v32, v32, v40
    v_add_f32 v33, v33, v41
    v_add_f32 v34, v34, v42
    v_add_f32 v35, v35, v43
    v_cvt_pk_bf16_f32 v32, v32, v33
    v_cvt_pk_bf16_f32 v33, v34, v35
    buffer_store_dwordx2 v[32:33], v4, s[16:19], s30 offen
    s_branch mn_fin
mn_aa:
    v_lshlrev_b32 v1, 4, v0
    v_bfe_u32 v4, v0, 5, 1
    v_lshlrev_b32 v2, 7, v4
    v_bfe_u32 v4, v0, 0, 3
    v_lshl_add_u32 v2, v4, 4, v2
    v_bfe_u32 v4, v0, 5, 1
    v_lshlrev_b32 v3, 8, v4
    v_bfe_u32 v4, v0, 0, 4
    v_lshl_add_u32 v3, v4, 3, v3
    v_bfe_u32 v4, v0, 4, 1
    v_lshl_add_u32 v3, v4, 2, v3
    v_and_b32 v4, 31, v0
    v_lshrrev_b32 v5, 5, v0
    v_lshlrev_b32 v5, 2, v5
    v_sub_u32 v4, v4, v5
    v_mov_b32 v5, 0xff800000
    v_cmp_gt_i32 vcc, 0, v4
    s_nop 1
    v_cndmask_b32 v16, 0, v5, vcc
    v_cmp_gt_i32 vcc, 1, v4
    s_nop 1
    v_cndmask_b32 v17, 0, v5, vcc
    v_cmp_gt_i32 vcc, 2, v4
    s_nop 1
    v_cndmask_b32 v18, 0, v5, vcc
    v_cmp_gt_i32 vcc, 3, v4
    s_nop 1
    v_cndmask_b32 v19, 0, v5, vcc
    v_cmp_gt_i32 vcc, 8, v4
    s_nop 1
    v_cndmask_b32 v20, 0, v5, vcc
    v_cmp_gt_i32 vcc, 9, v4
    s_nop 1
    v_cndmask_b32 v21, 0, v5, vcc
    v_cmp_gt_i32 vcc, 10, v4
    s_nop 1
    v_cndmask_b32 v22, 0, v5, vcc
    v_cmp_gt_i32 vcc, 11, v4
    s_nop 1
    v_cndmask_b32 v23, 0, v5, vcc
    v_cmp_gt_i32 vcc, 16, v4
    s_nop 1
    v_cndmask_b32 v24, 0, v5, vcc
    v_cmp_gt_i32 vcc, 17, v4
    s_nop 1
    v_cndmask_b32 v25, 0, v5, vcc
    v_cmp_gt_i32 vcc, 18, v4
    s_nop 1
    v_cndmask_b32 v26, 0, v5, vcc
    v_cmp_gt_i32 vcc, 19, v4
    s_nop 1
    v_cndmask_b32 v27, 0, v5, vcc
    v_cmp_gt_i32 vcc, 24, v4
    s_nop 1
    v_cndmask_b32 v28, 0, v5, vcc
    v_cmp_gt_i32 vcc, 25, v4
    s_nop 1
    v_cndmask_b32 v29, 0, v5, vcc
    v_cmp_gt_i32 vcc, 26, v4
    s_nop 1
    v_cndmask_b32 v30, 0, v5, vcc
    v_cmp_gt_i32 vcc, 27, v4
    s_nop 1
    v_cndmask_b32 v31, 0, v5, vcc
    v_mov_b64 v[74:75], 0
    v_mov_b64 v[78:79], 0
    v_mov_b64 v[82:83], 0
    v_mov_b64 v[86:87], 0
    v_mov_b64 v[90:91], 0
    s_lshl_b32 s60, s7, 2
    s_add_u32 s60, s60, s4
    s_and_b32 s21, s60, 31
    s_lshr_b32 s20, s60, 5
    s_lshl_b32 s23, s21, 7
    s_add_u32 s24, s23, 146804736
    s_add_u32 s23, s23, 146800640
    s_lshr_b32 s22, s21, 1
    s_lshl_b32 s22, s22, 7
    s_add_u32 s22, s22, 146808832
    s_mov_b32 s25, 0
    s_mov_b32 s26, 0
    s_mov_b32 s32, s20
    s_mov_b32 s30, 0x80000000
    s_mov_b32 s31, 0
    s_mov_b32 s33, 0
    v_lshlrev_b32 v8, 3, v1
aa_loop_261:
    s_lshl_b32 s36, s20, 5
    s_add_u32 s36, s36, s21
    s_lshl_b32 s28, s36, 12
    s_add_u32 s28, s28, 135266304
    s_lshl_b32 s29, s36, 13
    s_add_u32 s29, s29, 100663296
    s_cmp_ge_u32 s20, 0
    s_cselect_b32 s32, 4, 2
    s_add_u32 s32, s32, s20
    s_add_u32 s40, s20, 1
    s_cmp_ge_u32 s31, s40
    s_cselect_b32 s36, s33, 0
    s_cmp_lg_u32 s36, 0
    s_cbranch_scc1 aa_cok_263
    s_waitcnt vmcnt(0)
    v_mov_b32 v5, 1
    s_mov_b64 exec, 1
    buffer_store_dword v5, off, s[12:15], s30 sc1
    s_mov_b64 exec, -1
    s_mov_b32 s30, 0x80000000
    s_cmp_lg_u32 s33, 0
    s_cbranch_scc1 aa_nq_264
    s_add_u32 s36, s20, 1
    s_cmp_ge_u32 s25, s36
    s_cbranch_scc1 aa_ok_265
    s_mov_b32 s39, 0
sp_266:
    buffer_load_dword v4, off, s[12:15], s22 offset:0 sc1
    s_waitcnt vmcnt(0)
    v_readfirstlane_b32 s38, v4
    s_nop 0
    s_cmp_ge_u32 s38, s36
    s_cbranch_scc1 spd_267
    s_add_u32 s39, s39, 1
    s_sleep 4
    s_cmp_lt_u32 s39, 32768
    s_cbranch_scc1 sp_266
spd_267:
    s_mov_b32 s25, s38
aa_ok_265:
    s_cmp_ge_u32 s26, s36
    s_cbranch_scc1 aa_ok_268
    s_cmp_gt_u32 s36, 51
    s_cselect_b32 s41, 4, 0
    s_add_u32 s41, s41, s23
    s_mov_b32 s39, 0
sp_269:
    buffer_load_dword v4, off, s[12:15], s41 offset:0 sc1
    s_waitcnt vmcnt(0)
    v_readfirstlane_b32 s38, v4
    s_nop 0
    s_cmp_ge_u32 s38, s36
    s_cbranch_scc1 spd_270
    s_add_u32 s39, s39, 1
    s_sleep 4
    s_cmp_lt_u32 s39, 32768
    s_cbranch_scc1 sp_269
spd_270:
    s_mov_b32 s26, s38
aa_ok_268:
    s_lshl_b32 s27, s21, 6
    s_add_u32 s27, s27, s20
    s_lshl_b32 s27, s27, 13
    s_add_u32 s37, s27, 0
    buffer_load_dwordx4 a[0:3], v1, s[12:15], s37 offen offset:0 sc1
    buffer_load_dwordx4 a[4:7], v1, s[12:15], s37 offen offset:1024 sc1
    buffer_load_dwordx4 a[8:11], v1, s[12:15], s37 offen offset:2048 sc1
    buffer_load_dwordx4 a[12:15], v1, s[12:15], s37 offen offset:3072 sc1
    s_add_u32 s37, s27, 4096
    buffer_load_dwordx4 a[16:19], v1, s[12:15], s37 offen offset:0 sc1
    buffer_load_dwordx4 a[20:23], v1, s[12:15], s37 offen offset:1024 sc1
    buffer_load_dwordx4 a[24:27], v1, s[12:15], s37 offen offset:2048 sc1
    buffer_load_dwordx4 a[28:31], v1, s[12:15], s37 offen offset:3072 sc1
    s_add_u32 s37, s27, 16777216
    buffer_load_dwordx4 a[32:35], v1, s[12:15], s37 offen offset:0 sc1
    buffer_load_dwordx4 a[36:39], v1, s[12:15], s37 offen offset:1024 sc1
    buffer_load_dwordx4 a[40:43], v1, s[12:15], s37 offen offset:2048 sc1
    buffer_load_dwordx4 a[44:47], v1, s[12:15], s37 offen offset:3072 sc1
    s_add_u32 s37, s27, 16781312
    buffer_load_dwordx4 a[48:51], v1, s[12:15], s37 offen offset:0 sc1
    buffer_load_dwordx4 a[52:55], v1, s[12:15], s37 offen offset:1024 sc1
    buffer_load_dwordx4 a[56:59], v1, s[12:15], s37 offen offset:2048 sc1
    buffer_load_dwordx4 a[60:63], v1, s[12:15], s37 offen offset:3072 sc1
    s_add_u32 s37, s27, 33554432
    buffer_load_dwordx4 a[64:67], v1, s[12:15], s37 offen offset:0 sc1
    buffer_load_dwordx4 a[68:71], v1, s[12:15], s37 offen offset:1024 sc1
    buffer_load_dwordx4 a[72:75], v1, s[12:15], s37 offen offset:2048 sc1
    buffer_load_dwordx4 a[76:79], v1, s[12:15], s37 offen offset:3072 sc1
    s_add_u32 s37, s27, 33558528
    buffer_load_dwordx4 a[80:83], v1, s[12:15], s37 offen offset:0 sc1
    buffer_load_dwordx4 a[84:87], v1, s[12:15], s37 offen offset:1024 sc1
    buffer_load_dwordx4 a[88:91], v1, s[12:15], s37 offen offset:2048 sc1
    buffer_load_dwordx4 a[92:95], v1, s[12:15], s37 offen offset:3072 sc1
aa_nq_264:
    s_mov_b32 s39, 0
sp_271:
    buffer_load_dword v4, off, s[12:15], s24 offset:0 sc1
    s_waitcnt vmcnt(0)
    v_readfirstlane_b32 s38, v4
    s_nop 0
    s_cmp_ge_u32 s38, s40
    s_cbranch_scc1 spd_272
    s_add_u32 s39, s39, 1
    s_sleep 2
    s_cmp_lt_u32 s39, 32768
    s_cbranch_scc1 sp_271
spd_272:
    s_mov_b32 s31, s38
aa_cok_263:
    buffer_load_dword v7, off, s[12:15], s24 sc1
    buffer_load_dwordx4 a[96:99], v2, s[12:15], s28 offen offset:512 sc1
    buffer_load_dwordx4 a[100:103], v2, s[12:15], s28 offen offset:768 sc1
    buffer_load_dwordx4 a[104:107], v2, s[12:15], s28 offen offset:1536 sc1
    buffer_load_dwordx4 a[108:111], v2, s[12:15], s28 offen offset:1792 sc1
    buffer_load_dwordx4 a[112:115], v2, s[12:15], s28 offen offset:2560 sc1
    buffer_load_dwordx4 a[116:119], v2, s[12:15], s28 offen offset:2816 sc1
    buffer_load_dwordx4 a[120:123], v2, s[12:15], s28 offen offset:3584 sc1
    buffer_load_dwordx4 a[124:127], v2, s[12:15], s28 offen offset:3840 sc1
    buffer_load_dword v76, v3, s[12:15], s28 offen offset:0 sc1
    buffer_load_dword v77, v3, s[12:15], s28 offen offset:128 sc1
    buffer_load_dword v80, v3, s[12:15], s28 offen offset:1024 sc1
    buffer_load_dword v81, v3, s[12:15], s28 offen offset:1152 sc1
    buffer_load_dword v84, v3, s[12:15], s28 offen offset:2048 sc1
    buffer_load_dword v85, v3, s[12:15], s28 offen offset:2176 sc1
    buffer_load_dword v88, v3, s[12:15], s28 offen offset:3072 sc1
    buffer_load_dword v89, v3, s[12:15], s28 offen offset:3200 sc1
    s_waitcnt vmcnt(25)
    v_mfma_f32_32x32x16_bf16 v[32:47], a[32:35], a[0:3], v[16:31]
    v_mfma_f32_32x32x16_bf16 v[32:47], a[36:39], a[4:7], v[32:47]
    v_mfma_f32_32x32x16_bf16 v[32:47], a[40:43], a[8:11], v[32:47]
    v_mfma_f32_32x32x16_bf16 v[32:47], a[44:47], a[12:15], v[32:47]
    v_mfma_f32_32x32x16_bf16 v[32:47], a[48:51], a[16:19], v[32:47]
    v_mfma_f32_32x32x16_bf16 v[32:47], a[52:55], a[20:23], v[32:47]
    v_mfma_f32_32x32x16_bf16 v[32:47], a[56:59], a[24:27], v[32:47]
    v_mfma_f32_32x32x16_bf16 v[32:47], a[60:63], a[28:31], v[32:47]
    s_max_u32 s36, s31, 2
    s_min_u32 s36, s36, 61
    s_cmp_gt_u32 s36, s32
    s_cselect_b32 s33, 1, 0
    s_cbranch_scc0 aa_nf_273
    s_add_u32 s36, s32, 1
    s_cmp_ge_u32 s25, s36
    s_cbranch_scc1 aa_ok_274
    s_mov_b32 s39, 0
sp_275:
    buffer_load_dword v4, off, s[12:15], s22 offset:0 sc1
    s_waitcnt vmcnt(0)
    v_readfirstlane_b32 s38, v4
    s_nop 0
    s_cmp_ge_u32 s38, s36
    s_cbranch_scc1 spd_276
    s_add_u32 s39, s39, 1
    s_sleep 4
    s_cmp_lt_u32 s39, 32768
    s_cbranch_scc1 sp_275
spd_276:
    s_mov_b32 s25, s38
aa_ok_274:
    s_cmp_ge_u32 s26, s36
    s_cbranch_scc1 aa_ok_277
    s_cmp_gt_u32 s36, 51
    s_cselect_b32 s41, 4, 0
    s_add_u32 s41, s41, s23
    s_mov_b32 s39, 0
sp_278:
    buffer_load_dword v4, off, s[12:15], s41 offset:0 sc1
    s_waitcnt vmcnt(0)
    v_readfirstlane_b32 s38, v4
    s_nop 0
    s_cmp_ge_u32 s38, s36
    s_cbranch_scc1 spd_279
    s_add_u32 s39, s39, 1
    s_sleep 4
    s_cmp_lt_u32 s39, 32768
    s_cbranch_scc1 sp_278
spd_279:
    s_mov_b32 s26, s38
aa_ok_277:
aa_nf_273:
    s_lshl_b32 s27, s21, 6
    s_add_u32 s27, s27, s32
    s_lshl_b32 s27, s27, 13
    s_cmp_eq_u32 s33, 0
    s_cselect_b32 s27, 0x40000000, s27
    s_add_u32 s37, s27, 0
    buffer_load_dwordx4 a[128:131], v1, s[12:15], s37 offen offset:0 sc1
    buffer_load_dwordx4 a[132:135], v1, s[12:15], s37 offen offset:1024 sc1
    buffer_load_dwordx4 a[136:139], v1, s[12:15], s37 offen offset:2048 sc1
    buffer_load_dwordx4 a[140:143], v1, s[12:15], s37 offen offset:3072 sc1
    s_add_u32 s37, s27, 4096
    buffer_load_dwordx4 a[144:147], v1, s[12:15], s37 offen offset:0 sc1
    buffer_load_dwordx4 a[148:151], v1, s[12:15], s37 offen offset:1024 sc1
    buffer_load_dwordx4 a[152:155], v1, s[12:15], s37 offen offset:2048 sc1
    buffer_load_dwordx4 a[156:159], v1, s[12:15], s37 offen offset:3072 sc1
    s_add_u32 s37, s27, 16777216
    buffer_load_dwordx4 a[160:163], v1, s[12:15], s37 offen offset:0 sc1
    buffer_load_dwordx4 a[164:167], v1, s[12:15], s37 offen offset:1024 sc1
    buffer_load_dwordx4 a[168:171], v1, s[12:15], s37 offen offset:2048 sc1
    buffer_load_dwordx4 a[172:175], v1, s[12:15], s37 offen offset:3072 sc1
    s_add_u32 s37, s27, 16781312
    buffer_load_dwordx4 a[176:179], v1, s[12:15], s37 offen offset:0 sc1
    buffer_load_dwordx4 a[180:183], v1, s[12:15], s37 offen offset:1024 sc1
    buffer_load_dwordx4 a[184:187], v1, s[12:15], s37 offen offset:2048 sc1
    buffer_load_dwordx4 a[188:191], v1, s[12:15], s37 offen offset:3072 sc1
    s_add_u32 s37, s27, 33554432
    buffer_load_dwordx4 a[192:195], v1, s[12:15], s37 offen offset:0 sc1
    buffer_load_dwordx4 a[196:199], v1, s[12:15], s37 offen offset:1024 sc1
    buffer_load_dwordx4 a[200:203], v1, s[12:15], s37 offen offset:2048 sc1
    buffer_load_dwordx4 a[204:207], v1, s[12:15], s37 offen offset:3072 sc1
    s_add_u32 s37, s27, 33558528
    buffer_load_dwordx4 a[208:211], v1, s[12:15], s37 offen offset:0 sc1
    buffer_load_dwordx4 a[212:215], v1, s[12:15], s37 offen offset:1024 sc1
    buffer_load_dwordx4 a[216:219], v1, s[12:15], s37 offen offset:2048 sc1
    buffer_load_dwordx4 a[220:223], v1, s[12:15], s37 offen offset:3072 sc1
    v_max3_f32 v4, v32, v33, v34
    v_max3_f32 v4, v4, v35, v36
    v_max3_f32 v4, v4, v37, v38
    v_max3_f32 v4, v4, v39, v40
    v_max3_f32 v4, v4, v41, v42
    v_max3_f32 v4, v4, v43, v44
    v_max3_f32 v4, v4, v45, v46
    s_waitcnt vmcnt(32)
    v_readfirstlane_b32 s31, v7
    v_mov_b32 v5, 1
    s_mov_b64 exec, 1
    buffer_store_dword v5, off, s[12:15], s30 sc1
    s_mov_b64 exec, -1
    s_mov_b32 s30, 0x80000000
    v_mfma_f32_32x32x16_bf16 v[48:63], a[96:99], a[0:3], 0
    v_mfma_f32_32x32x16_bf16 v[48:63], a[100:103], a[4:7], v[48:63]
    v_mfma_f32_32x32x16_bf16 v[48:63], a[104:107], a[8:11], v[48:63]
    v_mfma_f32_32x32x16_bf16 v[48:63], a[108:111], a[12:15], v[48:63]
    v_mfma_f32_32x32x16_bf16 v[48:63], a[112:115], a[16:19], v[48:63]
    v_mfma_f32_32x32x16_bf16 v[48:63], a[116:119], a[20:23], v[48:63]
    v_mfma_f32_32x32x16_bf16 v[48:63], a[120:123], a[24:27], v[48:63]
    v_mfma_f32_32x32x16_bf16 v[48:63], a[124:127], a[28:31], v[48:63]
    s_nop 11
    v_max3_f32 v4, v4, v47, v48
    v_max3_f32 v4, v4, v49, v50
    v_max_f32 v4, v4, v51
    v_mov_b32 v5, v4
    s_nop 1
    v_permlane32_swap_b32 v4, v5
    v_max_f32 v4, v4, v5
    v_sub_f32 v32, v32, v4
    v_sub_f32 v33, v33, v4
    v_sub_f32 v34, v34, v4
    v_sub_f32 v35, v35, v4
    v_sub_f32 v36, v36, v4
    v_sub_f32 v37, v37, v4
    v_sub_f32 v38, v38, v4
    v_sub_f32 v39, v39, v4
    v_sub_f32 v40, v40, v4
    v_sub_f32 v41, v41, v4
    v_sub_f32 v42, v42, v4
    v_sub_f32 v43, v43, v4
    v_sub_f32 v44, v44, v4
    v_sub_f32 v45, v45, v4
    v_sub_f32 v46, v46, v4
    v_sub_f32 v47, v47, v4
    v_sub_f32 v48, v48, v4
    v_sub_f32 v49, v49, v4
    v_sub_f32 v50, v50, v4
    v_sub_f32 v51, v51, v4
    v_exp_f32 v32, v32
    v_exp_f32 v33, v33
    v_exp_f32 v34, v34
    v_exp_f32 v35, v35
    v_exp_f32 v36, v36
    v_exp_f32 v37, v37
    v_exp_f32 v38, v38
    v_exp_f32 v39, v39
    v_exp_f32 v40, v40
    v_exp_f32 v41, v41
    v_exp_f32 v42, v42
    v_exp_f32 v43, v43
    v_exp_f32 v44, v44
    v_exp_f32 v45, v45
    v_exp_f32 v46, v46
    v_exp_f32 v47, v47
    v_exp_f32 v48, v48
    v_exp_f32 v49, v49
    v_exp_f32 v50, v50
    v_exp_f32 v51, v51
    v_cvt_pk_bf16_f32 v64, v32, v33
    v_cvt_pk_bf16_f32 v65, v34, v35
    v_cvt_pk_bf16_f32 v66, v36, v37
    v_cvt_pk_bf16_f32 v67, v38, v39
    v_cvt_pk_bf16_f32 v68, v40, v41
    v_cvt_pk_bf16_f32 v69, v42, v43
    v_cvt_pk_bf16_f32 v70, v44, v45
    v_cvt_pk_bf16_f32 v71, v46, v47
    v_cvt_pk_bf16_f32 v72, v48, v49
    v_cvt_pk_bf16_f32 v73, v50, v51
    s_waitcnt vmcnt(25)
    v_mfma_f32_32x32x16_bf16 v[96:111], a[64:67], v[64:67], 0
    v_add_f32 v6, v32, v33
    v_add_f32 v6, v6, v34
    v_add_f32 v6, v6, v35
    v_add_f32 v6, v6, v36
    v_add_f32 v6, v6, v37
    v_add_f32 v6, v6, v38
    v_mfma_f32_32x32x16_bf16 v[96:111], a[68:71], v[68:71], v[96:111]
    v_add_f32 v6, v6, v39
    v_add_f32 v6, v6, v40
    v_add_f32 v6, v6, v41
    v_add_f32 v6, v6, v42
    v_add_f32 v6, v6, v43
    v_add_f32 v6, v6, v44
    v_mfma_f32_32x32x16_bf16 v[96:111], v[76:79], v[72:75], v[96:111]
    v_add_f32 v6, v6, v45
    v_add_f32 v6, v6, v46
    v_add_f32 v6, v6, v47
    v_add_f32 v6, v6, v48
    v_add_f32 v6, v6, v49
    v_add_f32 v6, v6, v50
    v_mfma_f32_32x32x16_bf16 v[112:127], a[72:75], v[64:67], 0
    v_add_f32 v6, v6, v51
    v_mov_b32 v5, v6
    s_nop 1
    v_permlane32_swap_b32 v6, v5
    v_add_f32 v6, v6, v5
    v_rcp_f32 v6, v6
    v_mfma_f32_32x32x16_bf16 v[112:127], a[76:79], v[68:71], v[112:127]
    v_mul_f32 v96, v96, v6
    v_mul_f32 v97, v97, v6
    v_mul_f32 v98, v98, v6
    v_mul_f32 v99, v99, v6
    v_mul_f32 v100, v100, v6
    v_mul_f32 v101, v101, v6
    v_mfma_f32_32x32x16_bf16 v[112:127], v[80:83], v[72:75], v[112:127]
    v_mul_f32 v102, v102, v6
    v_mul_f32 v103, v103, v6
    v_cvt_pk_bf16_f32 v160, v96, v97
    v_cvt_pk_bf16_f32 v161, v98, v99
    v_cvt_pk_bf16_f32 v162, v100, v101
    v_cvt_pk_bf16_f32 v163, v102, v103
    v_mfma_f32_32x32x16_bf16 v[128:143], a[80:83], v[64:67], 0
    buffer_store_dwordx4 v[160:163], v1, s[12:15], s29 offen offset:0 sc1
    v_mul_f32 v104, v104, v6
    v_mul_f32 v105, v105, v6
    v_mul_f32 v106, v106, v6
    v_mul_f32 v107, v107, v6
    v_mul_f32 v108, v108, v6
    v_mfma_f32_32x32x16_bf16 v[128:143], a[84:87], v[68:71], v[128:143]
    v_mul_f32 v109, v109, v6
    v_mul_f32 v110, v110, v6
    v_mul_f32 v111, v111, v6
    v_cvt_pk_bf16_f32 v164, v104, v105
    v_cvt_pk_bf16_f32 v165, v106, v107
    v_cvt_pk_bf16_f32 v166, v108, v109
    v_mfma_f32_32x32x16_bf16 v[128:143], v[84:87], v[72:75], v[128:143]
    v_cvt_pk_bf16_f32 v167, v110, v111
    buffer_store_dwordx4 v[164:167], v1, s[12:15], s29 offen offset:1024 sc1
    v_mul_f32 v112, v112, v6
    v_mul_f32 v113, v113, v6
    v_mul_f32 v114, v114, v6
    v_mul_f32 v115, v115, v6
    v_mfma_f32_32x32x16_bf16 v[144:159], a[88:91], v[64:67], 0
    v_mul_f32 v116, v116, v6
    v_mul_f32 v117, v117, v6
    v_mul_f32 v118, v118, v6
    v_mul_f32 v119, v119, v6
    v_cvt_pk_bf16_f32 v168, v112, v113
    v_cvt_pk_bf16_f32 v169, v114, v115
    v_mfma_f32_32x32x16_bf16 v[144:159], a[92:95], v[68:71], v[144:159]
    v_cvt_pk_bf16_f32 v170, v116, v117
    v_cvt_pk_bf16_f32 v171, v118, v119
    buffer_store_dwordx4 v[168:171], v1, s[12:15], s29 offen offset:2048 sc1
    v_mul_f32 v120, v120, v6
    v_mul_f32 v121, v121, v6
    v_mul_f32 v122, v122, v6
    v_mfma_f32_32x32x16_bf16 v[144:159], v[88:91], v[72:75], v[144:159]
    v_mul_f32 v123, v123, v6
    v_mul_f32 v124, v124, v6
    v_mul_f32 v125, v125, v6
    v_mul_f32 v126, v126, v6
    v_mul_f32 v127, v127, v6
    v_cvt_pk_bf16_f32 v172, v120, v121
    v_cvt_pk_bf16_f32 v173, v122, v123
    v_cvt_pk_bf16_f32 v174, v124, v125
    v_cvt_pk_bf16_f32 v175, v126, v127
    buffer_store_dwordx4 v[172:175], v1, s[12:15], s29 offen offset:3072 sc1
    v_mul_f32 v128, v128, v6
    v_mul_f32 v129, v129, v6
    v_mul_f32 v130, v130, v6
    v_mul_f32 v131, v131, v6
    v_mul_f32 v132, v132, v6
    v_mul_f32 v133, v133, v6
    v_mul_f32 v134, v134, v6
    v_mul_f32 v135, v135, v6
    v_cvt_pk_bf16_f32 v176, v128, v129
    v_cvt_pk_bf16_f32 v177, v130, v131
    v_cvt_pk_bf16_f32 v178, v132, v133
    v_cvt_pk_bf16_f32 v179, v134, v135
    s_add_u32 s29, s29, 4096
    buffer_store_dwordx4 v[176:179], v1, s[12:15], s29 offen offset:0 sc1
    v_mul_f32 v136, v136, v6
    v_mul_f32 v137, v137, v6
    v_mul_f32 v138, v138, v6
    v_mul_f32 v139, v139, v6
    v_mul_f32 v140, v140, v6
    v_mul_f32 v141, v141, v6
    v_mul_f32 v142, v142, v6
    v_mul_f32 v143, v143, v6
    v_cvt_pk_bf16_f32 v180, v136, v137
    v_cvt_pk_bf16_f32 v181, v138, v139
    v_cvt_pk_bf16_f32 v182, v140, v141
    v_cvt_pk_bf16_f32 v183, v142, v143
    buffer_store_dwordx4 v[180:183], v1, s[12:15], s29 offen offset:1024 sc1
    v_mul_f32 v144, v144, v6
    v_mul_f32 v145, v145, v6
    v_mul_f32 v146, v146, v6
    v_mul_f32 v147, v147, v6
    v_mul_f32 v148, v148, v6
    v_mul_f32 v149, v149, v6
    v_mul_f32 v150, v150, v6
    v_mul_f32 v151, v151, v6
    v_cvt_pk_bf16_f32 v184, v144, v145
    v_cvt_pk_bf16_f32 v185, v146, v147
    v_cvt_pk_bf16_f32 v186, v148, v149
    v_cvt_pk_bf16_f32 v187, v150, v151
    buffer_store_dwordx4 v[184:187], v1, s[12:15], s29 offen offset:2048 sc1
    v_mul_f32 v152, v152, v6
    v_mul_f32 v153, v153, v6
    v_mul_f32 v154, v154, v6
    v_mul_f32 v155, v155, v6
    v_mul_f32 v156, v156, v6
    v_mul_f32 v157, v157, v6
    v_mul_f32 v158, v158, v6
    v_mul_f32_e64 v159, v159, v6
    v_cvt_pk_bf16_f32 v188, v152, v153
    v_cvt_pk_bf16_f32 v189, v154, v155
    v_cvt_pk_bf16_f32 v190, v156, v157
    v_cvt_pk_bf16_f32 v191, v158, v159
    buffer_store_dwordx4 v[188:191], v1, s[12:15], s29 offen offset:3072 sc1
    s_lshl_b32 s30, s20, 5
    s_add_u32 s30, s30, s21
    s_lshl_b32 s30, s30, 2
    s_add_u32 s30, s30, 146821120
    s_mov_b32 s20, s32
    s_cmp_ge_u32 s20, 61
    s_cbranch_scc1 aa_done_262
    s_lshl_b32 s36, s20, 5
    s_add_u32 s36, s36, s21
    s_lshl_b32 s28, s36, 12
    s_add_u32 s28, s28, 135266304
    s_lshl_b32 s29, s36, 13
    s_add_u32 s29, s29, 100663296
    s_cmp_ge_u32 s20, 0
    s_cselect_b32 s32, 4, 2
    s_add_u32 s32, s32, s20
    s_add_u32 s40, s20, 1
    s_cmp_ge_u32 s31, s40
    s_cselect_b32 s36, s33, 0
    s_cmp_lg_u32 s36, 0
    s_cbranch_scc1 aa_cok_280
    s_waitcnt vmcnt(0)
    v_mov_b32 v5, 1
    s_mov_b64 exec, 1
    buffer_store_dword v5, off, s[12:15], s30 sc1
    s_mov_b64 exec, -1
    s_mov_b32 s30, 0x80000000
    s_cmp_lg_u32 s33, 0
    s_cbranch_scc1 aa_nq_281
    s_add_u32 s36, s20, 1
    s_cmp_ge_u32 s25, s36
    s_cbranch_scc1 aa_ok_282
    s_mov_b32 s39, 0
sp_283:
    buffer_load_dword v4, off, s[12:15], s22 offset:0 sc1
    s_waitcnt vmcnt(0)
    v_readfirstlane_b32 s38, v4
    s_nop 0
    s_cmp_ge_u32 s38, s36
    s_cbranch_scc1 spd_284
    s_add_u32 s39, s39, 1
    s_sleep 4
    s_cmp_lt_u32 s39, 32768
    s_cbranch_scc1 sp_283
spd_284:
    s_mov_b32 s25, s38
aa_ok_282:
    s_cmp_ge_u32 s26, s36
    s_cbranch_scc1 aa_ok_285
    s_cmp_gt_u32 s36, 51
    s_cselect_b32 s41, 4, 0
    s_add_u32 s41, s41, s23
    s_mov_b32 s39, 0
sp_286:
    buffer_load_dword v4, off, s[12:15], s41 offset:0 sc1
    s_waitcnt vmcnt(0)
    v_readfirstlane_b32 s38, v4
    s_nop 0
    s_cmp_ge_u32 s38, s36
    s_cbranch_scc1 spd_287
    s_add_u32 s39, s39, 1
    s_sleep 4
    s_cmp_lt_u32 s39, 32768
    s_cbranch_scc1 sp_286
spd_287:
    s_mov_b32 s26, s38
aa_ok_285:
    s_lshl_b32 s27, s21, 6
    s_add_u32 s27, s27, s20
    s_lshl_b32 s27, s27, 13
    s_add_u32 s37, s27, 0
    buffer_load_dwordx4 a[128:131], v1, s[12:15], s37 offen offset:0 sc1
    buffer_load_dwordx4 a[132:135], v1, s[12:15], s37 offen offset:1024 sc1
    buffer_load_dwordx4 a[136:139], v1, s[12:15], s37 offen offset:2048 sc1
    buffer_load_dwordx4 a[140:143], v1, s[12:15], s37 offen offset:3072 sc1
    s_add_u32 s37, s27, 4096
    buffer_load_dwordx4 a[144:147], v1, s[12:15], s37 offen offset:0 sc1
    buffer_load_dwordx4 a[148:151], v1, s[12:15], s37 offen offset:1024 sc1
    buffer_load_dwordx4 a[152:155], v1, s[12:15], s37 offen offset:2048 sc1
    buffer_load_dwordx4 a[156:159], v1, s[12:15], s37 offen offset:3072 sc1
    s_add_u32 s37, s27, 16777216
    buffer_load_dwordx4 a[160:163], v1, s[12:15], s37 offen offset:0 sc1
    buffer_load_dwordx4 a[164:167], v1, s[12:15], s37 offen offset:1024 sc1
    buffer_load_dwordx4 a[168:171], v1, s[12:15], s37 offen offset:2048 sc1
    buffer_load_dwordx4 a[172:175], v1, s[12:15], s37 offen offset:3072 sc1
    s_add_u32 s37, s27, 16781312
    buffer_load_dwordx4 a[176:179], v1, s[12:15], s37 offen offset:0 sc1
    buffer_load_dwordx4 a[180:183], v1, s[12:15], s37 offen offset:1024 sc1
    buffer_load_dwordx4 a[184:187], v1, s[12:15], s37 offen offset:2048 sc1
    buffer_load_dwordx4 a[188:191], v1, s[12:15], s37 offen offset:3072 sc1
    s_add_u32 s37, s27, 33554432
    buffer_load_dwordx4 a[192:195], v1, s[12:15], s37 offen offset:0 sc1
    buffer_load_dwordx4 a[196:199], v1, s[12:15], s37 offen offset:1024 sc1
    buffer_load_dwordx4 a[200:203], v1, s[12:15], s37 offen offset:2048 sc1
    buffer_load_dwordx4 a[204:207], v1, s[12:15], s37 offen offset:3072 sc1
    s_add_u32 s37, s27, 33558528
    buffer_load_dwordx4 a[208:211], v1, s[12:15], s37 offen offset:0 sc1
    buffer_load_dwordx4 a[212:215], v1, s[12:15], s37 offen offset:1024 sc1
    buffer_load_dwordx4 a[216:219], v1, s[12:15], s37 offen offset:2048 sc1
    buffer_load_dwordx4 a[220:223], v1, s[12:15], s37 offen offset:3072 sc1
aa_nq_281:
    s_mov_b32 s39, 0
sp_288:
    buffer_load_dword v4, off, s[12:15], s24 offset:0 sc1
    s_waitcnt vmcnt(0)
    v_readfirstlane_b32 s38, v4
    s_nop 0
    s_cmp_ge_u32 s38, s40
    s_cbranch_scc1 spd_289
    s_add_u32 s39, s39, 1
    s_sleep 2
    s_cmp_lt_u32 s39, 32768
    s_cbranch_scc1 sp_288
spd_289:
    s_mov_b32 s31, s38
aa_cok_280:
    buffer_load_dword v7, off, s[12:15], s24 sc1
    buffer_load_dwordx4 a[96:99], v2, s[12:15], s28 offen offset:512 sc1
    buffer_load_dwordx4 a[100:103], v2, s[12:15], s28 offen offset:768 sc1
    buffer_load_dwordx4 a[104:107], v2, s[12:15], s28 offen offset:1536 sc1
    buffer_load_dwordx4 a[108:111], v2, s[12:15], s28 offen offset:1792 sc1
    buffer_load_dwordx4 a[112:115], v2, s[12:15], s28 offen offset:2560 sc1
    buffer_load_dwordx4 a[116:119], v2, s[12:15], s28 offen offset:2816 sc1
    buffer_load_dwordx4 a[120:123], v2, s[12:15], s28 offen offset:3584 sc1
    buffer_load_dwordx4 a[124:127], v2, s[12:15], s28 offen offset:3840 sc1
    buffer_load_dword v76, v3, s[12:15], s28 offen offset:0 sc1
    buffer_load_dword v77, v3, s[12:15], s28 offen offset:128 sc1
    buffer_load_dword v80, v3, s[12:15], s28 offen offset:1024 sc1
    buffer_load_dword v81, v3, s[12:15], s28 offen offset:1152 sc1
    buffer_load_dword v84, v3, s[12:15], s28 offen offset:2048 sc1
    buffer_load_dword v85, v3, s[12:15], s28 offen offset:2176 sc1
    buffer_load_dword v88, v3, s[12:15], s28 offen offset:3072 sc1
    buffer_load_dword v89, v3, s[12:15], s28 offen offset:3200 sc1
    s_waitcnt vmcnt(25)
    v_mfma_f32_32x32x16_bf16 v[32:47], a[160:163], a[128:131], v[16:31]
    v_mfma_f32_32x32x16_bf16 v[32:47], a[164:167], a[132:135], v[32:47]
    v_mfma_f32_32x32x16_bf16 v[32:47], a[168:171], a[136:139], v[32:47]
    v_mfma_f32_32x32x16_bf16 v[32:47], a[172:175], a[140:143], v[32:47]
    v_mfma_f32_32x32x16_bf16 v[32:47], a[176:179], a[144:147], v[32:47]
    v_mfma_f32_32x32x16_bf16 v[32:47], a[180:183], a[148:151], v[32:47]
    v_mfma_f32_32x32x16_bf16 v[32:47], a[184:187], a[152:155], v[32:47]
    v_mfma_f32_32x32x16_bf16 v[32:47], a[188:191], a[156:159], v[32:47]
    s_max_u32 s36, s31, 2
    s_min_u32 s36, s36, 61
    s_cmp_gt_u32 s36, s32
    s_cselect_b32 s33, 1, 0
    s_cbranch_scc0 aa_nf_290
    s_add_u32 s36, s32, 1
    s_cmp_ge_u32 s25, s36
    s_cbranch_scc1 aa_ok_291
    s_mov_b32 s39, 0
sp_292:
    buffer_load_dword v4, off, s[12:15], s22 offset:0 sc1
    s_waitcnt vmcnt(0)
    v_readfirstlane_b32 s38, v4
    s_nop 0
    s_cmp_ge_u32 s38, s36
    s_cbranch_scc1 spd_293
    s_add_u32 s39, s39, 1
    s_sleep 4
    s_cmp_lt_u32 s39, 32768
    s_cbranch_scc1 sp_292
spd_293:
    s_mov_b32 s25, s38
aa_ok_291:
    s_cmp_ge_u32 s26, s36
    s_cbranch_scc1 aa_ok_294
    s_cmp_gt_u32 s36, 51
    s_cselect_b32 s41, 4, 0
    s_add_u32 s41, s41, s23
    s_mov_b32 s39, 0
sp_295:
    buffer_load_dword v4, off, s[12:15], s41 offset:0 sc1
    s_waitcnt vmcnt(0)
    v_readfirstlane_b32 s38, v4
    s_nop 0
    s_cmp_ge_u32 s38, s36
    s_cbranch_scc1 spd_296
    s_add_u32 s39, s39, 1
    s_sleep 4
    s_cmp_lt_u32 s39, 32768
    s_cbranch_scc1 sp_295
spd_296:
    s_mov_b32 s26, s38
aa_ok_294:
aa_nf_290:
    s_lshl_b32 s27, s21, 6
    s_add_u32 s27, s27, s32
    s_lshl_b32 s27, s27, 13
    s_cmp_eq_u32 s33, 0
    s_cselect_b32 s27, 0x40000000, s27
    s_add_u32 s37, s27, 0
    buffer_load_dwordx4 a[0:3], v1, s[12:15], s37 offen offset:0 sc1
    buffer_load_dwordx4 a[4:7], v1, s[12:15], s37 offen offset:1024 sc1
    buffer_load_dwordx4 a[8:11], v1, s[12:15], s37 offen offset:2048 sc1
    buffer_load_dwordx4 a[12:15], v1, s[12:15], s37 offen offset:3072 sc1
    s_add_u32 s37, s27, 4096
    buffer_load_dwordx4 a[16:19], v1, s[12:15], s37 offen offset:0 sc1
    buffer_load_dwordx4 a[20:23], v1, s[12:15], s37 offen offset:1024 sc1
    buffer_load_dwordx4 a[24:27], v1, s[12:15], s37 offen offset:2048 sc1
    buffer_load_dwordx4 a[28:31], v1, s[12:15], s37 offen offset:3072 sc1
    s_add_u32 s37, s27, 16777216
    buffer_load_dwordx4 a[32:35], v1, s[12:15], s37 offen offset:0 sc1
    buffer_load_dwordx4 a[36:39], v1, s[12:15], s37 offen offset:1024 sc1
    buffer_load_dwordx4 a[40:43], v1, s[12:15], s37 offen offset:2048 sc1
    buffer_load_dwordx4 a[44:47], v1, s[12:15], s37 offen offset:3072 sc1
    s_add_u32 s37, s27, 16781312
    buffer_load_dwordx4 a[48:51], v1, s[12:15], s37 offen offset:0 sc1
    buffer_load_dwordx4 a[52:55], v1, s[12:15], s37 offen offset:1024 sc1
    buffer_load_dwordx4 a[56:59], v1, s[12:15], s37 offen offset:2048 sc1
    buffer_load_dwordx4 a[60:63], v1, s[12:15], s37 offen offset:3072 sc1
    s_add_u32 s37, s27, 33554432
    buffer_load_dwordx4 a[64:67], v1, s[12:15], s37 offen offset:0 sc1
    buffer_load_dwordx4 a[68:71], v1, s[12:15], s37 offen offset:1024 sc1
    buffer_load_dwordx4 a[72:75], v1, s[12:15], s37 offen offset:2048 sc1
    buffer_load_dwordx4 a[76:79], v1, s[12:15], s37 offen offset:3072 sc1
    s_add_u32 s37, s27, 33558528
    buffer_load_dwordx4 a[80:83], v1, s[12:15], s37 offen offset:0 sc1
    buffer_load_dwordx4 a[84:87], v1, s[12:15], s37 offen offset:1024 sc1
    buffer_load_dwordx4 a[88:91], v1, s[12:15], s37 offen offset:2048 sc1
    buffer_load_dwordx4 a[92:95], v1, s[12:15], s37 offen offset:3072 sc1
    v_max3_f32 v4, v32, v33, v34
    v_max3_f32 v4, v4, v35, v36
    v_max3_f32 v4, v4, v37, v38
    v_max3_f32 v4, v4, v39, v40
    v_max3_f32 v4, v4, v41, v42
    v_max3_f32 v4, v4, v43, v44
    v_max3_f32 v4, v4, v45, v46
    s_waitcnt vmcnt(32)
    v_readfirstlane_b32 s31, v7
    v_mov_b32 v5, 1
    s_mov_b64 exec, 1
    buffer_store_dword v5, off, s[12:15], s30 sc1
    s_mov_b64 exec, -1
    s_mov_b32 s30, 0x80000000
    v_mfma_f32_32x32x16_bf16 v[48:63], a[96:99], a[128:131], 0
    v_mfma_f32_32x32x16_bf16 v[48:63], a[100:103], a[132:135], v[48:63]
    v_mfma_f32_32x32x16_bf16 v[48:63], a[104:107], a[136:139], v[48:63]
    v_mfma_f32_32x32x16_bf16 v[48:63], a[108:111], a[140:143], v[48:63]
    v_mfma_f32_32x32x16_bf16 v[48:63], a[112:115], a[144:147], v[48:63]
    v_mfma_f32_32x32x16_bf16 v[48:63], a[116:119], a[148:151], v[48:63]
    v_mfma_f32_32x32x16_bf16 v[48:63], a[120:123], a[152:155], v[48:63]
    v_mfma_f32_32x32x16_bf16 v[48:63], a[124:127], a[156:159], v[48:63]
    s_nop 11
    v_max3_f32 v4, v4, v47, v48
    v_max3_f32 v4, v4, v49, v50
    v_max_f32 v4, v4, v51
    v_mov_b32 v5, v4
    s_nop 1
    v_permlane32_swap_b32 v4, v5
    v_max_f32 v4, v4, v5
    v_sub_f32 v32, v32, v4
    v_sub_f32 v33, v33, v4
    v_sub_f32 v34, v34, v4
    v_sub_f32 v35, v35, v4
    v_sub_f32 v36, v36, v4
    v_sub_f32 v37, v37, v4
    v_sub_f32 v38, v38, v4
    v_sub_f32 v39, v39, v4
    v_sub_f32 v40, v40, v4
    v_sub_f32 v41, v41, v4
    v_sub_f32 v42, v42, v4
    v_sub_f32 v43, v43, v4
    v_sub_f32 v44, v44, v4
    v_sub_f32 v45, v45, v4
    v_sub_f32 v46, v46, v4
    v_sub_f32 v47, v47, v4
    v_sub_f32 v48, v48, v4
    v_sub_f32 v49, v49, v4
    v_sub_f32 v50, v50, v4
    v_sub_f32 v51, v51, v4
    v_exp_f32 v32, v32
    v_exp_f32 v33, v33
    v_exp_f32 v34, v34
    v_exp_f32 v35, v35
    v_exp_f32 v36, v36
    v_exp_f32 v37, v37
    v_exp_f32 v38, v38
    v_exp_f32 v39, v39
    v_exp_f32 v40, v40
    v_exp_f32 v41, v41
    v_exp_f32 v42, v42
    v_exp_f32 v43, v43
    v_exp_f32 v44, v44
    v_exp_f32 v45, v45
    v_exp_f32 v46, v46
    v_exp_f32 v47, v47
    v_exp_f32 v48, v48
    v_exp_f32 v49, v49
    v_exp_f32 v50, v50
    v_exp_f32 v51, v51
    v_cvt_pk_bf16_f32 v64, v32, v33
    v_cvt_pk_bf16_f32 v65, v34, v35
    v_cvt_pk_bf16_f32 v66, v36, v37
    v_cvt_pk_bf16_f32 v67, v38, v39
    v_cvt_pk_bf16_f32 v68, v40, v41
    v_cvt_pk_bf16_f32 v69, v42, v43
    v_cvt_pk_bf16_f32 v70, v44, v45
    v_cvt_pk_bf16_f32 v71, v46, v47
    v_cvt_pk_bf16_f32 v72, v48, v49
    v_cvt_pk_bf16_f32 v73, v50, v51
    s_waitcnt vmcnt(25)
    v_mfma_f32_32x32x16_bf16 v[96:111], a[192:195], v[64:67], 0
    v_add_f32 v6, v32, v33
    v_add_f32 v6, v6, v34
    v_add_f32 v6, v6, v35
    v_add_f32 v6, v6, v36
    v_add_f32 v6, v6, v37
    v_add_f32 v6, v6, v38
    v_mfma_f32_32x32x16_bf16 v[96:111], a[196:199], v[68:71], v[96:111]
    v_add_f32 v6, v6, v39
    v_add_f32 v6, v6, v40
    v_add_f32 v6, v6, v41
    v_add_f32 v6, v6, v42
    v_add_f32 v6, v6, v43
    v_add_f32 v6, v6, v44
    v_mfma_f32_32x32x16_bf16 v[96:111], v[76:79], v[72:75], v[96:111]
    v_add_f32 v6, v6, v45
    v_add_f32 v6, v6, v46
    v_add_f32 v6, v6, v47
    v_add_f32 v6, v6, v48
    v_add_f32 v6, v6, v49
    v_add_f32 v6, v6, v50
    v_mfma_f32_32x32x16_bf16 v[112:127], a[200:203], v[64:67], 0
    v_add_f32 v6, v6, v51
    v_mov_b32 v5, v6
    s_nop 1
    v_permlane32_swap_b32 v6, v5
    v_add_f32 v6, v6, v5
    v_rcp_f32 v6, v6
    v_mfma_f32_32x32x16_bf16 v[112:127], a[204:207], v[68:71], v[112:127]
    v_mul_f32 v96, v96, v6
    v_mul_f32 v97, v97, v6
    v_mul_f32 v98, v98, v6
    v_mul_f32 v99, v99, v6
    v_mul_f32 v100, v100, v6
    v_mul_f32 v101, v101, v6
    v_mfma_f32_32x32x16_bf16 v[112:127], v[80:83], v[72:75], v[112:127]
    v_mul_f32 v102, v102, v6
    v_mul_f32 v103, v103, v6
    v_cvt_pk_bf16_f32 v160, v96, v97
    v_cvt_pk_bf16_f32 v161, v98, v99
    v_cvt_pk_bf16_f32 v162, v100, v101
    v_cvt_pk_bf16_f32 v163, v102, v103
    v_mfma_f32_32x32x16_bf16 v[128:143], a[208:211], v[64:67], 0
    buffer_store_dwordx4 v[160:163], v1, s[12:15], s29 offen offset:0 sc1
    v_mul_f32 v104, v104, v6
    v_mul_f32 v105, v105, v6
    v_mul_f32 v106, v106, v6
    v_mul_f32 v107, v107, v6
    v_mul_f32 v108, v108, v6
    v_mfma_f32_32x32x16_bf16 v[128:143], a[212:215], v[68:71], v[128:143]
    v_mul_f32 v109, v109, v6
    v_mul_f32 v110, v110, v6
    v_mul_f32 v111, v111, v6
    v_cvt_pk_bf16_f32 v164, v104, v105
    v_cvt_pk_bf16_f32 v165, v106, v107
    v_cvt_pk_bf16_f32 v166, v108, v109
    v_mfma_f32_32x32x16_bf16 v[128:143], v[84:87], v[72:75], v[128:143]
    v_cvt_pk_bf16_f32 v167, v110, v111
    buffer_store_dwordx4 v[164:167], v1, s[12:15], s29 offen offset:1024 sc1
    v_mul_f32 v112, v112, v6
    v_mul_f32 v113, v113, v6
    v_mul_f32 v114, v114, v6
    v_mul_f32 v115, v115, v6
    v_mfma_f32_32x32x16_bf16 v[144:159], a[216:219], v[64:67], 0
    v_mul_f32 v116, v116, v6
    v_mul_f32 v117, v117, v6
    v_mul_f32 v118, v118, v6
    v_mul_f32 v119, v119, v6
    v_cvt_pk_bf16_f32 v168, v112, v113
    v_cvt_pk_bf16_f32 v169, v114, v115
    v_mfma_f32_32x32x16_bf16 v[144:159], a[220:223], v[68:71], v[144:159]
    v_cvt_pk_bf16_f32 v170, v116, v117
    v_cvt_pk_bf16_f32 v171, v118, v119
    buffer_store_dwordx4 v[168:171], v1, s[12:15], s29 offen offset:2048 sc1
    v_mul_f32 v120, v120, v6
    v_mul_f32 v121, v121, v6
    v_mul_f32 v122, v122, v6
    v_mfma_f32_32x32x16_bf16 v[144:159], v[88:91], v[72:75], v[144:159]
    v_mul_f32 v123, v123, v6
    v_mul_f32 v124, v124, v6
    v_mul_f32 v125, v125, v6
    v_mul_f32 v126, v126, v6
    v_mul_f32 v127, v127, v6
    v_cvt_pk_bf16_f32 v172, v120, v121
    v_cvt_pk_bf16_f32 v173, v122, v123
    v_cvt_pk_bf16_f32 v174, v124, v125
    v_cvt_pk_bf16_f32 v175, v126, v127
    buffer_store_dwordx4 v[172:175], v1, s[12:15], s29 offen offset:3072 sc1
    v_mul_f32 v128, v128, v6
    v_mul_f32 v129, v129, v6
    v_mul_f32 v130, v130, v6
    v_mul_f32 v131, v131, v6
    v_mul_f32 v132, v132, v6
    v_mul_f32 v133, v133, v6
    v_mul_f32 v134, v134, v6
    v_mul_f32 v135, v135, v6
    v_cvt_pk_bf16_f32 v176, v128, v129
    v_cvt_pk_bf16_f32 v177, v130, v131
    v_cvt_pk_bf16_f32 v178, v132, v133
    v_cvt_pk_bf16_f32 v179, v134, v135
    s_add_u32 s29, s29, 4096
    buffer_store_dwordx4 v[176:179], v1, s[12:15], s29 offen offset:0 sc1
    v_mul_f32 v136, v136, v6
    v_mul_f32 v137, v137, v6
    v_mul_f32 v138, v138, v6
    v_mul_f32 v139, v139, v6
    v_mul_f32 v140, v140, v6
    v_mul_f32 v141, v141, v6
    v_mul_f32 v142, v142, v6
    v_mul_f32 v143, v143, v6
    v_cvt_pk_bf16_f32 v180, v136, v137
    v_cvt_pk_bf16_f32 v181, v138, v139
    v_cvt_pk_bf16_f32 v182, v140, v141
    v_cvt_pk_bf16_f32 v183, v142, v143
    buffer_store_dwordx4 v[180:183], v1, s[12:15], s29 offen offset:1024 sc1
    v_mul_f32 v144, v144, v6
    v_mul_f32 v145, v145, v6
    v_mul_f32 v146, v146, v6
    v_mul_f32 v147, v147, v6
    v_mul_f32 v148, v148, v6
    v_mul_f32 v149, v149, v6
    v_mul_f32 v150, v150, v6
    v_mul_f32 v151, v151, v6
    v_cvt_pk_bf16_f32 v184, v144, v145
    v_cvt_pk_bf16_f32 v185, v146, v147
    v_cvt_pk_bf16_f32 v186, v148, v149
    v_cvt_pk_bf16_f32 v187, v150, v151
    buffer_store_dwordx4 v[184:187], v1, s[12:15], s29 offen offset:2048 sc1
    v_mul_f32 v152, v152, v6
    v_mul_f32 v153, v153, v6
    v_mul_f32 v154, v154, v6
    v_mul_f32 v155, v155, v6
    v_mul_f32 v156, v156, v6
    v_mul_f32 v157, v157, v6
    v_mul_f32_e64 v158, v158, v6
    v_mul_f32_e64 v159, v159, v6
    v_cvt_pk_bf16_f32 v188, v152, v153
    v_cvt_pk_bf16_f32 v189, v154, v155
    v_cvt_pk_bf16_f32 v190, v156, v157
    v_cvt_pk_bf16_f32 v191, v158, v159
    buffer_store_dwordx4 v[188:191], v1, s[12:15], s29 offen offset:3072 sc1
    s_lshl_b32 s30, s20, 5
    s_add_u32 s30, s30, s21
    s_lshl_b32 s30, s30, 2
    s_add_u32 s30, s30, 146821120
    s_mov_b32 s20, s32
    s_cmp_ge_u32 s20, 61
    s_cbranch_scc0 aa_loop_261
aa_done_262:
    s_waitcnt vmcnt(0)
    v_mov_b32 v5, 1
    s_mov_b64 exec, 1
    buffer_store_dword v5, off, s[12:15], s30 sc1
    s_mov_b64 exec, -1
    s_mov_b32 s30, 0x80000000
mn_fin:
mn_exit:
    s_endpgm

.section .rodata,"a"
.p2align 6
.amdhsa_kernel concat_heads__memory_aug_recurrent_mem_tr__compressed_kv_cla__prompt_kernel
  .amdhsa_next_free_vgpr 512
  .amdhsa_next_free_sgpr 102
  .amdhsa_accum_offset 256
  .amdhsa_group_segment_fixed_size 0
  .amdhsa_kernarg_size 128
  .amdhsa_user_sgpr_count 2
  .amdhsa_user_sgpr_kernarg_segment_ptr 1
  .amdhsa_system_sgpr_workgroup_id_x 1
.end_amdhsa_kernel
.text
```
